```python
import torch

def _softmax(x, axis=-1):
    return torch.softmax(x, dim=axis)

def _gelu(x):
    return torch.nn.functional.gelu(x, approximate='tanh')

def _silu(x):
    return torch.nn.functional.silu(x)

def _sigmoid(x):
    return torch.sigmoid(x)

def _layernorm(x, axis=-1, eps=1e-05):
    m = x.mean(dim=axis, keepdim=True)
    v = x.var(dim=axis, keepdim=True, unbiased=False)
    return (x - m) / torch.sqrt(v + eps)

def _scatter_add(tgt, idx, src, axis=0):
    return tgt.clone().index_add_(axis, idx, src)

def _segment_sum(src, seg, n):
    out = torch.zeros((n,) + src.shape[1:], dtype=src.dtype)
    return out.index_add_(0, seg, src)

def _pad(x, pw):
    flat = tuple((v for pair in reversed(pw) for v in pair))
    return torch.nn.functional.pad(x, flat)
kernel_name = 'parallel_sum__mha_block__mixer_gmlp__prompt'

def setup_inputs():

    _w = lambda a: (lambda t: t.to(torch.bfloat16) if t.is_floating_point() else t)(torch.as_tensor(a))

    def _A_setup():
        B, S, D, H = (1, 2048, 576, 32)
        return {'x': _w((lambda *s: torch.randn(*s, dtype=torch.bfloat16) * 0.05)(B, S, D)), 'wqkv': _w((lambda *s: torch.randn(*s, dtype=torch.bfloat16) * 0.2)(D, 3 * D)), 'wo': _w((lambda *s: torch.randn(*s, dtype=torch.bfloat16) * 0.1)(D, D))}
    _A_in = _A_setup()

    def _B_setup():
        B, S, D, F = (1, 2048, 576, 4608)
        Fh = F // 2
        return {'x': _w((lambda *s: torch.randn(*s, dtype=torch.bfloat16) * 0.05)(B, S, D)), 'w_in': _w((lambda *s: torch.randn(*s, dtype=torch.bfloat16) * 0.8)(D, 2 * Fh)), 'w_sp': _w(0.01 * (lambda *s: torch.randn(*s, dtype=torch.bfloat16) * 0.8)(S, S)), 'b_sp': _w(1.0 + 0.01 * (lambda *s: torch.randn(*s, dtype=torch.bfloat16) * 0.1)(S)), 'w_out': _w((lambda *s: torch.randn(*s, dtype=torch.bfloat16) * 0.1)(Fh, D))}
    _B_in = _B_setup()
    return {'A_x': _A_in['x'], 'A_wqkv': _A_in['wqkv'], 'A_wo': _A_in['wo'], 'B_x': _B_in['x'], 'B_w_in': _B_in['w_in'], 'B_w_sp': _B_in['w_sp'], 'B_b_sp': _B_in['b_sp'], 'B_w_out': _B_in['w_out']}

def reference(A_x, A_wqkv, A_wo, B_x, B_w_in, B_w_sp, B_b_sp, B_w_out):

    def _A_ref(x, wqkv, wo):
        B, S, D = x.shape
        H = 32
        Dh = D // H
        qkv = (lambda x, *d: x.permute(*d))((x @ wqkv).reshape(B, S, 3, H, Dh), 2, 0, 3, 1, 4)
        q, k, v = (qkv[0], qkv[1], qkv[2])
        scores = torch.einsum('bhqd,bhkd->bhqk', q, k) * Dh ** (-0.5)
        p = _softmax(scores, axis=-1)
        o = torch.einsum('bhqk,bhkd->bhqd', p, v)
        return (lambda x, *d: x.permute(*d))(o, 0, 2, 1, 3).reshape(B, S, D) @ wo

    def _B_ref(x, w_in, w_sp, b_sp, w_out):
        B, S, D = x.shape
        F = w_in.shape[-1]
        Fh = F // 2
        z = _gelu(torch.einsum('bsd,df->bsf', x, w_in))
        z1 = z[..., :Fh].clone()
        z2 = _layernorm(z[..., Fh:], axis=-1)
        g = torch.einsum('ts,bsf->btf', w_sp, z2) + b_sp[None, :, None]
        return torch.einsum('bsf,fd->bsd', z1 * g, w_out)
    x = A_x
    xn = _layernorm(x, axis=-1)
    return x + _A_ref(xn, A_wqkv, A_wo) + _B_ref(xn, B_w_in, B_w_sp, B_b_sp, B_w_out)
```

```asm
; @launch kernel=k1_kernel grid=(256,1,1) block=(256,1,1) lds=156672
; @launch kernel=k2_kernel grid=(256,1,1) block=(512,1,1) lds=163840
.amdgcn_target "amdgcn-amd-amdhsa--gfx950"
.text
.globl k1_kernel
.p2align 8
.type k1_kernel,@function
k1_kernel:
    s_cmp_ge_u32 s2, 256
    s_cbranch_scc1 L1_end
    s_load_dwordx4 s[68:71], s[0:1], 0
    s_getpc_b64 s[88:89]
Lpc_1:
    s_lshr_b32 s90, s2, 3
    s_mul_i32 s90, s90, 24
    v_add_lshl_u32 v2, v0, s90, 7
    s_sub_u32 s88, s88, Lpc_1-k1_kernel
    s_subb_u32 s89, s89, 0
    v_min_u32 v2, Lcode_end-k1_kernel-4, v2
    v_cmp_gt_u32 s[90:91], 24, v0
    v_mov_b32 v3, s89
    v_add_co_u32 v2, vcc, s88, v2
    s_nop 1
    v_addc_co_u32 v3, vcc, 0, v3, vcc
    s_and_saveexec_b64 s[88:89], s[90:91]
    s_cbranch_execz Lpcs_1
    global_load_dword v252, v[2:3], off
Lpcs_1:
    s_mov_b64 exec, s[88:89]
    s_load_dwordx2 s[72:73], s[0:1], 32
    s_load_dwordx4 s[76:79], s[0:1], 72
    s_load_dwordx2 s[84:85], s[0:1], 40
    s_load_dwordx2 s[24:25], s[0:1], 56
    s_load_dwordx2 s[92:93], s[0:1], 16
    v_lshrrev_b32 v247, 6, v0
    v_and_b32 v246, 63, v0
    s_bfe_u32 s29, s2, 0x10002
    v_readfirstlane_b32 s28, v247
    s_lshl_b32 s29, s29, 3
    s_lshr_b32 s59, s2, 5
    s_add_u32 s29, s29, s59
    s_and_b32 s30, s2, 3
    s_lshl_b32 s30, s30, 2
    s_bfe_u32 s59, s2, 0x20003
    s_add_u32 s30, s30, s59
    s_lshl_b32 s31, s30, 2
    s_add_u32 s31, s31, s28
    v_lshrrev_b32 v204, 3, v246
    v_and_b32 v205, 7, v246
    v_lshrrev_b32 v206, 4, v246
    v_xor_b32 v205, v205, v206
    v_mul_u32_u24 v204, 1152, v204
    v_lshl_add_u32 v180, v205, 4, v204
    v_xor_b32 v205, 4, v205
    v_lshl_add_u32 v181, v205, 4, v204
    v_add_u32 v182, 16384, v180
    v_add_u32 v183, 24576, v181
    v_add_u32 v181, 8192, v181
    s_mul_i32 s59, s31, 36864
    s_lshl_b32 s60, s28, 14
    s_add_u32 s60, s60, 73728
    s_mov_b32 s97, s60
    s_mov_b32 s98, s59
    v_and_b32 v204, 31, v246
    v_bfe_u32 v205, v246, 1, 3
    v_lshrrev_b32 v206, 5, v246
    v_xor_b32 v205, v205, v206
    v_lshlrev_b32 v204, 7, v204
    v_add_u32 v204, s60, v204
    v_xor_b32 v206, 0, v205
    v_lshl_add_u32 v184, v206, 4, v204
    v_xor_b32 v206, 2, v205
    v_lshl_add_u32 v185, v206, 4, v204
    v_xor_b32 v206, 4, v205
    v_lshl_add_u32 v186, v206, 4, v204
    v_xor_b32 v206, 6, v205
    v_lshl_add_u32 v187, v206, 4, v204
    v_lshrrev_b32 v204, 3, v246
    v_and_b32 v205, 7, v246
    v_bfe_u32 v206, v246, 4, 1
    v_lshlrev_b32 v206, 2, v206
    v_xor_b32 v205, v205, v206
    v_lshlrev_b32 v205, 4, v205
    v_mul_u32_u24 v224, 9216, v204
    v_add_u32 v224, v224, v205
    v_add_u32 v225, 72704, v224
    v_add_u32 v226, 145408, v224
    v_add_u32 v227, 218112, v224
    v_mul_u32_u24 v228, 3456, v204
    v_add_u32 v228, v228, v205
    v_add_u32 v229, 26624, v228
    v_add_u32 v230, 53248, v228
    v_add_u32 v231, 79872, v228
    s_mul_i32 s57, s28, 18432
    s_mul_i32 s74, s31, 147456
    s_add_u32 s74, s74, 7143424
    s_mul_i32 s75, s31, 36864
    s_mul_i32 s80, s31, 37888
    s_add_u32 s80, s80, 4718592
    s_cmp_lt_u32 s29, 4
    s_cbranch_scc0 L1_parB
    s_mul_i32 s59, s29, 3
    s_add_u32 s60, s59, 0
    s_lshl_b32 s32, s60, 7
    s_lshl_b32 s35, s60, 7
    s_add_u32 s32, s32, 4608
    s_lshl_b32 s40, s60, 11
    s_add_u32 s40, s40, s74
    s_lshl_b32 s43, s60, 12
    s_add_u32 s43, s43, s75
    s_cmp_lt_u32 s60, 9
    s_mov_b32 s61, 0
    s_cselect_b32 s61, s61, 2322432
    s_cselect_b32 s51, 0x3eae1a93, 1.0
    s_add_u32 s43, s43, s61
    s_add_u32 s60, s59, 1
    s_lshl_b32 s33, s60, 7
    s_lshl_b32 s36, s60, 7
    s_add_u32 s33, s33, 4608
    s_lshl_b32 s41, s60, 11
    s_add_u32 s41, s41, s74
    s_lshl_b32 s44, s60, 12
    s_add_u32 s44, s44, s75
    s_cmp_lt_u32 s60, 9
    s_mov_b32 s61, 0
    s_cselect_b32 s61, s61, 2322432
    s_cselect_b32 s52, 0x3eae1a93, 1.0
    s_add_u32 s44, s44, s61
    s_add_u32 s60, s59, 2
    s_lshl_b32 s34, s60, 7
    s_lshl_b32 s37, s60, 7
    s_add_u32 s34, s34, 4608
    s_lshl_b32 s42, s60, 11
    s_add_u32 s42, s42, s74
    s_lshl_b32 s45, s60, 12
    s_add_u32 s45, s45, s75
    s_cmp_lt_u32 s60, 9
    s_mov_b32 s61, 0
    s_cselect_b32 s61, s61, 2322432
    s_cselect_b32 s53, 0x3eae1a93, 1.0
    s_add_u32 s45, s45, s61
    s_mov_b32 s38, 0
    s_mov_b32 s63, 0
    s_branch L1_parE
L1_parB:
    s_sub_u32 s81, s29, 4
    s_lshl_b32 s60, s81, 1
    s_add_u32 s60, s60, 12
    s_lshl_b32 s32, s60, 7
    s_add_u32 s32, s32, 4608
    s_lshl_b32 s40, s60, 11
    s_add_u32 s40, s40, s74
    s_lshl_b32 s60, s81, 1
    s_add_u32 s60, s60, 13
    s_lshl_b32 s33, s60, 7
    s_add_u32 s33, s33, 4608
    s_lshl_b32 s41, s60, 11
    s_add_u32 s41, s41, s74
    s_mul_i32 s61, s31, 184320
    s_add_u32 s61, s61, 26036224
    s_mul_i32 s60, s81, 3
    s_add_u32 s60, s60, 0
    s_lshl_b32 s34, s60, 7
    s_lshl_b32 s42, s60, 11
    s_add_u32 s42, s42, s61
    s_mul_i32 s60, s81, 3
    s_add_u32 s60, s60, 1
    s_lshl_b32 s35, s60, 7
    s_lshl_b32 s43, s60, 11
    s_add_u32 s43, s43, s61
    s_mul_i32 s60, s81, 3
    s_add_u32 s60, s60, 2
    s_lshl_b32 s36, s60, 7
    s_lshl_b32 s44, s60, 11
    s_add_u32 s44, s44, s61
    s_add_u32 s60, s81, 12
    s_lshl_b32 s37, s60, 7
    s_lshl_b32 s61, s60, 12
    s_add_u32 s61, s61, s75
    s_add_u32 s61, s61, 2322432
    s_sub_u32 s60, s60, 18
    s_lshl_b32 s60, s60, 11
    s_add_u32 s60, s60, s80
    s_cmp_lt_u32 s29, 10
    s_cselect_b32 s45, s61, s60
    s_mov_b32 s53, 1.0
    s_lshr_b32 s60, s81, 1
    s_add_u32 s60, s60, 6
    s_min_u32 s60, s60, 8
    s_and_b32 s63, s81, 1
    s_lshl_b32 s46, s60, 11
    s_add_u32 s46, s46, s80
    s_lshl_b32 s61, s63, 10
    s_add_u32 s46, s46, s61
    s_add_u32 s60, s60, 18
    s_lshl_b32 s38, s60, 7
    s_mov_b32 s54, 1.0
L1_parE:
    s_mul_i32 s59, s31, 9
    v_add_u32 v247, s59, v246
    v_add_u32 v208, 55, v246
    v_lshrrev_b32 v208, 6, v208
    v_lshlrev_b32 v208, 31, v208
    v_mul_u32_u24 v160, 9216, v247
    v_mul_u32_u24 v161, 3456, v247
    v_or_b32 v160, v160, v208
    v_or_b32 v161, v161, v208
    s_waitcnt lgkmcnt(0)
    s_mov_b32 s4, s68
    s_and_b32 s5, s69, 0xffff
    s_mov_b32 s6, 2359296
    s_mov_b32 s7, 0x20000
    s_and_b32 s61, s29, 7
    s_mul_i32 s61, s61, 4608
    s_add_u32 s61, s61, s98
    v_lshlrev_b32 v247, 7, v246
    s_mov_b32 exec_hi, 15
    buffer_load_dword v252, v247, s[4:7], s61 offen
    s_mov_b64 exec, -1
    s_add_u32 m0, s97, 0
    s_add_u32 s61, s98, 0
    buffer_load_dwordx4 v180, s[4:7], s61 offen offset:0 lds
    buffer_load_dwordx4 v181, s[4:7], s61 offen offset:1024 lds
    buffer_load_dwordx4 v182, s[4:7], s61 offen offset:2048 lds
    buffer_load_dwordx4 v183, s[4:7], s61 offen offset:3072 lds
    s_mov_b32 s8, s70
    s_and_b32 s9, s71, 0xffff
    s_mov_b32 s10, 1990656
    s_mov_b32 s11, 0x20000
    s_mov_b32 s12, s72
    s_and_b32 s13, s73, 0xffff
    s_mov_b32 s14, 5308416
    s_mov_b32 s15, 0x20000
    s_mov_b32 s20, s76
    s_and_b32 s21, s77, 0xffff
    s_mov_b32 s22, 256
    s_mov_b32 s23, 0x20000
    s_mov_b32 s16, s78
    s_and_b32 s17, s79, 0xffff
    s_mov_b32 s18, 38133760
    s_mov_b32 s19, 0x20000
    s_and_b32 s85, s85, 0xffff
    s_mov_b32 s86, 8388608
    s_mov_b32 s87, 0x20000
    s_and_b32 s25, s25, 0xffff
    s_mov_b32 s26, 2654208
    s_mov_b32 s27, 0x20000
    s_and_b32 s93, s93, 0xffff
    s_mov_b32 s94, 663552
    s_mov_b32 s95, 0x20000
    s_lshl_b32 s66, s30, 14
    s_lshl_b32 s59, s28, 8
    s_add_u32 s66, s66, s59
    s_add_u32 s66, s66, 37814272
    s_lshl_b32 s59, s29, 10
    s_add_u32 s65, s66, s59
    s_lshl_b32 s67, s30, 4
    s_lshl_b32 s99, s2, 2
    s_add_u32 s99, s99, s28
    s_mov_b32 s100, 4096
    s_lshl_b32 s96, s99, 6
    v_lshrrev_b32 v254, 4, v246
    v_min_u32 v254, 1, v254
    v_lshlrev_b32 v254, 24, v254
    v_bfe_u32 v247, v246, 3, 1
    v_lshl_add_u32 v254, v247, 5, v254
    v_and_b32 v247, 7, v246
    v_add_u32 v254, v254, v247
    v_add_lshl_u32 v254, v254, s96, 7
    s_mov_b32 s62, 0x3f803f80
    v_bfe_u32 v204, v246, 2, 2
    v_lshrrev_b32 v205, 5, v246
    v_and_b32 v206, 3, v246
    v_bfe_u32 v207, v246, 4, 1
    v_lshl_add_u32 v232, v205, 2, v204
    v_lshlrev_b32 v232, 7, v232
    v_lshlrev_b32 v233, 3, v206
    v_lshl_add_u32 v233, v207, 5, v233
    v_bfe_u32 v234, v246, 3, 1
    v_lshl_add_u32 v233, v234, 6, v233
    v_add_u32 v232, v232, v233
    v_xor_b32 v235, 64, v232
    v_add_u32 v233, 49152, v232
    v_add_u32 v234, 98304, v232
    v_add_u32 v236, 49152, v235
    v_add_u32 v237, 98304, v235
    v_lshlrev_b32 v238, 4, v246
    v_and_b32 v239, 15, v246
    v_lshlrev_b32 v239, 4, v239
    v_lshl_add_u32 v239, v207, 9, v239
    v_lshl_add_u32 v239, v205, 8, v239
    v_and_b32 v243, 15, v246
    v_lshlrev_b32 v243, 4, v243
    v_lshl_add_u32 v243, v205, 8, v243
    v_mul_u32_u24 v247, 92160, v207
    v_add_u32 v243, v243, v247
    s_mul_i32 s59, s28, 2304
    s_add_u32 s59, s59, 147456
    v_and_b32 v240, 31, v246
    v_lshlrev_b32 v240, 4, v240
    v_mul_u32_u24 v247, 576, v205
    v_add3_u32 v240, v240, v247, s59
    v_mul_u32_u24 v241, 1152, v207
    v_and_b32 v247, 1, v206
    v_mul_u32_u24 v247, 576, v247
    v_add3_u32 v241, v241, v247, s59
    v_lshrrev_b32 v247, 1, v206
    v_lshl_add_u32 v241, v247, 3, v241
    v_lshl_add_u32 v241, v204, 4, v241
    v_lshl_add_u32 v242, v205, 7, v241
    v_lshl_add_u32 v241, v205, 6, v241
    v_mov_b32 v244, 0
    v_mov_b32 v245, 0
    v_and_b32 v247, 31, v246
    v_lshrrev_b32 v208, 5, v246
    v_lshlrev_b32 v208, 3, v208
    v_sub_u32 v247, v247, v208
    v_mov_b32 v209, 0x3f80
    v_mov_b32 v210, 0x3f800000
    v_mov_b32 v196, 0
    v_cmp_eq_u32 s[88:89], 0, v247
    s_nop 1
    v_cndmask_b32 v196, v196, v209, s[88:89]
    v_cmp_eq_u32 s[88:89], 1, v247
    s_nop 1
    v_cndmask_b32 v196, v196, v210, s[88:89]
    v_mov_b32 v197, 0
    v_cmp_eq_u32 s[88:89], 2, v247
    s_nop 1
    v_cndmask_b32 v197, v197, v209, s[88:89]
    v_cmp_eq_u32 s[88:89], 3, v247
    s_nop 1
    v_cndmask_b32 v197, v197, v210, s[88:89]
    v_mov_b32 v198, 0
    v_cmp_eq_u32 s[88:89], 4, v247
    s_nop 1
    v_cndmask_b32 v198, v198, v209, s[88:89]
    v_cmp_eq_u32 s[88:89], 5, v247
    s_nop 1
    v_cndmask_b32 v198, v198, v210, s[88:89]
    v_mov_b32 v199, 0
    v_cmp_eq_u32 s[88:89], 6, v247
    s_nop 1
    v_cndmask_b32 v199, v199, v209, s[88:89]
    v_cmp_eq_u32 s[88:89], 7, v247
    s_nop 1
    v_cndmask_b32 v199, v199, v210, s[88:89]
    v_mov_b32 v200, 0
    v_cmp_eq_u32 s[88:89], 16, v247
    s_nop 1
    v_cndmask_b32 v200, v200, v209, s[88:89]
    v_cmp_eq_u32 s[88:89], 17, v247
    s_nop 1
    v_cndmask_b32 v200, v200, v210, s[88:89]
    v_mov_b32 v201, 0
    v_cmp_eq_u32 s[88:89], 18, v247
    s_nop 1
    v_cndmask_b32 v201, v201, v209, s[88:89]
    v_cmp_eq_u32 s[88:89], 19, v247
    s_nop 1
    v_cndmask_b32 v201, v201, v210, s[88:89]
    v_mov_b32 v202, 0
    v_cmp_eq_u32 s[88:89], 20, v247
    s_nop 1
    v_cndmask_b32 v202, v202, v209, s[88:89]
    v_cmp_eq_u32 s[88:89], 21, v247
    s_nop 1
    v_cndmask_b32 v202, v202, v210, s[88:89]
    v_mov_b32 v203, 0
    v_cmp_eq_u32 s[88:89], 22, v247
    s_nop 1
    v_cndmask_b32 v203, v203, v209, s[88:89]
    v_cmp_eq_u32 s[88:89], 23, v247
    s_nop 1
    v_cndmask_b32 v203, v203, v210, s[88:89]
    s_add_u32 m0, s97, 4096
    s_add_u32 s61, s98, 128
    buffer_load_dwordx4 v180, s[4:7], s61 offen offset:0 lds
    buffer_load_dwordx4 v181, s[4:7], s61 offen offset:1024 lds
    buffer_load_dwordx4 v182, s[4:7], s61 offen offset:2048 lds
    buffer_load_dwordx4 v183, s[4:7], s61 offen offset:3072 lds
    s_add_u32 m0, s97, 8192
    s_add_u32 s61, s98, 256
    buffer_load_dwordx4 v180, s[4:7], s61 offen offset:0 lds
    buffer_load_dwordx4 v181, s[4:7], s61 offen offset:1024 lds
    buffer_load_dwordx4 v182, s[4:7], s61 offen offset:2048 lds
    buffer_load_dwordx4 v183, s[4:7], s61 offen offset:3072 lds
    s_waitcnt vmcnt(8)
    ds_read_b128 v[0:3], v184 offset:0
    ds_read_b128 v[4:7], v185 offset:0
    ds_read_b128 v[8:11], v186 offset:0
    ds_read_b128 v[12:15], v187 offset:0
    s_add_u32 m0, s97, 12288
    s_add_u32 s61, s98, 384
    buffer_load_dwordx4 v180, s[4:7], s61 offen offset:0 lds
    buffer_load_dwordx4 v181, s[4:7], s61 offen offset:1024 lds
    buffer_load_dwordx4 v182, s[4:7], s61 offen offset:2048 lds
    buffer_load_dwordx4 v183, s[4:7], s61 offen offset:3072 lds
    s_waitcnt vmcnt(8)
    ds_read_b128 v[16:19], v184 offset:4096
    ds_read_b128 v[20:23], v185 offset:4096
    ds_read_b128 v[24:27], v186 offset:4096
    ds_read_b128 v[28:31], v187 offset:4096
    s_waitcnt lgkmcnt(4)
    s_add_u32 m0, s97, 0
    s_add_u32 s61, s98, 512
    buffer_load_dwordx4 v180, s[4:7], s61 offen offset:0 lds
    buffer_load_dwordx4 v181, s[4:7], s61 offen offset:1024 lds
    buffer_load_dwordx4 v182, s[4:7], s61 offen offset:2048 lds
    buffer_load_dwordx4 v183, s[4:7], s61 offen offset:3072 lds
    v_dot2_f32_bf16 v244, v0, s62, v244
    v_dot2_f32_bf16 v245, v0, v0, v245
    v_dot2_f32_bf16 v244, v1, s62, v244
    v_dot2_f32_bf16 v245, v1, v1, v245
    v_dot2_f32_bf16 v244, v2, s62, v244
    v_dot2_f32_bf16 v245, v2, v2, v245
    v_dot2_f32_bf16 v244, v3, s62, v244
    v_dot2_f32_bf16 v245, v3, v3, v245
    v_dot2_f32_bf16 v244, v4, s62, v244
    v_dot2_f32_bf16 v245, v4, v4, v245
    v_dot2_f32_bf16 v244, v5, s62, v244
    v_dot2_f32_bf16 v245, v5, v5, v245
    v_dot2_f32_bf16 v244, v6, s62, v244
    v_dot2_f32_bf16 v245, v6, v6, v245
    v_dot2_f32_bf16 v244, v7, s62, v244
    v_dot2_f32_bf16 v245, v7, v7, v245
    v_dot2_f32_bf16 v244, v8, s62, v244
    v_dot2_f32_bf16 v245, v8, v8, v245
    v_dot2_f32_bf16 v244, v9, s62, v244
    v_dot2_f32_bf16 v245, v9, v9, v245
    v_dot2_f32_bf16 v244, v10, s62, v244
    v_dot2_f32_bf16 v245, v10, v10, v245
    v_dot2_f32_bf16 v244, v11, s62, v244
    v_dot2_f32_bf16 v245, v11, v11, v245
    v_dot2_f32_bf16 v244, v12, s62, v244
    v_dot2_f32_bf16 v245, v12, v12, v245
    v_dot2_f32_bf16 v244, v13, s62, v244
    v_dot2_f32_bf16 v245, v13, v13, v245
    v_dot2_f32_bf16 v244, v14, s62, v244
    v_dot2_f32_bf16 v245, v14, v14, v245
    v_dot2_f32_bf16 v244, v15, s62, v244
    v_dot2_f32_bf16 v245, v15, v15, v245
    s_waitcnt vmcnt(8)
    ds_read_b128 v[32:35], v184 offset:8192
    ds_read_b128 v[36:39], v185 offset:8192
    ds_read_b128 v[40:43], v186 offset:8192
    ds_read_b128 v[44:47], v187 offset:8192
    s_waitcnt lgkmcnt(4)
    s_add_u32 m0, s97, 4096
    s_add_u32 s61, s98, 640
    buffer_load_dwordx4 v180, s[4:7], s61 offen offset:0 lds
    buffer_load_dwordx4 v181, s[4:7], s61 offen offset:1024 lds
    buffer_load_dwordx4 v182, s[4:7], s61 offen offset:2048 lds
    buffer_load_dwordx4 v183, s[4:7], s61 offen offset:3072 lds
    v_dot2_f32_bf16 v244, v16, s62, v244
    v_dot2_f32_bf16 v245, v16, v16, v245
    v_dot2_f32_bf16 v244, v17, s62, v244
    v_dot2_f32_bf16 v245, v17, v17, v245
    v_dot2_f32_bf16 v244, v18, s62, v244
    v_dot2_f32_bf16 v245, v18, v18, v245
    v_dot2_f32_bf16 v244, v19, s62, v244
    v_dot2_f32_bf16 v245, v19, v19, v245
    v_dot2_f32_bf16 v244, v20, s62, v244
    v_dot2_f32_bf16 v245, v20, v20, v245
    v_dot2_f32_bf16 v244, v21, s62, v244
    v_dot2_f32_bf16 v245, v21, v21, v245
    v_dot2_f32_bf16 v244, v22, s62, v244
    v_dot2_f32_bf16 v245, v22, v22, v245
    v_dot2_f32_bf16 v244, v23, s62, v244
    v_dot2_f32_bf16 v245, v23, v23, v245
    v_dot2_f32_bf16 v244, v24, s62, v244
    v_dot2_f32_bf16 v245, v24, v24, v245
    v_dot2_f32_bf16 v244, v25, s62, v244
    v_dot2_f32_bf16 v245, v25, v25, v245
    v_dot2_f32_bf16 v244, v26, s62, v244
    v_dot2_f32_bf16 v245, v26, v26, v245
    v_dot2_f32_bf16 v244, v27, s62, v244
    v_dot2_f32_bf16 v245, v27, v27, v245
    v_dot2_f32_bf16 v244, v28, s62, v244
    v_dot2_f32_bf16 v245, v28, v28, v245
    v_dot2_f32_bf16 v244, v29, s62, v244
    v_dot2_f32_bf16 v245, v29, v29, v245
    v_dot2_f32_bf16 v244, v30, s62, v244
    v_dot2_f32_bf16 v245, v30, v30, v245
    v_dot2_f32_bf16 v244, v31, s62, v244
    v_dot2_f32_bf16 v245, v31, v31, v245
    s_waitcnt vmcnt(8)
    ds_read_b128 v[48:51], v184 offset:12288
    ds_read_b128 v[68:71], v185 offset:12288
    ds_read_b128 v[72:75], v186 offset:12288
    ds_read_b128 v[76:79], v187 offset:12288
    s_waitcnt lgkmcnt(4)
    s_add_u32 m0, s97, 8192
    s_add_u32 s61, s98, 768
    buffer_load_dwordx4 v180, s[4:7], s61 offen offset:0 lds
    buffer_load_dwordx4 v181, s[4:7], s61 offen offset:1024 lds
    buffer_load_dwordx4 v182, s[4:7], s61 offen offset:2048 lds
    buffer_load_dwordx4 v183, s[4:7], s61 offen offset:3072 lds
    v_dot2_f32_bf16 v244, v32, s62, v244
    v_dot2_f32_bf16 v245, v32, v32, v245
    v_dot2_f32_bf16 v244, v33, s62, v244
    v_dot2_f32_bf16 v245, v33, v33, v245
    v_dot2_f32_bf16 v244, v34, s62, v244
    v_dot2_f32_bf16 v245, v34, v34, v245
    v_dot2_f32_bf16 v244, v35, s62, v244
    v_dot2_f32_bf16 v245, v35, v35, v245
    v_dot2_f32_bf16 v244, v36, s62, v244
    v_dot2_f32_bf16 v245, v36, v36, v245
    v_dot2_f32_bf16 v244, v37, s62, v244
    v_dot2_f32_bf16 v245, v37, v37, v245
    v_dot2_f32_bf16 v244, v38, s62, v244
    v_dot2_f32_bf16 v245, v38, v38, v245
    v_dot2_f32_bf16 v244, v39, s62, v244
    v_dot2_f32_bf16 v245, v39, v39, v245
    v_dot2_f32_bf16 v244, v40, s62, v244
    v_dot2_f32_bf16 v245, v40, v40, v245
    v_dot2_f32_bf16 v244, v41, s62, v244
    v_dot2_f32_bf16 v245, v41, v41, v245
    v_dot2_f32_bf16 v244, v42, s62, v244
    v_dot2_f32_bf16 v245, v42, v42, v245
    v_dot2_f32_bf16 v244, v43, s62, v244
    v_dot2_f32_bf16 v245, v43, v43, v245
    v_dot2_f32_bf16 v244, v44, s62, v244
    v_dot2_f32_bf16 v245, v44, v44, v245
    v_dot2_f32_bf16 v244, v45, s62, v244
    v_dot2_f32_bf16 v245, v45, v45, v245
    v_dot2_f32_bf16 v244, v46, s62, v244
    v_dot2_f32_bf16 v245, v46, v46, v245
    v_dot2_f32_bf16 v244, v47, s62, v244
    v_dot2_f32_bf16 v245, v47, v47, v245
    s_waitcnt vmcnt(8)
    ds_read_b128 v[80:83], v184 offset:0
    ds_read_b128 v[84:87], v185 offset:0
    ds_read_b128 v[88:91], v186 offset:0
    ds_read_b128 v[92:95], v187 offset:0
    s_waitcnt lgkmcnt(4)
    s_add_u32 m0, s97, 12288
    s_add_u32 s61, s98, 896
    buffer_load_dwordx4 v180, s[4:7], s61 offen offset:0 lds
    buffer_load_dwordx4 v181, s[4:7], s61 offen offset:1024 lds
    buffer_load_dwordx4 v182, s[4:7], s61 offen offset:2048 lds
    buffer_load_dwordx4 v183, s[4:7], s61 offen offset:3072 lds
    v_dot2_f32_bf16 v244, v48, s62, v244
    v_dot2_f32_bf16 v245, v48, v48, v245
    v_dot2_f32_bf16 v244, v49, s62, v244
    v_dot2_f32_bf16 v245, v49, v49, v245
    v_dot2_f32_bf16 v244, v50, s62, v244
    v_dot2_f32_bf16 v245, v50, v50, v245
    v_dot2_f32_bf16 v244, v51, s62, v244
    v_dot2_f32_bf16 v245, v51, v51, v245
    v_dot2_f32_bf16 v244, v68, s62, v244
    v_dot2_f32_bf16 v245, v68, v68, v245
    v_dot2_f32_bf16 v244, v69, s62, v244
    v_dot2_f32_bf16 v245, v69, v69, v245
    v_dot2_f32_bf16 v244, v70, s62, v244
    v_dot2_f32_bf16 v245, v70, v70, v245
    v_dot2_f32_bf16 v244, v71, s62, v244
    v_dot2_f32_bf16 v245, v71, v71, v245
    v_dot2_f32_bf16 v244, v72, s62, v244
    v_dot2_f32_bf16 v245, v72, v72, v245
    v_dot2_f32_bf16 v244, v73, s62, v244
    v_dot2_f32_bf16 v245, v73, v73, v245
    v_dot2_f32_bf16 v244, v74, s62, v244
    v_dot2_f32_bf16 v245, v74, v74, v245
    v_dot2_f32_bf16 v244, v75, s62, v244
    v_dot2_f32_bf16 v245, v75, v75, v245
    v_dot2_f32_bf16 v244, v76, s62, v244
    v_dot2_f32_bf16 v245, v76, v76, v245
    v_dot2_f32_bf16 v244, v77, s62, v244
    v_dot2_f32_bf16 v245, v77, v77, v245
    v_dot2_f32_bf16 v244, v78, s62, v244
    v_dot2_f32_bf16 v245, v78, v78, v245
    v_dot2_f32_bf16 v244, v79, s62, v244
    v_dot2_f32_bf16 v245, v79, v79, v245
    s_waitcnt vmcnt(8)
    ds_read_b128 v[96:99], v184 offset:4096
    ds_read_b128 v[100:103], v185 offset:4096
    ds_read_b128 v[104:107], v186 offset:4096
    ds_read_b128 v[108:111], v187 offset:4096
    s_waitcnt lgkmcnt(4)
    s_add_u32 m0, s97, 0
    s_add_u32 s61, s98, 1024
    buffer_load_dwordx4 v180, s[4:7], s61 offen offset:0 lds
    buffer_load_dwordx4 v181, s[4:7], s61 offen offset:1024 lds
    buffer_load_dwordx4 v182, s[4:7], s61 offen offset:2048 lds
    buffer_load_dwordx4 v183, s[4:7], s61 offen offset:3072 lds
    v_dot2_f32_bf16 v244, v80, s62, v244
    v_dot2_f32_bf16 v245, v80, v80, v245
    v_dot2_f32_bf16 v244, v81, s62, v244
    v_dot2_f32_bf16 v245, v81, v81, v245
    v_dot2_f32_bf16 v244, v82, s62, v244
    v_dot2_f32_bf16 v245, v82, v82, v245
    v_dot2_f32_bf16 v244, v83, s62, v244
    v_dot2_f32_bf16 v245, v83, v83, v245
    v_dot2_f32_bf16 v244, v84, s62, v244
    v_dot2_f32_bf16 v245, v84, v84, v245
    v_dot2_f32_bf16 v244, v85, s62, v244
    v_dot2_f32_bf16 v245, v85, v85, v245
    v_dot2_f32_bf16 v244, v86, s62, v244
    v_dot2_f32_bf16 v245, v86, v86, v245
    v_dot2_f32_bf16 v244, v87, s62, v244
    v_dot2_f32_bf16 v245, v87, v87, v245
    v_dot2_f32_bf16 v244, v88, s62, v244
    v_dot2_f32_bf16 v245, v88, v88, v245
    v_dot2_f32_bf16 v244, v89, s62, v244
    v_dot2_f32_bf16 v245, v89, v89, v245
    v_dot2_f32_bf16 v244, v90, s62, v244
    v_dot2_f32_bf16 v245, v90, v90, v245
    v_dot2_f32_bf16 v244, v91, s62, v244
    v_dot2_f32_bf16 v245, v91, v91, v245
    v_dot2_f32_bf16 v244, v92, s62, v244
    v_dot2_f32_bf16 v245, v92, v92, v245
    v_dot2_f32_bf16 v244, v93, s62, v244
    v_dot2_f32_bf16 v245, v93, v93, v245
    v_dot2_f32_bf16 v244, v94, s62, v244
    v_dot2_f32_bf16 v245, v94, v94, v245
    v_dot2_f32_bf16 v244, v95, s62, v244
    v_dot2_f32_bf16 v245, v95, v95, v245
    s_waitcnt vmcnt(8)
    ds_read_b128 v[112:115], v184 offset:8192
    ds_read_b128 v[116:119], v185 offset:8192
    ds_read_b128 v[120:123], v186 offset:8192
    ds_read_b128 v[124:127], v187 offset:8192
    s_waitcnt lgkmcnt(4)
    v_dot2_f32_bf16 v244, v96, s62, v244
    v_dot2_f32_bf16 v245, v96, v96, v245
    v_dot2_f32_bf16 v244, v97, s62, v244
    v_dot2_f32_bf16 v245, v97, v97, v245
    v_dot2_f32_bf16 v244, v98, s62, v244
    v_dot2_f32_bf16 v245, v98, v98, v245
    v_dot2_f32_bf16 v244, v99, s62, v244
    v_dot2_f32_bf16 v245, v99, v99, v245
    v_dot2_f32_bf16 v244, v100, s62, v244
    v_dot2_f32_bf16 v245, v100, v100, v245
    v_dot2_f32_bf16 v244, v101, s62, v244
    v_dot2_f32_bf16 v245, v101, v101, v245
    v_dot2_f32_bf16 v244, v102, s62, v244
    v_dot2_f32_bf16 v245, v102, v102, v245
    v_dot2_f32_bf16 v244, v103, s62, v244
    v_dot2_f32_bf16 v245, v103, v103, v245
    v_dot2_f32_bf16 v244, v104, s62, v244
    v_dot2_f32_bf16 v245, v104, v104, v245
    v_dot2_f32_bf16 v244, v105, s62, v244
    v_dot2_f32_bf16 v245, v105, v105, v245
    v_dot2_f32_bf16 v244, v106, s62, v244
    v_dot2_f32_bf16 v245, v106, v106, v245
    v_dot2_f32_bf16 v244, v107, s62, v244
    v_dot2_f32_bf16 v245, v107, v107, v245
    v_dot2_f32_bf16 v244, v108, s62, v244
    v_dot2_f32_bf16 v245, v108, v108, v245
    v_dot2_f32_bf16 v244, v109, s62, v244
    v_dot2_f32_bf16 v245, v109, v109, v245
    v_dot2_f32_bf16 v244, v110, s62, v244
    v_dot2_f32_bf16 v245, v110, v110, v245
    v_dot2_f32_bf16 v244, v111, s62, v244
    v_dot2_f32_bf16 v245, v111, v111, v245
    s_add_u32 m0, s57, 0
    s_mul_i32 s56, s28, 1327104
    s_add_u32 s56, s56, s32
    buffer_load_dwordx4 v224, s[12:15], s56 offen offset:0  lds
    buffer_load_dwordx4 v225, s[12:15], s56 offen offset:1024  lds
    buffer_load_dwordx4 v226, s[12:15], s56 offen offset:2048  lds
    buffer_load_dwordx4 v227, s[12:15], s56 offen offset:3072  lds
    s_waitcnt vmcnt(8)
    ds_read_b128 v[128:131], v184 offset:12288
    ds_read_b128 v[132:135], v185 offset:12288
    ds_read_b128 v[136:139], v186 offset:12288
    ds_read_b128 v[140:143], v187 offset:12288
    s_waitcnt lgkmcnt(4)
    v_dot2_f32_bf16 v244, v112, s62, v244
    v_dot2_f32_bf16 v245, v112, v112, v245
    v_dot2_f32_bf16 v244, v113, s62, v244
    v_dot2_f32_bf16 v245, v113, v113, v245
    v_dot2_f32_bf16 v244, v114, s62, v244
    v_dot2_f32_bf16 v245, v114, v114, v245
    v_dot2_f32_bf16 v244, v115, s62, v244
    v_dot2_f32_bf16 v245, v115, v115, v245
    v_dot2_f32_bf16 v244, v116, s62, v244
    v_dot2_f32_bf16 v245, v116, v116, v245
    v_dot2_f32_bf16 v244, v117, s62, v244
    v_dot2_f32_bf16 v245, v117, v117, v245
    v_dot2_f32_bf16 v244, v118, s62, v244
    v_dot2_f32_bf16 v245, v118, v118, v245
    v_dot2_f32_bf16 v244, v119, s62, v244
    v_dot2_f32_bf16 v245, v119, v119, v245
    v_dot2_f32_bf16 v244, v120, s62, v244
    v_dot2_f32_bf16 v245, v120, v120, v245
    v_dot2_f32_bf16 v244, v121, s62, v244
    v_dot2_f32_bf16 v245, v121, v121, v245
    v_dot2_f32_bf16 v244, v122, s62, v244
    v_dot2_f32_bf16 v245, v122, v122, v245
    v_dot2_f32_bf16 v244, v123, s62, v244
    v_dot2_f32_bf16 v245, v123, v123, v245
    v_dot2_f32_bf16 v244, v124, s62, v244
    v_dot2_f32_bf16 v245, v124, v124, v245
    v_dot2_f32_bf16 v244, v125, s62, v244
    v_dot2_f32_bf16 v245, v125, v125, v245
    v_dot2_f32_bf16 v244, v126, s62, v244
    v_dot2_f32_bf16 v245, v126, v126, v245
    v_dot2_f32_bf16 v244, v127, s62, v244
    v_dot2_f32_bf16 v245, v127, v127, v245
    s_add_u32 m0, s57, 4096
    s_add_u32 s56, s56, 294912
    buffer_load_dwordx4 v224, s[12:15], s56 offen offset:0  lds
    buffer_load_dwordx4 v225, s[12:15], s56 offen offset:1024  lds
    buffer_load_dwordx4 v226, s[12:15], s56 offen offset:2048  lds
    buffer_load_dwordx4 v227, s[12:15], s56 offen offset:3072  lds
    s_waitcnt vmcnt(8)
    ds_read_b128 v[144:147], v184 offset:0
    ds_read_b128 v[148:151], v185 offset:0
    ds_read_b128 v[152:155], v186 offset:0
    ds_read_b128 v[156:159], v187 offset:0
    s_waitcnt lgkmcnt(4)
    v_dot2_f32_bf16 v244, v128, s62, v244
    v_dot2_f32_bf16 v245, v128, v128, v245
    v_dot2_f32_bf16 v244, v129, s62, v244
    v_dot2_f32_bf16 v245, v129, v129, v245
    v_dot2_f32_bf16 v244, v130, s62, v244
    v_dot2_f32_bf16 v245, v130, v130, v245
    v_dot2_f32_bf16 v244, v131, s62, v244
    v_dot2_f32_bf16 v245, v131, v131, v245
    v_dot2_f32_bf16 v244, v132, s62, v244
    v_dot2_f32_bf16 v245, v132, v132, v245
    v_dot2_f32_bf16 v244, v133, s62, v244
    v_dot2_f32_bf16 v245, v133, v133, v245
    v_dot2_f32_bf16 v244, v134, s62, v244
    v_dot2_f32_bf16 v245, v134, v134, v245
    v_dot2_f32_bf16 v244, v135, s62, v244
    v_dot2_f32_bf16 v245, v135, v135, v245
    v_dot2_f32_bf16 v244, v136, s62, v244
    v_dot2_f32_bf16 v245, v136, v136, v245
    v_dot2_f32_bf16 v244, v137, s62, v244
    v_dot2_f32_bf16 v245, v137, v137, v245
    v_dot2_f32_bf16 v244, v138, s62, v244
    v_dot2_f32_bf16 v245, v138, v138, v245
    v_dot2_f32_bf16 v244, v139, s62, v244
    v_dot2_f32_bf16 v245, v139, v139, v245
    v_dot2_f32_bf16 v244, v140, s62, v244
    v_dot2_f32_bf16 v245, v140, v140, v245
    v_dot2_f32_bf16 v244, v141, s62, v244
    v_dot2_f32_bf16 v245, v141, v141, v245
    v_dot2_f32_bf16 v244, v142, s62, v244
    v_dot2_f32_bf16 v245, v142, v142, v245
    v_dot2_f32_bf16 v244, v143, s62, v244
    v_dot2_f32_bf16 v245, v143, v143, v245
    s_add_u32 m0, s57, 8192
    s_add_u32 s56, s56, 294912
    buffer_load_dwordx4 v224, s[12:15], s56 offen offset:0  lds
    buffer_load_dwordx4 v225, s[12:15], s56 offen offset:1024  lds
    buffer_load_dwordx4 v226, s[12:15], s56 offen offset:2048  lds
    buffer_load_dwordx4 v227, s[12:15], s56 offen offset:3072  lds
    s_waitcnt lgkmcnt(0)
    v_dot2_f32_bf16 v244, v144, s62, v244
    v_dot2_f32_bf16 v245, v144, v144, v245
    v_dot2_f32_bf16 v244, v145, s62, v244
    v_dot2_f32_bf16 v245, v145, v145, v245
    v_dot2_f32_bf16 v244, v146, s62, v244
    v_dot2_f32_bf16 v245, v146, v146, v245
    v_dot2_f32_bf16 v244, v147, s62, v244
    v_dot2_f32_bf16 v245, v147, v147, v245
    v_dot2_f32_bf16 v244, v148, s62, v244
    v_dot2_f32_bf16 v245, v148, v148, v245
    v_dot2_f32_bf16 v244, v149, s62, v244
    v_dot2_f32_bf16 v245, v149, v149, v245
    v_dot2_f32_bf16 v244, v150, s62, v244
    v_dot2_f32_bf16 v245, v150, v150, v245
    v_dot2_f32_bf16 v244, v151, s62, v244
    v_dot2_f32_bf16 v245, v151, v151, v245
    v_dot2_f32_bf16 v244, v152, s62, v244
    v_dot2_f32_bf16 v245, v152, v152, v245
    v_dot2_f32_bf16 v244, v153, s62, v244
    v_dot2_f32_bf16 v245, v153, v153, v245
    v_dot2_f32_bf16 v244, v154, s62, v244
    v_dot2_f32_bf16 v245, v154, v154, v245
    v_dot2_f32_bf16 v244, v155, s62, v244
    v_dot2_f32_bf16 v245, v155, v155, v245
    v_dot2_f32_bf16 v244, v156, s62, v244
    v_dot2_f32_bf16 v245, v156, v156, v245
    v_dot2_f32_bf16 v244, v157, s62, v244
    v_dot2_f32_bf16 v245, v157, v157, v245
    v_dot2_f32_bf16 v244, v158, s62, v244
    v_dot2_f32_bf16 v245, v158, v158, v245
    v_dot2_f32_bf16 v244, v159, s62, v244
    v_dot2_f32_bf16 v245, v159, v159, v245
    s_nop 2
    v_mov_b32 v204, v244
    v_mov_b32 v205, v245
    s_nop 1
    v_permlane32_swap_b32 v204, v244
    v_permlane32_swap_b32 v205, v245
    v_add_f32 v204, v204, v244
    v_add_f32 v205, v205, v245
    v_mul_f32 v204, 0x3ae38e39, v204
    v_mul_f32 v205, 0x3ae38e39, v205
    v_fma_f32 v205, -v204, v204, v205
    v_max_f32 v205, 0, v205
    v_cvt_pk_bf16_f32 v206, v204, v205
    v_lshlrev_b32 v204, 16, v206
    v_and_b32 v205, 0xffff0000, v206
    v_add_f32 v205, 0x3727c5ac, v205
    v_cvt_pk_bf16_f32 v205, v205, v205
    v_and_b32 v205, 0xffff0000, v205
    v_sqrt_f32 v205, v205
    s_nop 0
    v_cvt_pk_bf16_f32 v205, v205, v205
    v_and_b32 v205, 0xffff0000, v205
    v_rcp_f32 v221, v205
    v_mul_f32 v223, v205, v205
    v_sub_f32 v204, 0, v204
    v_mov_b32 v204, v204
    v_mov_b32 v205, v204
    v_mov_b32 v206, v204
    v_mov_b32 v207, v204
    v_mov_b32 v208, v204
    v_mov_b32 v209, v204
    v_mov_b32 v210, v204
    v_mov_b32 v211, v204
    v_mov_b32 v212, v204
    v_mov_b32 v213, v204
    v_mov_b32 v214, v204
    v_mov_b32 v215, v204
    v_mov_b32 v216, v204
    v_mov_b32 v217, v204
    v_mov_b32 v218, v204
    v_mov_b32 v219, v204
    v_mul_f32 v223, 0x3727c5ac, v223
    v_mul_f32 v250, 0xc0135761, v221
    v_mul_f32 v251, v221, v221
    v_mul_f32 v251, v251, v221
    v_mul_f32 v251, 0xbdd2d3e8, v251
    v_mov_b32 v244, 0
    v_mov_b32 v245, 0
    s_cmp_lg_u32 s29, 12
    s_cbranch_scc1 L1_nors
    v_and_b32 v247, 31, v246
    v_lshlrev_b32 v247, 2, v247
    s_lshl_b32 s59, s31, 7
    s_add_u32 s59, s59, 38076416
    buffer_store_dword v221, v247, s[16:19], s59 offen
    s_cmp_ge_u32 s31, 3
    s_cbranch_scc1 L1_nors
    v_lshlrev_b32 v247, 8, v246
    s_lshl_b32 s59, s31, 14
    s_add_u32 s59, s59, 38084608
    buffer_store_dword v244, v247, s[16:19], s59 offen
L1_nors:
    v_mfma_f32_32x32x16_bf16 v[164:179], v[196:199], v[152:155], v[204:219]
    s_add_u32 m0, s57, 12288
    s_add_u32 s56, s56, 294912
    buffer_load_dwordx4 v224, s[12:15], s56 offen offset:0  lds
    v_mfma_f32_32x32x16_bf16 v[164:179], v[200:203], v[156:159], v[164:179]
    v_mfma_f32_32x32x16_bf16 v[180:195], v[196:199], v[144:147], v[204:219]
    buffer_load_dwordx4 v225, s[12:15], s56 offen offset:1024  lds
    v_mfma_f32_32x32x16_bf16 v[180:195], v[200:203], v[148:151], v[180:195]
    s_nop 8
    buffer_load_dwordx4 v226, s[12:15], s56 offen offset:2048  lds
    v_mfma_f32_32x32x16_bf16 v[52:67], v[196:199], v[136:139], v[204:219]
    v_cvt_pk_bf16_f32 v152, v164, v165
    v_cvt_pk_bf16_f32 v153, v166, v167
    v_cvt_pk_bf16_f32 v154, v168, v169
    v_cvt_pk_bf16_f32 v155, v170, v171
    v_mfma_f32_32x32x16_bf16 v[52:67], v[200:203], v[140:143], v[52:67]
    v_cvt_pk_bf16_f32 v156, v172, v173
    v_cvt_pk_bf16_f32 v157, v174, v175
    v_cvt_pk_bf16_f32 v158, v176, v177
    v_cvt_pk_bf16_f32 v159, v178, v179
    s_nop 0
    v_mfma_f32_32x32x16_bf16 v[164:179], v[196:199], v[128:131], v[204:219]
    buffer_load_dwordx4 v227, s[12:15], s56 offen offset:3072  lds
    v_cvt_pk_bf16_f32 v144, v180, v181
    v_cvt_pk_bf16_f32 v145, v182, v183
    v_cvt_pk_bf16_f32 v146, v184, v185
    v_cvt_pk_bf16_f32 v147, v186, v187
    v_mfma_f32_32x32x16_bf16 v[164:179], v[200:203], v[132:135], v[164:179]
    v_cvt_pk_bf16_f32 v148, v188, v189
    v_cvt_pk_bf16_f32 v149, v190, v191
    v_cvt_pk_bf16_f32 v150, v192, v193
    v_cvt_pk_bf16_f32 v151, v194, v195
    s_nop 0
    v_mfma_f32_32x32x16_bf16 v[180:195], v[196:199], v[120:123], v[204:219]
    s_add_u32 m0, s57, 16384
    s_add_u32 s56, s56, 294912
    buffer_load_dwordx4 v224, s[12:15], s56 offen offset:0  lds
    v_cvt_pk_bf16_f32 v136, v52, v53
    v_cvt_pk_bf16_f32 v137, v54, v55
    v_cvt_pk_bf16_f32 v138, v56, v57
    v_cvt_pk_bf16_f32 v139, v58, v59
    v_mfma_f32_32x32x16_bf16 v[180:195], v[200:203], v[124:127], v[180:195]
    v_cvt_pk_bf16_f32 v140, v60, v61
    v_cvt_pk_bf16_f32 v141, v62, v63
    v_cvt_pk_bf16_f32 v142, v64, v65
    v_cvt_pk_bf16_f32 v143, v66, v67
    s_nop 0
    v_mfma_f32_32x32x16_bf16 v[52:67], v[196:199], v[112:115], v[204:219]
    buffer_load_dwordx4 v225, s[12:15], s56 offen offset:1024  lds
    v_cvt_pk_bf16_f32 v128, v164, v165
    v_cvt_pk_bf16_f32 v129, v166, v167
    v_cvt_pk_bf16_f32 v130, v168, v169
    v_cvt_pk_bf16_f32 v131, v170, v171
    v_mfma_f32_32x32x16_bf16 v[52:67], v[200:203], v[116:119], v[52:67]
    v_cvt_pk_bf16_f32 v132, v172, v173
    v_cvt_pk_bf16_f32 v133, v174, v175
    v_cvt_pk_bf16_f32 v134, v176, v177
    v_cvt_pk_bf16_f32 v135, v178, v179
    s_nop 0
    buffer_load_dword v252, v160, s[12:15], s33 offen
    buffer_load_dword v252, v160, s[12:15], s34 offen
    s_lshl_b32 s59, s28, 6
    v_add_lshl_u32 v247, v246, s59, 8
    buffer_load_dword v252, v247, s[20:23], s67 offen sc1
    v_mfma_f32_32x32x16_bf16 v[164:179], v[196:199], v[104:107], v[204:219]
    v_cvt_pk_bf16_f32 v120, v180, v181
    v_cvt_pk_bf16_f32 v121, v182, v183
    v_cvt_pk_bf16_f32 v122, v184, v185
    v_cvt_pk_bf16_f32 v123, v186, v187
    v_mfma_f32_32x32x16_bf16 v[164:179], v[200:203], v[108:111], v[164:179]
    v_cvt_pk_bf16_f32 v124, v188, v189
    v_cvt_pk_bf16_f32 v125, v190, v191
    v_cvt_pk_bf16_f32 v126, v192, v193
    v_cvt_pk_bf16_f32 v127, v194, v195
    s_nop 0
    v_mfma_f32_32x32x16_bf16 v[180:195], v[196:199], v[96:99], v[204:219]
    v_cvt_pk_bf16_f32 v112, v52, v53
    v_cvt_pk_bf16_f32 v113, v54, v55
    v_cvt_pk_bf16_f32 v114, v56, v57
    v_cvt_pk_bf16_f32 v115, v58, v59
    v_mfma_f32_32x32x16_bf16 v[180:195], v[200:203], v[100:103], v[180:195]
    v_cvt_pk_bf16_f32 v116, v60, v61
    v_cvt_pk_bf16_f32 v117, v62, v63
    v_cvt_pk_bf16_f32 v118, v64, v65
    v_cvt_pk_bf16_f32 v119, v66, v67
    s_nop 0
    v_mfma_f32_32x32x16_bf16 v[52:67], v[196:199], v[88:91], v[204:219]
    v_cvt_pk_bf16_f32 v104, v164, v165
    v_cvt_pk_bf16_f32 v105, v166, v167
    v_cvt_pk_bf16_f32 v106, v168, v169
    v_cvt_pk_bf16_f32 v107, v170, v171
    v_mfma_f32_32x32x16_bf16 v[52:67], v[200:203], v[92:95], v[52:67]
    v_cvt_pk_bf16_f32 v108, v172, v173
    v_cvt_pk_bf16_f32 v109, v174, v175
    v_cvt_pk_bf16_f32 v110, v176, v177
    v_cvt_pk_bf16_f32 v111, v178, v179
    s_nop 0
    v_mfma_f32_32x32x16_bf16 v[164:179], v[196:199], v[80:83], v[204:219]
    v_cvt_pk_bf16_f32 v96, v180, v181
    v_cvt_pk_bf16_f32 v97, v182, v183
    v_cvt_pk_bf16_f32 v98, v184, v185
    v_cvt_pk_bf16_f32 v99, v186, v187
    v_mfma_f32_32x32x16_bf16 v[164:179], v[200:203], v[84:87], v[164:179]
    v_cvt_pk_bf16_f32 v100, v188, v189
    v_cvt_pk_bf16_f32 v101, v190, v191
    v_cvt_pk_bf16_f32 v102, v192, v193
    v_cvt_pk_bf16_f32 v103, v194, v195
    s_nop 0
    v_mfma_f32_32x32x16_bf16 v[180:195], v[196:199], v[72:75], v[204:219]
    v_cvt_pk_bf16_f32 v88, v52, v53
    v_cvt_pk_bf16_f32 v89, v54, v55
    v_cvt_pk_bf16_f32 v90, v56, v57
    v_cvt_pk_bf16_f32 v91, v58, v59
    v_mfma_f32_32x32x16_bf16 v[180:195], v[200:203], v[76:79], v[180:195]
    v_cvt_pk_bf16_f32 v92, v60, v61
    v_cvt_pk_bf16_f32 v93, v62, v63
    v_cvt_pk_bf16_f32 v94, v64, v65
    v_cvt_pk_bf16_f32 v95, v66, v67
    s_nop 0
    v_mfma_f32_32x32x16_bf16 v[52:67], v[196:199], v[48:51], v[204:219]
    v_cvt_pk_bf16_f32 v80, v164, v165
    v_cvt_pk_bf16_f32 v81, v166, v167
    v_cvt_pk_bf16_f32 v82, v168, v169
    v_cvt_pk_bf16_f32 v83, v170, v171
    v_mfma_f32_32x32x16_bf16 v[52:67], v[200:203], v[68:71], v[52:67]
    v_cvt_pk_bf16_f32 v84, v172, v173
    v_cvt_pk_bf16_f32 v85, v174, v175
    v_cvt_pk_bf16_f32 v86, v176, v177
    v_cvt_pk_bf16_f32 v87, v178, v179
    s_nop 0
    v_mfma_f32_32x32x16_bf16 v[164:179], v[196:199], v[40:43], v[204:219]
    v_cvt_pk_bf16_f32 v72, v180, v181
    v_cvt_pk_bf16_f32 v73, v182, v183
    v_cvt_pk_bf16_f32 v74, v184, v185
    v_cvt_pk_bf16_f32 v75, v186, v187
    v_mfma_f32_32x32x16_bf16 v[164:179], v[200:203], v[44:47], v[164:179]
    v_cvt_pk_bf16_f32 v76, v188, v189
    v_cvt_pk_bf16_f32 v77, v190, v191
    v_cvt_pk_bf16_f32 v78, v192, v193
    v_cvt_pk_bf16_f32 v79, v194, v195
    s_nop 0
    v_mfma_f32_32x32x16_bf16 v[180:195], v[196:199], v[32:35], v[204:219]
    v_cvt_pk_bf16_f32 v48, v52, v53
    v_cvt_pk_bf16_f32 v49, v54, v55
    v_cvt_pk_bf16_f32 v50, v56, v57
    v_cvt_pk_bf16_f32 v51, v58, v59
    v_mfma_f32_32x32x16_bf16 v[180:195], v[200:203], v[36:39], v[180:195]
    v_cvt_pk_bf16_f32 v68, v60, v61
    v_cvt_pk_bf16_f32 v69, v62, v63
    v_cvt_pk_bf16_f32 v70, v64, v65
    v_cvt_pk_bf16_f32 v71, v66, v67
    s_nop 0
    v_mfma_f32_32x32x16_bf16 v[52:67], v[196:199], v[24:27], v[204:219]
    v_cvt_pk_bf16_f32 v40, v164, v165
    v_cvt_pk_bf16_f32 v41, v166, v167
    v_cvt_pk_bf16_f32 v42, v168, v169
    v_cvt_pk_bf16_f32 v43, v170, v171
    v_mfma_f32_32x32x16_bf16 v[52:67], v[200:203], v[28:31], v[52:67]
    v_cvt_pk_bf16_f32 v44, v172, v173
    v_cvt_pk_bf16_f32 v45, v174, v175
    v_cvt_pk_bf16_f32 v46, v176, v177
    v_cvt_pk_bf16_f32 v47, v178, v179
    s_nop 0
    v_mfma_f32_32x32x16_bf16 v[164:179], v[196:199], v[16:19], v[204:219]
    v_cvt_pk_bf16_f32 v32, v180, v181
    v_cvt_pk_bf16_f32 v33, v182, v183
    v_cvt_pk_bf16_f32 v34, v184, v185
    v_cvt_pk_bf16_f32 v35, v186, v187
    v_mfma_f32_32x32x16_bf16 v[164:179], v[200:203], v[20:23], v[164:179]
    v_cvt_pk_bf16_f32 v36, v188, v189
    v_cvt_pk_bf16_f32 v37, v190, v191
    v_cvt_pk_bf16_f32 v38, v192, v193
    v_cvt_pk_bf16_f32 v39, v194, v195
    s_nop 0
    v_mfma_f32_32x32x16_bf16 v[180:195], v[196:199], v[8:11], v[204:219]
    v_cvt_pk_bf16_f32 v24, v52, v53
    v_cvt_pk_bf16_f32 v25, v54, v55
    v_cvt_pk_bf16_f32 v26, v56, v57
    v_cvt_pk_bf16_f32 v27, v58, v59
    v_mfma_f32_32x32x16_bf16 v[180:195], v[200:203], v[12:15], v[180:195]
    v_cvt_pk_bf16_f32 v28, v60, v61
    v_cvt_pk_bf16_f32 v29, v62, v63
    v_cvt_pk_bf16_f32 v30, v64, v65
    v_cvt_pk_bf16_f32 v31, v66, v67
    s_nop 0
    s_waitcnt vmcnt(3)
    s_barrier
    ds_read_b64_tr_b16 a[92:93], v232 offset:0
    ds_read_b64_tr_b16 a[94:95], v232 offset:1024
    ds_read_b64_tr_b16 a[96:97], v232 offset:2048
    ds_read_b64_tr_b16 a[98:99], v232 offset:3072
    ds_read_b64_tr_b16 a[100:101], v232 offset:4096
    ds_read_b64_tr_b16 a[102:103], v232 offset:5120
    ds_read_b64_tr_b16 a[104:105], v232 offset:6144
    ds_read_b64_tr_b16 a[106:107], v232 offset:7168
    ds_read_b64_tr_b16 a[108:109], v232 offset:8192
    ds_read_b64_tr_b16 a[110:111], v232 offset:9216
    ds_read_b64_tr_b16 a[112:113], v232 offset:10240
    ds_read_b64_tr_b16 a[114:115], v232 offset:11264
    v_mfma_f32_32x32x16_bf16 v[52:67], v[196:199], v[0:3], v[204:219]
    v_cvt_pk_bf16_f32 v16, v164, v165
    v_cvt_pk_bf16_f32 v17, v166, v167
    v_cvt_pk_bf16_f32 v18, v168, v169
    v_cvt_pk_bf16_f32 v19, v170, v171
    v_mfma_f32_32x32x16_bf16 v[52:67], v[200:203], v[4:7], v[52:67]
    v_cvt_pk_bf16_f32 v20, v172, v173
    v_cvt_pk_bf16_f32 v21, v174, v175
    v_cvt_pk_bf16_f32 v22, v176, v177
    v_cvt_pk_bf16_f32 v23, v178, v179
    s_nop 0
    v_cvt_pk_bf16_f32 v8, v180, v181
    v_cvt_pk_bf16_f32 v9, v182, v183
    v_cvt_pk_bf16_f32 v10, v184, v185
    v_cvt_pk_bf16_f32 v11, v186, v187
    v_cvt_pk_bf16_f32 v12, v188, v189
    v_cvt_pk_bf16_f32 v13, v190, v191
    v_cvt_pk_bf16_f32 v14, v192, v193
    v_cvt_pk_bf16_f32 v15, v194, v195
    s_nop 0
    s_nop 2
    v_cvt_pk_bf16_f32 v0, v52, v53
    v_cvt_pk_bf16_f32 v1, v54, v55
    v_cvt_pk_bf16_f32 v2, v56, v57
    v_cvt_pk_bf16_f32 v3, v58, v59
    v_cvt_pk_bf16_f32 v4, v60, v61
    v_cvt_pk_bf16_f32 v5, v62, v63
    v_cvt_pk_bf16_f32 v6, v64, v65
    v_cvt_pk_bf16_f32 v7, v66, v67
    s_nop 0
    s_waitcnt lgkmcnt(10)
    s_nop 0
    v_mfma_f32_32x32x16_bf16 v[164:179], a[92:95], v[0:3], 0
    s_waitcnt lgkmcnt(6)
    s_add_u32 m0, s57, 73728
    s_mul_i32 s56, s28, 1327104
    s_add_u32 s56, s56, s33
    ds_read_b64_tr_b16 a[116:117], v232 offset:12288
    ds_read_b64_tr_b16 a[118:119], v232 offset:13312
    v_mfma_f32_32x32x16_bf16 v[164:179], a[96:99], v[4:7], v[164:179]
    buffer_load_dwordx4 v224, s[12:15], s56 offen offset:0  lds
    ds_read_b64_tr_b16 a[120:121], v232 offset:14336
    ds_read_b64_tr_b16 a[122:123], v232 offset:15360
    v_mfma_f32_32x32x16_bf16 v[164:179], a[100:103], v[8:11], v[164:179]
    s_waitcnt lgkmcnt(6)
    buffer_load_dwordx4 v225, s[12:15], s56 offen offset:1024  lds
    ds_read_b64_tr_b16 a[124:125], v232 offset:16384
    ds_read_b64_tr_b16 a[126:127], v232 offset:17408
    v_mfma_f32_32x32x16_bf16 v[164:179], a[104:107], v[12:15], v[164:179]
    ds_read_b64_tr_b16 a[92:93], v232 offset:18432
    ds_read_b64_tr_b16 a[94:95], v232 offset:19456
    v_mfma_f32_32x32x16_bf16 v[164:179], a[108:111], v[16:19], v[164:179]
    s_waitcnt lgkmcnt(6)
    buffer_load_dwordx4 v226, s[12:15], s56 offen offset:2048  lds
    ds_read_b64_tr_b16 a[96:97], v232 offset:20480
    ds_read_b64_tr_b16 a[98:99], v232 offset:21504
    v_mfma_f32_32x32x16_bf16 v[164:179], a[112:115], v[20:23], v[164:179]
    ds_read_b64_tr_b16 a[100:101], v232 offset:22528
    ds_read_b64_tr_b16 a[102:103], v232 offset:23552
    v_mfma_f32_32x32x16_bf16 v[164:179], a[116:119], v[24:27], v[164:179]
    s_waitcnt lgkmcnt(6)
    buffer_load_dwordx4 v227, s[12:15], s56 offen offset:3072  lds
    ds_read_b64_tr_b16 a[104:105], v232 offset:24576
    ds_read_b64_tr_b16 a[106:107], v232 offset:25600
    v_mfma_f32_32x32x16_bf16 v[164:179], a[120:123], v[28:31], v[164:179]
    s_add_u32 m0, s57, 77824
    s_add_u32 s56, s56, 294912
    ds_read_b64_tr_b16 a[108:109], v232 offset:26624
    ds_read_b64_tr_b16 a[110:111], v232 offset:27648
    v_mfma_f32_32x32x16_bf16 v[164:179], a[124:127], v[32:35], v[164:179]
    s_waitcnt lgkmcnt(6)
    buffer_load_dwordx4 v224, s[12:15], s56 offen offset:0  lds
    ds_read_b64_tr_b16 a[112:113], v232 offset:28672
    ds_read_b64_tr_b16 a[114:115], v232 offset:29696
    v_mfma_f32_32x32x16_bf16 v[164:179], a[92:95], v[36:39], v[164:179]
    ds_read_b64_tr_b16 a[116:117], v232 offset:30720
    ds_read_b64_tr_b16 a[118:119], v232 offset:31744
    v_mfma_f32_32x32x16_bf16 v[164:179], a[96:99], v[40:43], v[164:179]
    s_waitcnt lgkmcnt(6)
    buffer_load_dwordx4 v225, s[12:15], s56 offen offset:1024  lds
    ds_read_b64_tr_b16 a[120:121], v232 offset:32768
    ds_read_b64_tr_b16 a[122:123], v232 offset:33792
    v_mfma_f32_32x32x16_bf16 v[164:179], a[100:103], v[44:47], v[164:179]
    ds_read_b64_tr_b16 a[124:125], v232 offset:34816
    ds_read_b64_tr_b16 a[126:127], v232 offset:35840
    v_mfma_f32_32x32x16_bf16 v[164:179], a[104:107], v[48:51], v[164:179]
    s_waitcnt lgkmcnt(6)
    buffer_load_dwordx4 v226, s[12:15], s56 offen offset:2048  lds
    ds_read_b64_tr_b16 a[92:93], v232 offset:36864
    ds_read_b64_tr_b16 a[94:95], v232 offset:37888
    v_mfma_f32_32x32x16_bf16 v[164:179], a[108:111], v[68:71], v[164:179]
    ds_read_b64_tr_b16 a[96:97], v232 offset:38912
    ds_read_b64_tr_b16 a[98:99], v232 offset:39936
    v_mfma_f32_32x32x16_bf16 v[164:179], a[112:115], v[72:75], v[164:179]
    s_waitcnt lgkmcnt(6)
    buffer_load_dwordx4 v227, s[12:15], s56 offen offset:3072  lds
    ds_read_b64_tr_b16 a[100:101], v232 offset:40960
    ds_read_b64_tr_b16 a[102:103], v232 offset:41984
    v_mfma_f32_32x32x16_bf16 v[164:179], a[116:119], v[76:79], v[164:179]
    s_add_u32 m0, s57, 81920
    s_add_u32 s56, s56, 294912
    ds_read_b64_tr_b16 a[104:105], v232 offset:43008
    ds_read_b64_tr_b16 a[106:107], v232 offset:44032
    v_mfma_f32_32x32x16_bf16 v[164:179], a[120:123], v[80:83], v[164:179]
    s_waitcnt lgkmcnt(6)
    buffer_load_dwordx4 v224, s[12:15], s56 offen offset:0  lds
    ds_read_b64_tr_b16 a[108:109], v232 offset:45056
    ds_read_b64_tr_b16 a[110:111], v232 offset:46080
    v_accvgpr_write_b32 a0, v68
    v_accvgpr_write_b32 a1, v69
    v_accvgpr_write_b32 a2, v70
    v_accvgpr_write_b32 a3, v71
    v_mfma_f32_32x32x16_bf16 v[164:179], a[124:127], v[84:87], v[164:179]
    ds_read_b64_tr_b16 a[112:113], v232 offset:47104
    ds_read_b64_tr_b16 a[114:115], v232 offset:48128
    v_accvgpr_write_b32 a4, v72
    v_accvgpr_write_b32 a5, v73
    v_accvgpr_write_b32 a6, v74
    v_accvgpr_write_b32 a7, v75
    v_accvgpr_write_b32 a8, v76
    v_accvgpr_write_b32 a9, v77
    v_mfma_f32_32x32x16_bf16 v[164:179], a[92:95], v[88:91], v[164:179]
    s_waitcnt lgkmcnt(6)
    buffer_load_dwordx4 v225, s[12:15], s56 offen offset:1024  lds
    ds_read_b64_tr_b16 a[116:117], v233 offset:0
    ds_read_b64_tr_b16 a[118:119], v233 offset:1024
    v_accvgpr_write_b32 a10, v78
    v_accvgpr_write_b32 a11, v79
    v_accvgpr_write_b32 a12, v80
    v_accvgpr_write_b32 a13, v81
    v_mfma_f32_32x32x16_bf16 v[164:179], a[96:99], v[92:95], v[164:179]
    ds_read_b64_tr_b16 a[120:121], v233 offset:2048
    ds_read_b64_tr_b16 a[122:123], v233 offset:3072
    v_accvgpr_write_b32 a14, v82
    v_accvgpr_write_b32 a15, v83
    v_accvgpr_write_b32 a16, v84
    v_accvgpr_write_b32 a17, v85
    v_accvgpr_write_b32 a18, v86
    v_accvgpr_write_b32 a19, v87
    v_mfma_f32_32x32x16_bf16 v[164:179], a[100:103], v[96:99], v[164:179]
    s_waitcnt lgkmcnt(6)
    buffer_load_dwordx4 v226, s[12:15], s56 offen offset:2048  lds
    ds_read_b64_tr_b16 a[124:125], v233 offset:4096
    ds_read_b64_tr_b16 a[126:127], v233 offset:5120
    v_accvgpr_write_b32 a20, v88
    v_accvgpr_write_b32 a21, v89
    v_accvgpr_write_b32 a22, v90
    v_accvgpr_write_b32 a23, v91
    v_mfma_f32_32x32x16_bf16 v[164:179], a[104:107], v[100:103], v[164:179]
    ds_read_b64_tr_b16 a[92:93], v233 offset:6144
    ds_read_b64_tr_b16 a[94:95], v233 offset:7168
    v_accvgpr_write_b32 a24, v92
    v_accvgpr_write_b32 a25, v93
    v_accvgpr_write_b32 a26, v94
    v_accvgpr_write_b32 a27, v95
    v_accvgpr_write_b32 a28, v96
    v_accvgpr_write_b32 a29, v97
    v_mfma_f32_32x32x16_bf16 v[164:179], a[108:111], v[104:107], v[164:179]
    s_waitcnt lgkmcnt(6)
    buffer_load_dwordx4 v227, s[12:15], s56 offen offset:3072  lds
    ds_read_b64_tr_b16 a[96:97], v233 offset:8192
    ds_read_b64_tr_b16 a[98:99], v233 offset:9216
    v_accvgpr_write_b32 a30, v98
    v_accvgpr_write_b32 a31, v99
    v_accvgpr_write_b32 a32, v100
    v_accvgpr_write_b32 a33, v101
    v_mfma_f32_32x32x16_bf16 v[164:179], a[112:115], v[108:111], v[164:179]
    s_add_u32 m0, s57, 86016
    s_add_u32 s56, s56, 294912
    ds_read_b64_tr_b16 a[100:101], v233 offset:10240
    ds_read_b64_tr_b16 a[102:103], v233 offset:11264
    v_accvgpr_write_b32 a34, v102
    v_accvgpr_write_b32 a35, v103
    v_accvgpr_write_b32 a36, v104
    v_accvgpr_write_b32 a37, v105
    v_accvgpr_write_b32 a38, v106
    v_mfma_f32_32x32x16_bf16 v[164:179], a[116:119], v[112:115], v[164:179]
    s_waitcnt lgkmcnt(6)
    buffer_load_dwordx4 v224, s[12:15], s56 offen offset:0  lds
    ds_read_b64_tr_b16 a[104:105], v233 offset:12288
    ds_read_b64_tr_b16 a[106:107], v233 offset:13312
    v_accvgpr_write_b32 a39, v107
    v_accvgpr_write_b32 a40, v108
    v_accvgpr_write_b32 a41, v109
    v_accvgpr_write_b32 a42, v110
    v_mfma_f32_32x32x16_bf16 v[164:179], a[120:123], v[116:119], v[164:179]
    ds_read_b64_tr_b16 a[108:109], v233 offset:14336
    ds_read_b64_tr_b16 a[110:111], v233 offset:15360
    v_accvgpr_write_b32 a43, v111
    v_accvgpr_write_b32 a44, v112
    v_accvgpr_write_b32 a45, v113
    v_accvgpr_write_b32 a46, v114
    v_accvgpr_write_b32 a47, v115
    v_accvgpr_write_b32 a48, v116
    v_mfma_f32_32x32x16_bf16 v[164:179], a[124:127], v[120:123], v[164:179]
    s_waitcnt lgkmcnt(6)
    buffer_load_dwordx4 v225, s[12:15], s56 offen offset:1024  lds
    ds_read_b64_tr_b16 a[112:113], v233 offset:16384
    ds_read_b64_tr_b16 a[114:115], v233 offset:17408
    v_accvgpr_write_b32 a49, v117
    v_accvgpr_write_b32 a50, v118
    v_accvgpr_write_b32 a51, v119
    v_accvgpr_write_b32 a52, v120
    v_mfma_f32_32x32x16_bf16 v[164:179], a[92:95], v[124:127], v[164:179]
    ds_read_b64_tr_b16 a[116:117], v233 offset:18432
    ds_read_b64_tr_b16 a[118:119], v233 offset:19456
    v_accvgpr_write_b32 a53, v121
    v_accvgpr_write_b32 a54, v122
    v_accvgpr_write_b32 a55, v123
    v_accvgpr_write_b32 a56, v124
    v_accvgpr_write_b32 a57, v125
    v_accvgpr_write_b32 a58, v126
    v_mfma_f32_32x32x16_bf16 v[164:179], a[96:99], v[128:131], v[164:179]
    s_waitcnt lgkmcnt(6)
    buffer_load_dwordx4 v226, s[12:15], s56 offen offset:2048  lds
    ds_read_b64_tr_b16 a[120:121], v233 offset:20480
    ds_read_b64_tr_b16 a[122:123], v233 offset:21504
    v_accvgpr_write_b32 a59, v127
    v_accvgpr_write_b32 a60, v128
    v_accvgpr_write_b32 a61, v129
    v_accvgpr_write_b32 a62, v130
    v_mfma_f32_32x32x16_bf16 v[164:179], a[100:103], v[132:135], v[164:179]
    ds_read_b64_tr_b16 a[124:125], v233 offset:22528
    ds_read_b64_tr_b16 a[126:127], v233 offset:23552
    v_accvgpr_write_b32 a63, v131
    v_accvgpr_write_b32 a64, v132
    v_accvgpr_write_b32 a65, v133
    v_accvgpr_write_b32 a66, v134
    v_accvgpr_write_b32 a67, v135
    v_accvgpr_write_b32 a68, v136
    v_mfma_f32_32x32x16_bf16 v[164:179], a[104:107], v[136:139], v[164:179]
    s_waitcnt lgkmcnt(6)
    buffer_load_dwordx4 v227, s[12:15], s56 offen offset:3072  lds
    ds_read_b64_tr_b16 a[92:93], v235 offset:0
    ds_read_b64_tr_b16 a[94:95], v235 offset:1024
    v_accvgpr_write_b32 a69, v137
    v_accvgpr_write_b32 a70, v138
    v_accvgpr_write_b32 a71, v139
    v_accvgpr_write_b32 a72, v140
    v_mfma_f32_32x32x16_bf16 v[164:179], a[108:111], v[140:143], v[164:179]
    s_add_u32 m0, s57, 90112
    s_add_u32 s56, s56, 294912
    ds_read_b64_tr_b16 a[96:97], v235 offset:2048
    ds_read_b64_tr_b16 a[98:99], v235 offset:3072
    v_accvgpr_write_b32 a73, v141
    v_accvgpr_write_b32 a74, v142
    v_accvgpr_write_b32 a75, v143
    v_accvgpr_write_b32 a76, v144
    v_mfma_f32_32x32x16_bf16 v[164:179], a[112:115], v[144:147], v[164:179]
    s_waitcnt lgkmcnt(6)
    buffer_load_dwordx4 v224, s[12:15], s56 offen offset:0  lds
    ds_read_b64_tr_b16 a[100:101], v235 offset:4096
    ds_read_b64_tr_b16 a[102:103], v235 offset:5120
    v_accvgpr_write_b32 a77, v145
    v_accvgpr_write_b32 a78, v146
    v_accvgpr_write_b32 a79, v147
    v_mfma_f32_32x32x16_bf16 v[164:179], a[116:119], v[148:151], v[164:179]
    ds_read_b64_tr_b16 a[104:105], v235 offset:6144
    ds_read_b64_tr_b16 a[106:107], v235 offset:7168
    v_accvgpr_write_b32 a80, v148
    v_accvgpr_write_b32 a81, v149
    v_accvgpr_write_b32 a82, v150
    v_accvgpr_write_b32 a83, v151
    v_accvgpr_write_b32 a84, v152
    v_mfma_f32_32x32x16_bf16 v[164:179], a[120:123], v[152:155], v[164:179]
    s_waitcnt lgkmcnt(6)
    buffer_load_dwordx4 v225, s[12:15], s56 offen offset:1024  lds
    ds_read_b64_tr_b16 a[108:109], v235 offset:8192
    ds_read_b64_tr_b16 a[110:111], v235 offset:9216
    v_accvgpr_write_b32 a85, v153
    v_accvgpr_write_b32 a86, v154
    v_accvgpr_write_b32 a87, v155
    v_mfma_f32_32x32x16_bf16 v[164:179], a[124:127], v[156:159], v[164:179]
    ds_read_b64_tr_b16 a[112:113], v235 offset:10240
    ds_read_b64_tr_b16 a[114:115], v235 offset:11264
    v_accvgpr_write_b32 a88, v156
    v_accvgpr_write_b32 a89, v157
    v_accvgpr_write_b32 a90, v158
    v_accvgpr_write_b32 a91, v159
    v_mfma_f32_32x32x16_bf16 v[180:195], a[92:95], v[0:3], 0
    s_waitcnt lgkmcnt(6)
    s_cmp_lt_u32 s29, 4
    s_cselect_b32 s4, s8, s12
    s_cselect_b32 s5, s9, s13
    s_cselect_b32 s6, s10, s14
    ds_read_b64_tr_b16 a[116:117], v235 offset:12288
    ds_read_b64_tr_b16 a[118:119], v235 offset:13312
    v_mfma_f32_32x32x16_bf16 v[180:195], a[96:99], v[4:7], v[180:195]
    s_cselect_b64 s[96:97], -1, 0
    ds_read_b64_tr_b16 a[120:121], v235 offset:14336
    ds_read_b64_tr_b16 a[122:123], v235 offset:15360
    v_mfma_f32_32x32x16_bf16 v[180:195], a[100:103], v[8:11], v[180:195]
    s_waitcnt lgkmcnt(6)
    ds_read_b64_tr_b16 a[124:125], v235 offset:16384
    ds_read_b64_tr_b16 a[126:127], v235 offset:17408
    v_mul_f32 v204, v164, v164
    v_mul_f32 v205, v165, v165
    v_mul_f32 v206, v166, v166
    v_mul_f32 v207, v167, v167
    v_fma_f32 v204, v204, v251, v250
    v_fma_f32 v205, v205, v251, v250
    v_mfma_f32_32x32x16_bf16 v[180:195], a[104:107], v[12:15], v[180:195]
    ds_read_b64_tr_b16 a[92:93], v235 offset:18432
    ds_read_b64_tr_b16 a[94:95], v235 offset:19456
    v_fma_f32 v206, v206, v251, v250
    v_fma_f32 v207, v207, v251, v250
    v_mul_f32 v204, v204, v164
    v_mul_f32 v205, v205, v165
    v_mul_f32 v206, v206, v166
    v_mul_f32 v207, v207, v167
    v_mfma_f32_32x32x16_bf16 v[180:195], a[108:111], v[16:19], v[180:195]
    s_waitcnt lgkmcnt(6)
    ds_read_b64_tr_b16 a[96:97], v235 offset:20480
    ds_read_b64_tr_b16 a[98:99], v235 offset:21504
    v_cndmask_b32 v162, v160, v161, s[96:97]
    v_exp_f32 v204, v204
    v_exp_f32 v205, v205
    v_add_f32 v204, 1.0, v204
    v_mfma_f32_32x32x16_bf16 v[180:195], a[112:115], v[20:23], v[180:195]
    ds_read_b64_tr_b16 a[100:101], v235 offset:22528
    ds_read_b64_tr_b16 a[102:103], v235 offset:23552
    v_exp_f32 v206, v206
    v_exp_f32 v207, v207
    v_add_f32 v205, 1.0, v205
    v_add_f32 v206, 1.0, v206
    v_mfma_f32_32x32x16_bf16 v[180:195], a[116:119], v[24:27], v[180:195]
    s_waitcnt lgkmcnt(6)
    ds_read_b64_tr_b16 a[104:105], v235 offset:24576
    ds_read_b64_tr_b16 a[106:107], v235 offset:25600
    v_add_f32 v207, 1.0, v207
    v_rcp_f32 v204, v204
    v_rcp_f32 v205, v205
    v_mul_f32 v68, v164, v204
    v_mfma_f32_32x32x16_bf16 v[180:195], a[120:123], v[28:31], v[180:195]
    ds_read_b64_tr_b16 a[108:109], v235 offset:26624
    ds_read_b64_tr_b16 a[110:111], v235 offset:27648
    v_rcp_f32 v206, v206
    v_rcp_f32 v207, v207
    v_mul_f32 v69, v165, v205
    v_mul_f32 v70, v166, v206
    v_mfma_f32_32x32x16_bf16 v[180:195], a[124:127], v[32:35], v[180:195]
    s_waitcnt lgkmcnt(6)
    buffer_load_dword v252, v162, s[4:7], s35 offen
    buffer_load_dword v252, v162, s[4:7], s36 offen
    buffer_load_dword v252, v254, s[84:87], 0 offen offset:0
    ds_read_b64_tr_b16 a[112:113], v235 offset:28672
    ds_read_b64_tr_b16 a[114:115], v235 offset:29696
    v_mfma_f32_32x32x16_bf16 v[180:195], a[92:95], v[36:39], v[180:195]
    ds_read_b64_tr_b16 a[116:117], v235 offset:30720
    ds_read_b64_tr_b16 a[118:119], v235 offset:31744
    v_mul_f32 v71, v167, v207
    v_add_f32 v244, v244, v68
    v_fmac_f32 v245, v68, v68
    v_add_f32 v244, v244, v69
    v_fmac_f32 v245, v69, v69
    v_add_f32 v244, v244, v70
    v_mfma_f32_32x32x16_bf16 v[180:195], a[96:99], v[40:43], v[180:195]
    s_waitcnt lgkmcnt(6)
    ds_read_b64_tr_b16 a[120:121], v235 offset:32768
    ds_read_b64_tr_b16 a[122:123], v235 offset:33792
    v_fmac_f32 v245, v70, v70
    v_add_f32 v244, v244, v71
    v_fmac_f32 v245, v71, v71
    v_mul_f32 v208, v168, v168
    v_mul_f32 v209, v169, v169
    v_mul_f32 v210, v170, v170
    v_mfma_f32_32x32x16_bf16 v[180:195], a[100:103], v[44:47], v[180:195]
    ds_read_b64_tr_b16 a[124:125], v235 offset:34816
    ds_read_b64_tr_b16 a[126:127], v235 offset:35840
    v_mul_f32 v211, v171, v171
    v_fma_f32 v208, v208, v251, v250
    v_fma_f32 v209, v209, v251, v250
    v_fma_f32 v210, v210, v251, v250
    v_fma_f32 v211, v211, v251, v250
    v_mul_f32 v208, v208, v168
    v_mfma_f32_32x32x16_bf16 v[180:195], a[104:107], v[48:51], v[180:195]
    s_waitcnt lgkmcnt(6)
    ds_read_b64_tr_b16 a[92:93], v235 offset:36864
    ds_read_b64_tr_b16 a[94:95], v235 offset:37888
    v_mul_f32 v209, v209, v169
    v_mul_f32 v210, v210, v170
    v_mul_f32 v211, v211, v171
    v_exp_f32 v208, v208
    v_mfma_f32_32x32x16_bf16 v[180:195], a[108:111], a[0:3], v[180:195]
    ds_read_b64_tr_b16 a[96:97], v235 offset:38912
    ds_read_b64_tr_b16 a[98:99], v235 offset:39936
    v_exp_f32 v209, v209
    v_exp_f32 v210, v210
    v_exp_f32 v211, v211
    v_mfma_f32_32x32x16_bf16 v[180:195], a[112:115], a[4:7], v[180:195]
    s_waitcnt lgkmcnt(6)
    ds_read_b64_tr_b16 a[100:101], v235 offset:40960
    ds_read_b64_tr_b16 a[102:103], v235 offset:41984
    v_add_f32 v208, 1.0, v208
    v_add_f32 v209, 1.0, v209
    v_add_f32 v210, 1.0, v210
    v_add_f32 v211, 1.0, v211
    v_rcp_f32 v208, v208
    v_mfma_f32_32x32x16_bf16 v[180:195], a[116:119], a[8:11], v[180:195]
    ds_read_b64_tr_b16 a[104:105], v235 offset:43008
    ds_read_b64_tr_b16 a[106:107], v235 offset:44032
    v_rcp_f32 v209, v209
    v_rcp_f32 v210, v210
    v_rcp_f32 v211, v211
    v_mfma_f32_32x32x16_bf16 v[180:195], a[120:123], a[12:15], v[180:195]
    s_waitcnt lgkmcnt(6)
    ds_read_b64_tr_b16 a[108:109], v235 offset:45056
    ds_read_b64_tr_b16 a[110:111], v235 offset:46080
    v_mul_f32 v72, v168, v208
    v_mul_f32 v73, v169, v209
    v_mul_f32 v74, v170, v210
    v_mul_f32 v75, v171, v211
    v_add_f32 v244, v244, v72
    v_mfma_f32_32x32x16_bf16 v[180:195], a[124:127], a[16:19], v[180:195]
    ds_read_b64_tr_b16 a[112:113], v235 offset:47104
    ds_read_b64_tr_b16 a[114:115], v235 offset:48128
    v_fmac_f32 v245, v72, v72
    v_add_f32 v244, v244, v73
    v_fmac_f32 v245, v73, v73
    v_add_f32 v244, v244, v74
    v_fmac_f32 v245, v74, v74
    v_mfma_f32_32x32x16_bf16 v[180:195], a[92:95], a[20:23], v[180:195]
    s_waitcnt lgkmcnt(6)
    ds_read_b64_tr_b16 a[116:117], v236 offset:0
    ds_read_b64_tr_b16 a[118:119], v236 offset:1024
    v_add_f32 v244, v244, v75
    v_fmac_f32 v245, v75, v75
    v_mul_f32 v204, v172, v172
    v_mul_f32 v205, v173, v173
    v_mul_f32 v206, v174, v174
    v_mfma_f32_32x32x16_bf16 v[180:195], a[96:99], a[24:27], v[180:195]
    ds_read_b64_tr_b16 a[120:121], v236 offset:2048
    ds_read_b64_tr_b16 a[122:123], v236 offset:3072
    v_mul_f32 v207, v175, v175
    v_fma_f32 v204, v204, v251, v250
    v_fma_f32 v205, v205, v251, v250
    v_fma_f32 v206, v206, v251, v250
    v_fma_f32 v207, v207, v251, v250
    v_mfma_f32_32x32x16_bf16 v[180:195], a[100:103], a[28:31], v[180:195]
    s_waitcnt lgkmcnt(6)
    ds_read_b64_tr_b16 a[124:125], v236 offset:4096
    ds_read_b64_tr_b16 a[126:127], v236 offset:5120
    v_mul_f32 v204, v204, v172
    v_mul_f32 v205, v205, v173
    v_mul_f32 v206, v206, v174
    v_mul_f32 v207, v207, v175
    v_mfma_f32_32x32x16_bf16 v[180:195], a[104:107], a[32:35], v[180:195]
    ds_read_b64_tr_b16 a[92:93], v236 offset:6144
    ds_read_b64_tr_b16 a[94:95], v236 offset:7168
    v_exp_f32 v204, v204
    v_exp_f32 v205, v205
    v_exp_f32 v206, v206
    v_mfma_f32_32x32x16_bf16 v[180:195], a[108:111], a[36:39], v[180:195]
    s_waitcnt lgkmcnt(6)
    ds_read_b64_tr_b16 a[96:97], v236 offset:8192
    ds_read_b64_tr_b16 a[98:99], v236 offset:9216
    v_exp_f32 v207, v207
    v_add_f32 v204, 1.0, v204
    v_add_f32 v205, 1.0, v205
    v_add_f32 v206, 1.0, v206
    v_mfma_f32_32x32x16_bf16 v[180:195], a[112:115], a[40:43], v[180:195]
    ds_read_b64_tr_b16 a[100:101], v236 offset:10240
    ds_read_b64_tr_b16 a[102:103], v236 offset:11264
    v_add_f32 v207, 1.0, v207
    v_rcp_f32 v204, v204
    v_rcp_f32 v205, v205
    v_mfma_f32_32x32x16_bf16 v[180:195], a[116:119], a[44:47], v[180:195]
    s_waitcnt lgkmcnt(6)
    ds_read_b64_tr_b16 a[104:105], v236 offset:12288
    ds_read_b64_tr_b16 a[106:107], v236 offset:13312
    v_rcp_f32 v206, v206
    v_rcp_f32 v207, v207
    v_mul_f32 v76, v172, v204
    v_mfma_f32_32x32x16_bf16 v[180:195], a[120:123], a[48:51], v[180:195]
    ds_read_b64_tr_b16 a[108:109], v236 offset:14336
    ds_read_b64_tr_b16 a[110:111], v236 offset:15360
    v_mul_f32 v77, v173, v205
    v_mul_f32 v78, v174, v206
    v_mul_f32 v79, v175, v207
    v_add_f32 v244, v244, v76
    v_fmac_f32 v245, v76, v76
    v_mfma_f32_32x32x16_bf16 v[180:195], a[124:127], a[52:55], v[180:195]
    s_waitcnt lgkmcnt(6)
    ds_read_b64_tr_b16 a[112:113], v236 offset:16384
    ds_read_b64_tr_b16 a[114:115], v236 offset:17408
    v_add_f32 v244, v244, v77
    v_fmac_f32 v245, v77, v77
    v_add_f32 v244, v244, v78
    v_fmac_f32 v245, v78, v78
    v_add_f32 v244, v244, v79
    v_mfma_f32_32x32x16_bf16 v[180:195], a[92:95], a[56:59], v[180:195]
    ds_read_b64_tr_b16 a[116:117], v236 offset:18432
    ds_read_b64_tr_b16 a[118:119], v236 offset:19456
    v_fmac_f32 v245, v79, v79
    v_mul_f32 v208, v176, v176
    v_mul_f32 v209, v177, v177
    v_mul_f32 v210, v178, v178
    v_mul_f32 v211, v179, v179
    v_mfma_f32_32x32x16_bf16 v[180:195], a[96:99], a[60:63], v[180:195]
    s_waitcnt lgkmcnt(6)
    ds_read_b64_tr_b16 a[120:121], v236 offset:20480
    ds_read_b64_tr_b16 a[122:123], v236 offset:21504
    v_fma_f32 v208, v208, v251, v250
    v_fma_f32 v209, v209, v251, v250
    v_fma_f32 v210, v210, v251, v250
    v_fma_f32 v211, v211, v251, v250
    v_mul_f32 v208, v208, v176
    v_mfma_f32_32x32x16_bf16 v[180:195], a[100:103], a[64:67], v[180:195]
    ds_read_b64_tr_b16 a[124:125], v236 offset:22528
    ds_read_b64_tr_b16 a[126:127], v236 offset:23552
    v_mul_f32 v209, v209, v177
    v_mul_f32 v210, v210, v178
    v_mul_f32 v211, v211, v179
    v_exp_f32 v208, v208
    v_mfma_f32_32x32x16_bf16 v[180:195], a[104:107], a[68:71], v[180:195]
    s_waitcnt lgkmcnt(6)
    s_waitcnt vmcnt(3)
    s_barrier
    ds_read_b64_tr_b16 a[92:93], v233 offset:24576
    ds_read_b64_tr_b16 a[94:95], v233 offset:25600
    v_exp_f32 v209, v209
    v_exp_f32 v210, v210
    v_add_f32 v208, 1.0, v208
    v_mfma_f32_32x32x16_bf16 v[180:195], a[108:111], a[72:75], v[180:195]
    ds_read_b64_tr_b16 a[96:97], v233 offset:26624
    ds_read_b64_tr_b16 a[98:99], v233 offset:27648
    v_exp_f32 v211, v211
    v_add_f32 v209, 1.0, v209
    v_add_f32 v210, 1.0, v210
    v_add_f32 v211, 1.0, v211
    v_mfma_f32_32x32x16_bf16 v[180:195], a[112:115], a[76:79], v[180:195]
    s_waitcnt lgkmcnt(6)
    ds_read_b64_tr_b16 a[100:101], v233 offset:28672
    ds_read_b64_tr_b16 a[102:103], v233 offset:29696
    v_rcp_f32 v208, v208
    v_rcp_f32 v209, v209
    v_mul_f32 v80, v176, v208
    v_mfma_f32_32x32x16_bf16 v[180:195], a[116:119], a[80:83], v[180:195]
    ds_read_b64_tr_b16 a[104:105], v233 offset:30720
    ds_read_b64_tr_b16 a[106:107], v233 offset:31744
    v_rcp_f32 v210, v210
    v_rcp_f32 v211, v211
    v_mul_f32 v81, v177, v209
    v_mfma_f32_32x32x16_bf16 v[180:195], a[120:123], a[84:87], v[180:195]
    s_waitcnt lgkmcnt(6)
    ds_read_b64_tr_b16 a[108:109], v233 offset:32768
    ds_read_b64_tr_b16 a[110:111], v233 offset:33792
    v_mul_f32 v82, v178, v210
    v_mul_f32 v83, v179, v211
    v_add_f32 v244, v244, v80
    v_fmac_f32 v245, v80, v80
    v_add_f32 v244, v244, v81
    v_mfma_f32_32x32x16_bf16 v[180:195], a[124:127], a[88:91], v[180:195]
    ds_read_b64_tr_b16 a[112:113], v233 offset:34816
    ds_read_b64_tr_b16 a[114:115], v233 offset:35840
    v_fmac_f32 v245, v81, v81
    v_add_f32 v244, v244, v82
    v_fmac_f32 v245, v82, v82
    v_add_f32 v244, v244, v83
    v_fmac_f32 v245, v83, v83
    s_barrier
    v_mfma_f32_32x32x16_bf16 v[164:179], a[92:95], v[0:3], 0
    s_waitcnt lgkmcnt(6)
    s_add_u32 m0, s57, 0
    s_mul_i32 s56, s28, 1327104
    s_add_u32 s56, s56, s34
    ds_read_b64_tr_b16 a[116:117], v233 offset:36864
    ds_read_b64_tr_b16 a[118:119], v233 offset:37888
    v_mfma_f32_32x32x16_bf16 v[164:179], a[96:99], v[4:7], v[164:179]
    buffer_load_dwordx4 v224, s[12:15], s56 offen offset:0  lds
    ds_read_b64_tr_b16 a[120:121], v233 offset:38912
    ds_read_b64_tr_b16 a[122:123], v233 offset:39936
    v_mfma_f32_32x32x16_bf16 v[164:179], a[100:103], v[8:11], v[164:179]
    s_waitcnt lgkmcnt(6)
    buffer_load_dwordx4 v225, s[12:15], s56 offen offset:1024  lds
    ds_read_b64_tr_b16 a[124:125], v233 offset:40960
    ds_read_b64_tr_b16 a[126:127], v233 offset:41984
    v_mfma_f32_32x32x16_bf16 v[164:179], a[104:107], v[12:15], v[164:179]
    ds_read_b64_tr_b16 a[92:93], v233 offset:43008
    ds_read_b64_tr_b16 a[94:95], v233 offset:44032
    v_mfma_f32_32x32x16_bf16 v[164:179], a[108:111], v[16:19], v[164:179]
    s_waitcnt lgkmcnt(6)
    buffer_load_dwordx4 v226, s[12:15], s56 offen offset:2048  lds
    ds_read_b64_tr_b16 a[96:97], v233 offset:45056
    ds_read_b64_tr_b16 a[98:99], v233 offset:46080
    v_mfma_f32_32x32x16_bf16 v[164:179], a[112:115], v[20:23], v[164:179]
    ds_read_b64_tr_b16 a[100:101], v233 offset:47104
    ds_read_b64_tr_b16 a[102:103], v233 offset:48128
    v_mfma_f32_32x32x16_bf16 v[164:179], a[116:119], v[24:27], v[164:179]
    s_waitcnt lgkmcnt(6)
    buffer_load_dwordx4 v227, s[12:15], s56 offen offset:3072  lds
    ds_read_b64_tr_b16 a[104:105], v234 offset:0
    ds_read_b64_tr_b16 a[106:107], v234 offset:1024
    v_mfma_f32_32x32x16_bf16 v[164:179], a[120:123], v[28:31], v[164:179]
    s_add_u32 m0, s57, 4096
    s_add_u32 s56, s56, 294912
    ds_read_b64_tr_b16 a[108:109], v234 offset:2048
    ds_read_b64_tr_b16 a[110:111], v234 offset:3072
    v_mfma_f32_32x32x16_bf16 v[164:179], a[124:127], v[32:35], v[164:179]
    s_waitcnt lgkmcnt(6)
    buffer_load_dwordx4 v224, s[12:15], s56 offen offset:0  lds
    ds_read_b64_tr_b16 a[112:113], v234 offset:4096
    ds_read_b64_tr_b16 a[114:115], v234 offset:5120
    v_mfma_f32_32x32x16_bf16 v[164:179], a[92:95], v[36:39], v[164:179]
    ds_read_b64_tr_b16 a[116:117], v234 offset:6144
    ds_read_b64_tr_b16 a[118:119], v234 offset:7168
    v_mfma_f32_32x32x16_bf16 v[164:179], a[96:99], v[40:43], v[164:179]
    s_waitcnt lgkmcnt(6)
    buffer_load_dwordx4 v225, s[12:15], s56 offen offset:1024  lds
    ds_read_b64_tr_b16 a[120:121], v234 offset:8192
    ds_read_b64_tr_b16 a[122:123], v234 offset:9216
    v_mfma_f32_32x32x16_bf16 v[164:179], a[100:103], v[44:47], v[164:179]
    ds_read_b64_tr_b16 a[124:125], v234 offset:10240
    ds_read_b64_tr_b16 a[126:127], v234 offset:11264
    v_mfma_f32_32x32x16_bf16 v[164:179], a[104:107], v[48:51], v[164:179]
    s_waitcnt lgkmcnt(6)
    buffer_load_dwordx4 v226, s[12:15], s56 offen offset:2048  lds
    ds_read_b64_tr_b16 a[92:93], v234 offset:12288
    ds_read_b64_tr_b16 a[94:95], v234 offset:13312
    v_mfma_f32_32x32x16_bf16 v[164:179], a[108:111], a[0:3], v[164:179]
    ds_read_b64_tr_b16 a[96:97], v234 offset:14336
    ds_read_b64_tr_b16 a[98:99], v234 offset:15360
    v_mfma_f32_32x32x16_bf16 v[164:179], a[112:115], a[4:7], v[164:179]
    s_waitcnt lgkmcnt(6)
    buffer_load_dwordx4 v227, s[12:15], s56 offen offset:3072  lds
    ds_read_b64_tr_b16 a[100:101], v234 offset:16384
    ds_read_b64_tr_b16 a[102:103], v234 offset:17408
    v_mfma_f32_32x32x16_bf16 v[164:179], a[116:119], a[8:11], v[164:179]
    s_add_u32 m0, s57, 8192
    s_add_u32 s56, s56, 294912
    ds_read_b64_tr_b16 a[104:105], v234 offset:18432
    ds_read_b64_tr_b16 a[106:107], v234 offset:19456
    v_mfma_f32_32x32x16_bf16 v[164:179], a[120:123], a[12:15], v[164:179]
    s_waitcnt lgkmcnt(6)
    buffer_load_dwordx4 v224, s[12:15], s56 offen offset:0  lds
    ds_read_b64_tr_b16 a[108:109], v234 offset:20480
    ds_read_b64_tr_b16 a[110:111], v234 offset:21504
    v_mul_f32 v204, v180, v180
    v_mul_f32 v205, v181, v181
    v_mul_f32 v206, v182, v182
    v_mul_f32 v207, v183, v183
    v_fma_f32 v204, v204, v251, v250
    v_fma_f32 v205, v205, v251, v250
    v_fma_f32 v206, v206, v251, v250
    v_fma_f32 v207, v207, v251, v250
    v_mfma_f32_32x32x16_bf16 v[164:179], a[124:127], a[16:19], v[164:179]
    ds_read_b64_tr_b16 a[112:113], v234 offset:22528
    ds_read_b64_tr_b16 a[114:115], v234 offset:23552
    v_mul_f32 v204, v204, v180
    v_mul_f32 v205, v205, v181
    v_mul_f32 v206, v206, v182
    v_mul_f32 v207, v207, v183
    v_exp_f32 v204, v204
    v_exp_f32 v205, v205
    v_exp_f32 v206, v206
    v_mfma_f32_32x32x16_bf16 v[164:179], a[92:95], a[20:23], v[164:179]
    s_waitcnt lgkmcnt(6)
    buffer_load_dwordx4 v225, s[12:15], s56 offen offset:1024  lds
    ds_read_b64_tr_b16 a[116:117], v234 offset:24576
    ds_read_b64_tr_b16 a[118:119], v234 offset:25600
    v_exp_f32 v207, v207
    v_add_f32 v204, 1.0, v204
    v_add_f32 v205, 1.0, v205
    v_add_f32 v206, 1.0, v206
    v_add_f32 v207, 1.0, v207
    v_rcp_f32 v204, v204
    v_mfma_f32_32x32x16_bf16 v[164:179], a[96:99], a[24:27], v[164:179]
    ds_read_b64_tr_b16 a[120:121], v234 offset:26624
    ds_read_b64_tr_b16 a[122:123], v234 offset:27648
    v_rcp_f32 v205, v205
    v_rcp_f32 v206, v206
    v_rcp_f32 v207, v207
    v_mul_f32 v84, v180, v204
    v_mul_f32 v85, v181, v205
    v_mul_f32 v86, v182, v206
    v_mul_f32 v87, v183, v207
    v_mfma_f32_32x32x16_bf16 v[164:179], a[100:103], a[28:31], v[164:179]
    s_waitcnt lgkmcnt(6)
    buffer_load_dwordx4 v226, s[12:15], s56 offen offset:2048  lds
    ds_read_b64_tr_b16 a[124:125], v234 offset:28672
    ds_read_b64_tr_b16 a[126:127], v234 offset:29696
    v_add_f32 v244, v244, v84
    v_fmac_f32 v245, v84, v84
    v_add_f32 v244, v244, v85
    v_fmac_f32 v245, v85, v85
    v_add_f32 v244, v244, v86
    v_fmac_f32 v245, v86, v86
    v_add_f32 v244, v244, v87
    v_fmac_f32 v245, v87, v87
    v_mfma_f32_32x32x16_bf16 v[164:179], a[104:107], a[32:35], v[164:179]
    ds_read_b64_tr_b16 a[92:93], v234 offset:30720
    ds_read_b64_tr_b16 a[94:95], v234 offset:31744
    v_mul_f32 v208, v184, v184
    v_mul_f32 v209, v185, v185
    v_mul_f32 v210, v186, v186
    v_mul_f32 v211, v187, v187
    v_fma_f32 v208, v208, v251, v250
    v_fma_f32 v209, v209, v251, v250
    v_fma_f32 v210, v210, v251, v250
    v_fma_f32 v211, v211, v251, v250
    v_mul_f32 v208, v208, v184
    v_mul_f32 v209, v209, v185
    v_mfma_f32_32x32x16_bf16 v[164:179], a[108:111], a[36:39], v[164:179]
    s_waitcnt lgkmcnt(6)
    buffer_load_dwordx4 v227, s[12:15], s56 offen offset:3072  lds
    ds_read_b64_tr_b16 a[96:97], v234 offset:32768
    ds_read_b64_tr_b16 a[98:99], v234 offset:33792
    v_mul_f32 v210, v210, v186
    v_mul_f32 v211, v211, v187
    v_exp_f32 v208, v208
    v_exp_f32 v209, v209
    v_exp_f32 v210, v210
    v_mfma_f32_32x32x16_bf16 v[164:179], a[112:115], a[40:43], v[164:179]
    s_add_u32 m0, s57, 12288
    s_add_u32 s56, s56, 294912
    ds_read_b64_tr_b16 a[100:101], v234 offset:34816
    ds_read_b64_tr_b16 a[102:103], v234 offset:35840
    v_exp_f32 v211, v211
    v_add_f32 v208, 1.0, v208
    v_add_f32 v209, 1.0, v209
    v_add_f32 v210, 1.0, v210
    v_add_f32 v211, 1.0, v211
    v_rcp_f32 v208, v208
    v_mfma_f32_32x32x16_bf16 v[164:179], a[116:119], a[44:47], v[164:179]
    s_waitcnt lgkmcnt(6)
    buffer_load_dwordx4 v224, s[12:15], s56 offen offset:0  lds
    ds_read_b64_tr_b16 a[104:105], v234 offset:36864
    ds_read_b64_tr_b16 a[106:107], v234 offset:37888
    v_rcp_f32 v209, v209
    v_rcp_f32 v210, v210
    v_rcp_f32 v211, v211
    v_mul_f32 v88, v184, v208
    v_mul_f32 v89, v185, v209
    v_mfma_f32_32x32x16_bf16 v[164:179], a[120:123], a[48:51], v[164:179]
    ds_read_b64_tr_b16 a[108:109], v234 offset:38912
    ds_read_b64_tr_b16 a[110:111], v234 offset:39936
    v_mul_f32 v90, v186, v210
    v_mul_f32 v91, v187, v211
    v_add_f32 v244, v244, v88
    v_fmac_f32 v245, v88, v88
    v_add_f32 v244, v244, v89
    v_fmac_f32 v245, v89, v89
    v_add_f32 v244, v244, v90
    v_fmac_f32 v245, v90, v90
    v_add_f32 v244, v244, v91
    v_fmac_f32 v245, v91, v91
    v_mfma_f32_32x32x16_bf16 v[164:179], a[124:127], a[52:55], v[164:179]
    s_waitcnt lgkmcnt(6)
    buffer_load_dwordx4 v225, s[12:15], s56 offen offset:1024  lds
    ds_read_b64_tr_b16 a[112:113], v234 offset:40960
    ds_read_b64_tr_b16 a[114:115], v234 offset:41984
    v_mul_f32 v204, v188, v188
    v_mul_f32 v205, v189, v189
    v_mul_f32 v206, v190, v190
    v_mul_f32 v207, v191, v191
    v_fma_f32 v204, v204, v251, v250
    v_fma_f32 v205, v205, v251, v250
    v_fma_f32 v206, v206, v251, v250
    v_fma_f32 v207, v207, v251, v250
    v_mfma_f32_32x32x16_bf16 v[164:179], a[92:95], a[56:59], v[164:179]
    ds_read_b64_tr_b16 a[116:117], v234 offset:43008
    ds_read_b64_tr_b16 a[118:119], v234 offset:44032
    v_mul_f32 v204, v204, v188
    v_mul_f32 v205, v205, v189
    v_mul_f32 v206, v206, v190
    v_mul_f32 v207, v207, v191
    v_exp_f32 v204, v204
    v_exp_f32 v205, v205
    v_exp_f32 v206, v206
    v_mfma_f32_32x32x16_bf16 v[164:179], a[96:99], a[60:63], v[164:179]
    s_waitcnt lgkmcnt(6)
    buffer_load_dwordx4 v226, s[12:15], s56 offen offset:2048  lds
    ds_read_b64_tr_b16 a[120:121], v234 offset:45056
    ds_read_b64_tr_b16 a[122:123], v234 offset:46080
    v_exp_f32 v207, v207
    v_add_f32 v204, 1.0, v204
    v_add_f32 v205, 1.0, v205
    v_add_f32 v206, 1.0, v206
    v_add_f32 v207, 1.0, v207
    v_rcp_f32 v204, v204
    v_mfma_f32_32x32x16_bf16 v[164:179], a[100:103], a[64:67], v[164:179]
    ds_read_b64_tr_b16 a[124:125], v234 offset:47104
    ds_read_b64_tr_b16 a[126:127], v234 offset:48128
    v_rcp_f32 v205, v205
    v_rcp_f32 v206, v206
    v_rcp_f32 v207, v207
    v_mul_f32 v92, v188, v204
    v_mul_f32 v93, v189, v205
    v_mul_f32 v94, v190, v206
    v_mul_f32 v95, v191, v207
    v_mfma_f32_32x32x16_bf16 v[164:179], a[104:107], a[68:71], v[164:179]
    s_waitcnt lgkmcnt(6)
    buffer_load_dwordx4 v227, s[12:15], s56 offen offset:3072  lds
    ds_read_b64_tr_b16 a[92:93], v236 offset:24576
    ds_read_b64_tr_b16 a[94:95], v236 offset:25600
    v_add_f32 v244, v244, v92
    v_fmac_f32 v245, v92, v92
    v_add_f32 v244, v244, v93
    v_fmac_f32 v245, v93, v93
    v_add_f32 v244, v244, v94
    v_fmac_f32 v245, v94, v94
    v_add_f32 v244, v244, v95
    v_fmac_f32 v245, v95, v95
    v_mfma_f32_32x32x16_bf16 v[164:179], a[108:111], a[72:75], v[164:179]
    s_add_u32 m0, s57, 16384
    s_add_u32 s56, s56, 294912
    ds_read_b64_tr_b16 a[96:97], v236 offset:26624
    ds_read_b64_tr_b16 a[98:99], v236 offset:27648
    v_mul_f32 v208, v192, v192
    v_mul_f32 v209, v193, v193
    v_mul_f32 v210, v194, v194
    v_mul_f32 v211, v195, v195
    v_fma_f32 v208, v208, v251, v250
    v_fma_f32 v209, v209, v251, v250
    v_fma_f32 v210, v210, v251, v250
    v_fma_f32 v211, v211, v251, v250
    v_mul_f32 v208, v208, v192
    v_mfma_f32_32x32x16_bf16 v[164:179], a[112:115], a[76:79], v[164:179]
    s_waitcnt lgkmcnt(6)
    buffer_load_dwordx4 v224, s[12:15], s56 offen offset:0  lds
    ds_read_b64_tr_b16 a[100:101], v236 offset:28672
    ds_read_b64_tr_b16 a[102:103], v236 offset:29696
    v_mul_f32 v209, v209, v193
    v_mul_f32 v210, v210, v194
    v_mul_f32 v211, v211, v195
    v_exp_f32 v208, v208
    v_exp_f32 v209, v209
    v_add_f32 v208, 1.0, v208
    v_mfma_f32_32x32x16_bf16 v[164:179], a[116:119], a[80:83], v[164:179]
    ds_read_b64_tr_b16 a[104:105], v236 offset:30720
    ds_read_b64_tr_b16 a[106:107], v236 offset:31744
    v_exp_f32 v210, v210
    v_exp_f32 v211, v211
    v_add_f32 v209, 1.0, v209
    v_add_f32 v210, 1.0, v210
    v_add_f32 v211, 1.0, v211
    v_rcp_f32 v208, v208
    v_mfma_f32_32x32x16_bf16 v[164:179], a[120:123], a[84:87], v[164:179]
    s_waitcnt lgkmcnt(6)
    buffer_load_dwordx4 v225, s[12:15], s56 offen offset:1024  lds
    ds_read_b64_tr_b16 a[108:109], v236 offset:32768
    ds_read_b64_tr_b16 a[110:111], v236 offset:33792
    v_rcp_f32 v209, v209
    v_rcp_f32 v210, v210
    v_rcp_f32 v211, v211
    v_mul_f32 v96, v192, v208
    v_mul_f32 v97, v193, v209
    v_mfma_f32_32x32x16_bf16 v[164:179], a[124:127], a[88:91], v[164:179]
    ds_read_b64_tr_b16 a[112:113], v236 offset:34816
    ds_read_b64_tr_b16 a[114:115], v236 offset:35840
    v_mul_f32 v98, v194, v210
    v_mul_f32 v99, v195, v211
    v_add_f32 v244, v244, v96
    v_fmac_f32 v245, v96, v96
    v_add_f32 v244, v244, v97
    v_fmac_f32 v245, v97, v97
    v_add_f32 v244, v244, v98
    v_fmac_f32 v245, v98, v98
    v_add_f32 v244, v244, v99
    v_fmac_f32 v245, v99, v99
    v_mfma_f32_32x32x16_bf16 v[180:195], a[92:95], v[0:3], 0
    s_waitcnt lgkmcnt(6)
    ds_read_b64_tr_b16 a[116:117], v236 offset:36864
    ds_read_b64_tr_b16 a[118:119], v236 offset:37888
    v_mfma_f32_32x32x16_bf16 v[180:195], a[96:99], v[4:7], v[180:195]
    buffer_load_dword v252, v161, s[8:11], s37 offen
    buffer_load_dword v252, v161, s[8:11], s38 offen
    ds_read_b64_tr_b16 a[120:121], v236 offset:38912
    ds_read_b64_tr_b16 a[122:123], v236 offset:39936
    v_mfma_f32_32x32x16_bf16 v[180:195], a[100:103], v[8:11], v[180:195]
    s_waitcnt lgkmcnt(6)
    buffer_load_dword v252, v254, s[84:87], 0 offen offset:1024
    ds_read_b64_tr_b16 a[124:125], v236 offset:40960
    ds_read_b64_tr_b16 a[126:127], v236 offset:41984
    v_mul_f32 v204, v164, v164
    v_mul_f32 v205, v165, v165
    v_mul_f32 v206, v166, v166
    v_mul_f32 v207, v167, v167
    v_mfma_f32_32x32x16_bf16 v[180:195], a[104:107], v[12:15], v[180:195]
    ds_read_b64_tr_b16 a[92:93], v236 offset:43008
    ds_read_b64_tr_b16 a[94:95], v236 offset:44032
    v_fma_f32 v204, v204, v251, v250
    v_fma_f32 v205, v205, v251, v250
    v_fma_f32 v206, v206, v251, v250
    v_fma_f32 v207, v207, v251, v250
    v_mul_f32 v204, v204, v164
    v_mul_f32 v205, v205, v165
    v_mfma_f32_32x32x16_bf16 v[180:195], a[108:111], v[16:19], v[180:195]
    s_waitcnt lgkmcnt(6)
    ds_read_b64_tr_b16 a[96:97], v236 offset:45056
    ds_read_b64_tr_b16 a[98:99], v236 offset:46080
    v_mul_f32 v206, v206, v166
    v_mul_f32 v207, v207, v167
    v_exp_f32 v204, v204
    v_exp_f32 v205, v205
    v_mfma_f32_32x32x16_bf16 v[180:195], a[112:115], v[20:23], v[180:195]
    ds_read_b64_tr_b16 a[100:101], v236 offset:47104
    ds_read_b64_tr_b16 a[102:103], v236 offset:48128
    v_exp_f32 v206, v206
    v_exp_f32 v207, v207
    v_add_f32 v204, 1.0, v204
    v_add_f32 v205, 1.0, v205
    v_mfma_f32_32x32x16_bf16 v[180:195], a[116:119], v[24:27], v[180:195]
    s_waitcnt lgkmcnt(6)
    ds_read_b64_tr_b16 a[104:105], v237 offset:0
    ds_read_b64_tr_b16 a[106:107], v237 offset:1024
    v_add_f32 v206, 1.0, v206
    v_add_f32 v207, 1.0, v207
    v_rcp_f32 v204, v204
    v_rcp_f32 v205, v205
    v_mfma_f32_32x32x16_bf16 v[180:195], a[120:123], v[28:31], v[180:195]
    ds_read_b64_tr_b16 a[108:109], v237 offset:2048
    ds_read_b64_tr_b16 a[110:111], v237 offset:3072
    v_rcp_f32 v206, v206
    v_rcp_f32 v207, v207
    v_mul_f32 v100, v164, v204
    v_mul_f32 v101, v165, v205
    v_mfma_f32_32x32x16_bf16 v[180:195], a[124:127], v[32:35], v[180:195]
    s_waitcnt lgkmcnt(6)
    ds_read_b64_tr_b16 a[112:113], v237 offset:4096
    ds_read_b64_tr_b16 a[114:115], v237 offset:5120
    v_mul_f32 v102, v166, v206
    v_mul_f32 v103, v167, v207
    v_add_f32 v244, v244, v100
    v_fmac_f32 v245, v100, v100
    v_add_f32 v244, v244, v101
    v_fmac_f32 v245, v101, v101
    v_mfma_f32_32x32x16_bf16 v[180:195], a[92:95], v[36:39], v[180:195]
    ds_read_b64_tr_b16 a[116:117], v237 offset:6144
    ds_read_b64_tr_b16 a[118:119], v237 offset:7168
    v_add_f32 v244, v244, v102
    v_fmac_f32 v245, v102, v102
    v_add_f32 v244, v244, v103
    v_fmac_f32 v245, v103, v103
    v_mul_f32 v208, v168, v168
    v_mul_f32 v209, v169, v169
    v_mfma_f32_32x32x16_bf16 v[180:195], a[96:99], v[40:43], v[180:195]
    s_waitcnt lgkmcnt(6)
    ds_read_b64_tr_b16 a[120:121], v237 offset:8192
    ds_read_b64_tr_b16 a[122:123], v237 offset:9216
    v_mul_f32 v210, v170, v170
    v_mul_f32 v211, v171, v171
    v_fma_f32 v208, v208, v251, v250
    v_fma_f32 v209, v209, v251, v250
    v_fma_f32 v210, v210, v251, v250
    v_mfma_f32_32x32x16_bf16 v[180:195], a[100:103], v[44:47], v[180:195]
    ds_read_b64_tr_b16 a[124:125], v237 offset:10240
    ds_read_b64_tr_b16 a[126:127], v237 offset:11264
    v_fma_f32 v211, v211, v251, v250
    v_mul_f32 v208, v208, v168
    v_mul_f32 v209, v209, v169
    v_mul_f32 v210, v210, v170
    v_mul_f32 v211, v211, v171
    v_mfma_f32_32x32x16_bf16 v[180:195], a[104:107], v[48:51], v[180:195]
    s_waitcnt lgkmcnt(6)
    ds_read_b64_tr_b16 a[92:93], v237 offset:12288
    ds_read_b64_tr_b16 a[94:95], v237 offset:13312
    v_exp_f32 v208, v208
    v_exp_f32 v209, v209
    v_add_f32 v208, 1.0, v208
    v_mfma_f32_32x32x16_bf16 v[180:195], a[108:111], a[0:3], v[180:195]
    ds_read_b64_tr_b16 a[96:97], v237 offset:14336
    ds_read_b64_tr_b16 a[98:99], v237 offset:15360
    v_exp_f32 v210, v210
    v_exp_f32 v211, v211
    v_add_f32 v209, 1.0, v209
    v_mfma_f32_32x32x16_bf16 v[180:195], a[112:115], a[4:7], v[180:195]
    s_waitcnt lgkmcnt(6)
    ds_read_b64_tr_b16 a[100:101], v237 offset:16384
    ds_read_b64_tr_b16 a[102:103], v237 offset:17408
    v_add_f32 v210, 1.0, v210
    v_add_f32 v211, 1.0, v211
    v_rcp_f32 v208, v208
    v_mfma_f32_32x32x16_bf16 v[180:195], a[116:119], a[8:11], v[180:195]
    ds_read_b64_tr_b16 a[104:105], v237 offset:18432
    ds_read_b64_tr_b16 a[106:107], v237 offset:19456
    v_rcp_f32 v209, v209
    v_rcp_f32 v210, v210
    v_rcp_f32 v211, v211
    v_mfma_f32_32x32x16_bf16 v[180:195], a[120:123], a[12:15], v[180:195]
    s_waitcnt lgkmcnt(6)
    ds_read_b64_tr_b16 a[108:109], v237 offset:20480
    ds_read_b64_tr_b16 a[110:111], v237 offset:21504
    v_mul_f32 v104, v168, v208
    v_mul_f32 v105, v169, v209
    v_mul_f32 v106, v170, v210
    v_mul_f32 v107, v171, v211
    v_add_f32 v244, v244, v104
    v_mfma_f32_32x32x16_bf16 v[180:195], a[124:127], a[16:19], v[180:195]
    ds_read_b64_tr_b16 a[112:113], v237 offset:22528
    ds_read_b64_tr_b16 a[114:115], v237 offset:23552
    v_fmac_f32 v245, v104, v104
    v_add_f32 v244, v244, v105
    v_fmac_f32 v245, v105, v105
    v_add_f32 v244, v244, v106
    v_fmac_f32 v245, v106, v106
    v_mfma_f32_32x32x16_bf16 v[180:195], a[92:95], a[20:23], v[180:195]
    s_waitcnt lgkmcnt(6)
    ds_read_b64_tr_b16 a[116:117], v237 offset:24576
    ds_read_b64_tr_b16 a[118:119], v237 offset:25600
    v_add_f32 v244, v244, v107
    v_fmac_f32 v245, v107, v107
    v_mul_f32 v204, v172, v172
    v_mul_f32 v205, v173, v173
    v_mul_f32 v206, v174, v174
    v_mfma_f32_32x32x16_bf16 v[180:195], a[96:99], a[24:27], v[180:195]
    ds_read_b64_tr_b16 a[120:121], v237 offset:26624
    ds_read_b64_tr_b16 a[122:123], v237 offset:27648
    v_mul_f32 v207, v175, v175
    v_fma_f32 v204, v204, v251, v250
    v_fma_f32 v205, v205, v251, v250
    v_fma_f32 v206, v206, v251, v250
    v_fma_f32 v207, v207, v251, v250
    v_mfma_f32_32x32x16_bf16 v[180:195], a[100:103], a[28:31], v[180:195]
    s_waitcnt lgkmcnt(6)
    ds_read_b64_tr_b16 a[124:125], v237 offset:28672
    ds_read_b64_tr_b16 a[126:127], v237 offset:29696
    v_mul_f32 v204, v204, v172
    v_mul_f32 v205, v205, v173
    v_mul_f32 v206, v206, v174
    v_mul_f32 v207, v207, v175
    v_mfma_f32_32x32x16_bf16 v[180:195], a[104:107], a[32:35], v[180:195]
    ds_read_b64_tr_b16 a[92:93], v237 offset:30720
    ds_read_b64_tr_b16 a[94:95], v237 offset:31744
    v_exp_f32 v204, v204
    v_exp_f32 v205, v205
    v_exp_f32 v206, v206
    v_mfma_f32_32x32x16_bf16 v[180:195], a[108:111], a[36:39], v[180:195]
    s_waitcnt lgkmcnt(6)
    ds_read_b64_tr_b16 a[96:97], v237 offset:32768
    ds_read_b64_tr_b16 a[98:99], v237 offset:33792
    v_exp_f32 v207, v207
    v_add_f32 v204, 1.0, v204
    v_add_f32 v205, 1.0, v205
    v_add_f32 v206, 1.0, v206
    v_mfma_f32_32x32x16_bf16 v[180:195], a[112:115], a[40:43], v[180:195]
    ds_read_b64_tr_b16 a[100:101], v237 offset:34816
    ds_read_b64_tr_b16 a[102:103], v237 offset:35840
    v_add_f32 v207, 1.0, v207
    v_rcp_f32 v204, v204
    v_rcp_f32 v205, v205
    v_mfma_f32_32x32x16_bf16 v[180:195], a[116:119], a[44:47], v[180:195]
    s_waitcnt lgkmcnt(6)
    ds_read_b64_tr_b16 a[104:105], v237 offset:36864
    ds_read_b64_tr_b16 a[106:107], v237 offset:37888
    v_rcp_f32 v206, v206
    v_rcp_f32 v207, v207
    v_mul_f32 v108, v172, v204
    v_mfma_f32_32x32x16_bf16 v[180:195], a[120:123], a[48:51], v[180:195]
    ds_read_b64_tr_b16 a[108:109], v237 offset:38912
    ds_read_b64_tr_b16 a[110:111], v237 offset:39936
    v_mul_f32 v109, v173, v205
    v_mul_f32 v110, v174, v206
    v_mul_f32 v111, v175, v207
    v_add_f32 v244, v244, v108
    v_fmac_f32 v245, v108, v108
    v_mfma_f32_32x32x16_bf16 v[180:195], a[124:127], a[52:55], v[180:195]
    s_waitcnt lgkmcnt(6)
    ds_read_b64_tr_b16 a[112:113], v237 offset:40960
    ds_read_b64_tr_b16 a[114:115], v237 offset:41984
    v_add_f32 v244, v244, v109
    v_fmac_f32 v245, v109, v109
    v_add_f32 v244, v244, v110
    v_fmac_f32 v245, v110, v110
    v_add_f32 v244, v244, v111
    v_mfma_f32_32x32x16_bf16 v[180:195], a[92:95], a[56:59], v[180:195]
    ds_read_b64_tr_b16 a[116:117], v237 offset:43008
    ds_read_b64_tr_b16 a[118:119], v237 offset:44032
    v_fmac_f32 v245, v111, v111
    v_mul_f32 v208, v176, v176
    v_mul_f32 v209, v177, v177
    v_mul_f32 v210, v178, v178
    v_mul_f32 v211, v179, v179
    v_mfma_f32_32x32x16_bf16 v[180:195], a[96:99], a[60:63], v[180:195]
    s_waitcnt lgkmcnt(6)
    ds_read_b64_tr_b16 a[120:121], v237 offset:45056
    ds_read_b64_tr_b16 a[122:123], v237 offset:46080
    v_fma_f32 v208, v208, v251, v250
    v_fma_f32 v209, v209, v251, v250
    v_fma_f32 v210, v210, v251, v250
    v_fma_f32 v211, v211, v251, v250
    v_mul_f32 v208, v208, v176
    v_mfma_f32_32x32x16_bf16 v[180:195], a[100:103], a[64:67], v[180:195]
    ds_read_b64_tr_b16 a[124:125], v237 offset:47104
    ds_read_b64_tr_b16 a[126:127], v237 offset:48128
    v_mul_f32 v209, v209, v177
    v_mul_f32 v210, v210, v178
    v_mul_f32 v211, v211, v179
    v_exp_f32 v208, v208
    v_mfma_f32_32x32x16_bf16 v[180:195], a[104:107], a[68:71], v[180:195]
    s_waitcnt lgkmcnt(6)
    s_waitcnt vmcnt(3)
    s_barrier
    ds_read_b64_tr_b16 a[92:93], v232 offset:0
    ds_read_b64_tr_b16 a[94:95], v232 offset:1024
    v_exp_f32 v209, v209
    v_exp_f32 v210, v210
    v_add_f32 v208, 1.0, v208
    v_mfma_f32_32x32x16_bf16 v[180:195], a[108:111], a[72:75], v[180:195]
    ds_read_b64_tr_b16 a[96:97], v232 offset:2048
    ds_read_b64_tr_b16 a[98:99], v232 offset:3072
    v_exp_f32 v211, v211
    v_add_f32 v209, 1.0, v209
    v_add_f32 v210, 1.0, v210
    v_add_f32 v211, 1.0, v211
    v_mfma_f32_32x32x16_bf16 v[180:195], a[112:115], a[76:79], v[180:195]
    s_waitcnt lgkmcnt(6)
    ds_read_b64_tr_b16 a[100:101], v232 offset:4096
    ds_read_b64_tr_b16 a[102:103], v232 offset:5120
    v_rcp_f32 v208, v208
    v_rcp_f32 v209, v209
    v_mul_f32 v112, v176, v208
    v_mfma_f32_32x32x16_bf16 v[180:195], a[116:119], a[80:83], v[180:195]
    ds_read_b64_tr_b16 a[104:105], v232 offset:6144
    ds_read_b64_tr_b16 a[106:107], v232 offset:7168
    v_rcp_f32 v210, v210
    v_rcp_f32 v211, v211
    v_mul_f32 v113, v177, v209
    v_mfma_f32_32x32x16_bf16 v[180:195], a[120:123], a[84:87], v[180:195]
    s_waitcnt lgkmcnt(6)
    ds_read_b64_tr_b16 a[108:109], v232 offset:8192
    ds_read_b64_tr_b16 a[110:111], v232 offset:9216
    v_mul_f32 v114, v178, v210
    v_mul_f32 v115, v179, v211
    v_add_f32 v244, v244, v112
    v_fmac_f32 v245, v112, v112
    v_add_f32 v244, v244, v113
    v_mfma_f32_32x32x16_bf16 v[180:195], a[124:127], a[88:91], v[180:195]
    ds_read_b64_tr_b16 a[112:113], v232 offset:10240
    ds_read_b64_tr_b16 a[114:115], v232 offset:11264
    v_fmac_f32 v245, v113, v113
    v_add_f32 v244, v244, v114
    v_fmac_f32 v245, v114, v114
    v_add_f32 v244, v244, v115
    v_fmac_f32 v245, v115, v115
    s_barrier
    s_cmp_lt_u32 s29, 4
    s_cbranch_scc0 L1_B
    v_mfma_f32_32x32x16_bf16 v[164:179], a[92:95], v[0:3], 0
    s_waitcnt lgkmcnt(6)
    s_add_u32 m0, s57, 73728
    s_mul_i32 s56, s28, 497664
    s_add_u32 s56, s56, s35
    ds_read_b64_tr_b16 a[116:117], v232 offset:12288
    ds_read_b64_tr_b16 a[118:119], v232 offset:13312
    v_mfma_f32_32x32x16_bf16 v[164:179], a[96:99], v[4:7], v[164:179]
    buffer_load_dwordx4 v228, s[8:11], s56 offen offset:0  lds
    ds_read_b64_tr_b16 a[120:121], v232 offset:14336
    ds_read_b64_tr_b16 a[122:123], v232 offset:15360
    v_mfma_f32_32x32x16_bf16 v[164:179], a[100:103], v[8:11], v[164:179]
    s_waitcnt lgkmcnt(6)
    buffer_load_dwordx4 v229, s[8:11], s56 offen offset:1024  lds
    ds_read_b64_tr_b16 a[124:125], v232 offset:16384
    ds_read_b64_tr_b16 a[126:127], v232 offset:17408
    v_mfma_f32_32x32x16_bf16 v[164:179], a[104:107], v[12:15], v[164:179]
    ds_read_b64_tr_b16 a[92:93], v232 offset:18432
    ds_read_b64_tr_b16 a[94:95], v232 offset:19456
    v_mfma_f32_32x32x16_bf16 v[164:179], a[108:111], v[16:19], v[164:179]
    s_waitcnt lgkmcnt(6)
    buffer_load_dwordx4 v230, s[8:11], s56 offen offset:2048  lds
    ds_read_b64_tr_b16 a[96:97], v232 offset:20480
    ds_read_b64_tr_b16 a[98:99], v232 offset:21504
    v_mfma_f32_32x32x16_bf16 v[164:179], a[112:115], v[20:23], v[164:179]
    ds_read_b64_tr_b16 a[100:101], v232 offset:22528
    ds_read_b64_tr_b16 a[102:103], v232 offset:23552
    v_mfma_f32_32x32x16_bf16 v[164:179], a[116:119], v[24:27], v[164:179]
    s_waitcnt lgkmcnt(6)
    buffer_load_dwordx4 v231, s[8:11], s56 offen offset:3072  lds
    ds_read_b64_tr_b16 a[104:105], v232 offset:24576
    ds_read_b64_tr_b16 a[106:107], v232 offset:25600
    v_mfma_f32_32x32x16_bf16 v[164:179], a[120:123], v[28:31], v[164:179]
    s_add_u32 m0, s57, 77824
    s_add_u32 s56, s56, 110592
    ds_read_b64_tr_b16 a[108:109], v232 offset:26624
    ds_read_b64_tr_b16 a[110:111], v232 offset:27648
    v_mfma_f32_32x32x16_bf16 v[164:179], a[124:127], v[32:35], v[164:179]
    s_waitcnt lgkmcnt(6)
    buffer_load_dwordx4 v228, s[8:11], s56 offen offset:0  lds
    ds_read_b64_tr_b16 a[112:113], v232 offset:28672
    ds_read_b64_tr_b16 a[114:115], v232 offset:29696
    v_mfma_f32_32x32x16_bf16 v[164:179], a[92:95], v[36:39], v[164:179]
    ds_read_b64_tr_b16 a[116:117], v232 offset:30720
    ds_read_b64_tr_b16 a[118:119], v232 offset:31744
    v_mfma_f32_32x32x16_bf16 v[164:179], a[96:99], v[40:43], v[164:179]
    s_waitcnt lgkmcnt(6)
    buffer_load_dwordx4 v229, s[8:11], s56 offen offset:1024  lds
    ds_read_b64_tr_b16 a[120:121], v232 offset:32768
    ds_read_b64_tr_b16 a[122:123], v232 offset:33792
    v_mfma_f32_32x32x16_bf16 v[164:179], a[100:103], v[44:47], v[164:179]
    ds_read_b64_tr_b16 a[124:125], v232 offset:34816
    ds_read_b64_tr_b16 a[126:127], v232 offset:35840
    v_mfma_f32_32x32x16_bf16 v[164:179], a[104:107], v[48:51], v[164:179]
    s_waitcnt lgkmcnt(6)
    buffer_load_dwordx4 v230, s[8:11], s56 offen offset:2048  lds
    ds_read_b64_tr_b16 a[92:93], v232 offset:36864
    ds_read_b64_tr_b16 a[94:95], v232 offset:37888
    v_mfma_f32_32x32x16_bf16 v[164:179], a[108:111], a[0:3], v[164:179]
    ds_read_b64_tr_b16 a[96:97], v232 offset:38912
    ds_read_b64_tr_b16 a[98:99], v232 offset:39936
    v_mfma_f32_32x32x16_bf16 v[164:179], a[112:115], a[4:7], v[164:179]
    s_waitcnt lgkmcnt(6)
    buffer_load_dwordx4 v231, s[8:11], s56 offen offset:3072  lds
    ds_read_b64_tr_b16 a[100:101], v232 offset:40960
    ds_read_b64_tr_b16 a[102:103], v232 offset:41984
    v_mfma_f32_32x32x16_bf16 v[164:179], a[116:119], a[8:11], v[164:179]
    s_add_u32 m0, s57, 81920
    s_add_u32 s56, s56, 110592
    ds_read_b64_tr_b16 a[104:105], v232 offset:43008
    ds_read_b64_tr_b16 a[106:107], v232 offset:44032
    v_mfma_f32_32x32x16_bf16 v[164:179], a[120:123], a[12:15], v[164:179]
    s_waitcnt lgkmcnt(6)
    buffer_load_dwordx4 v228, s[8:11], s56 offen offset:0  lds
    ds_read_b64_tr_b16 a[108:109], v232 offset:45056
    ds_read_b64_tr_b16 a[110:111], v232 offset:46080
    v_mul_f32 v204, v180, v180
    v_mul_f32 v205, v181, v181
    v_mul_f32 v206, v182, v182
    v_mul_f32 v207, v183, v183
    v_fma_f32 v204, v204, v251, v250
    v_fma_f32 v205, v205, v251, v250
    v_fma_f32 v206, v206, v251, v250
    v_fma_f32 v207, v207, v251, v250
    v_mfma_f32_32x32x16_bf16 v[164:179], a[124:127], a[16:19], v[164:179]
    ds_read_b64_tr_b16 a[112:113], v232 offset:47104
    ds_read_b64_tr_b16 a[114:115], v232 offset:48128
    v_mul_f32 v204, v204, v180
    v_mul_f32 v205, v205, v181
    v_mul_f32 v206, v206, v182
    v_mul_f32 v207, v207, v183
    v_exp_f32 v204, v204
    v_exp_f32 v205, v205
    v_exp_f32 v206, v206
    v_mfma_f32_32x32x16_bf16 v[164:179], a[92:95], a[20:23], v[164:179]
    s_waitcnt lgkmcnt(6)
    buffer_load_dwordx4 v229, s[8:11], s56 offen offset:1024  lds
    ds_read_b64_tr_b16 a[116:117], v233 offset:0
    ds_read_b64_tr_b16 a[118:119], v233 offset:1024
    v_exp_f32 v207, v207
    v_add_f32 v204, 1.0, v204
    v_add_f32 v205, 1.0, v205
    v_add_f32 v206, 1.0, v206
    v_add_f32 v207, 1.0, v207
    v_rcp_f32 v204, v204
    v_mfma_f32_32x32x16_bf16 v[164:179], a[96:99], a[24:27], v[164:179]
    ds_read_b64_tr_b16 a[120:121], v233 offset:2048
    ds_read_b64_tr_b16 a[122:123], v233 offset:3072
    v_rcp_f32 v205, v205
    v_rcp_f32 v206, v206
    v_rcp_f32 v207, v207
    v_mul_f32 v116, v180, v204
    v_mul_f32 v117, v181, v205
    v_mul_f32 v118, v182, v206
    v_mul_f32 v119, v183, v207
    v_mfma_f32_32x32x16_bf16 v[164:179], a[100:103], a[28:31], v[164:179]
    s_waitcnt lgkmcnt(6)
    buffer_load_dwordx4 v230, s[8:11], s56 offen offset:2048  lds
    ds_read_b64_tr_b16 a[124:125], v233 offset:4096
    ds_read_b64_tr_b16 a[126:127], v233 offset:5120
    v_add_f32 v244, v244, v116
    v_fmac_f32 v245, v116, v116
    v_add_f32 v244, v244, v117
    v_fmac_f32 v245, v117, v117
    v_add_f32 v244, v244, v118
    v_fmac_f32 v245, v118, v118
    v_add_f32 v244, v244, v119
    v_fmac_f32 v245, v119, v119
    v_mfma_f32_32x32x16_bf16 v[164:179], a[104:107], a[32:35], v[164:179]
    ds_read_b64_tr_b16 a[92:93], v233 offset:6144
    ds_read_b64_tr_b16 a[94:95], v233 offset:7168
    v_mul_f32 v208, v184, v184
    v_mul_f32 v209, v185, v185
    v_mul_f32 v210, v186, v186
    v_mul_f32 v211, v187, v187
    v_fma_f32 v208, v208, v251, v250
    v_fma_f32 v209, v209, v251, v250
    v_fma_f32 v210, v210, v251, v250
    v_fma_f32 v211, v211, v251, v250
    v_mul_f32 v208, v208, v184
    v_mul_f32 v209, v209, v185
    v_mfma_f32_32x32x16_bf16 v[164:179], a[108:111], a[36:39], v[164:179]
    s_waitcnt lgkmcnt(6)
    buffer_load_dwordx4 v231, s[8:11], s56 offen offset:3072  lds
    ds_read_b64_tr_b16 a[96:97], v233 offset:8192
    ds_read_b64_tr_b16 a[98:99], v233 offset:9216
    v_mul_f32 v210, v210, v186
    v_mul_f32 v211, v211, v187
    v_exp_f32 v208, v208
    v_exp_f32 v209, v209
    v_exp_f32 v210, v210
    v_mfma_f32_32x32x16_bf16 v[164:179], a[112:115], a[40:43], v[164:179]
    s_add_u32 m0, s57, 86016
    s_add_u32 s56, s56, 110592
    ds_read_b64_tr_b16 a[100:101], v233 offset:10240
    ds_read_b64_tr_b16 a[102:103], v233 offset:11264
    v_exp_f32 v211, v211
    v_add_f32 v208, 1.0, v208
    v_add_f32 v209, 1.0, v209
    v_add_f32 v210, 1.0, v210
    v_add_f32 v211, 1.0, v211
    v_rcp_f32 v208, v208
    v_mfma_f32_32x32x16_bf16 v[164:179], a[116:119], a[44:47], v[164:179]
    s_waitcnt lgkmcnt(6)
    buffer_load_dwordx4 v228, s[8:11], s56 offen offset:0  lds
    ds_read_b64_tr_b16 a[104:105], v233 offset:12288
    ds_read_b64_tr_b16 a[106:107], v233 offset:13312
    v_rcp_f32 v209, v209
    v_rcp_f32 v210, v210
    v_rcp_f32 v211, v211
    v_mul_f32 v120, v184, v208
    v_mul_f32 v121, v185, v209
    v_mfma_f32_32x32x16_bf16 v[164:179], a[120:123], a[48:51], v[164:179]
    ds_read_b64_tr_b16 a[108:109], v233 offset:14336
    ds_read_b64_tr_b16 a[110:111], v233 offset:15360
    v_mul_f32 v122, v186, v210
    v_mul_f32 v123, v187, v211
    v_add_f32 v244, v244, v120
    v_fmac_f32 v245, v120, v120
    v_add_f32 v244, v244, v121
    v_fmac_f32 v245, v121, v121
    v_add_f32 v244, v244, v122
    v_fmac_f32 v245, v122, v122
    v_add_f32 v244, v244, v123
    v_fmac_f32 v245, v123, v123
    v_mfma_f32_32x32x16_bf16 v[164:179], a[124:127], a[52:55], v[164:179]
    s_waitcnt lgkmcnt(6)
    buffer_load_dwordx4 v229, s[8:11], s56 offen offset:1024  lds
    ds_read_b64_tr_b16 a[112:113], v233 offset:16384
    ds_read_b64_tr_b16 a[114:115], v233 offset:17408
    v_mul_f32 v204, v188, v188
    v_mul_f32 v205, v189, v189
    v_mul_f32 v206, v190, v190
    v_mul_f32 v207, v191, v191
    v_fma_f32 v204, v204, v251, v250
    v_fma_f32 v205, v205, v251, v250
    v_fma_f32 v206, v206, v251, v250
    v_fma_f32 v207, v207, v251, v250
    v_mfma_f32_32x32x16_bf16 v[164:179], a[92:95], a[56:59], v[164:179]
    ds_read_b64_tr_b16 a[116:117], v233 offset:18432
    ds_read_b64_tr_b16 a[118:119], v233 offset:19456
    v_mul_f32 v204, v204, v188
    v_mul_f32 v205, v205, v189
    v_mul_f32 v206, v206, v190
    v_mul_f32 v207, v207, v191
    v_exp_f32 v204, v204
    v_exp_f32 v205, v205
    v_exp_f32 v206, v206
    v_mfma_f32_32x32x16_bf16 v[164:179], a[96:99], a[60:63], v[164:179]
    s_waitcnt lgkmcnt(6)
    buffer_load_dwordx4 v230, s[8:11], s56 offen offset:2048  lds
    ds_read_b64_tr_b16 a[120:121], v233 offset:20480
    ds_read_b64_tr_b16 a[122:123], v233 offset:21504
    v_exp_f32 v207, v207
    v_add_f32 v204, 1.0, v204
    v_add_f32 v205, 1.0, v205
    v_add_f32 v206, 1.0, v206
    v_add_f32 v207, 1.0, v207
    v_rcp_f32 v204, v204
    v_mfma_f32_32x32x16_bf16 v[164:179], a[100:103], a[64:67], v[164:179]
    ds_read_b64_tr_b16 a[124:125], v233 offset:22528
    ds_read_b64_tr_b16 a[126:127], v233 offset:23552
    v_rcp_f32 v205, v205
    v_rcp_f32 v206, v206
    v_rcp_f32 v207, v207
    v_mul_f32 v124, v188, v204
    v_mul_f32 v125, v189, v205
    v_mul_f32 v126, v190, v206
    v_mul_f32 v127, v191, v207
    v_mfma_f32_32x32x16_bf16 v[164:179], a[104:107], a[68:71], v[164:179]
    s_waitcnt lgkmcnt(6)
    buffer_load_dwordx4 v231, s[8:11], s56 offen offset:3072  lds
    ds_read_b64_tr_b16 a[92:93], v235 offset:0
    ds_read_b64_tr_b16 a[94:95], v235 offset:1024
    v_add_f32 v244, v244, v124
    v_fmac_f32 v245, v124, v124
    v_add_f32 v244, v244, v125
    v_fmac_f32 v245, v125, v125
    v_add_f32 v244, v244, v126
    v_fmac_f32 v245, v126, v126
    v_add_f32 v244, v244, v127
    v_fmac_f32 v245, v127, v127
    v_mfma_f32_32x32x16_bf16 v[164:179], a[108:111], a[72:75], v[164:179]
    s_add_u32 m0, s57, 90112
    s_add_u32 s56, s56, 110592
    ds_read_b64_tr_b16 a[96:97], v235 offset:2048
    ds_read_b64_tr_b16 a[98:99], v235 offset:3072
    v_mul_f32 v208, v192, v192
    v_mul_f32 v209, v193, v193
    v_mul_f32 v210, v194, v194
    v_mul_f32 v211, v195, v195
    v_fma_f32 v208, v208, v251, v250
    v_fma_f32 v209, v209, v251, v250
    v_fma_f32 v210, v210, v251, v250
    v_fma_f32 v211, v211, v251, v250
    v_mul_f32 v208, v208, v192
    v_mfma_f32_32x32x16_bf16 v[164:179], a[112:115], a[76:79], v[164:179]
    s_waitcnt lgkmcnt(6)
    buffer_load_dwordx4 v228, s[8:11], s56 offen offset:0  lds
    ds_read_b64_tr_b16 a[100:101], v235 offset:4096
    ds_read_b64_tr_b16 a[102:103], v235 offset:5120
    v_mul_f32 v209, v209, v193
    v_mul_f32 v210, v210, v194
    v_mul_f32 v211, v211, v195
    v_exp_f32 v208, v208
    v_exp_f32 v209, v209
    v_add_f32 v208, 1.0, v208
    v_mfma_f32_32x32x16_bf16 v[164:179], a[116:119], a[80:83], v[164:179]
    ds_read_b64_tr_b16 a[104:105], v235 offset:6144
    ds_read_b64_tr_b16 a[106:107], v235 offset:7168
    v_exp_f32 v210, v210
    v_exp_f32 v211, v211
    v_add_f32 v209, 1.0, v209
    v_add_f32 v210, 1.0, v210
    v_add_f32 v211, 1.0, v211
    v_rcp_f32 v208, v208
    v_mfma_f32_32x32x16_bf16 v[164:179], a[120:123], a[84:87], v[164:179]
    s_waitcnt lgkmcnt(6)
    buffer_load_dwordx4 v229, s[8:11], s56 offen offset:1024  lds
    ds_read_b64_tr_b16 a[108:109], v235 offset:8192
    ds_read_b64_tr_b16 a[110:111], v235 offset:9216
    v_rcp_f32 v209, v209
    v_rcp_f32 v210, v210
    v_rcp_f32 v211, v211
    v_mul_f32 v128, v192, v208
    v_mul_f32 v129, v193, v209
    v_mfma_f32_32x32x16_bf16 v[164:179], a[124:127], a[88:91], v[164:179]
    ds_read_b64_tr_b16 a[112:113], v235 offset:10240
    ds_read_b64_tr_b16 a[114:115], v235 offset:11264
    v_mul_f32 v130, v194, v210
    v_mul_f32 v131, v195, v211
    v_add_f32 v244, v244, v128
    v_fmac_f32 v245, v128, v128
    v_add_f32 v244, v244, v129
    v_fmac_f32 v245, v129, v129
    v_add_f32 v244, v244, v130
    v_fmac_f32 v245, v130, v130
    v_add_f32 v244, v244, v131
    v_fmac_f32 v245, v131, v131
    v_mfma_f32_32x32x16_bf16 v[180:195], a[92:95], v[0:3], 0
    s_waitcnt lgkmcnt(6)
    ds_read_b64_tr_b16 a[116:117], v235 offset:12288
    ds_read_b64_tr_b16 a[118:119], v235 offset:13312
    v_mfma_f32_32x32x16_bf16 v[180:195], a[96:99], v[4:7], v[180:195]
    ds_read_b64_tr_b16 a[120:121], v235 offset:14336
    ds_read_b64_tr_b16 a[122:123], v235 offset:15360
    v_mfma_f32_32x32x16_bf16 v[180:195], a[100:103], v[8:11], v[180:195]
    s_waitcnt lgkmcnt(6)
    ds_read_b64_tr_b16 a[124:125], v235 offset:16384
    ds_read_b64_tr_b16 a[126:127], v235 offset:17408
    v_mul_f32 v204, v164, v164
    v_mul_f32 v205, v165, v165
    v_mul_f32 v206, v166, v166
    v_mul_f32 v207, v167, v167
    v_fma_f32 v204, v204, v251, v250
    v_fma_f32 v205, v205, v251, v250
    v_mfma_f32_32x32x16_bf16 v[180:195], a[104:107], v[12:15], v[180:195]
    ds_read_b64_tr_b16 a[92:93], v235 offset:18432
    ds_read_b64_tr_b16 a[94:95], v235 offset:19456
    v_fma_f32 v206, v206, v251, v250
    v_fma_f32 v207, v207, v251, v250
    v_mul_f32 v204, v204, v164
    v_mul_f32 v205, v205, v165
    v_mul_f32 v206, v206, v166
    v_mul_f32 v207, v207, v167
    v_mfma_f32_32x32x16_bf16 v[180:195], a[108:111], v[16:19], v[180:195]
    s_waitcnt lgkmcnt(6)
    ds_read_b64_tr_b16 a[96:97], v235 offset:20480
    ds_read_b64_tr_b16 a[98:99], v235 offset:21504
    v_exp_f32 v204, v204
    v_exp_f32 v205, v205
    v_exp_f32 v206, v206
    v_mfma_f32_32x32x16_bf16 v[180:195], a[112:115], v[20:23], v[180:195]
    ds_read_b64_tr_b16 a[100:101], v235 offset:22528
    ds_read_b64_tr_b16 a[102:103], v235 offset:23552
    v_exp_f32 v207, v207
    v_add_f32 v204, 1.0, v204
    v_add_f32 v205, 1.0, v205
    v_add_f32 v206, 1.0, v206
    v_add_f32 v207, 1.0, v207
    v_mfma_f32_32x32x16_bf16 v[180:195], a[116:119], v[24:27], v[180:195]
    s_waitcnt lgkmcnt(6)
    ds_read_b64_tr_b16 a[104:105], v235 offset:24576
    ds_read_b64_tr_b16 a[106:107], v235 offset:25600
    v_rcp_f32 v204, v204
    v_rcp_f32 v205, v205
    v_rcp_f32 v206, v206
    v_mfma_f32_32x32x16_bf16 v[180:195], a[120:123], v[28:31], v[180:195]
    ds_read_b64_tr_b16 a[108:109], v235 offset:26624
    ds_read_b64_tr_b16 a[110:111], v235 offset:27648
    v_rcp_f32 v207, v207
    v_mul_f32 v132, v164, v204
    v_mul_f32 v133, v165, v205
    v_mul_f32 v134, v166, v206
    v_mul_f32 v135, v167, v207
    v_mfma_f32_32x32x16_bf16 v[180:195], a[124:127], v[32:35], v[180:195]
    s_waitcnt lgkmcnt(6)
    ds_read_b64_tr_b16 a[112:113], v235 offset:28672
    ds_read_b64_tr_b16 a[114:115], v235 offset:29696
    v_add_f32 v244, v244, v132
    v_fmac_f32 v245, v132, v132
    v_add_f32 v244, v244, v133
    v_fmac_f32 v245, v133, v133
    v_add_f32 v244, v244, v134
    v_mfma_f32_32x32x16_bf16 v[180:195], a[92:95], v[36:39], v[180:195]
    ds_read_b64_tr_b16 a[116:117], v235 offset:30720
    ds_read_b64_tr_b16 a[118:119], v235 offset:31744
    v_fmac_f32 v245, v134, v134
    v_add_f32 v244, v244, v135
    v_fmac_f32 v245, v135, v135
    v_mul_f32 v208, v168, v168
    v_mul_f32 v209, v169, v169
    v_mfma_f32_32x32x16_bf16 v[180:195], a[96:99], v[40:43], v[180:195]
    s_waitcnt lgkmcnt(6)
    ds_read_b64_tr_b16 a[120:121], v235 offset:32768
    ds_read_b64_tr_b16 a[122:123], v235 offset:33792
    v_mul_f32 v210, v170, v170
    v_mul_f32 v211, v171, v171
    v_fma_f32 v208, v208, v251, v250
    v_fma_f32 v209, v209, v251, v250
    v_fma_f32 v210, v210, v251, v250
    v_mfma_f32_32x32x16_bf16 v[180:195], a[100:103], v[44:47], v[180:195]
    ds_read_b64_tr_b16 a[124:125], v235 offset:34816
    ds_read_b64_tr_b16 a[126:127], v235 offset:35840
    v_fma_f32 v211, v211, v251, v250
    v_mul_f32 v208, v208, v168
    v_mul_f32 v209, v209, v169
    v_mul_f32 v210, v210, v170
    v_mul_f32 v211, v211, v171
    v_mfma_f32_32x32x16_bf16 v[180:195], a[104:107], v[48:51], v[180:195]
    s_waitcnt lgkmcnt(6)
    ds_read_b64_tr_b16 a[92:93], v235 offset:36864
    ds_read_b64_tr_b16 a[94:95], v235 offset:37888
    v_exp_f32 v208, v208
    v_exp_f32 v209, v209
    v_add_f32 v208, 1.0, v208
    v_mfma_f32_32x32x16_bf16 v[180:195], a[108:111], a[0:3], v[180:195]
    ds_read_b64_tr_b16 a[96:97], v235 offset:38912
    ds_read_b64_tr_b16 a[98:99], v235 offset:39936
    v_exp_f32 v210, v210
    v_exp_f32 v211, v211
    v_add_f32 v209, 1.0, v209
    v_mfma_f32_32x32x16_bf16 v[180:195], a[112:115], a[4:7], v[180:195]
    s_waitcnt lgkmcnt(6)
    ds_read_b64_tr_b16 a[100:101], v235 offset:40960
    ds_read_b64_tr_b16 a[102:103], v235 offset:41984
    v_add_f32 v210, 1.0, v210
    v_add_f32 v211, 1.0, v211
    v_rcp_f32 v208, v208
    v_mfma_f32_32x32x16_bf16 v[180:195], a[116:119], a[8:11], v[180:195]
    ds_read_b64_tr_b16 a[104:105], v235 offset:43008
    ds_read_b64_tr_b16 a[106:107], v235 offset:44032
    v_rcp_f32 v209, v209
    v_rcp_f32 v210, v210
    v_rcp_f32 v211, v211
    v_mfma_f32_32x32x16_bf16 v[180:195], a[120:123], a[12:15], v[180:195]
    s_waitcnt lgkmcnt(6)
    ds_read_b64_tr_b16 a[108:109], v235 offset:45056
    ds_read_b64_tr_b16 a[110:111], v235 offset:46080
    v_mul_f32 v136, v168, v208
    v_mul_f32 v137, v169, v209
    v_mul_f32 v138, v170, v210
    v_mul_f32 v139, v171, v211
    v_add_f32 v244, v244, v136
    v_mfma_f32_32x32x16_bf16 v[180:195], a[124:127], a[16:19], v[180:195]
    ds_read_b64_tr_b16 a[112:113], v235 offset:47104
    ds_read_b64_tr_b16 a[114:115], v235 offset:48128
    v_fmac_f32 v245, v136, v136
    v_add_f32 v244, v244, v137
    v_fmac_f32 v245, v137, v137
    v_add_f32 v244, v244, v138
    v_fmac_f32 v245, v138, v138
    v_mfma_f32_32x32x16_bf16 v[180:195], a[92:95], a[20:23], v[180:195]
    s_waitcnt lgkmcnt(6)
    ds_read_b64_tr_b16 a[116:117], v236 offset:0
    ds_read_b64_tr_b16 a[118:119], v236 offset:1024
    v_add_f32 v244, v244, v139
    v_fmac_f32 v245, v139, v139
    v_mul_f32 v204, v172, v172
    v_mul_f32 v205, v173, v173
    v_mul_f32 v206, v174, v174
    v_mfma_f32_32x32x16_bf16 v[180:195], a[96:99], a[24:27], v[180:195]
    ds_read_b64_tr_b16 a[120:121], v236 offset:2048
    ds_read_b64_tr_b16 a[122:123], v236 offset:3072
    v_mul_f32 v207, v175, v175
    v_fma_f32 v204, v204, v251, v250
    v_fma_f32 v205, v205, v251, v250
    v_fma_f32 v206, v206, v251, v250
    v_fma_f32 v207, v207, v251, v250
    v_mfma_f32_32x32x16_bf16 v[180:195], a[100:103], a[28:31], v[180:195]
    s_waitcnt lgkmcnt(6)
    ds_read_b64_tr_b16 a[124:125], v236 offset:4096
    ds_read_b64_tr_b16 a[126:127], v236 offset:5120
    v_mul_f32 v204, v204, v172
    v_mul_f32 v205, v205, v173
    v_mul_f32 v206, v206, v174
    v_mul_f32 v207, v207, v175
    v_mfma_f32_32x32x16_bf16 v[180:195], a[104:107], a[32:35], v[180:195]
    ds_read_b64_tr_b16 a[92:93], v236 offset:6144
    ds_read_b64_tr_b16 a[94:95], v236 offset:7168
    v_exp_f32 v204, v204
    v_exp_f32 v205, v205
    v_exp_f32 v206, v206
    v_mfma_f32_32x32x16_bf16 v[180:195], a[108:111], a[36:39], v[180:195]
    s_waitcnt lgkmcnt(6)
    ds_read_b64_tr_b16 a[96:97], v236 offset:8192
    ds_read_b64_tr_b16 a[98:99], v236 offset:9216
    v_exp_f32 v207, v207
    v_add_f32 v204, 1.0, v204
    v_add_f32 v205, 1.0, v205
    v_add_f32 v206, 1.0, v206
    v_mfma_f32_32x32x16_bf16 v[180:195], a[112:115], a[40:43], v[180:195]
    ds_read_b64_tr_b16 a[100:101], v236 offset:10240
    ds_read_b64_tr_b16 a[102:103], v236 offset:11264
    v_add_f32 v207, 1.0, v207
    v_rcp_f32 v204, v204
    v_rcp_f32 v205, v205
    v_mfma_f32_32x32x16_bf16 v[180:195], a[116:119], a[44:47], v[180:195]
    s_waitcnt lgkmcnt(6)
    ds_read_b64_tr_b16 a[104:105], v236 offset:12288
    ds_read_b64_tr_b16 a[106:107], v236 offset:13312
    v_rcp_f32 v206, v206
    v_rcp_f32 v207, v207
    v_mul_f32 v140, v172, v204
    v_mfma_f32_32x32x16_bf16 v[180:195], a[120:123], a[48:51], v[180:195]
    ds_read_b64_tr_b16 a[108:109], v236 offset:14336
    ds_read_b64_tr_b16 a[110:111], v236 offset:15360
    v_mul_f32 v141, v173, v205
    v_mul_f32 v142, v174, v206
    v_mul_f32 v143, v175, v207
    v_add_f32 v244, v244, v140
    v_fmac_f32 v245, v140, v140
    v_mfma_f32_32x32x16_bf16 v[180:195], a[124:127], a[52:55], v[180:195]
    s_waitcnt lgkmcnt(6)
    ds_read_b64_tr_b16 a[112:113], v236 offset:16384
    ds_read_b64_tr_b16 a[114:115], v236 offset:17408
    v_add_f32 v244, v244, v141
    v_fmac_f32 v245, v141, v141
    v_add_f32 v244, v244, v142
    v_fmac_f32 v245, v142, v142
    v_add_f32 v244, v244, v143
    v_mfma_f32_32x32x16_bf16 v[180:195], a[92:95], a[56:59], v[180:195]
    ds_read_b64_tr_b16 a[116:117], v236 offset:18432
    ds_read_b64_tr_b16 a[118:119], v236 offset:19456
    v_fmac_f32 v245, v143, v143
    v_mul_f32 v208, v176, v176
    v_mul_f32 v209, v177, v177
    v_mul_f32 v210, v178, v178
    v_mul_f32 v211, v179, v179
    v_mfma_f32_32x32x16_bf16 v[180:195], a[96:99], a[60:63], v[180:195]
    s_waitcnt lgkmcnt(6)
    ds_read_b64_tr_b16 a[120:121], v236 offset:20480
    ds_read_b64_tr_b16 a[122:123], v236 offset:21504
    v_fma_f32 v208, v208, v251, v250
    v_fma_f32 v209, v209, v251, v250
    v_fma_f32 v210, v210, v251, v250
    v_fma_f32 v211, v211, v251, v250
    v_mul_f32 v208, v208, v176
    v_mfma_f32_32x32x16_bf16 v[180:195], a[100:103], a[64:67], v[180:195]
    ds_read_b64_tr_b16 a[124:125], v236 offset:22528
    ds_read_b64_tr_b16 a[126:127], v236 offset:23552
    v_mul_f32 v209, v209, v177
    v_mul_f32 v210, v210, v178
    v_mul_f32 v211, v211, v179
    v_exp_f32 v208, v208
    v_mfma_f32_32x32x16_bf16 v[180:195], a[104:107], a[68:71], v[180:195]
    s_waitcnt lgkmcnt(6)
    s_waitcnt vmcnt(0)
    s_barrier
    ds_read_b64_tr_b16 a[92:93], v233 offset:24576
    ds_read_b64_tr_b16 a[94:95], v233 offset:25600
    v_exp_f32 v209, v209
    v_exp_f32 v210, v210
    v_add_f32 v208, 1.0, v208
    v_mfma_f32_32x32x16_bf16 v[180:195], a[108:111], a[72:75], v[180:195]
    ds_read_b64_tr_b16 a[96:97], v233 offset:26624
    ds_read_b64_tr_b16 a[98:99], v233 offset:27648
    v_exp_f32 v211, v211
    v_add_f32 v209, 1.0, v209
    v_add_f32 v210, 1.0, v210
    v_add_f32 v211, 1.0, v211
    v_mfma_f32_32x32x16_bf16 v[180:195], a[112:115], a[76:79], v[180:195]
    s_waitcnt lgkmcnt(6)
    ds_read_b64_tr_b16 a[100:101], v233 offset:28672
    ds_read_b64_tr_b16 a[102:103], v233 offset:29696
    v_rcp_f32 v208, v208
    v_rcp_f32 v209, v209
    v_mul_f32 v144, v176, v208
    v_mfma_f32_32x32x16_bf16 v[180:195], a[116:119], a[80:83], v[180:195]
    ds_read_b64_tr_b16 a[104:105], v233 offset:30720
    ds_read_b64_tr_b16 a[106:107], v233 offset:31744
    v_rcp_f32 v210, v210
    v_rcp_f32 v211, v211
    v_mul_f32 v145, v177, v209
    v_mfma_f32_32x32x16_bf16 v[180:195], a[120:123], a[84:87], v[180:195]
    s_waitcnt lgkmcnt(6)
    ds_read_b64_tr_b16 a[108:109], v233 offset:32768
    ds_read_b64_tr_b16 a[110:111], v233 offset:33792
    v_mul_f32 v146, v178, v210
    v_mul_f32 v147, v179, v211
    v_add_f32 v244, v244, v144
    v_fmac_f32 v245, v144, v144
    v_add_f32 v244, v244, v145
    v_mfma_f32_32x32x16_bf16 v[180:195], a[124:127], a[88:91], v[180:195]
    ds_read_b64_tr_b16 a[112:113], v233 offset:34816
    ds_read_b64_tr_b16 a[114:115], v233 offset:35840
    v_fmac_f32 v245, v145, v145
    v_add_f32 v244, v244, v146
    v_fmac_f32 v245, v146, v146
    v_add_f32 v244, v244, v147
    v_fmac_f32 v245, v147, v147
    s_barrier
    v_mfma_f32_32x32x16_bf16 v[164:179], a[92:95], v[0:3], 0
    s_waitcnt lgkmcnt(6)
    s_add_u32 m0, s57, 0
    s_mul_i32 s56, s28, 497664
    s_add_u32 s56, s56, s36
    ds_read_b64_tr_b16 a[116:117], v233 offset:36864
    ds_read_b64_tr_b16 a[118:119], v233 offset:37888
    v_mfma_f32_32x32x16_bf16 v[164:179], a[96:99], v[4:7], v[164:179]
    buffer_load_dwordx4 v228, s[8:11], s56 offen offset:0  lds
    ds_read_b64_tr_b16 a[120:121], v233 offset:38912
    ds_read_b64_tr_b16 a[122:123], v233 offset:39936
    v_mfma_f32_32x32x16_bf16 v[164:179], a[100:103], v[8:11], v[164:179]
    s_waitcnt lgkmcnt(6)
    buffer_load_dwordx4 v229, s[8:11], s56 offen offset:1024  lds
    ds_read_b64_tr_b16 a[124:125], v233 offset:40960
    ds_read_b64_tr_b16 a[126:127], v233 offset:41984
    v_mfma_f32_32x32x16_bf16 v[164:179], a[104:107], v[12:15], v[164:179]
    ds_read_b64_tr_b16 a[92:93], v233 offset:43008
    ds_read_b64_tr_b16 a[94:95], v233 offset:44032
    v_mfma_f32_32x32x16_bf16 v[164:179], a[108:111], v[16:19], v[164:179]
    s_waitcnt lgkmcnt(6)
    buffer_load_dwordx4 v230, s[8:11], s56 offen offset:2048  lds
    ds_read_b64_tr_b16 a[96:97], v233 offset:45056
    ds_read_b64_tr_b16 a[98:99], v233 offset:46080
    v_mfma_f32_32x32x16_bf16 v[164:179], a[112:115], v[20:23], v[164:179]
    ds_read_b64_tr_b16 a[100:101], v233 offset:47104
    ds_read_b64_tr_b16 a[102:103], v233 offset:48128
    v_mfma_f32_32x32x16_bf16 v[164:179], a[116:119], v[24:27], v[164:179]
    s_waitcnt lgkmcnt(6)
    buffer_load_dwordx4 v231, s[8:11], s56 offen offset:3072  lds
    ds_read_b64_tr_b16 a[104:105], v234 offset:0
    ds_read_b64_tr_b16 a[106:107], v234 offset:1024
    v_mfma_f32_32x32x16_bf16 v[164:179], a[120:123], v[28:31], v[164:179]
    s_add_u32 m0, s57, 4096
    s_add_u32 s56, s56, 110592
    ds_read_b64_tr_b16 a[108:109], v234 offset:2048
    ds_read_b64_tr_b16 a[110:111], v234 offset:3072
    v_mfma_f32_32x32x16_bf16 v[164:179], a[124:127], v[32:35], v[164:179]
    s_waitcnt lgkmcnt(6)
    buffer_load_dwordx4 v228, s[8:11], s56 offen offset:0  lds
    ds_read_b64_tr_b16 a[112:113], v234 offset:4096
    ds_read_b64_tr_b16 a[114:115], v234 offset:5120
    v_mfma_f32_32x32x16_bf16 v[164:179], a[92:95], v[36:39], v[164:179]
    ds_read_b64_tr_b16 a[116:117], v234 offset:6144
    ds_read_b64_tr_b16 a[118:119], v234 offset:7168
    v_mfma_f32_32x32x16_bf16 v[164:179], a[96:99], v[40:43], v[164:179]
    s_waitcnt lgkmcnt(6)
    buffer_load_dwordx4 v229, s[8:11], s56 offen offset:1024  lds
    ds_read_b64_tr_b16 a[120:121], v234 offset:8192
    ds_read_b64_tr_b16 a[122:123], v234 offset:9216
    v_mfma_f32_32x32x16_bf16 v[164:179], a[100:103], v[44:47], v[164:179]
    ds_read_b64_tr_b16 a[124:125], v234 offset:10240
    ds_read_b64_tr_b16 a[126:127], v234 offset:11264
    v_mfma_f32_32x32x16_bf16 v[164:179], a[104:107], v[48:51], v[164:179]
    s_waitcnt lgkmcnt(6)
    buffer_load_dwordx4 v230, s[8:11], s56 offen offset:2048  lds
    ds_read_b64_tr_b16 a[92:93], v234 offset:12288
    ds_read_b64_tr_b16 a[94:95], v234 offset:13312
    v_mfma_f32_32x32x16_bf16 v[164:179], a[108:111], a[0:3], v[164:179]
    ds_read_b64_tr_b16 a[96:97], v234 offset:14336
    ds_read_b64_tr_b16 a[98:99], v234 offset:15360
    v_mfma_f32_32x32x16_bf16 v[164:179], a[112:115], a[4:7], v[164:179]
    s_waitcnt lgkmcnt(6)
    buffer_load_dwordx4 v231, s[8:11], s56 offen offset:3072  lds
    ds_read_b64_tr_b16 a[100:101], v234 offset:16384
    ds_read_b64_tr_b16 a[102:103], v234 offset:17408
    v_mfma_f32_32x32x16_bf16 v[164:179], a[116:119], a[8:11], v[164:179]
    s_add_u32 m0, s57, 8192
    s_add_u32 s56, s56, 110592
    ds_read_b64_tr_b16 a[104:105], v234 offset:18432
    ds_read_b64_tr_b16 a[106:107], v234 offset:19456
    v_mfma_f32_32x32x16_bf16 v[164:179], a[120:123], a[12:15], v[164:179]
    s_waitcnt lgkmcnt(6)
    buffer_load_dwordx4 v228, s[8:11], s56 offen offset:0  lds
    ds_read_b64_tr_b16 a[108:109], v234 offset:20480
    ds_read_b64_tr_b16 a[110:111], v234 offset:21504
    v_mul_f32 v204, v180, v180
    v_mul_f32 v205, v181, v181
    v_mul_f32 v206, v182, v182
    v_mul_f32 v207, v183, v183
    v_fma_f32 v204, v204, v251, v250
    v_fma_f32 v205, v205, v251, v250
    v_fma_f32 v206, v206, v251, v250
    v_fma_f32 v207, v207, v251, v250
    v_mfma_f32_32x32x16_bf16 v[164:179], a[124:127], a[16:19], v[164:179]
    ds_read_b64_tr_b16 a[112:113], v234 offset:22528
    ds_read_b64_tr_b16 a[114:115], v234 offset:23552
    v_mul_f32 v204, v204, v180
    v_mul_f32 v205, v205, v181
    v_mul_f32 v206, v206, v182
    v_mul_f32 v207, v207, v183
    v_exp_f32 v204, v204
    v_exp_f32 v205, v205
    v_exp_f32 v206, v206
    v_mfma_f32_32x32x16_bf16 v[164:179], a[92:95], a[20:23], v[164:179]
    s_waitcnt lgkmcnt(6)
    buffer_load_dwordx4 v229, s[8:11], s56 offen offset:1024  lds
    ds_read_b64_tr_b16 a[116:117], v234 offset:24576
    ds_read_b64_tr_b16 a[118:119], v234 offset:25600
    v_exp_f32 v207, v207
    v_add_f32 v204, 1.0, v204
    v_add_f32 v205, 1.0, v205
    v_add_f32 v206, 1.0, v206
    v_add_f32 v207, 1.0, v207
    v_rcp_f32 v204, v204
    v_mfma_f32_32x32x16_bf16 v[164:179], a[96:99], a[24:27], v[164:179]
    ds_read_b64_tr_b16 a[120:121], v234 offset:26624
    ds_read_b64_tr_b16 a[122:123], v234 offset:27648
    v_rcp_f32 v205, v205
    v_rcp_f32 v206, v206
    v_rcp_f32 v207, v207
    v_mul_f32 v148, v180, v204
    v_mul_f32 v149, v181, v205
    v_mul_f32 v150, v182, v206
    v_mul_f32 v151, v183, v207
    v_mfma_f32_32x32x16_bf16 v[164:179], a[100:103], a[28:31], v[164:179]
    s_waitcnt lgkmcnt(6)
    buffer_load_dwordx4 v230, s[8:11], s56 offen offset:2048  lds
    ds_read_b64_tr_b16 a[124:125], v234 offset:28672
    ds_read_b64_tr_b16 a[126:127], v234 offset:29696
    v_add_f32 v244, v244, v148
    v_fmac_f32 v245, v148, v148
    v_add_f32 v244, v244, v149
    v_fmac_f32 v245, v149, v149
    v_add_f32 v244, v244, v150
    v_fmac_f32 v245, v150, v150
    v_add_f32 v244, v244, v151
    v_fmac_f32 v245, v151, v151
    v_mfma_f32_32x32x16_bf16 v[164:179], a[104:107], a[32:35], v[164:179]
    ds_read_b64_tr_b16 a[92:93], v234 offset:30720
    ds_read_b64_tr_b16 a[94:95], v234 offset:31744
    v_mul_f32 v208, v184, v184
    v_mul_f32 v209, v185, v185
    v_mul_f32 v210, v186, v186
    v_mul_f32 v211, v187, v187
    v_fma_f32 v208, v208, v251, v250
    v_fma_f32 v209, v209, v251, v250
    v_fma_f32 v210, v210, v251, v250
    v_fma_f32 v211, v211, v251, v250
    v_mul_f32 v208, v208, v184
    v_mul_f32 v209, v209, v185
    v_mfma_f32_32x32x16_bf16 v[164:179], a[108:111], a[36:39], v[164:179]
    s_waitcnt lgkmcnt(6)
    buffer_load_dwordx4 v231, s[8:11], s56 offen offset:3072  lds
    ds_read_b64_tr_b16 a[96:97], v234 offset:32768
    ds_read_b64_tr_b16 a[98:99], v234 offset:33792
    v_mul_f32 v210, v210, v186
    v_mul_f32 v211, v211, v187
    v_exp_f32 v208, v208
    v_exp_f32 v209, v209
    v_exp_f32 v210, v210
    v_mfma_f32_32x32x16_bf16 v[164:179], a[112:115], a[40:43], v[164:179]
    s_add_u32 m0, s57, 12288
    s_add_u32 s56, s56, 110592
    ds_read_b64_tr_b16 a[100:101], v234 offset:34816
    ds_read_b64_tr_b16 a[102:103], v234 offset:35840
    v_exp_f32 v211, v211
    v_add_f32 v208, 1.0, v208
    v_add_f32 v209, 1.0, v209
    v_add_f32 v210, 1.0, v210
    v_add_f32 v211, 1.0, v211
    v_rcp_f32 v208, v208
    v_mfma_f32_32x32x16_bf16 v[164:179], a[116:119], a[44:47], v[164:179]
    s_waitcnt lgkmcnt(6)
    buffer_load_dwordx4 v228, s[8:11], s56 offen offset:0  lds
    ds_read_b64_tr_b16 a[104:105], v234 offset:36864
    ds_read_b64_tr_b16 a[106:107], v234 offset:37888
    v_rcp_f32 v209, v209
    v_rcp_f32 v210, v210
    v_rcp_f32 v211, v211
    v_mul_f32 v152, v184, v208
    v_mul_f32 v153, v185, v209
    v_mfma_f32_32x32x16_bf16 v[164:179], a[120:123], a[48:51], v[164:179]
    ds_read_b64_tr_b16 a[108:109], v234 offset:38912
    ds_read_b64_tr_b16 a[110:111], v234 offset:39936
    v_mul_f32 v154, v186, v210
    v_mul_f32 v155, v187, v211
    v_add_f32 v244, v244, v152
    v_fmac_f32 v245, v152, v152
    v_add_f32 v244, v244, v153
    v_fmac_f32 v245, v153, v153
    v_add_f32 v244, v244, v154
    v_fmac_f32 v245, v154, v154
    v_add_f32 v244, v244, v155
    v_fmac_f32 v245, v155, v155
    v_mfma_f32_32x32x16_bf16 v[164:179], a[124:127], a[52:55], v[164:179]
    s_waitcnt lgkmcnt(6)
    buffer_load_dwordx4 v229, s[8:11], s56 offen offset:1024  lds
    ds_read_b64_tr_b16 a[112:113], v234 offset:40960
    ds_read_b64_tr_b16 a[114:115], v234 offset:41984
    v_mul_f32 v204, v188, v188
    v_mul_f32 v205, v189, v189
    v_mul_f32 v206, v190, v190
    v_mul_f32 v207, v191, v191
    v_fma_f32 v204, v204, v251, v250
    v_fma_f32 v205, v205, v251, v250
    v_fma_f32 v206, v206, v251, v250
    v_fma_f32 v207, v207, v251, v250
    v_mfma_f32_32x32x16_bf16 v[164:179], a[92:95], a[56:59], v[164:179]
    ds_read_b64_tr_b16 a[116:117], v234 offset:43008
    ds_read_b64_tr_b16 a[118:119], v234 offset:44032
    v_mul_f32 v204, v204, v188
    v_mul_f32 v205, v205, v189
    v_mul_f32 v206, v206, v190
    v_mul_f32 v207, v207, v191
    v_exp_f32 v204, v204
    v_exp_f32 v205, v205
    v_exp_f32 v206, v206
    v_mfma_f32_32x32x16_bf16 v[164:179], a[96:99], a[60:63], v[164:179]
    s_waitcnt lgkmcnt(6)
    buffer_load_dwordx4 v230, s[8:11], s56 offen offset:2048  lds
    ds_read_b64_tr_b16 a[120:121], v234 offset:45056
    ds_read_b64_tr_b16 a[122:123], v234 offset:46080
    v_exp_f32 v207, v207
    v_add_f32 v204, 1.0, v204
    v_add_f32 v205, 1.0, v205
    v_add_f32 v206, 1.0, v206
    v_add_f32 v207, 1.0, v207
    v_rcp_f32 v204, v204
    v_mfma_f32_32x32x16_bf16 v[164:179], a[100:103], a[64:67], v[164:179]
    ds_read_b64_tr_b16 a[124:125], v234 offset:47104
    ds_read_b64_tr_b16 a[126:127], v234 offset:48128
    v_rcp_f32 v205, v205
    v_rcp_f32 v206, v206
    v_rcp_f32 v207, v207
    v_mul_f32 v156, v188, v204
    v_mul_f32 v157, v189, v205
    v_mul_f32 v158, v190, v206
    v_mul_f32 v159, v191, v207
    v_mfma_f32_32x32x16_bf16 v[164:179], a[104:107], a[68:71], v[164:179]
    s_waitcnt lgkmcnt(6)
    buffer_load_dwordx4 v231, s[8:11], s56 offen offset:3072  lds
    ds_read_b64_tr_b16 a[92:93], v236 offset:24576
    ds_read_b64_tr_b16 a[94:95], v236 offset:25600
    v_add_f32 v244, v244, v156
    v_fmac_f32 v245, v156, v156
    v_add_f32 v244, v244, v157
    v_fmac_f32 v245, v157, v157
    v_add_f32 v244, v244, v158
    v_fmac_f32 v245, v158, v158
    v_add_f32 v244, v244, v159
    v_fmac_f32 v245, v159, v159
    v_mfma_f32_32x32x16_bf16 v[164:179], a[108:111], a[72:75], v[164:179]
    s_add_u32 m0, s57, 16384
    s_add_u32 s56, s56, 110592
    ds_read_b64_tr_b16 a[96:97], v236 offset:26624
    ds_read_b64_tr_b16 a[98:99], v236 offset:27648
    v_mul_f32 v208, v192, v192
    v_mul_f32 v209, v193, v193
    v_mul_f32 v210, v194, v194
    v_mul_f32 v211, v195, v195
    v_fma_f32 v208, v208, v251, v250
    v_fma_f32 v209, v209, v251, v250
    v_fma_f32 v210, v210, v251, v250
    v_fma_f32 v211, v211, v251, v250
    v_mul_f32 v208, v208, v192
    v_mfma_f32_32x32x16_bf16 v[164:179], a[112:115], a[76:79], v[164:179]
    s_waitcnt lgkmcnt(6)
    buffer_load_dwordx4 v228, s[8:11], s56 offen offset:0  lds
    ds_read_b64_tr_b16 a[100:101], v236 offset:28672
    ds_read_b64_tr_b16 a[102:103], v236 offset:29696
    v_mul_f32 v209, v209, v193
    v_mul_f32 v210, v210, v194
    v_mul_f32 v211, v211, v195
    v_exp_f32 v208, v208
    v_exp_f32 v209, v209
    v_add_f32 v208, 1.0, v208
    v_mfma_f32_32x32x16_bf16 v[164:179], a[116:119], a[80:83], v[164:179]
    ds_read_b64_tr_b16 a[104:105], v236 offset:30720
    ds_read_b64_tr_b16 a[106:107], v236 offset:31744
    v_exp_f32 v210, v210
    v_exp_f32 v211, v211
    v_add_f32 v209, 1.0, v209
    v_add_f32 v210, 1.0, v210
    v_add_f32 v211, 1.0, v211
    v_rcp_f32 v208, v208
    v_mfma_f32_32x32x16_bf16 v[164:179], a[120:123], a[84:87], v[164:179]
    s_waitcnt lgkmcnt(6)
    buffer_load_dwordx4 v229, s[8:11], s56 offen offset:1024  lds
    ds_read_b64_tr_b16 a[108:109], v236 offset:32768
    ds_read_b64_tr_b16 a[110:111], v236 offset:33792
    v_rcp_f32 v209, v209
    v_rcp_f32 v210, v210
    v_rcp_f32 v211, v211
    v_mul_f32 v160, v192, v208
    v_mul_f32 v161, v193, v209
    v_mfma_f32_32x32x16_bf16 v[164:179], a[124:127], a[88:91], v[164:179]
    ds_read_b64_tr_b16 a[112:113], v236 offset:34816
    ds_read_b64_tr_b16 a[114:115], v236 offset:35840
    v_mul_f32 v162, v194, v210
    v_mul_f32 v163, v195, v211
    v_add_f32 v244, v244, v160
    v_fmac_f32 v245, v160, v160
    v_add_f32 v244, v244, v161
    v_fmac_f32 v245, v161, v161
    v_add_f32 v244, v244, v162
    v_fmac_f32 v245, v162, v162
    v_add_f32 v244, v244, v163
    v_fmac_f32 v245, v163, v163
    v_mov_b32 v204, v244
    v_mov_b32 v205, v245
    v_and_b32 v247, 31, v246
    v_permlane32_swap_b32 v204, v244
    v_permlane32_swap_b32 v205, v245
    v_lshlrev_b32 v247, 3, v247
    v_add_f32 v244, v244, v204
    v_add_f32 v245, v245, v205
    buffer_store_dwordx2 v[244:245], v247, s[16:19], s65 offen sc1
    s_lshl_b32 s59, s28, 6
    v_add_u32 v247, s59, v246
    v_lshlrev_b32 v247, 8, v247
    v_mov_b32 v255, 1
    s_cmp_eq_u32 s28, 0
    s_cselect_b32 s101, 16, 0
    v_mfma_f32_32x32x16_bf16 v[180:195], a[92:95], v[0:3], 0
    s_waitcnt lgkmcnt(6)
    ds_read_b64_tr_b16 a[116:117], v236 offset:36864
    ds_read_b64_tr_b16 a[118:119], v236 offset:37888
    v_mfma_f32_32x32x16_bf16 v[180:195], a[96:99], v[4:7], v[180:195]
    ds_read_b64_tr_b16 a[120:121], v236 offset:38912
    ds_read_b64_tr_b16 a[122:123], v236 offset:39936
    v_mfma_f32_32x32x16_bf16 v[180:195], a[100:103], v[8:11], v[180:195]
    s_waitcnt lgkmcnt(6)
    ds_read_b64_tr_b16 a[124:125], v236 offset:40960
    ds_read_b64_tr_b16 a[126:127], v236 offset:41984
    v_mul_f32 v222, s51, v221
    v_mul_f32 v204, v222, v164
    v_mul_f32 v205, v222, v165
    v_mul_f32 v206, v222, v166
    v_mfma_f32_32x32x16_bf16 v[180:195], a[104:107], v[12:15], v[180:195]
    ds_read_b64_tr_b16 a[92:93], v236 offset:43008
    ds_read_b64_tr_b16 a[94:95], v236 offset:44032
    v_mul_f32 v207, v222, v167
    v_cvt_pk_bf16_f32 v196, v204, v205
    v_cvt_pk_bf16_f32 v197, v206, v207
    v_mul_f32 v208, v222, v168
    v_mfma_f32_32x32x16_bf16 v[180:195], a[108:111], v[16:19], v[180:195]
    s_waitcnt lgkmcnt(6)
    ds_read_b64_tr_b16 a[96:97], v236 offset:45056
    ds_read_b64_tr_b16 a[98:99], v236 offset:46080
    v_mul_f32 v209, v222, v169
    v_mul_f32 v210, v222, v170
    v_mul_f32 v211, v222, v171
    v_cvt_pk_bf16_f32 v198, v208, v209
    v_mfma_f32_32x32x16_bf16 v[180:195], a[112:115], v[20:23], v[180:195]
    ds_read_b64_tr_b16 a[100:101], v236 offset:47104
    ds_read_b64_tr_b16 a[102:103], v236 offset:48128
    v_cvt_pk_bf16_f32 v199, v210, v211
    v_mul_f32 v204, v222, v172
    v_mul_f32 v205, v222, v173
    v_mul_f32 v206, v222, v174
    v_mfma_f32_32x32x16_bf16 v[180:195], a[116:119], v[24:27], v[180:195]
    s_waitcnt lgkmcnt(6)
    buffer_store_dwordx4 v[196:199], v238, s[16:19], s43 offen offset:0 sc1
    ds_read_b64_tr_b16 a[104:105], v237 offset:0
    ds_read_b64_tr_b16 a[106:107], v237 offset:1024
    v_mul_f32 v207, v222, v175
    v_cvt_pk_bf16_f32 v200, v204, v205
    v_mfma_f32_32x32x16_bf16 v[180:195], a[120:123], v[28:31], v[180:195]
    ds_read_b64_tr_b16 a[108:109], v237 offset:2048
    ds_read_b64_tr_b16 a[110:111], v237 offset:3072
    v_cvt_pk_bf16_f32 v201, v206, v207
    v_mul_f32 v208, v222, v176
    v_mul_f32 v209, v222, v177
    v_mul_f32 v210, v222, v178
    v_mfma_f32_32x32x16_bf16 v[180:195], a[124:127], v[32:35], v[180:195]
    s_waitcnt lgkmcnt(6)
    ds_read_b64_tr_b16 a[112:113], v237 offset:4096
    ds_read_b64_tr_b16 a[114:115], v237 offset:5120
    v_mul_f32 v211, v222, v179
    v_cvt_pk_bf16_f32 v202, v208, v209
    v_cvt_pk_bf16_f32 v203, v210, v211
    v_mfma_f32_32x32x16_bf16 v[180:195], a[92:95], v[36:39], v[180:195]
    buffer_store_dwordx4 v[200:203], v238, s[16:19], s43 offen offset:1024 sc1
    ds_read_b64_tr_b16 a[116:117], v237 offset:6144
    ds_read_b64_tr_b16 a[118:119], v237 offset:7168
    v_mfma_f32_32x32x16_bf16 v[180:195], a[96:99], v[40:43], v[180:195]
    s_waitcnt lgkmcnt(6)
    ds_read_b64_tr_b16 a[120:121], v237 offset:8192
    ds_read_b64_tr_b16 a[122:123], v237 offset:9216
    v_mfma_f32_32x32x16_bf16 v[180:195], a[100:103], v[44:47], v[180:195]
    ds_read_b64_tr_b16 a[124:125], v237 offset:10240
    ds_read_b64_tr_b16 a[126:127], v237 offset:11264
    v_mfma_f32_32x32x16_bf16 v[180:195], a[104:107], v[48:51], v[180:195]
    s_waitcnt lgkmcnt(6)
    ds_read_b64_tr_b16 a[92:93], v237 offset:12288
    ds_read_b64_tr_b16 a[94:95], v237 offset:13312
    v_mfma_f32_32x32x16_bf16 v[180:195], a[108:111], a[0:3], v[180:195]
    ds_read_b64_tr_b16 a[96:97], v237 offset:14336
    ds_read_b64_tr_b16 a[98:99], v237 offset:15360
    v_mfma_f32_32x32x16_bf16 v[180:195], a[112:115], a[4:7], v[180:195]
    s_waitcnt lgkmcnt(6)
    ds_read_b64_tr_b16 a[100:101], v237 offset:16384
    ds_read_b64_tr_b16 a[102:103], v237 offset:17408
    v_mfma_f32_32x32x16_bf16 v[180:195], a[116:119], a[8:11], v[180:195]
    ds_read_b64_tr_b16 a[104:105], v237 offset:18432
    ds_read_b64_tr_b16 a[106:107], v237 offset:19456
    v_mfma_f32_32x32x16_bf16 v[180:195], a[120:123], a[12:15], v[180:195]
    s_waitcnt lgkmcnt(6)
    ds_read_b64_tr_b16 a[108:109], v237 offset:20480
    ds_read_b64_tr_b16 a[110:111], v237 offset:21504
    v_mfma_f32_32x32x16_bf16 v[180:195], a[124:127], a[16:19], v[180:195]
    ds_read_b64_tr_b16 a[112:113], v237 offset:22528
    ds_read_b64_tr_b16 a[114:115], v237 offset:23552
    v_mfma_f32_32x32x16_bf16 v[180:195], a[92:95], a[20:23], v[180:195]
    s_waitcnt lgkmcnt(6)
    ds_read_b64_tr_b16 a[116:117], v237 offset:24576
    ds_read_b64_tr_b16 a[118:119], v237 offset:25600
    v_mfma_f32_32x32x16_bf16 v[180:195], a[96:99], a[24:27], v[180:195]
    ds_read_b64_tr_b16 a[120:121], v237 offset:26624
    ds_read_b64_tr_b16 a[122:123], v237 offset:27648
    v_mfma_f32_32x32x16_bf16 v[180:195], a[100:103], a[28:31], v[180:195]
    s_waitcnt lgkmcnt(6)
    ds_read_b64_tr_b16 a[124:125], v237 offset:28672
    ds_read_b64_tr_b16 a[126:127], v237 offset:29696
    v_mfma_f32_32x32x16_bf16 v[180:195], a[104:107], a[32:35], v[180:195]
    ds_read_b64_tr_b16 a[92:93], v237 offset:30720
    ds_read_b64_tr_b16 a[94:95], v237 offset:31744
    v_mfma_f32_32x32x16_bf16 v[180:195], a[108:111], a[36:39], v[180:195]
    s_waitcnt lgkmcnt(6)
    ds_read_b64_tr_b16 a[96:97], v237 offset:32768
    ds_read_b64_tr_b16 a[98:99], v237 offset:33792
    v_mfma_f32_32x32x16_bf16 v[180:195], a[112:115], a[40:43], v[180:195]
    ds_read_b64_tr_b16 a[100:101], v237 offset:34816
    ds_read_b64_tr_b16 a[102:103], v237 offset:35840
    v_mfma_f32_32x32x16_bf16 v[180:195], a[116:119], a[44:47], v[180:195]
    s_waitcnt lgkmcnt(6)
    ds_read_b64_tr_b16 a[104:105], v237 offset:36864
    ds_read_b64_tr_b16 a[106:107], v237 offset:37888
    v_mfma_f32_32x32x16_bf16 v[180:195], a[120:123], a[48:51], v[180:195]
    ds_read_b64_tr_b16 a[108:109], v237 offset:38912
    ds_read_b64_tr_b16 a[110:111], v237 offset:39936
    v_mfma_f32_32x32x16_bf16 v[180:195], a[124:127], a[52:55], v[180:195]
    s_waitcnt lgkmcnt(6)
    ds_read_b64_tr_b16 a[112:113], v237 offset:40960
    ds_read_b64_tr_b16 a[114:115], v237 offset:41984
    v_mfma_f32_32x32x16_bf16 v[180:195], a[92:95], a[56:59], v[180:195]
    ds_read_b64_tr_b16 a[116:117], v237 offset:43008
    ds_read_b64_tr_b16 a[118:119], v237 offset:44032
    v_mfma_f32_32x32x16_bf16 v[180:195], a[96:99], a[60:63], v[180:195]
    s_waitcnt lgkmcnt(6)
    ds_read_b64_tr_b16 a[120:121], v237 offset:45056
    ds_read_b64_tr_b16 a[122:123], v237 offset:46080
    v_mfma_f32_32x32x16_bf16 v[180:195], a[100:103], a[64:67], v[180:195]
    ds_read_b64_tr_b16 a[124:125], v237 offset:47104
    ds_read_b64_tr_b16 a[126:127], v237 offset:48128
    v_mfma_f32_32x32x16_bf16 v[180:195], a[104:107], a[68:71], v[180:195]
    s_waitcnt lgkmcnt(6)
    s_waitcnt vmcnt(2)
    s_barrier
    ds_read_b64_tr_b16 a[92:93], v232 offset:0
    ds_read_b64_tr_b16 a[94:95], v232 offset:1024
    v_mfma_f32_32x32x16_bf16 v[180:195], a[108:111], a[72:75], v[180:195]
    ds_read_b64_tr_b16 a[96:97], v232 offset:2048
    ds_read_b64_tr_b16 a[98:99], v232 offset:3072
    v_mfma_f32_32x32x16_bf16 v[180:195], a[112:115], a[76:79], v[180:195]
    s_waitcnt lgkmcnt(6)
    ds_read_b64_tr_b16 a[100:101], v232 offset:4096
    ds_read_b64_tr_b16 a[102:103], v232 offset:5120
    v_mfma_f32_32x32x16_bf16 v[180:195], a[116:119], a[80:83], v[180:195]
    ds_read_b64_tr_b16 a[104:105], v232 offset:6144
    ds_read_b64_tr_b16 a[106:107], v232 offset:7168
    v_mfma_f32_32x32x16_bf16 v[180:195], a[120:123], a[84:87], v[180:195]
    s_waitcnt lgkmcnt(6)
    ds_read_b64_tr_b16 a[108:109], v232 offset:8192
    ds_read_b64_tr_b16 a[110:111], v232 offset:9216
    v_mfma_f32_32x32x16_bf16 v[180:195], a[124:127], a[88:91], v[180:195]
    ds_read_b64_tr_b16 a[112:113], v232 offset:10240
    ds_read_b64_tr_b16 a[114:115], v232 offset:11264
    s_barrier
    v_mfma_f32_32x32x16_bf16 v[164:179], a[92:95], v[0:3], 0
    s_waitcnt lgkmcnt(6)
    s_add_u32 m0, s57, 73728
    s_mul_i32 s56, s28, 497664
    s_add_u32 s56, s56, s37
    ds_read_b64_tr_b16 a[116:117], v232 offset:12288
    ds_read_b64_tr_b16 a[118:119], v232 offset:13312
    v_mfma_f32_32x32x16_bf16 v[164:179], a[96:99], v[4:7], v[164:179]
    buffer_load_dwordx4 v228, s[8:11], s56 offen offset:0  lds
    ds_read_b64_tr_b16 a[120:121], v232 offset:14336
    ds_read_b64_tr_b16 a[122:123], v232 offset:15360
    v_mfma_f32_32x32x16_bf16 v[164:179], a[100:103], v[8:11], v[164:179]
    s_waitcnt lgkmcnt(6)
    buffer_load_dwordx4 v229, s[8:11], s56 offen offset:1024  lds
    ds_read_b64_tr_b16 a[124:125], v232 offset:16384
    ds_read_b64_tr_b16 a[126:127], v232 offset:17408
    v_mfma_f32_32x32x16_bf16 v[164:179], a[104:107], v[12:15], v[164:179]
    ds_read_b64_tr_b16 a[92:93], v232 offset:18432
    ds_read_b64_tr_b16 a[94:95], v232 offset:19456
    v_mfma_f32_32x32x16_bf16 v[164:179], a[108:111], v[16:19], v[164:179]
    s_waitcnt lgkmcnt(6)
    buffer_load_dwordx4 v230, s[8:11], s56 offen offset:2048  lds
    ds_read_b64_tr_b16 a[96:97], v232 offset:20480
    ds_read_b64_tr_b16 a[98:99], v232 offset:21504
    v_mfma_f32_32x32x16_bf16 v[164:179], a[112:115], v[20:23], v[164:179]
    ds_read_b64_tr_b16 a[100:101], v232 offset:22528
    ds_read_b64_tr_b16 a[102:103], v232 offset:23552
    v_mfma_f32_32x32x16_bf16 v[164:179], a[116:119], v[24:27], v[164:179]
    s_waitcnt lgkmcnt(6)
    buffer_load_dwordx4 v231, s[8:11], s56 offen offset:3072  lds
    ds_read_b64_tr_b16 a[104:105], v232 offset:24576
    ds_read_b64_tr_b16 a[106:107], v232 offset:25600
    v_mfma_f32_32x32x16_bf16 v[164:179], a[120:123], v[28:31], v[164:179]
    s_add_u32 m0, s57, 77824
    s_add_u32 s56, s56, 110592
    ds_read_b64_tr_b16 a[108:109], v232 offset:26624
    ds_read_b64_tr_b16 a[110:111], v232 offset:27648
    v_mfma_f32_32x32x16_bf16 v[164:179], a[124:127], v[32:35], v[164:179]
    s_waitcnt lgkmcnt(6)
    buffer_load_dwordx4 v228, s[8:11], s56 offen offset:0  lds
    ds_read_b64_tr_b16 a[112:113], v232 offset:28672
    ds_read_b64_tr_b16 a[114:115], v232 offset:29696
    v_mfma_f32_32x32x16_bf16 v[164:179], a[92:95], v[36:39], v[164:179]
    ds_read_b64_tr_b16 a[116:117], v232 offset:30720
    ds_read_b64_tr_b16 a[118:119], v232 offset:31744
    v_mfma_f32_32x32x16_bf16 v[164:179], a[96:99], v[40:43], v[164:179]
    s_waitcnt lgkmcnt(6)
    buffer_load_dwordx4 v229, s[8:11], s56 offen offset:1024  lds
    ds_read_b64_tr_b16 a[120:121], v232 offset:32768
    ds_read_b64_tr_b16 a[122:123], v232 offset:33792
    v_mfma_f32_32x32x16_bf16 v[164:179], a[100:103], v[44:47], v[164:179]
    ds_read_b64_tr_b16 a[124:125], v232 offset:34816
    ds_read_b64_tr_b16 a[126:127], v232 offset:35840
    v_mfma_f32_32x32x16_bf16 v[164:179], a[104:107], v[48:51], v[164:179]
    s_waitcnt lgkmcnt(6)
    buffer_load_dwordx4 v230, s[8:11], s56 offen offset:2048  lds
    ds_read_b64_tr_b16 a[92:93], v232 offset:36864
    ds_read_b64_tr_b16 a[94:95], v232 offset:37888
    v_mfma_f32_32x32x16_bf16 v[164:179], a[108:111], a[0:3], v[164:179]
    ds_read_b64_tr_b16 a[96:97], v232 offset:38912
    ds_read_b64_tr_b16 a[98:99], v232 offset:39936
    v_mfma_f32_32x32x16_bf16 v[164:179], a[112:115], a[4:7], v[164:179]
    s_waitcnt lgkmcnt(6)
    buffer_load_dwordx4 v231, s[8:11], s56 offen offset:3072  lds
    ds_read_b64_tr_b16 a[100:101], v232 offset:40960
    ds_read_b64_tr_b16 a[102:103], v232 offset:41984
    v_mfma_f32_32x32x16_bf16 v[164:179], a[116:119], a[8:11], v[164:179]
    s_add_u32 m0, s57, 81920
    s_add_u32 s56, s56, 110592
    ds_read_b64_tr_b16 a[104:105], v232 offset:43008
    ds_read_b64_tr_b16 a[106:107], v232 offset:44032
    v_mfma_f32_32x32x16_bf16 v[164:179], a[120:123], a[12:15], v[164:179]
    s_waitcnt lgkmcnt(6)
    buffer_load_dwordx4 v228, s[8:11], s56 offen offset:0  lds
    buffer_atomic_add v255, v247, s[20:23], s67 offen sc1
    ds_read_b64_tr_b16 a[108:109], v232 offset:45056
    ds_read_b64_tr_b16 a[110:111], v232 offset:46080
    v_mfma_f32_32x32x16_bf16 v[164:179], a[124:127], a[16:19], v[164:179]
    ds_read_b64_tr_b16 a[112:113], v232 offset:47104
    ds_read_b64_tr_b16 a[114:115], v232 offset:48128
    v_mul_f32 v222, s51, v221
    v_mul_f32 v204, v222, v180
    v_mul_f32 v205, v222, v181
    v_mul_f32 v206, v222, v182
    v_mfma_f32_32x32x16_bf16 v[164:179], a[92:95], a[20:23], v[164:179]
    s_waitcnt lgkmcnt(6)
    buffer_load_dwordx4 v229, s[8:11], s56 offen offset:1024  lds
    ds_read_b64_tr_b16 a[116:117], v233 offset:0
    ds_read_b64_tr_b16 a[118:119], v233 offset:1024
    v_mul_f32 v207, v222, v183
    v_cvt_pk_bf16_f32 v196, v204, v205
    v_mfma_f32_32x32x16_bf16 v[164:179], a[96:99], a[24:27], v[164:179]
    ds_read_b64_tr_b16 a[120:121], v233 offset:2048
    ds_read_b64_tr_b16 a[122:123], v233 offset:3072
    v_cvt_pk_bf16_f32 v197, v206, v207
    v_mul_f32 v208, v222, v184
    v_mul_f32 v209, v222, v185
    v_mul_f32 v210, v222, v186
    v_mfma_f32_32x32x16_bf16 v[164:179], a[100:103], a[28:31], v[164:179]
    s_waitcnt lgkmcnt(6)
    buffer_load_dwordx4 v230, s[8:11], s56 offen offset:2048  lds
    ds_read_b64_tr_b16 a[124:125], v233 offset:4096
    ds_read_b64_tr_b16 a[126:127], v233 offset:5120
    v_mul_f32 v211, v222, v187
    v_cvt_pk_bf16_f32 v198, v208, v209
    v_mfma_f32_32x32x16_bf16 v[164:179], a[104:107], a[32:35], v[164:179]
    ds_read_b64_tr_b16 a[92:93], v233 offset:6144
    ds_read_b64_tr_b16 a[94:95], v233 offset:7168
    v_cvt_pk_bf16_f32 v199, v210, v211
    v_mul_f32 v204, v222, v188
    v_mul_f32 v205, v222, v189
    v_mul_f32 v206, v222, v190
    v_mfma_f32_32x32x16_bf16 v[164:179], a[108:111], a[36:39], v[164:179]
    s_waitcnt lgkmcnt(6)
    buffer_load_dwordx4 v231, s[8:11], s56 offen offset:3072  lds
    buffer_store_dwordx4 v[196:199], v238, s[16:19], s43 offen offset:2048 sc1
    ds_read_b64_tr_b16 a[96:97], v233 offset:8192
    ds_read_b64_tr_b16 a[98:99], v233 offset:9216
    v_mfma_f32_32x32x16_bf16 v[164:179], a[112:115], a[40:43], v[164:179]
    s_add_u32 m0, s57, 86016
    s_add_u32 s56, s56, 110592
    ds_read_b64_tr_b16 a[100:101], v233 offset:10240
    ds_read_b64_tr_b16 a[102:103], v233 offset:11264
    v_mul_f32 v207, v222, v191
    v_cvt_pk_bf16_f32 v200, v204, v205
    v_cvt_pk_bf16_f32 v201, v206, v207
    v_mfma_f32_32x32x16_bf16 v[164:179], a[116:119], a[44:47], v[164:179]
    s_waitcnt lgkmcnt(6)
    buffer_load_dwordx4 v228, s[8:11], s56 offen offset:0  lds
    ds_read_b64_tr_b16 a[104:105], v233 offset:12288
    ds_read_b64_tr_b16 a[106:107], v233 offset:13312
    v_mul_f32 v208, v222, v192
    v_mul_f32 v209, v222, v193
    v_mfma_f32_32x32x16_bf16 v[164:179], a[120:123], a[48:51], v[164:179]
    ds_read_b64_tr_b16 a[108:109], v233 offset:14336
    ds_read_b64_tr_b16 a[110:111], v233 offset:15360
    v_mul_f32 v210, v222, v194
    v_mul_f32 v211, v222, v195
    v_cvt_pk_bf16_f32 v202, v208, v209
    v_cvt_pk_bf16_f32 v203, v210, v211
    v_mfma_f32_32x32x16_bf16 v[164:179], a[124:127], a[52:55], v[164:179]
    s_waitcnt lgkmcnt(6)
    buffer_load_dwordx4 v229, s[8:11], s56 offen offset:1024  lds
    buffer_store_dwordx4 v[200:203], v238, s[16:19], s43 offen offset:3072 sc1
    ds_read_b64_tr_b16 a[112:113], v233 offset:16384
    ds_read_b64_tr_b16 a[114:115], v233 offset:17408
    v_mfma_f32_32x32x16_bf16 v[164:179], a[92:95], a[56:59], v[164:179]
    ds_read_b64_tr_b16 a[116:117], v233 offset:18432
    ds_read_b64_tr_b16 a[118:119], v233 offset:19456
    v_mfma_f32_32x32x16_bf16 v[164:179], a[96:99], a[60:63], v[164:179]
    s_waitcnt lgkmcnt(6)
    buffer_load_dwordx4 v230, s[8:11], s56 offen offset:2048  lds
    ds_read_b64_tr_b16 a[120:121], v233 offset:20480
    ds_read_b64_tr_b16 a[122:123], v233 offset:21504
    v_mfma_f32_32x32x16_bf16 v[164:179], a[100:103], a[64:67], v[164:179]
    ds_read_b64_tr_b16 a[124:125], v233 offset:22528
    ds_read_b64_tr_b16 a[126:127], v233 offset:23552
    v_mfma_f32_32x32x16_bf16 v[164:179], a[104:107], a[68:71], v[164:179]
    s_waitcnt lgkmcnt(6)
    buffer_load_dwordx4 v231, s[8:11], s56 offen offset:3072  lds
    ds_read_b64_tr_b16 a[92:93], v235 offset:0
    ds_read_b64_tr_b16 a[94:95], v235 offset:1024
    v_mfma_f32_32x32x16_bf16 v[164:179], a[108:111], a[72:75], v[164:179]
    s_add_u32 m0, s57, 90112
    s_add_u32 s56, s56, 110592
    ds_read_b64_tr_b16 a[96:97], v235 offset:2048
    ds_read_b64_tr_b16 a[98:99], v235 offset:3072
    v_mfma_f32_32x32x16_bf16 v[164:179], a[112:115], a[76:79], v[164:179]
    s_waitcnt lgkmcnt(6)
    buffer_load_dwordx4 v228, s[8:11], s56 offen offset:0  lds
    ds_read_b64_tr_b16 a[100:101], v235 offset:4096
    ds_read_b64_tr_b16 a[102:103], v235 offset:5120
    v_mfma_f32_32x32x16_bf16 v[164:179], a[116:119], a[80:83], v[164:179]
    ds_read_b64_tr_b16 a[104:105], v235 offset:6144
    ds_read_b64_tr_b16 a[106:107], v235 offset:7168
    v_mfma_f32_32x32x16_bf16 v[164:179], a[120:123], a[84:87], v[164:179]
    s_waitcnt lgkmcnt(6)
    buffer_load_dwordx4 v229, s[8:11], s56 offen offset:1024  lds
    ds_read_b64_tr_b16 a[108:109], v235 offset:8192
    ds_read_b64_tr_b16 a[110:111], v235 offset:9216
    v_mfma_f32_32x32x16_bf16 v[164:179], a[124:127], a[88:91], v[164:179]
    ds_read_b64_tr_b16 a[112:113], v235 offset:10240
    ds_read_b64_tr_b16 a[114:115], v235 offset:11264
    v_mfma_f32_32x32x16_bf16 v[180:195], a[92:95], v[0:3], 0
    s_waitcnt lgkmcnt(6)
    ds_read_b64_tr_b16 a[116:117], v235 offset:12288
    ds_read_b64_tr_b16 a[118:119], v235 offset:13312
    v_and_b32 v254, 31, v246
    v_lshrrev_b32 v248, 5, v246
    v_lshlrev_b32 v254, 3, v254
    v_lshl_add_u32 v254, v248, 13, v254
    v_mfma_f32_32x32x16_bf16 v[180:195], a[96:99], v[4:7], v[180:195]
    ds_read_b64_tr_b16 a[120:121], v235 offset:14336
    ds_read_b64_tr_b16 a[122:123], v235 offset:15360
    v_mfma_f32_32x32x16_bf16 v[180:195], a[100:103], v[8:11], v[180:195]
    s_waitcnt lgkmcnt(6)
    buffer_load_dword v255, v247, s[20:23], s67 offen sc1
    ds_read_b64_tr_b16 a[124:125], v235 offset:16384
    ds_read_b64_tr_b16 a[126:127], v235 offset:17408
    v_mul_f32 v222, s52, v221
    v_mul_f32 v204, v222, v164
    v_mfma_f32_32x32x16_bf16 v[180:195], a[104:107], v[12:15], v[180:195]
    ds_read_b64_tr_b16 a[92:93], v235 offset:18432
    ds_read_b64_tr_b16 a[94:95], v235 offset:19456
    v_mul_f32 v205, v222, v165
    v_mul_f32 v206, v222, v166
    v_mul_f32 v207, v222, v167
    v_cvt_pk_bf16_f32 v196, v204, v205
    v_mfma_f32_32x32x16_bf16 v[180:195], a[108:111], v[16:19], v[180:195]
    s_waitcnt lgkmcnt(6)
    ds_read_b64_tr_b16 a[96:97], v235 offset:20480
    ds_read_b64_tr_b16 a[98:99], v235 offset:21504
    v_cvt_pk_bf16_f32 v197, v206, v207
    v_mul_f32 v208, v222, v168
    v_mul_f32 v209, v222, v169
    v_mul_f32 v210, v222, v170
    v_mfma_f32_32x32x16_bf16 v[180:195], a[112:115], v[20:23], v[180:195]
    ds_read_b64_tr_b16 a[100:101], v235 offset:22528
    ds_read_b64_tr_b16 a[102:103], v235 offset:23552
    v_mul_f32 v211, v222, v171
    v_cvt_pk_bf16_f32 v198, v208, v209
    v_cvt_pk_bf16_f32 v199, v210, v211
    v_mul_f32 v204, v222, v172
    v_mfma_f32_32x32x16_bf16 v[180:195], a[116:119], v[24:27], v[180:195]
    s_waitcnt lgkmcnt(6)
    buffer_store_dwordx4 v[196:199], v238, s[16:19], s44 offen offset:0 sc1
    ds_read_b64_tr_b16 a[104:105], v235 offset:24576
    ds_read_b64_tr_b16 a[106:107], v235 offset:25600
    v_mul_f32 v205, v222, v173
    v_mul_f32 v206, v222, v174
    v_mfma_f32_32x32x16_bf16 v[180:195], a[120:123], v[28:31], v[180:195]
    ds_read_b64_tr_b16 a[108:109], v235 offset:26624
    ds_read_b64_tr_b16 a[110:111], v235 offset:27648
    v_mul_f32 v207, v222, v175
    v_cvt_pk_bf16_f32 v200, v204, v205
    v_cvt_pk_bf16_f32 v201, v206, v207
    v_mul_f32 v208, v222, v176
    v_mfma_f32_32x32x16_bf16 v[180:195], a[124:127], v[32:35], v[180:195]
    s_waitcnt lgkmcnt(6)
    ds_read_b64_tr_b16 a[112:113], v235 offset:28672
    ds_read_b64_tr_b16 a[114:115], v235 offset:29696
    v_mul_f32 v209, v222, v177
    v_mul_f32 v210, v222, v178
    v_mul_f32 v211, v222, v179
    v_cvt_pk_bf16_f32 v202, v208, v209
    v_mfma_f32_32x32x16_bf16 v[180:195], a[92:95], v[36:39], v[180:195]
    ds_read_b64_tr_b16 a[116:117], v235 offset:30720
    ds_read_b64_tr_b16 a[118:119], v235 offset:31744
    v_cvt_pk_bf16_f32 v203, v210, v211
    v_mfma_f32_32x32x16_bf16 v[180:195], a[96:99], v[40:43], v[180:195]
    s_waitcnt lgkmcnt(6)
    buffer_store_dwordx4 v[200:203], v238, s[16:19], s44 offen offset:1024 sc1
    ds_read_b64_tr_b16 a[120:121], v235 offset:32768
    ds_read_b64_tr_b16 a[122:123], v235 offset:33792
    v_mfma_f32_32x32x16_bf16 v[180:195], a[100:103], v[44:47], v[180:195]
    ds_read_b64_tr_b16 a[124:125], v235 offset:34816
    ds_read_b64_tr_b16 a[126:127], v235 offset:35840
    v_mfma_f32_32x32x16_bf16 v[180:195], a[104:107], v[48:51], v[180:195]
    s_waitcnt lgkmcnt(6)
    ds_read_b64_tr_b16 a[92:93], v235 offset:36864
    ds_read_b64_tr_b16 a[94:95], v235 offset:37888
    v_mfma_f32_32x32x16_bf16 v[180:195], a[108:111], a[0:3], v[180:195]
    ds_read_b64_tr_b16 a[96:97], v235 offset:38912
    ds_read_b64_tr_b16 a[98:99], v235 offset:39936
    v_mfma_f32_32x32x16_bf16 v[180:195], a[112:115], a[4:7], v[180:195]
    s_waitcnt lgkmcnt(6)
    ds_read_b64_tr_b16 a[100:101], v235 offset:40960
    ds_read_b64_tr_b16 a[102:103], v235 offset:41984
    v_mfma_f32_32x32x16_bf16 v[180:195], a[116:119], a[8:11], v[180:195]
    ds_read_b64_tr_b16 a[104:105], v235 offset:43008
    ds_read_b64_tr_b16 a[106:107], v235 offset:44032
    v_mfma_f32_32x32x16_bf16 v[180:195], a[120:123], a[12:15], v[180:195]
    s_waitcnt lgkmcnt(6)
    ds_read_b64_tr_b16 a[108:109], v235 offset:45056
    ds_read_b64_tr_b16 a[110:111], v235 offset:46080
    v_mfma_f32_32x32x16_bf16 v[180:195], a[124:127], a[16:19], v[180:195]
    ds_read_b64_tr_b16 a[112:113], v235 offset:47104
    ds_read_b64_tr_b16 a[114:115], v235 offset:48128
    v_mfma_f32_32x32x16_bf16 v[180:195], a[92:95], a[20:23], v[180:195]
    s_waitcnt lgkmcnt(6)
    ds_read_b64_tr_b16 a[116:117], v236 offset:0
    ds_read_b64_tr_b16 a[118:119], v236 offset:1024
    v_mfma_f32_32x32x16_bf16 v[180:195], a[96:99], a[24:27], v[180:195]
    ds_read_b64_tr_b16 a[120:121], v236 offset:2048
    ds_read_b64_tr_b16 a[122:123], v236 offset:3072
    v_mfma_f32_32x32x16_bf16 v[180:195], a[100:103], a[28:31], v[180:195]
    s_waitcnt lgkmcnt(6)
    ds_read_b64_tr_b16 a[124:125], v236 offset:4096
    ds_read_b64_tr_b16 a[126:127], v236 offset:5120
    v_mfma_f32_32x32x16_bf16 v[180:195], a[104:107], a[32:35], v[180:195]
    ds_read_b64_tr_b16 a[92:93], v236 offset:6144
    ds_read_b64_tr_b16 a[94:95], v236 offset:7168
    v_mfma_f32_32x32x16_bf16 v[180:195], a[108:111], a[36:39], v[180:195]
    s_waitcnt lgkmcnt(6)
    ds_read_b64_tr_b16 a[96:97], v236 offset:8192
    ds_read_b64_tr_b16 a[98:99], v236 offset:9216
    v_mfma_f32_32x32x16_bf16 v[180:195], a[112:115], a[40:43], v[180:195]
    ds_read_b64_tr_b16 a[100:101], v236 offset:10240
    ds_read_b64_tr_b16 a[102:103], v236 offset:11264
    v_mfma_f32_32x32x16_bf16 v[180:195], a[116:119], a[44:47], v[180:195]
    s_waitcnt lgkmcnt(6)
    ds_read_b64_tr_b16 a[104:105], v236 offset:12288
    ds_read_b64_tr_b16 a[106:107], v236 offset:13312
    v_mfma_f32_32x32x16_bf16 v[180:195], a[120:123], a[48:51], v[180:195]
    ds_read_b64_tr_b16 a[108:109], v236 offset:14336
    ds_read_b64_tr_b16 a[110:111], v236 offset:15360
    v_mfma_f32_32x32x16_bf16 v[180:195], a[124:127], a[52:55], v[180:195]
    s_waitcnt lgkmcnt(6)
    s_waitcnt vmcnt(2)
    ds_read_b64_tr_b16 a[112:113], v236 offset:16384
    ds_read_b64_tr_b16 a[114:115], v236 offset:17408
    v_mfma_f32_32x32x16_bf16 v[180:195], a[92:95], a[56:59], v[180:195]
    v_readfirstlane_b32 s96, v255
    s_nop 0
    s_cmp_lt_u32 s96, s101
    s_cbranch_scc1 L1_poll_A
L1_poll_A_ok:
    ds_read_b64_tr_b16 a[116:117], v236 offset:18432
    ds_read_b64_tr_b16 a[118:119], v236 offset:19456
    v_mfma_f32_32x32x16_bf16 v[180:195], a[96:99], a[60:63], v[180:195]
    s_waitcnt lgkmcnt(6)
    s_add_u32 s97, s66, 4096
    ds_read_b64_tr_b16 a[120:121], v236 offset:20480
    ds_read_b64_tr_b16 a[122:123], v236 offset:21504
    v_mfma_f32_32x32x16_bf16 v[180:195], a[100:103], a[64:67], v[180:195]
    ds_read_b64_tr_b16 a[124:125], v236 offset:22528
    ds_read_b64_tr_b16 a[126:127], v236 offset:23552
    v_mfma_f32_32x32x16_bf16 v[180:195], a[104:107], a[68:71], v[180:195]
    s_waitcnt lgkmcnt(6)
    s_barrier
    ds_read_b64_tr_b16 a[92:93], v233 offset:24576
    ds_read_b64_tr_b16 a[94:95], v233 offset:25600
    v_mfma_f32_32x32x16_bf16 v[180:195], a[108:111], a[72:75], v[180:195]
    buffer_load_dwordx2 v[52:53], v254, s[16:19], s66 offen offset:0 sc1
    buffer_load_dwordx2 v[54:55], v254, s[16:19], s66 offen offset:1024 sc1
    ds_read_b64_tr_b16 a[96:97], v233 offset:26624
    ds_read_b64_tr_b16 a[98:99], v233 offset:27648
    v_mfma_f32_32x32x16_bf16 v[180:195], a[112:115], a[76:79], v[180:195]
    s_waitcnt lgkmcnt(6)
    buffer_load_dwordx2 v[56:57], v254, s[16:19], s66 offen offset:2048 sc1
    buffer_load_dwordx2 v[58:59], v254, s[16:19], s66 offen offset:3072 sc1
    ds_read_b64_tr_b16 a[100:101], v233 offset:28672
    ds_read_b64_tr_b16 a[102:103], v233 offset:29696
    v_mfma_f32_32x32x16_bf16 v[180:195], a[116:119], a[80:83], v[180:195]
    buffer_load_dwordx2 v[60:61], v254, s[16:19], s97 offen offset:0 sc1
    buffer_load_dwordx2 v[62:63], v254, s[16:19], s97 offen offset:1024 sc1
    ds_read_b64_tr_b16 a[104:105], v233 offset:30720
    ds_read_b64_tr_b16 a[106:107], v233 offset:31744
    v_mfma_f32_32x32x16_bf16 v[180:195], a[120:123], a[84:87], v[180:195]
    s_waitcnt lgkmcnt(6)
    buffer_load_dwordx2 v[64:65], v254, s[16:19], s97 offen offset:2048 sc1
    buffer_load_dwordx2 v[66:67], v254, s[16:19], s97 offen offset:3072 sc1
    ds_read_b64_tr_b16 a[108:109], v233 offset:32768
    ds_read_b64_tr_b16 a[110:111], v233 offset:33792
    v_mfma_f32_32x32x16_bf16 v[180:195], a[124:127], a[88:91], v[180:195]
    ds_read_b64_tr_b16 a[112:113], v233 offset:34816
    ds_read_b64_tr_b16 a[114:115], v233 offset:35840
    s_barrier
    v_mfma_f32_32x32x16_bf16 v[164:179], a[92:95], v[0:3], 0
    s_waitcnt lgkmcnt(6)
    ds_read_b64_tr_b16 a[116:117], v233 offset:36864
    ds_read_b64_tr_b16 a[118:119], v233 offset:37888
    v_mfma_f32_32x32x16_bf16 v[164:179], a[96:99], v[4:7], v[164:179]
    ds_read_b64_tr_b16 a[120:121], v233 offset:38912
    ds_read_b64_tr_b16 a[122:123], v233 offset:39936
    v_mfma_f32_32x32x16_bf16 v[164:179], a[100:103], v[8:11], v[164:179]
    s_waitcnt lgkmcnt(6)
    ds_read_b64_tr_b16 a[124:125], v233 offset:40960
    ds_read_b64_tr_b16 a[126:127], v233 offset:41984
    v_mul_f32 v222, s52, v221
    v_mul_f32 v204, v222, v180
    v_mul_f32 v205, v222, v181
    v_mul_f32 v206, v222, v182
    v_mfma_f32_32x32x16_bf16 v[164:179], a[104:107], v[12:15], v[164:179]
    ds_read_b64_tr_b16 a[92:93], v233 offset:43008
    ds_read_b64_tr_b16 a[94:95], v233 offset:44032
    v_mul_f32 v207, v222, v183
    v_cvt_pk_bf16_f32 v196, v204, v205
    v_cvt_pk_bf16_f32 v197, v206, v207
    v_mul_f32 v208, v222, v184
    v_mfma_f32_32x32x16_bf16 v[164:179], a[108:111], v[16:19], v[164:179]
    s_waitcnt lgkmcnt(6)
    ds_read_b64_tr_b16 a[96:97], v233 offset:45056
    ds_read_b64_tr_b16 a[98:99], v233 offset:46080
    v_mul_f32 v209, v222, v185
    v_mul_f32 v210, v222, v186
    v_mul_f32 v211, v222, v187
    v_cvt_pk_bf16_f32 v198, v208, v209
    v_mfma_f32_32x32x16_bf16 v[164:179], a[112:115], v[20:23], v[164:179]
    ds_read_b64_tr_b16 a[100:101], v233 offset:47104
    ds_read_b64_tr_b16 a[102:103], v233 offset:48128
    v_cvt_pk_bf16_f32 v199, v210, v211
    v_mul_f32 v204, v222, v188
    v_mul_f32 v205, v222, v189
    v_mul_f32 v206, v222, v190
    v_mfma_f32_32x32x16_bf16 v[164:179], a[116:119], v[24:27], v[164:179]
    s_waitcnt lgkmcnt(6)
    buffer_store_dwordx4 v[196:199], v238, s[16:19], s44 offen offset:2048 sc1
    ds_read_b64_tr_b16 a[104:105], v234 offset:0
    ds_read_b64_tr_b16 a[106:107], v234 offset:1024
    v_mul_f32 v207, v222, v191
    v_cvt_pk_bf16_f32 v200, v204, v205
    v_mfma_f32_32x32x16_bf16 v[164:179], a[120:123], v[28:31], v[164:179]
    ds_read_b64_tr_b16 a[108:109], v234 offset:2048
    ds_read_b64_tr_b16 a[110:111], v234 offset:3072
    v_cvt_pk_bf16_f32 v201, v206, v207
    v_mul_f32 v208, v222, v192
    v_mul_f32 v209, v222, v193
    v_mul_f32 v210, v222, v194
    v_mfma_f32_32x32x16_bf16 v[164:179], a[124:127], v[32:35], v[164:179]
    s_waitcnt lgkmcnt(6)
    ds_read_b64_tr_b16 a[112:113], v234 offset:4096
    ds_read_b64_tr_b16 a[114:115], v234 offset:5120
    v_mul_f32 v211, v222, v195
    v_cvt_pk_bf16_f32 v202, v208, v209
    v_cvt_pk_bf16_f32 v203, v210, v211
    v_mfma_f32_32x32x16_bf16 v[164:179], a[92:95], v[36:39], v[164:179]
    buffer_store_dwordx4 v[200:203], v238, s[16:19], s44 offen offset:3072 sc1
    ds_read_b64_tr_b16 a[116:117], v234 offset:6144
    ds_read_b64_tr_b16 a[118:119], v234 offset:7168
    v_mfma_f32_32x32x16_bf16 v[164:179], a[96:99], v[40:43], v[164:179]
    s_waitcnt lgkmcnt(6)
    ds_read_b64_tr_b16 a[120:121], v234 offset:8192
    ds_read_b64_tr_b16 a[122:123], v234 offset:9216
    v_mfma_f32_32x32x16_bf16 v[164:179], a[100:103], v[44:47], v[164:179]
    ds_read_b64_tr_b16 a[124:125], v234 offset:10240
    ds_read_b64_tr_b16 a[126:127], v234 offset:11264
    v_mfma_f32_32x32x16_bf16 v[164:179], a[104:107], v[48:51], v[164:179]
    s_waitcnt lgkmcnt(6)
    ds_read_b64_tr_b16 a[92:93], v234 offset:12288
    ds_read_b64_tr_b16 a[94:95], v234 offset:13312
    v_mfma_f32_32x32x16_bf16 v[164:179], a[108:111], a[0:3], v[164:179]
    ds_read_b64_tr_b16 a[96:97], v234 offset:14336
    ds_read_b64_tr_b16 a[98:99], v234 offset:15360
    v_mfma_f32_32x32x16_bf16 v[164:179], a[112:115], a[4:7], v[164:179]
    s_waitcnt lgkmcnt(6)
    ds_read_b64_tr_b16 a[100:101], v234 offset:16384
    ds_read_b64_tr_b16 a[102:103], v234 offset:17408
    v_mfma_f32_32x32x16_bf16 v[164:179], a[116:119], a[8:11], v[164:179]
    ds_read_b64_tr_b16 a[104:105], v234 offset:18432
    ds_read_b64_tr_b16 a[106:107], v234 offset:19456
    v_mfma_f32_32x32x16_bf16 v[164:179], a[120:123], a[12:15], v[164:179]
    s_waitcnt lgkmcnt(6)
    ds_read_b64_tr_b16 a[108:109], v234 offset:20480
    ds_read_b64_tr_b16 a[110:111], v234 offset:21504
    v_mfma_f32_32x32x16_bf16 v[164:179], a[124:127], a[16:19], v[164:179]
    ds_read_b64_tr_b16 a[112:113], v234 offset:22528
    ds_read_b64_tr_b16 a[114:115], v234 offset:23552
    v_mfma_f32_32x32x16_bf16 v[164:179], a[92:95], a[20:23], v[164:179]
    s_waitcnt lgkmcnt(6)
    ds_read_b64_tr_b16 a[116:117], v234 offset:24576
    ds_read_b64_tr_b16 a[118:119], v234 offset:25600
    v_mfma_f32_32x32x16_bf16 v[164:179], a[96:99], a[24:27], v[164:179]
    ds_read_b64_tr_b16 a[120:121], v234 offset:26624
    ds_read_b64_tr_b16 a[122:123], v234 offset:27648
    v_mfma_f32_32x32x16_bf16 v[164:179], a[100:103], a[28:31], v[164:179]
    s_waitcnt lgkmcnt(6)
    ds_read_b64_tr_b16 a[124:125], v234 offset:28672
    ds_read_b64_tr_b16 a[126:127], v234 offset:29696
    v_mfma_f32_32x32x16_bf16 v[164:179], a[104:107], a[32:35], v[164:179]
    ds_read_b64_tr_b16 a[92:93], v234 offset:30720
    ds_read_b64_tr_b16 a[94:95], v234 offset:31744
    v_mfma_f32_32x32x16_bf16 v[164:179], a[108:111], a[36:39], v[164:179]
    s_waitcnt lgkmcnt(6)
    s_waitcnt vmcnt(2)
    ds_read_b64_tr_b16 a[96:97], v234 offset:32768
    ds_read_b64_tr_b16 a[98:99], v234 offset:33792
    v_add_f32 v52, v52, v60
    v_add_f32 v53, v53, v61
    v_add_f32 v54, v54, v62
    v_mfma_f32_32x32x16_bf16 v[164:179], a[112:115], a[40:43], v[164:179]
    ds_read_b64_tr_b16 a[100:101], v234 offset:34816
    ds_read_b64_tr_b16 a[102:103], v234 offset:35840
    v_add_f32 v55, v55, v63
    v_add_f32 v56, v56, v64
    v_add_f32 v57, v57, v65
    v_add_f32 v58, v58, v66
    v_mfma_f32_32x32x16_bf16 v[164:179], a[116:119], a[44:47], v[164:179]
    s_waitcnt lgkmcnt(6)
    ds_read_b64_tr_b16 a[104:105], v234 offset:36864
    ds_read_b64_tr_b16 a[106:107], v234 offset:37888
    v_add_f32 v59, v59, v67
    v_add_f32 v52, v52, v56
    v_add_f32 v53, v53, v57
    v_add_f32 v54, v54, v58
    v_mfma_f32_32x32x16_bf16 v[164:179], a[120:123], a[48:51], v[164:179]
    ds_read_b64_tr_b16 a[108:109], v234 offset:38912
    ds_read_b64_tr_b16 a[110:111], v234 offset:39936
    v_add_f32 v55, v55, v59
    v_add_f32 v52, v52, v54
    v_add_f32 v53, v53, v55
    v_mov_b32 v54, v52
    v_mfma_f32_32x32x16_bf16 v[164:179], a[124:127], a[52:55], v[164:179]
    s_waitcnt lgkmcnt(6)
    ds_read_b64_tr_b16 a[112:113], v234 offset:40960
    ds_read_b64_tr_b16 a[114:115], v234 offset:41984
    v_mov_b32 v55, v53
    v_mfma_f32_32x32x16_bf16 v[164:179], a[92:95], a[56:59], v[164:179]
    ds_read_b64_tr_b16 a[116:117], v234 offset:43008
    ds_read_b64_tr_b16 a[118:119], v234 offset:44032
    v_mfma_f32_32x32x16_bf16 v[164:179], a[96:99], a[60:63], v[164:179]
    s_waitcnt lgkmcnt(6)
    ds_read_b64_tr_b16 a[120:121], v234 offset:45056
    ds_read_b64_tr_b16 a[122:123], v234 offset:46080
    v_permlane32_swap_b32 v54, v52
    v_permlane32_swap_b32 v55, v53
    v_mfma_f32_32x32x16_bf16 v[164:179], a[100:103], a[64:67], v[164:179]
    ds_read_b64_tr_b16 a[124:125], v234 offset:47104
    ds_read_b64_tr_b16 a[126:127], v234 offset:48128
    v_add_f32 v52, v52, v54
    v_add_f32 v53, v53, v55
    v_mul_f32 v52, 0x39e38e39, v52
    v_mul_f32 v53, 0x39e38e39, v53
    v_mfma_f32_32x32x16_bf16 v[164:179], a[104:107], a[68:71], v[164:179]
    s_waitcnt lgkmcnt(6)
    ds_read_b64_tr_b16 a[92:93], v236 offset:24576
    ds_read_b64_tr_b16 a[94:95], v236 offset:25600
    v_fma_f32 v53, -v52, v52, v53
    v_max_f32 v53, 0, v53
    v_add_f32 v53, v223, v53
    v_mfma_f32_32x32x16_bf16 v[164:179], a[108:111], a[72:75], v[164:179]
    ds_read_b64_tr_b16 a[96:97], v236 offset:26624
    ds_read_b64_tr_b16 a[98:99], v236 offset:27648
    v_rsq_f32 v248, v53
    v_mfma_f32_32x32x16_bf16 v[164:179], a[112:115], a[76:79], v[164:179]
    s_waitcnt lgkmcnt(6)
    ds_read_b64_tr_b16 a[100:101], v236 offset:28672
    ds_read_b64_tr_b16 a[102:103], v236 offset:29696
    v_mul_f32 v249, v52, v248
    v_sub_f32 v249, 0, v249
    v_fma_f32 v68, v68, v248, v249
    v_fma_f32 v69, v69, v248, v249
    v_mfma_f32_32x32x16_bf16 v[164:179], a[116:119], a[80:83], v[164:179]
    ds_read_b64_tr_b16 a[104:105], v236 offset:30720
    ds_read_b64_tr_b16 a[106:107], v236 offset:31744
    v_cvt_pk_bf16_f32 v68, v68, v69
    v_fma_f32 v70, v70, v248, v249
    v_fma_f32 v71, v71, v248, v249
    v_cvt_pk_bf16_f32 v69, v70, v71
    v_mfma_f32_32x32x16_bf16 v[164:179], a[120:123], a[84:87], v[164:179]
    s_waitcnt lgkmcnt(6)
    ds_read_b64_tr_b16 a[108:109], v236 offset:32768
    ds_read_b64_tr_b16 a[110:111], v236 offset:33792
    v_fma_f32 v72, v72, v248, v249
    v_fma_f32 v73, v73, v248, v249
    v_cvt_pk_bf16_f32 v70, v72, v73
    v_fma_f32 v74, v74, v248, v249
    v_mfma_f32_32x32x16_bf16 v[164:179], a[124:127], a[88:91], v[164:179]
    ds_read_b64_tr_b16 a[112:113], v236 offset:34816
    ds_read_b64_tr_b16 a[114:115], v236 offset:35840
    v_fma_f32 v75, v75, v248, v249
    v_cvt_pk_bf16_f32 v71, v74, v75
    v_fma_f32 v76, v76, v248, v249
    v_fma_f32 v77, v77, v248, v249
    v_mfma_f32_32x32x16_bf16 v[180:195], a[92:95], v[0:3], 0
    s_waitcnt lgkmcnt(6)
    ds_read_b64_tr_b16 a[116:117], v236 offset:36864
    ds_read_b64_tr_b16 a[118:119], v236 offset:37888
    v_mfma_f32_32x32x16_bf16 v[180:195], a[96:99], v[4:7], v[180:195]
    ds_read_b64_tr_b16 a[120:121], v236 offset:38912
    ds_read_b64_tr_b16 a[122:123], v236 offset:39936
    v_mfma_f32_32x32x16_bf16 v[180:195], a[100:103], v[8:11], v[180:195]
    s_waitcnt lgkmcnt(6)
    ds_read_b64_tr_b16 a[124:125], v236 offset:40960
    ds_read_b64_tr_b16 a[126:127], v236 offset:41984
    v_mul_f32 v222, s53, v221
    v_mul_f32 v204, v222, v164
    v_mul_f32 v205, v222, v165
    v_mul_f32 v206, v222, v166
    v_mfma_f32_32x32x16_bf16 v[180:195], a[104:107], v[12:15], v[180:195]
    ds_read_b64_tr_b16 a[92:93], v236 offset:43008
    ds_read_b64_tr_b16 a[94:95], v236 offset:44032
    v_mul_f32 v207, v222, v167
    v_cvt_pk_bf16_f32 v196, v204, v205
    v_cvt_pk_bf16_f32 v197, v206, v207
    v_mul_f32 v208, v222, v168
    v_mfma_f32_32x32x16_bf16 v[180:195], a[108:111], v[16:19], v[180:195]
    s_waitcnt lgkmcnt(6)
    ds_read_b64_tr_b16 a[96:97], v236 offset:45056
    ds_read_b64_tr_b16 a[98:99], v236 offset:46080
    v_mul_f32 v209, v222, v169
    v_mul_f32 v210, v222, v170
    v_mul_f32 v211, v222, v171
    v_cvt_pk_bf16_f32 v198, v208, v209
    v_mfma_f32_32x32x16_bf16 v[180:195], a[112:115], v[20:23], v[180:195]
    ds_read_b64_tr_b16 a[100:101], v236 offset:47104
    ds_read_b64_tr_b16 a[102:103], v236 offset:48128
    v_cvt_pk_bf16_f32 v199, v210, v211
    v_mul_f32 v204, v222, v172
    v_mul_f32 v205, v222, v173
    v_mul_f32 v206, v222, v174
    v_mfma_f32_32x32x16_bf16 v[180:195], a[116:119], v[24:27], v[180:195]
    s_waitcnt lgkmcnt(6)
    buffer_store_dwordx4 v[196:199], v238, s[16:19], s45 offen offset:0 sc1
    ds_read_b64_tr_b16 a[104:105], v237 offset:0
    ds_read_b64_tr_b16 a[106:107], v237 offset:1024
    v_mul_f32 v207, v222, v175
    v_cvt_pk_bf16_f32 v200, v204, v205
    v_mfma_f32_32x32x16_bf16 v[180:195], a[120:123], v[28:31], v[180:195]
    ds_read_b64_tr_b16 a[108:109], v237 offset:2048
    ds_read_b64_tr_b16 a[110:111], v237 offset:3072
    v_cvt_pk_bf16_f32 v201, v206, v207
    v_mul_f32 v208, v222, v176
    v_mul_f32 v209, v222, v177
    v_mul_f32 v210, v222, v178
    v_mfma_f32_32x32x16_bf16 v[180:195], a[124:127], v[32:35], v[180:195]
    s_waitcnt lgkmcnt(6)
    ds_read_b64_tr_b16 a[112:113], v237 offset:4096
    ds_read_b64_tr_b16 a[114:115], v237 offset:5120
    v_mul_f32 v211, v222, v179
    v_cvt_pk_bf16_f32 v202, v208, v209
    v_cvt_pk_bf16_f32 v203, v210, v211
    v_cvt_pk_bf16_f32 v72, v76, v77
    v_mfma_f32_32x32x16_bf16 v[180:195], a[92:95], v[36:39], v[180:195]
    buffer_store_dwordx4 v[200:203], v238, s[16:19], s45 offen offset:1024 sc1
    ds_read_b64_tr_b16 a[116:117], v237 offset:6144
    ds_read_b64_tr_b16 a[118:119], v237 offset:7168
    v_fma_f32 v78, v78, v248, v249
    v_fma_f32 v79, v79, v248, v249
    v_mfma_f32_32x32x16_bf16 v[180:195], a[96:99], v[40:43], v[180:195]
    s_waitcnt lgkmcnt(6)
    ds_read_b64_tr_b16 a[120:121], v237 offset:8192
    ds_read_b64_tr_b16 a[122:123], v237 offset:9216
    v_cvt_pk_bf16_f32 v73, v78, v79
    v_fma_f32 v80, v80, v248, v249
    v_fma_f32 v81, v81, v248, v249
    v_cvt_pk_bf16_f32 v74, v80, v81
    v_mfma_f32_32x32x16_bf16 v[180:195], a[100:103], v[44:47], v[180:195]
    ds_write_b128 v240, v[68:71] offset:0
    ds_read_b64_tr_b16 a[124:125], v237 offset:10240
    ds_read_b64_tr_b16 a[126:127], v237 offset:11264
    v_fma_f32 v82, v82, v248, v249
    v_fma_f32 v83, v83, v248, v249
    v_cvt_pk_bf16_f32 v75, v82, v83
    v_mfma_f32_32x32x16_bf16 v[180:195], a[104:107], v[48:51], v[180:195]
    s_waitcnt lgkmcnt(7)
    ds_write_b128 v240, v[72:75] offset:1152
    s_add_u32 s97, s40, 73728
    ds_read_b64_tr_b16 a[92:93], v237 offset:12288
    ds_read_b64_tr_b16 a[94:95], v237 offset:13312
    v_fma_f32 v84, v84, v248, v249
    v_fma_f32 v85, v85, v248, v249
    v_mfma_f32_32x32x16_bf16 v[180:195], a[108:111], a[0:3], v[180:195]
    ds_read_b64_tr_b16 a[96:97], v237 offset:14336
    ds_read_b64_tr_b16 a[98:99], v237 offset:15360
    v_cvt_pk_bf16_f32 v84, v84, v85
    v_fma_f32 v86, v86, v248, v249
    v_fma_f32 v87, v87, v248, v249
    v_cvt_pk_bf16_f32 v85, v86, v87
    v_mfma_f32_32x32x16_bf16 v[180:195], a[112:115], a[4:7], v[180:195]
    s_waitcnt lgkmcnt(8)
    s_waitcnt lgkmcnt(4)
    ds_read_b64_tr_b16 v[76:77], v242 offset:0
    ds_read_b64_tr_b16 v[78:79], v242 offset:64
    ds_read_b64_tr_b16 v[80:81], v242 offset:256
    ds_read_b64_tr_b16 a[100:101], v237 offset:16384
    ds_read_b64_tr_b16 a[102:103], v237 offset:17408
    v_mfma_f32_32x32x16_bf16 v[180:195], a[116:119], a[8:11], v[180:195]
    ds_read_b64_tr_b16 v[82:83], v242 offset:320
    ds_read_b64_tr_b16 a[104:105], v237 offset:18432
    ds_read_b64_tr_b16 a[106:107], v237 offset:19456
    v_fma_f32 v88, v88, v248, v249
    v_fma_f32 v89, v89, v248, v249
    v_cvt_pk_bf16_f32 v86, v88, v89
    v_mfma_f32_32x32x16_bf16 v[180:195], a[120:123], a[12:15], v[180:195]
    s_waitcnt lgkmcnt(10)
    ds_read_b64_tr_b16 a[108:109], v237 offset:20480
    ds_read_b64_tr_b16 a[110:111], v237 offset:21504
    v_fma_f32 v90, v90, v248, v249
    v_fma_f32 v91, v91, v248, v249
    v_cvt_pk_bf16_f32 v87, v90, v91
    v_fma_f32 v92, v92, v248, v249
    v_mfma_f32_32x32x16_bf16 v[180:195], a[124:127], a[16:19], v[180:195]
    ds_read_b64_tr_b16 a[112:113], v237 offset:22528
    ds_read_b64_tr_b16 a[114:115], v237 offset:23552
    v_fma_f32 v93, v93, v248, v249
    v_cvt_pk_bf16_f32 v88, v92, v93
    v_fma_f32 v94, v94, v248, v249
    v_fma_f32 v95, v95, v248, v249
    v_mfma_f32_32x32x16_bf16 v[180:195], a[92:95], a[20:23], v[180:195]
    s_waitcnt lgkmcnt(7)
    s_waitcnt lgkmcnt(6)
    buffer_store_dwordx4 v[76:79], v239, s[16:19], s40 offen offset:0 sc1
    ds_read_b64_tr_b16 a[116:117], v237 offset:24576
    ds_read_b64_tr_b16 a[118:119], v237 offset:25600
    v_cvt_pk_bf16_f32 v89, v94, v95
    v_mfma_f32_32x32x16_bf16 v[180:195], a[96:99], a[24:27], v[180:195]
    buffer_store_dwordx4 v[80:83], v239, s[16:19], s97 offen offset:0 sc1
    ds_read_b64_tr_b16 a[120:121], v237 offset:26624
    ds_read_b64_tr_b16 a[122:123], v237 offset:27648
    v_fma_f32 v96, v96, v248, v249
    v_fma_f32 v97, v97, v248, v249
    v_mfma_f32_32x32x16_bf16 v[180:195], a[100:103], a[28:31], v[180:195]
    s_waitcnt lgkmcnt(6)
    ds_read_b64_tr_b16 a[124:125], v237 offset:28672
    ds_read_b64_tr_b16 a[126:127], v237 offset:29696
    v_cvt_pk_bf16_f32 v90, v96, v97
    v_fma_f32 v98, v98, v248, v249
    v_fma_f32 v99, v99, v248, v249
    v_cvt_pk_bf16_f32 v91, v98, v99
    v_mfma_f32_32x32x16_bf16 v[180:195], a[104:107], a[32:35], v[180:195]
    ds_write_b128 v240, v[84:87] offset:0
    ds_write_b128 v240, v[88:91] offset:1152
    s_add_u32 s97, s40, 73728
    ds_read_b64_tr_b16 a[92:93], v237 offset:30720
    ds_read_b64_tr_b16 a[94:95], v237 offset:31744
    v_fma_f32 v100, v100, v248, v249
    v_fma_f32 v101, v101, v248, v249
    v_mfma_f32_32x32x16_bf16 v[180:195], a[108:111], a[36:39], v[180:195]
    s_waitcnt lgkmcnt(8)
    ds_read_b64_tr_b16 a[96:97], v237 offset:32768
    ds_read_b64_tr_b16 a[98:99], v237 offset:33792
    v_cvt_pk_bf16_f32 v100, v100, v101
    v_fma_f32 v102, v102, v248, v249
    v_fma_f32 v103, v103, v248, v249
    v_cvt_pk_bf16_f32 v101, v102, v103
    v_mfma_f32_32x32x16_bf16 v[180:195], a[112:115], a[40:43], v[180:195]
    s_waitcnt lgkmcnt(4)
    ds_read_b64_tr_b16 v[92:93], v242 offset:0
    ds_read_b64_tr_b16 v[94:95], v242 offset:64
    ds_read_b64_tr_b16 v[96:97], v242 offset:256
    ds_read_b64_tr_b16 v[98:99], v242 offset:320
    ds_read_b64_tr_b16 a[100:101], v237 offset:34816
    ds_read_b64_tr_b16 a[102:103], v237 offset:35840
    v_mfma_f32_32x32x16_bf16 v[180:195], a[116:119], a[44:47], v[180:195]
    ds_read_b64_tr_b16 a[104:105], v237 offset:36864
    ds_read_b64_tr_b16 a[106:107], v237 offset:37888
    v_fma_f32 v104, v104, v248, v249
    v_fma_f32 v105, v105, v248, v249
    v_cvt_pk_bf16_f32 v102, v104, v105
    v_fma_f32 v106, v106, v248, v249
    v_mfma_f32_32x32x16_bf16 v[180:195], a[120:123], a[48:51], v[180:195]
    ds_read_b64_tr_b16 a[108:109], v237 offset:38912
    ds_read_b64_tr_b16 a[110:111], v237 offset:39936
    v_fma_f32 v107, v107, v248, v249
    v_cvt_pk_bf16_f32 v103, v106, v107
    v_fma_f32 v108, v108, v248, v249
    v_fma_f32 v109, v109, v248, v249
    v_mfma_f32_32x32x16_bf16 v[180:195], a[124:127], a[52:55], v[180:195]
    s_waitcnt lgkmcnt(10)
    s_waitcnt lgkmcnt(6)
    buffer_store_dwordx4 v[92:95], v239, s[16:19], s40 offen offset:1024 sc1
    ds_read_b64_tr_b16 a[112:113], v237 offset:40960
    ds_read_b64_tr_b16 a[114:115], v237 offset:41984
    v_cvt_pk_bf16_f32 v104, v108, v109
    v_mfma_f32_32x32x16_bf16 v[180:195], a[92:95], a[56:59], v[180:195]
    buffer_store_dwordx4 v[96:99], v239, s[16:19], s97 offen offset:1024 sc1
    ds_read_b64_tr_b16 a[116:117], v237 offset:43008
    ds_read_b64_tr_b16 a[118:119], v237 offset:44032
    v_fma_f32 v110, v110, v248, v249
    v_fma_f32 v111, v111, v248, v249
    v_mfma_f32_32x32x16_bf16 v[180:195], a[96:99], a[60:63], v[180:195]
    s_waitcnt lgkmcnt(6)
    ds_read_b64_tr_b16 a[120:121], v237 offset:45056
    ds_read_b64_tr_b16 a[122:123], v237 offset:46080
    v_cvt_pk_bf16_f32 v105, v110, v111
    v_fma_f32 v112, v112, v248, v249
    v_fma_f32 v113, v113, v248, v249
    v_cvt_pk_bf16_f32 v106, v112, v113
    v_mfma_f32_32x32x16_bf16 v[180:195], a[100:103], a[64:67], v[180:195]
    ds_write_b128 v240, v[100:103] offset:0
    ds_read_b64_tr_b16 a[124:125], v237 offset:47104
    ds_read_b64_tr_b16 a[126:127], v237 offset:48128
    v_fma_f32 v114, v114, v248, v249
    v_fma_f32 v115, v115, v248, v249
    v_cvt_pk_bf16_f32 v107, v114, v115
    v_mfma_f32_32x32x16_bf16 v[180:195], a[104:107], a[68:71], v[180:195]
    s_waitcnt lgkmcnt(7)
    ds_write_b128 v240, v[104:107] offset:1152
    s_add_u32 s97, s41, 73728
    v_fma_f32 v116, v116, v248, v249
    v_fma_f32 v117, v117, v248, v249
    v_cvt_pk_bf16_f32 v116, v116, v117
    v_fma_f32 v118, v118, v248, v249
    v_mfma_f32_32x32x16_bf16 v[180:195], a[108:111], a[72:75], v[180:195]
    v_fma_f32 v119, v119, v248, v249
    v_cvt_pk_bf16_f32 v117, v118, v119
    v_fma_f32 v120, v120, v248, v249
    v_fma_f32 v121, v121, v248, v249
    v_cvt_pk_bf16_f32 v118, v120, v121
    v_fma_f32 v122, v122, v248, v249
    v_mfma_f32_32x32x16_bf16 v[180:195], a[112:115], a[76:79], v[180:195]
    s_waitcnt lgkmcnt(4)
    s_waitcnt lgkmcnt(0)
    ds_read_b64_tr_b16 v[108:109], v242 offset:0
    ds_read_b64_tr_b16 v[110:111], v242 offset:64
    ds_read_b64_tr_b16 v[112:113], v242 offset:256
    ds_read_b64_tr_b16 v[114:115], v242 offset:320
    v_fma_f32 v123, v123, v248, v249
    v_mfma_f32_32x32x16_bf16 v[180:195], a[116:119], a[80:83], v[180:195]
    v_cvt_pk_bf16_f32 v119, v122, v123
    v_fma_f32 v124, v124, v248, v249
    v_fma_f32 v125, v125, v248, v249
    v_cvt_pk_bf16_f32 v120, v124, v125
    v_fma_f32 v126, v126, v248, v249
    v_fma_f32 v127, v127, v248, v249
    v_mfma_f32_32x32x16_bf16 v[180:195], a[120:123], a[84:87], v[180:195]
    v_cvt_pk_bf16_f32 v121, v126, v127
    v_fma_f32 v128, v128, v248, v249
    v_fma_f32 v129, v129, v248, v249
    v_cvt_pk_bf16_f32 v122, v128, v129
    v_fma_f32 v130, v130, v248, v249
    v_fma_f32 v131, v131, v248, v249
    v_mfma_f32_32x32x16_bf16 v[180:195], a[124:127], a[88:91], v[180:195]
    s_waitcnt lgkmcnt(0)
    buffer_store_dwordx4 v[108:111], v239, s[16:19], s41 offen offset:0 sc1
    buffer_store_dwordx4 v[112:115], v239, s[16:19], s97 offen offset:0 sc1
    ds_write_b128 v240, v[116:119] offset:0
    v_cvt_pk_bf16_f32 v123, v130, v131
    s_nop 11
    ds_write_b128 v240, v[120:123] offset:1152
    s_waitcnt lgkmcnt(0)
    ds_read_b64_tr_b16 v[124:125], v242 offset:0
    ds_read_b64_tr_b16 v[126:127], v242 offset:64
    ds_read_b64_tr_b16 v[128:129], v242 offset:256
    ds_read_b64_tr_b16 v[130:131], v242 offset:320
    s_add_u32 s97, s41, 73728
    s_waitcnt lgkmcnt(0)
    buffer_store_dwordx4 v[124:127], v239, s[16:19], s41 offen offset:1024 sc1
    buffer_store_dwordx4 v[128:131], v239, s[16:19], s97 offen offset:1024 sc1
    v_fma_f32 v132, v132, v248, v249
    v_fma_f32 v133, v133, v248, v249
    v_cvt_pk_bf16_f32 v132, v132, v133
    v_fma_f32 v134, v134, v248, v249
    v_fma_f32 v135, v135, v248, v249
    v_cvt_pk_bf16_f32 v133, v134, v135
    v_fma_f32 v136, v136, v248, v249
    v_fma_f32 v137, v137, v248, v249
    v_cvt_pk_bf16_f32 v134, v136, v137
    v_fma_f32 v138, v138, v248, v249
    v_fma_f32 v139, v139, v248, v249
    v_cvt_pk_bf16_f32 v135, v138, v139
    v_fma_f32 v140, v140, v248, v249
    v_fma_f32 v141, v141, v248, v249
    v_cvt_pk_bf16_f32 v136, v140, v141
    v_fma_f32 v142, v142, v248, v249
    v_fma_f32 v143, v143, v248, v249
    v_cvt_pk_bf16_f32 v137, v142, v143
    v_fma_f32 v144, v144, v248, v249
    v_fma_f32 v145, v145, v248, v249
    v_cvt_pk_bf16_f32 v138, v144, v145
    v_fma_f32 v146, v146, v248, v249
    v_fma_f32 v147, v147, v248, v249
    v_cvt_pk_bf16_f32 v139, v146, v147
    ds_write_b128 v240, v[132:135] offset:0
    ds_write_b128 v240, v[136:139] offset:1152
    s_waitcnt lgkmcnt(0)
    ds_read_b64_tr_b16 v[140:141], v242 offset:0
    ds_read_b64_tr_b16 v[142:143], v242 offset:64
    ds_read_b64_tr_b16 v[144:145], v242 offset:256
    ds_read_b64_tr_b16 v[146:147], v242 offset:320
    s_add_u32 s97, s42, 73728
    s_waitcnt lgkmcnt(0)
    buffer_store_dwordx4 v[140:143], v239, s[16:19], s42 offen offset:0 sc1
    buffer_store_dwordx4 v[144:147], v239, s[16:19], s97 offen offset:0 sc1
    v_fma_f32 v148, v148, v248, v249
    v_fma_f32 v149, v149, v248, v249
    v_cvt_pk_bf16_f32 v148, v148, v149
    v_fma_f32 v150, v150, v248, v249
    v_fma_f32 v151, v151, v248, v249
    v_cvt_pk_bf16_f32 v149, v150, v151
    v_fma_f32 v152, v152, v248, v249
    v_fma_f32 v153, v153, v248, v249
    v_cvt_pk_bf16_f32 v150, v152, v153
    v_fma_f32 v154, v154, v248, v249
    v_fma_f32 v155, v155, v248, v249
    v_cvt_pk_bf16_f32 v151, v154, v155
    v_fma_f32 v156, v156, v248, v249
    v_fma_f32 v157, v157, v248, v249
    v_cvt_pk_bf16_f32 v152, v156, v157
    v_fma_f32 v158, v158, v248, v249
    v_fma_f32 v159, v159, v248, v249
    v_cvt_pk_bf16_f32 v153, v158, v159
    v_fma_f32 v160, v160, v248, v249
    v_fma_f32 v161, v161, v248, v249
    v_cvt_pk_bf16_f32 v154, v160, v161
    v_fma_f32 v162, v162, v248, v249
    v_fma_f32 v163, v163, v248, v249
    v_cvt_pk_bf16_f32 v155, v162, v163
    ds_write_b128 v240, v[148:151] offset:0
    ds_write_b128 v240, v[152:155] offset:1152
    s_waitcnt lgkmcnt(0)
    ds_read_b64_tr_b16 v[156:157], v242 offset:0
    ds_read_b64_tr_b16 v[158:159], v242 offset:64
    ds_read_b64_tr_b16 v[160:161], v242 offset:256
    ds_read_b64_tr_b16 v[162:163], v242 offset:320
    s_add_u32 s97, s42, 73728
    s_waitcnt lgkmcnt(0)
    buffer_store_dwordx4 v[156:159], v239, s[16:19], s42 offen offset:1024 sc1
    buffer_store_dwordx4 v[160:163], v239, s[16:19], s97 offen offset:1024 sc1
    v_mul_f32 v222, s53, v221
    v_mul_f32 v204, v222, v180
    v_mul_f32 v205, v222, v181
    v_mul_f32 v206, v222, v182
    v_mul_f32 v207, v222, v183
    v_cvt_pk_bf16_f32 v196, v204, v205
    v_cvt_pk_bf16_f32 v197, v206, v207
    v_mul_f32 v208, v222, v184
    v_mul_f32 v209, v222, v185
    v_mul_f32 v210, v222, v186
    v_mul_f32 v211, v222, v187
    v_cvt_pk_bf16_f32 v198, v208, v209
    v_cvt_pk_bf16_f32 v199, v210, v211
    buffer_store_dwordx4 v[196:199], v238, s[16:19], s45 offen offset:2048 sc1
    v_mul_f32 v204, v222, v188
    v_mul_f32 v205, v222, v189
    v_mul_f32 v206, v222, v190
    v_mul_f32 v207, v222, v191
    v_cvt_pk_bf16_f32 v200, v204, v205
    v_cvt_pk_bf16_f32 v201, v206, v207
    v_mul_f32 v208, v222, v192
    v_mul_f32 v209, v222, v193
    v_mul_f32 v210, v222, v194
    v_mul_f32 v211, v222, v195
    v_cvt_pk_bf16_f32 v202, v208, v209
    v_cvt_pk_bf16_f32 v203, v210, v211
    buffer_store_dwordx4 v[200:203], v238, s[16:19], s45 offen offset:3072 sc1
    s_endpgm
L1_poll_A:
    s_mov_b32 s98, 0x400000
L1_poll_A_l:
    buffer_load_dword v255, off, s[20:23], s67 sc1
    s_waitcnt vmcnt(0)
    v_readfirstlane_b32 s96, v255
    s_sub_u32 s98, s98, 1
    s_cbranch_scc1 L1_poll_A_ok
    s_cmp_lt_u32 s96, 16
    s_cbranch_scc1 L1_poll_A_l
    s_branch L1_poll_A_ok
L1_B:
    v_mfma_f32_32x32x16_bf16 v[164:179], a[92:95], v[0:3], 0
    s_waitcnt lgkmcnt(6)
    s_add_u32 m0, s57, 73728
    s_mul_i32 s56, s28, 1327104
    s_add_u32 s56, s56, s35
    ds_read_b64_tr_b16 a[116:117], v232 offset:12288
    ds_read_b64_tr_b16 a[118:119], v232 offset:13312
    v_mfma_f32_32x32x16_bf16 v[164:179], a[96:99], v[4:7], v[164:179]
    buffer_load_dwordx4 v224, s[12:15], s56 offen offset:0  lds
    ds_read_b64_tr_b16 a[120:121], v232 offset:14336
    ds_read_b64_tr_b16 a[122:123], v232 offset:15360
    v_mfma_f32_32x32x16_bf16 v[164:179], a[100:103], v[8:11], v[164:179]
    s_waitcnt lgkmcnt(6)
    buffer_load_dwordx4 v225, s[12:15], s56 offen offset:1024  lds
    ds_read_b64_tr_b16 a[124:125], v232 offset:16384
    ds_read_b64_tr_b16 a[126:127], v232 offset:17408
    v_mfma_f32_32x32x16_bf16 v[164:179], a[104:107], v[12:15], v[164:179]
    ds_read_b64_tr_b16 a[92:93], v232 offset:18432
    ds_read_b64_tr_b16 a[94:95], v232 offset:19456
    v_mfma_f32_32x32x16_bf16 v[164:179], a[108:111], v[16:19], v[164:179]
    s_waitcnt lgkmcnt(6)
    buffer_load_dwordx4 v226, s[12:15], s56 offen offset:2048  lds
    ds_read_b64_tr_b16 a[96:97], v232 offset:20480
    ds_read_b64_tr_b16 a[98:99], v232 offset:21504
    v_mfma_f32_32x32x16_bf16 v[164:179], a[112:115], v[20:23], v[164:179]
    ds_read_b64_tr_b16 a[100:101], v232 offset:22528
    ds_read_b64_tr_b16 a[102:103], v232 offset:23552
    v_mfma_f32_32x32x16_bf16 v[164:179], a[116:119], v[24:27], v[164:179]
    s_waitcnt lgkmcnt(6)
    buffer_load_dwordx4 v227, s[12:15], s56 offen offset:3072  lds
    ds_read_b64_tr_b16 a[104:105], v232 offset:24576
    ds_read_b64_tr_b16 a[106:107], v232 offset:25600
    v_mfma_f32_32x32x16_bf16 v[164:179], a[120:123], v[28:31], v[164:179]
    s_add_u32 m0, s57, 77824
    s_add_u32 s56, s56, 294912
    ds_read_b64_tr_b16 a[108:109], v232 offset:26624
    ds_read_b64_tr_b16 a[110:111], v232 offset:27648
    v_mfma_f32_32x32x16_bf16 v[164:179], a[124:127], v[32:35], v[164:179]
    s_waitcnt lgkmcnt(6)
    buffer_load_dwordx4 v224, s[12:15], s56 offen offset:0  lds
    ds_read_b64_tr_b16 a[112:113], v232 offset:28672
    ds_read_b64_tr_b16 a[114:115], v232 offset:29696
    v_mfma_f32_32x32x16_bf16 v[164:179], a[92:95], v[36:39], v[164:179]
    ds_read_b64_tr_b16 a[116:117], v232 offset:30720
    ds_read_b64_tr_b16 a[118:119], v232 offset:31744
    v_mfma_f32_32x32x16_bf16 v[164:179], a[96:99], v[40:43], v[164:179]
    s_waitcnt lgkmcnt(6)
    buffer_load_dwordx4 v225, s[12:15], s56 offen offset:1024  lds
    ds_read_b64_tr_b16 a[120:121], v232 offset:32768
    ds_read_b64_tr_b16 a[122:123], v232 offset:33792
    v_mfma_f32_32x32x16_bf16 v[164:179], a[100:103], v[44:47], v[164:179]
    ds_read_b64_tr_b16 a[124:125], v232 offset:34816
    ds_read_b64_tr_b16 a[126:127], v232 offset:35840
    v_mfma_f32_32x32x16_bf16 v[164:179], a[104:107], v[48:51], v[164:179]
    s_waitcnt lgkmcnt(6)
    buffer_load_dwordx4 v226, s[12:15], s56 offen offset:2048  lds
    ds_read_b64_tr_b16 a[92:93], v232 offset:36864
    ds_read_b64_tr_b16 a[94:95], v232 offset:37888
    v_mfma_f32_32x32x16_bf16 v[164:179], a[108:111], a[0:3], v[164:179]
    ds_read_b64_tr_b16 a[96:97], v232 offset:38912
    ds_read_b64_tr_b16 a[98:99], v232 offset:39936
    v_mfma_f32_32x32x16_bf16 v[164:179], a[112:115], a[4:7], v[164:179]
    s_waitcnt lgkmcnt(6)
    buffer_load_dwordx4 v227, s[12:15], s56 offen offset:3072  lds
    ds_read_b64_tr_b16 a[100:101], v232 offset:40960
    ds_read_b64_tr_b16 a[102:103], v232 offset:41984
    v_mfma_f32_32x32x16_bf16 v[164:179], a[116:119], a[8:11], v[164:179]
    s_add_u32 m0, s57, 81920
    s_add_u32 s56, s56, 294912
    ds_read_b64_tr_b16 a[104:105], v232 offset:43008
    ds_read_b64_tr_b16 a[106:107], v232 offset:44032
    v_mfma_f32_32x32x16_bf16 v[164:179], a[120:123], a[12:15], v[164:179]
    s_waitcnt lgkmcnt(6)
    buffer_load_dwordx4 v224, s[12:15], s56 offen offset:0  lds
    ds_read_b64_tr_b16 a[108:109], v232 offset:45056
    ds_read_b64_tr_b16 a[110:111], v232 offset:46080
    v_mul_f32 v204, v180, v180
    v_mul_f32 v205, v181, v181
    v_mul_f32 v206, v182, v182
    v_mul_f32 v207, v183, v183
    v_fma_f32 v204, v204, v251, v250
    v_fma_f32 v205, v205, v251, v250
    v_fma_f32 v206, v206, v251, v250
    v_fma_f32 v207, v207, v251, v250
    v_mfma_f32_32x32x16_bf16 v[164:179], a[124:127], a[16:19], v[164:179]
    ds_read_b64_tr_b16 a[112:113], v232 offset:47104
    ds_read_b64_tr_b16 a[114:115], v232 offset:48128
    v_mul_f32 v204, v204, v180
    v_mul_f32 v205, v205, v181
    v_mul_f32 v206, v206, v182
    v_mul_f32 v207, v207, v183
    v_exp_f32 v204, v204
    v_exp_f32 v205, v205
    v_exp_f32 v206, v206
    v_mfma_f32_32x32x16_bf16 v[164:179], a[92:95], a[20:23], v[164:179]
    s_waitcnt lgkmcnt(6)
    buffer_load_dwordx4 v225, s[12:15], s56 offen offset:1024  lds
    ds_read_b64_tr_b16 a[116:117], v233 offset:0
    ds_read_b64_tr_b16 a[118:119], v233 offset:1024
    v_exp_f32 v207, v207
    v_add_f32 v204, 1.0, v204
    v_add_f32 v205, 1.0, v205
    v_add_f32 v206, 1.0, v206
    v_add_f32 v207, 1.0, v207
    v_rcp_f32 v204, v204
    v_mfma_f32_32x32x16_bf16 v[164:179], a[96:99], a[24:27], v[164:179]
    ds_read_b64_tr_b16 a[120:121], v233 offset:2048
    ds_read_b64_tr_b16 a[122:123], v233 offset:3072
    v_rcp_f32 v205, v205
    v_rcp_f32 v206, v206
    v_rcp_f32 v207, v207
    v_mul_f32 v116, v180, v204
    v_mul_f32 v117, v181, v205
    v_mul_f32 v118, v182, v206
    v_mul_f32 v119, v183, v207
    v_mfma_f32_32x32x16_bf16 v[164:179], a[100:103], a[28:31], v[164:179]
    s_waitcnt lgkmcnt(6)
    buffer_load_dwordx4 v226, s[12:15], s56 offen offset:2048  lds
    ds_read_b64_tr_b16 a[124:125], v233 offset:4096
    ds_read_b64_tr_b16 a[126:127], v233 offset:5120
    v_add_f32 v244, v244, v116
    v_fmac_f32 v245, v116, v116
    v_add_f32 v244, v244, v117
    v_fmac_f32 v245, v117, v117
    v_add_f32 v244, v244, v118
    v_fmac_f32 v245, v118, v118
    v_add_f32 v244, v244, v119
    v_fmac_f32 v245, v119, v119
    v_mfma_f32_32x32x16_bf16 v[164:179], a[104:107], a[32:35], v[164:179]
    ds_read_b64_tr_b16 a[92:93], v233 offset:6144
    ds_read_b64_tr_b16 a[94:95], v233 offset:7168
    v_mul_f32 v208, v184, v184
    v_mul_f32 v209, v185, v185
    v_mul_f32 v210, v186, v186
    v_mul_f32 v211, v187, v187
    v_fma_f32 v208, v208, v251, v250
    v_fma_f32 v209, v209, v251, v250
    v_fma_f32 v210, v210, v251, v250
    v_fma_f32 v211, v211, v251, v250
    v_mul_f32 v208, v208, v184
    v_mul_f32 v209, v209, v185
    v_mfma_f32_32x32x16_bf16 v[164:179], a[108:111], a[36:39], v[164:179]
    s_waitcnt lgkmcnt(6)
    buffer_load_dwordx4 v227, s[12:15], s56 offen offset:3072  lds
    ds_read_b64_tr_b16 a[96:97], v233 offset:8192
    ds_read_b64_tr_b16 a[98:99], v233 offset:9216
    v_mul_f32 v210, v210, v186
    v_mul_f32 v211, v211, v187
    v_exp_f32 v208, v208
    v_exp_f32 v209, v209
    v_exp_f32 v210, v210
    v_mfma_f32_32x32x16_bf16 v[164:179], a[112:115], a[40:43], v[164:179]
    s_add_u32 m0, s57, 86016
    s_add_u32 s56, s56, 294912
    ds_read_b64_tr_b16 a[100:101], v233 offset:10240
    ds_read_b64_tr_b16 a[102:103], v233 offset:11264
    v_exp_f32 v211, v211
    v_add_f32 v208, 1.0, v208
    v_add_f32 v209, 1.0, v209
    v_add_f32 v210, 1.0, v210
    v_add_f32 v211, 1.0, v211
    v_rcp_f32 v208, v208
    v_mfma_f32_32x32x16_bf16 v[164:179], a[116:119], a[44:47], v[164:179]
    s_waitcnt lgkmcnt(6)
    buffer_load_dwordx4 v224, s[12:15], s56 offen offset:0  lds
    ds_read_b64_tr_b16 a[104:105], v233 offset:12288
    ds_read_b64_tr_b16 a[106:107], v233 offset:13312
    v_rcp_f32 v209, v209
    v_rcp_f32 v210, v210
    v_rcp_f32 v211, v211
    v_mul_f32 v120, v184, v208
    v_mul_f32 v121, v185, v209
    v_mfma_f32_32x32x16_bf16 v[164:179], a[120:123], a[48:51], v[164:179]
    ds_read_b64_tr_b16 a[108:109], v233 offset:14336
    ds_read_b64_tr_b16 a[110:111], v233 offset:15360
    v_mul_f32 v122, v186, v210
    v_mul_f32 v123, v187, v211
    v_add_f32 v244, v244, v120
    v_fmac_f32 v245, v120, v120
    v_add_f32 v244, v244, v121
    v_fmac_f32 v245, v121, v121
    v_add_f32 v244, v244, v122
    v_fmac_f32 v245, v122, v122
    v_add_f32 v244, v244, v123
    v_fmac_f32 v245, v123, v123
    v_mfma_f32_32x32x16_bf16 v[164:179], a[124:127], a[52:55], v[164:179]
    s_waitcnt lgkmcnt(6)
    buffer_load_dwordx4 v225, s[12:15], s56 offen offset:1024  lds
    ds_read_b64_tr_b16 a[112:113], v233 offset:16384
    ds_read_b64_tr_b16 a[114:115], v233 offset:17408
    v_mul_f32 v204, v188, v188
    v_mul_f32 v205, v189, v189
    v_mul_f32 v206, v190, v190
    v_mul_f32 v207, v191, v191
    v_fma_f32 v204, v204, v251, v250
    v_fma_f32 v205, v205, v251, v250
    v_fma_f32 v206, v206, v251, v250
    v_fma_f32 v207, v207, v251, v250
    v_mfma_f32_32x32x16_bf16 v[164:179], a[92:95], a[56:59], v[164:179]
    ds_read_b64_tr_b16 a[116:117], v233 offset:18432
    ds_read_b64_tr_b16 a[118:119], v233 offset:19456
    v_mul_f32 v204, v204, v188
    v_mul_f32 v205, v205, v189
    v_mul_f32 v206, v206, v190
    v_mul_f32 v207, v207, v191
    v_exp_f32 v204, v204
    v_exp_f32 v205, v205
    v_exp_f32 v206, v206
    v_mfma_f32_32x32x16_bf16 v[164:179], a[96:99], a[60:63], v[164:179]
    s_waitcnt lgkmcnt(6)
    buffer_load_dwordx4 v226, s[12:15], s56 offen offset:2048  lds
    ds_read_b64_tr_b16 a[120:121], v233 offset:20480
    ds_read_b64_tr_b16 a[122:123], v233 offset:21504
    v_exp_f32 v207, v207
    v_add_f32 v204, 1.0, v204
    v_add_f32 v205, 1.0, v205
    v_add_f32 v206, 1.0, v206
    v_add_f32 v207, 1.0, v207
    v_rcp_f32 v204, v204
    v_mfma_f32_32x32x16_bf16 v[164:179], a[100:103], a[64:67], v[164:179]
    ds_read_b64_tr_b16 a[124:125], v233 offset:22528
    ds_read_b64_tr_b16 a[126:127], v233 offset:23552
    v_rcp_f32 v205, v205
    v_rcp_f32 v206, v206
    v_rcp_f32 v207, v207
    v_mul_f32 v124, v188, v204
    v_mul_f32 v125, v189, v205
    v_mul_f32 v126, v190, v206
    v_mul_f32 v127, v191, v207
    v_mfma_f32_32x32x16_bf16 v[164:179], a[104:107], a[68:71], v[164:179]
    s_waitcnt lgkmcnt(6)
    buffer_load_dwordx4 v227, s[12:15], s56 offen offset:3072  lds
    ds_read_b64_tr_b16 a[92:93], v235 offset:0
    ds_read_b64_tr_b16 a[94:95], v235 offset:1024
    v_add_f32 v244, v244, v124
    v_fmac_f32 v245, v124, v124
    v_add_f32 v244, v244, v125
    v_fmac_f32 v245, v125, v125
    v_add_f32 v244, v244, v126
    v_fmac_f32 v245, v126, v126
    v_add_f32 v244, v244, v127
    v_fmac_f32 v245, v127, v127
    v_mfma_f32_32x32x16_bf16 v[164:179], a[108:111], a[72:75], v[164:179]
    s_add_u32 m0, s57, 90112
    s_add_u32 s56, s56, 294912
    ds_read_b64_tr_b16 a[96:97], v235 offset:2048
    ds_read_b64_tr_b16 a[98:99], v235 offset:3072
    v_mul_f32 v208, v192, v192
    v_mul_f32 v209, v193, v193
    v_mul_f32 v210, v194, v194
    v_mul_f32 v211, v195, v195
    v_fma_f32 v208, v208, v251, v250
    v_fma_f32 v209, v209, v251, v250
    v_fma_f32 v210, v210, v251, v250
    v_fma_f32 v211, v211, v251, v250
    v_mul_f32 v208, v208, v192
    v_mfma_f32_32x32x16_bf16 v[164:179], a[112:115], a[76:79], v[164:179]
    s_waitcnt lgkmcnt(6)
    buffer_load_dwordx4 v224, s[12:15], s56 offen offset:0  lds
    ds_read_b64_tr_b16 a[100:101], v235 offset:4096
    ds_read_b64_tr_b16 a[102:103], v235 offset:5120
    v_mul_f32 v209, v209, v193
    v_mul_f32 v210, v210, v194
    v_mul_f32 v211, v211, v195
    v_exp_f32 v208, v208
    v_exp_f32 v209, v209
    v_add_f32 v208, 1.0, v208
    v_mfma_f32_32x32x16_bf16 v[164:179], a[116:119], a[80:83], v[164:179]
    ds_read_b64_tr_b16 a[104:105], v235 offset:6144
    ds_read_b64_tr_b16 a[106:107], v235 offset:7168
    v_exp_f32 v210, v210
    v_exp_f32 v211, v211
    v_add_f32 v209, 1.0, v209
    v_add_f32 v210, 1.0, v210
    v_add_f32 v211, 1.0, v211
    v_rcp_f32 v208, v208
    v_mfma_f32_32x32x16_bf16 v[164:179], a[120:123], a[84:87], v[164:179]
    s_waitcnt lgkmcnt(6)
    buffer_load_dwordx4 v225, s[12:15], s56 offen offset:1024  lds
    ds_read_b64_tr_b16 a[108:109], v235 offset:8192
    ds_read_b64_tr_b16 a[110:111], v235 offset:9216
    v_rcp_f32 v209, v209
    v_rcp_f32 v210, v210
    v_rcp_f32 v211, v211
    v_mul_f32 v128, v192, v208
    v_mul_f32 v129, v193, v209
    v_mfma_f32_32x32x16_bf16 v[164:179], a[124:127], a[88:91], v[164:179]
    ds_read_b64_tr_b16 a[112:113], v235 offset:10240
    ds_read_b64_tr_b16 a[114:115], v235 offset:11264
    v_mul_f32 v130, v194, v210
    v_mul_f32 v131, v195, v211
    v_add_f32 v244, v244, v128
    v_fmac_f32 v245, v128, v128
    v_add_f32 v244, v244, v129
    v_fmac_f32 v245, v129, v129
    v_add_f32 v244, v244, v130
    v_fmac_f32 v245, v130, v130
    v_add_f32 v244, v244, v131
    v_fmac_f32 v245, v131, v131
    v_mov_b32 v204, v244
    v_mov_b32 v205, v245
    v_and_b32 v247, 31, v246
    v_permlane32_swap_b32 v204, v244
    v_permlane32_swap_b32 v205, v245
    v_lshlrev_b32 v247, 3, v247
    v_add_f32 v244, v244, v204
    v_add_f32 v245, v245, v205
    buffer_store_dwordx2 v[244:245], v247, s[16:19], s65 offen sc1
    s_lshl_b32 s59, s28, 6
    v_add_u32 v247, s59, v246
    v_lshlrev_b32 v247, 8, v247
    v_mov_b32 v255, 1
    s_cmp_eq_u32 s28, 0
    s_cselect_b32 s101, 16, 0
    v_mfma_f32_32x32x16_bf16 v[180:195], a[92:95], v[0:3], 0
    s_waitcnt lgkmcnt(6)
    ds_read_b64_tr_b16 a[116:117], v235 offset:12288
    ds_read_b64_tr_b16 a[118:119], v235 offset:13312
    v_mfma_f32_32x32x16_bf16 v[180:195], a[96:99], v[4:7], v[180:195]
    ds_read_b64_tr_b16 a[120:121], v235 offset:14336
    ds_read_b64_tr_b16 a[122:123], v235 offset:15360
    v_mfma_f32_32x32x16_bf16 v[180:195], a[100:103], v[8:11], v[180:195]
    s_waitcnt lgkmcnt(6)
    ds_read_b64_tr_b16 a[124:125], v235 offset:16384
    ds_read_b64_tr_b16 a[126:127], v235 offset:17408
    v_mul_f32 v204, v164, v164
    v_mul_f32 v205, v165, v165
    v_mul_f32 v206, v166, v166
    v_mul_f32 v207, v167, v167
    v_fma_f32 v204, v204, v251, v250
    v_mfma_f32_32x32x16_bf16 v[180:195], a[104:107], v[12:15], v[180:195]
    ds_read_b64_tr_b16 a[92:93], v235 offset:18432
    ds_read_b64_tr_b16 a[94:95], v235 offset:19456
    v_fma_f32 v205, v205, v251, v250
    v_fma_f32 v206, v206, v251, v250
    v_fma_f32 v207, v207, v251, v250
    v_mul_f32 v204, v204, v164
    v_mul_f32 v205, v205, v165
    v_mfma_f32_32x32x16_bf16 v[180:195], a[108:111], v[16:19], v[180:195]
    s_waitcnt lgkmcnt(6)
    ds_read_b64_tr_b16 a[96:97], v235 offset:20480
    ds_read_b64_tr_b16 a[98:99], v235 offset:21504
    v_mul_f32 v206, v206, v166
    v_mul_f32 v207, v207, v167
    v_exp_f32 v204, v204
    v_mfma_f32_32x32x16_bf16 v[180:195], a[112:115], v[20:23], v[180:195]
    ds_read_b64_tr_b16 a[100:101], v235 offset:22528
    ds_read_b64_tr_b16 a[102:103], v235 offset:23552
    v_exp_f32 v205, v205
    v_exp_f32 v206, v206
    v_add_f32 v204, 1.0, v204
    v_mfma_f32_32x32x16_bf16 v[180:195], a[116:119], v[24:27], v[180:195]
    s_waitcnt lgkmcnt(6)
    ds_read_b64_tr_b16 a[104:105], v235 offset:24576
    ds_read_b64_tr_b16 a[106:107], v235 offset:25600
    v_exp_f32 v207, v207
    v_add_f32 v205, 1.0, v205
    v_add_f32 v206, 1.0, v206
    v_add_f32 v207, 1.0, v207
    v_mfma_f32_32x32x16_bf16 v[180:195], a[120:123], v[28:31], v[180:195]
    ds_read_b64_tr_b16 a[108:109], v235 offset:26624
    ds_read_b64_tr_b16 a[110:111], v235 offset:27648
    v_rcp_f32 v204, v204
    v_rcp_f32 v205, v205
    v_mul_f32 v204, v164, v204
    v_mfma_f32_32x32x16_bf16 v[180:195], a[124:127], v[32:35], v[180:195]
    s_waitcnt lgkmcnt(6)
    ds_read_b64_tr_b16 a[112:113], v235 offset:28672
    ds_read_b64_tr_b16 a[114:115], v235 offset:29696
    v_rcp_f32 v206, v206
    v_rcp_f32 v207, v207
    v_mul_f32 v205, v165, v205
    v_mfma_f32_32x32x16_bf16 v[180:195], a[92:95], v[36:39], v[180:195]
    ds_read_b64_tr_b16 a[116:117], v235 offset:30720
    ds_read_b64_tr_b16 a[118:119], v235 offset:31744
    v_mul_f32 v206, v166, v206
    v_mul_f32 v207, v167, v207
    v_cvt_pk_bf16_f32 v196, v204, v205
    v_cvt_pk_bf16_f32 v197, v206, v207
    v_mul_f32 v208, v168, v168
    v_mfma_f32_32x32x16_bf16 v[180:195], a[96:99], v[40:43], v[180:195]
    s_waitcnt lgkmcnt(6)
    ds_read_b64_tr_b16 a[120:121], v235 offset:32768
    ds_read_b64_tr_b16 a[122:123], v235 offset:33792
    v_mul_f32 v209, v169, v169
    v_mul_f32 v210, v170, v170
    v_mul_f32 v211, v171, v171
    v_fma_f32 v208, v208, v251, v250
    v_fma_f32 v209, v209, v251, v250
    v_mfma_f32_32x32x16_bf16 v[180:195], a[100:103], v[44:47], v[180:195]
    ds_read_b64_tr_b16 a[124:125], v235 offset:34816
    ds_read_b64_tr_b16 a[126:127], v235 offset:35840
    v_fma_f32 v210, v210, v251, v250
    v_fma_f32 v211, v211, v251, v250
    v_mul_f32 v208, v208, v168
    v_mul_f32 v209, v209, v169
    v_mul_f32 v210, v210, v170
    v_mfma_f32_32x32x16_bf16 v[180:195], a[104:107], v[48:51], v[180:195]
    s_waitcnt lgkmcnt(6)
    ds_read_b64_tr_b16 a[92:93], v235 offset:36864
    ds_read_b64_tr_b16 a[94:95], v235 offset:37888
    v_mul_f32 v211, v211, v171
    v_exp_f32 v208, v208
    v_exp_f32 v209, v209
    v_mfma_f32_32x32x16_bf16 v[180:195], a[108:111], a[0:3], v[180:195]
    ds_read_b64_tr_b16 a[96:97], v235 offset:38912
    ds_read_b64_tr_b16 a[98:99], v235 offset:39936
    v_exp_f32 v210, v210
    v_exp_f32 v211, v211
    v_add_f32 v208, 1.0, v208
    v_mfma_f32_32x32x16_bf16 v[180:195], a[112:115], a[4:7], v[180:195]
    s_waitcnt lgkmcnt(6)
    ds_read_b64_tr_b16 a[100:101], v235 offset:40960
    ds_read_b64_tr_b16 a[102:103], v235 offset:41984
    v_add_f32 v209, 1.0, v209
    v_add_f32 v210, 1.0, v210
    v_add_f32 v211, 1.0, v211
    v_rcp_f32 v208, v208
    v_mfma_f32_32x32x16_bf16 v[180:195], a[116:119], a[8:11], v[180:195]
    ds_read_b64_tr_b16 a[104:105], v235 offset:43008
    ds_read_b64_tr_b16 a[106:107], v235 offset:44032
    v_rcp_f32 v209, v209
    v_rcp_f32 v210, v210
    v_mul_f32 v208, v168, v208
    v_mfma_f32_32x32x16_bf16 v[180:195], a[120:123], a[12:15], v[180:195]
    s_waitcnt lgkmcnt(6)
    ds_read_b64_tr_b16 a[108:109], v235 offset:45056
    ds_read_b64_tr_b16 a[110:111], v235 offset:46080
    v_rcp_f32 v211, v211
    v_mul_f32 v209, v169, v209
    v_mul_f32 v210, v170, v210
    v_mul_f32 v211, v171, v211
    v_mfma_f32_32x32x16_bf16 v[180:195], a[124:127], a[16:19], v[180:195]
    ds_read_b64_tr_b16 a[112:113], v235 offset:47104
    ds_read_b64_tr_b16 a[114:115], v235 offset:48128
    v_cvt_pk_bf16_f32 v200, v208, v209
    v_cvt_pk_bf16_f32 v201, v210, v211
    v_mul_f32 v204, v172, v172
    v_mul_f32 v205, v173, v173
    v_mul_f32 v206, v174, v174
    v_mfma_f32_32x32x16_bf16 v[180:195], a[92:95], a[20:23], v[180:195]
    s_waitcnt lgkmcnt(6)
    ds_read_b64_tr_b16 a[116:117], v236 offset:0
    ds_read_b64_tr_b16 a[118:119], v236 offset:1024
    v_mul_f32 v207, v175, v175
    v_fma_f32 v204, v204, v251, v250
    v_fma_f32 v205, v205, v251, v250
    v_fma_f32 v206, v206, v251, v250
    v_fma_f32 v207, v207, v251, v250
    v_mfma_f32_32x32x16_bf16 v[180:195], a[96:99], a[24:27], v[180:195]
    ds_read_b64_tr_b16 a[120:121], v236 offset:2048
    ds_read_b64_tr_b16 a[122:123], v236 offset:3072
    v_mul_f32 v204, v204, v172
    v_mul_f32 v205, v205, v173
    v_mul_f32 v206, v206, v174
    v_mul_f32 v207, v207, v175
    v_mfma_f32_32x32x16_bf16 v[180:195], a[100:103], a[28:31], v[180:195]
    s_waitcnt lgkmcnt(6)
    ds_read_b64_tr_b16 a[124:125], v236 offset:4096
    ds_read_b64_tr_b16 a[126:127], v236 offset:5120
    v_exp_f32 v204, v204
    v_exp_f32 v205, v205
    v_add_f32 v204, 1.0, v204
    v_mfma_f32_32x32x16_bf16 v[180:195], a[104:107], a[32:35], v[180:195]
    ds_read_b64_tr_b16 a[92:93], v236 offset:6144
    ds_read_b64_tr_b16 a[94:95], v236 offset:7168
    v_exp_f32 v206, v206
    v_exp_f32 v207, v207
    v_add_f32 v205, 1.0, v205
    v_mfma_f32_32x32x16_bf16 v[180:195], a[108:111], a[36:39], v[180:195]
    s_waitcnt lgkmcnt(6)
    ds_read_b64_tr_b16 a[96:97], v236 offset:8192
    ds_read_b64_tr_b16 a[98:99], v236 offset:9216
    v_add_f32 v206, 1.0, v206
    v_add_f32 v207, 1.0, v207
    v_rcp_f32 v204, v204
    v_mul_f32 v208, v176, v176
    v_mfma_f32_32x32x16_bf16 v[180:195], a[112:115], a[40:43], v[180:195]
    ds_read_b64_tr_b16 a[100:101], v236 offset:10240
    ds_read_b64_tr_b16 a[102:103], v236 offset:11264
    v_rcp_f32 v205, v205
    v_rcp_f32 v206, v206
    v_mul_f32 v204, v172, v204
    v_mfma_f32_32x32x16_bf16 v[180:195], a[116:119], a[44:47], v[180:195]
    s_waitcnt lgkmcnt(6)
    ds_read_b64_tr_b16 a[104:105], v236 offset:12288
    ds_read_b64_tr_b16 a[106:107], v236 offset:13312
    v_rcp_f32 v207, v207
    v_mul_f32 v205, v173, v205
    v_mul_f32 v206, v174, v206
    v_mfma_f32_32x32x16_bf16 v[180:195], a[120:123], a[48:51], v[180:195]
    ds_read_b64_tr_b16 a[108:109], v236 offset:14336
    ds_read_b64_tr_b16 a[110:111], v236 offset:15360
    v_mul_f32 v207, v175, v207
    v_cvt_pk_bf16_f32 v198, v204, v205
    v_cvt_pk_bf16_f32 v199, v206, v207
    v_mul_f32 v209, v177, v177
    v_mfma_f32_32x32x16_bf16 v[180:195], a[124:127], a[52:55], v[180:195]
    s_waitcnt lgkmcnt(6)
    buffer_store_dwordx4 v[196:199], v243, s[16:19], s42 offen offset:0 sc1
    ds_read_b64_tr_b16 a[112:113], v236 offset:16384
    ds_read_b64_tr_b16 a[114:115], v236 offset:17408
    v_mul_f32 v210, v178, v178
    v_mul_f32 v211, v179, v179
    v_mfma_f32_32x32x16_bf16 v[180:195], a[92:95], a[56:59], v[180:195]
    ds_read_b64_tr_b16 a[116:117], v236 offset:18432
    ds_read_b64_tr_b16 a[118:119], v236 offset:19456
    v_fma_f32 v208, v208, v251, v250
    v_fma_f32 v209, v209, v251, v250
    v_fma_f32 v210, v210, v251, v250
    v_fma_f32 v211, v211, v251, v250
    v_mfma_f32_32x32x16_bf16 v[180:195], a[96:99], a[60:63], v[180:195]
    s_waitcnt lgkmcnt(6)
    ds_read_b64_tr_b16 a[120:121], v236 offset:20480
    ds_read_b64_tr_b16 a[122:123], v236 offset:21504
    v_mul_f32 v208, v208, v176
    v_mul_f32 v209, v209, v177
    v_mul_f32 v210, v210, v178
    v_mul_f32 v211, v211, v179
    v_mfma_f32_32x32x16_bf16 v[180:195], a[100:103], a[64:67], v[180:195]
    ds_read_b64_tr_b16 a[124:125], v236 offset:22528
    ds_read_b64_tr_b16 a[126:127], v236 offset:23552
    v_exp_f32 v208, v208
    v_exp_f32 v209, v209
    v_mfma_f32_32x32x16_bf16 v[180:195], a[104:107], a[68:71], v[180:195]
    s_waitcnt lgkmcnt(6)
    s_waitcnt vmcnt(1)
    s_barrier
    ds_read_b64_tr_b16 a[92:93], v233 offset:24576
    ds_read_b64_tr_b16 a[94:95], v233 offset:25600
    v_exp_f32 v210, v210
    v_exp_f32 v211, v211
    v_mfma_f32_32x32x16_bf16 v[180:195], a[108:111], a[72:75], v[180:195]
    ds_read_b64_tr_b16 a[96:97], v233 offset:26624
    ds_read_b64_tr_b16 a[98:99], v233 offset:27648
    v_add_f32 v208, 1.0, v208
    v_add_f32 v209, 1.0, v209
    v_add_f32 v210, 1.0, v210
    v_add_f32 v211, 1.0, v211
    v_mfma_f32_32x32x16_bf16 v[180:195], a[112:115], a[76:79], v[180:195]
    s_waitcnt lgkmcnt(6)
    ds_read_b64_tr_b16 a[100:101], v233 offset:28672
    ds_read_b64_tr_b16 a[102:103], v233 offset:29696
    v_rcp_f32 v208, v208
    v_rcp_f32 v209, v209
    v_mfma_f32_32x32x16_bf16 v[180:195], a[116:119], a[80:83], v[180:195]
    ds_read_b64_tr_b16 a[104:105], v233 offset:30720
    ds_read_b64_tr_b16 a[106:107], v233 offset:31744
    v_rcp_f32 v210, v210
    v_rcp_f32 v211, v211
    v_mfma_f32_32x32x16_bf16 v[180:195], a[120:123], a[84:87], v[180:195]
    s_waitcnt lgkmcnt(6)
    ds_read_b64_tr_b16 a[108:109], v233 offset:32768
    ds_read_b64_tr_b16 a[110:111], v233 offset:33792
    v_mul_f32 v208, v176, v208
    v_mul_f32 v209, v177, v209
    v_mul_f32 v210, v178, v210
    v_mul_f32 v211, v179, v211
    v_mfma_f32_32x32x16_bf16 v[180:195], a[124:127], a[88:91], v[180:195]
    ds_read_b64_tr_b16 a[112:113], v233 offset:34816
    ds_read_b64_tr_b16 a[114:115], v233 offset:35840
    v_cvt_pk_bf16_f32 v202, v208, v209
    v_cvt_pk_bf16_f32 v203, v210, v211
    buffer_store_dwordx4 v[200:203], v243, s[16:19], s42 offen offset:512 sc1
    s_barrier
    v_mfma_f32_32x32x16_bf16 v[164:179], a[92:95], v[0:3], 0
    s_waitcnt lgkmcnt(6)
    s_add_u32 m0, s57, 0
    s_mul_i32 s56, s28, 1327104
    s_add_u32 s56, s56, s36
    ds_read_b64_tr_b16 a[116:117], v233 offset:36864
    ds_read_b64_tr_b16 a[118:119], v233 offset:37888
    v_mfma_f32_32x32x16_bf16 v[164:179], a[96:99], v[4:7], v[164:179]
    buffer_load_dwordx4 v224, s[12:15], s56 offen offset:0  lds
    ds_read_b64_tr_b16 a[120:121], v233 offset:38912
    ds_read_b64_tr_b16 a[122:123], v233 offset:39936
    v_mfma_f32_32x32x16_bf16 v[164:179], a[100:103], v[8:11], v[164:179]
    s_waitcnt lgkmcnt(6)
    buffer_load_dwordx4 v225, s[12:15], s56 offen offset:1024  lds
    ds_read_b64_tr_b16 a[124:125], v233 offset:40960
    ds_read_b64_tr_b16 a[126:127], v233 offset:41984
    v_mfma_f32_32x32x16_bf16 v[164:179], a[104:107], v[12:15], v[164:179]
    ds_read_b64_tr_b16 a[92:93], v233 offset:43008
    ds_read_b64_tr_b16 a[94:95], v233 offset:44032
    v_mfma_f32_32x32x16_bf16 v[164:179], a[108:111], v[16:19], v[164:179]
    s_waitcnt lgkmcnt(6)
    buffer_load_dwordx4 v226, s[12:15], s56 offen offset:2048  lds
    ds_read_b64_tr_b16 a[96:97], v233 offset:45056
    ds_read_b64_tr_b16 a[98:99], v233 offset:46080
    v_mfma_f32_32x32x16_bf16 v[164:179], a[112:115], v[20:23], v[164:179]
    ds_read_b64_tr_b16 a[100:101], v233 offset:47104
    ds_read_b64_tr_b16 a[102:103], v233 offset:48128
    v_mfma_f32_32x32x16_bf16 v[164:179], a[116:119], v[24:27], v[164:179]
    s_waitcnt lgkmcnt(6)
    buffer_load_dwordx4 v227, s[12:15], s56 offen offset:3072  lds
    ds_read_b64_tr_b16 a[104:105], v234 offset:0
    ds_read_b64_tr_b16 a[106:107], v234 offset:1024
    v_mfma_f32_32x32x16_bf16 v[164:179], a[120:123], v[28:31], v[164:179]
    s_add_u32 m0, s57, 4096
    s_add_u32 s56, s56, 294912
    ds_read_b64_tr_b16 a[108:109], v234 offset:2048
    ds_read_b64_tr_b16 a[110:111], v234 offset:3072
    v_mfma_f32_32x32x16_bf16 v[164:179], a[124:127], v[32:35], v[164:179]
    s_waitcnt lgkmcnt(6)
    buffer_load_dwordx4 v224, s[12:15], s56 offen offset:0  lds
    ds_read_b64_tr_b16 a[112:113], v234 offset:4096
    ds_read_b64_tr_b16 a[114:115], v234 offset:5120
    v_mfma_f32_32x32x16_bf16 v[164:179], a[92:95], v[36:39], v[164:179]
    ds_read_b64_tr_b16 a[116:117], v234 offset:6144
    ds_read_b64_tr_b16 a[118:119], v234 offset:7168
    v_mfma_f32_32x32x16_bf16 v[164:179], a[96:99], v[40:43], v[164:179]
    s_waitcnt lgkmcnt(6)
    buffer_load_dwordx4 v225, s[12:15], s56 offen offset:1024  lds
    ds_read_b64_tr_b16 a[120:121], v234 offset:8192
    ds_read_b64_tr_b16 a[122:123], v234 offset:9216
    v_mfma_f32_32x32x16_bf16 v[164:179], a[100:103], v[44:47], v[164:179]
    ds_read_b64_tr_b16 a[124:125], v234 offset:10240
    ds_read_b64_tr_b16 a[126:127], v234 offset:11264
    v_mfma_f32_32x32x16_bf16 v[164:179], a[104:107], v[48:51], v[164:179]
    s_waitcnt lgkmcnt(6)
    buffer_load_dwordx4 v226, s[12:15], s56 offen offset:2048  lds
    ds_read_b64_tr_b16 a[92:93], v234 offset:12288
    ds_read_b64_tr_b16 a[94:95], v234 offset:13312
    v_mfma_f32_32x32x16_bf16 v[164:179], a[108:111], a[0:3], v[164:179]
    ds_read_b64_tr_b16 a[96:97], v234 offset:14336
    ds_read_b64_tr_b16 a[98:99], v234 offset:15360
    v_mfma_f32_32x32x16_bf16 v[164:179], a[112:115], a[4:7], v[164:179]
    s_waitcnt lgkmcnt(6)
    buffer_load_dwordx4 v227, s[12:15], s56 offen offset:3072  lds
    ds_read_b64_tr_b16 a[100:101], v234 offset:16384
    ds_read_b64_tr_b16 a[102:103], v234 offset:17408
    v_mfma_f32_32x32x16_bf16 v[164:179], a[116:119], a[8:11], v[164:179]
    s_add_u32 m0, s57, 8192
    s_add_u32 s56, s56, 294912
    ds_read_b64_tr_b16 a[104:105], v234 offset:18432
    ds_read_b64_tr_b16 a[106:107], v234 offset:19456
    v_mfma_f32_32x32x16_bf16 v[164:179], a[120:123], a[12:15], v[164:179]
    s_waitcnt lgkmcnt(6)
    buffer_load_dwordx4 v224, s[12:15], s56 offen offset:0  lds
    ds_read_b64_tr_b16 a[108:109], v234 offset:20480
    ds_read_b64_tr_b16 a[110:111], v234 offset:21504
    v_mul_f32 v204, v180, v180
    v_mul_f32 v205, v181, v181
    v_mul_f32 v206, v182, v182
    v_mul_f32 v207, v183, v183
    v_fma_f32 v204, v204, v251, v250
    v_fma_f32 v205, v205, v251, v250
    v_fma_f32 v206, v206, v251, v250
    v_mfma_f32_32x32x16_bf16 v[164:179], a[124:127], a[16:19], v[164:179]
    ds_read_b64_tr_b16 a[112:113], v234 offset:22528
    ds_read_b64_tr_b16 a[114:115], v234 offset:23552
    v_fma_f32 v207, v207, v251, v250
    v_mul_f32 v204, v204, v180
    v_mul_f32 v205, v205, v181
    v_mul_f32 v206, v206, v182
    v_mul_f32 v207, v207, v183
    v_exp_f32 v204, v204
    v_exp_f32 v205, v205
    v_mfma_f32_32x32x16_bf16 v[164:179], a[92:95], a[20:23], v[164:179]
    s_waitcnt lgkmcnt(6)
    buffer_load_dwordx4 v225, s[12:15], s56 offen offset:1024  lds
    ds_read_b64_tr_b16 a[116:117], v234 offset:24576
    ds_read_b64_tr_b16 a[118:119], v234 offset:25600
    v_exp_f32 v206, v206
    v_exp_f32 v207, v207
    v_add_f32 v204, 1.0, v204
    v_add_f32 v205, 1.0, v205
    v_add_f32 v206, 1.0, v206
    v_mfma_f32_32x32x16_bf16 v[164:179], a[96:99], a[24:27], v[164:179]
    ds_read_b64_tr_b16 a[120:121], v234 offset:26624
    ds_read_b64_tr_b16 a[122:123], v234 offset:27648
    v_add_f32 v207, 1.0, v207
    v_rcp_f32 v204, v204
    v_rcp_f32 v205, v205
    v_rcp_f32 v206, v206
    v_rcp_f32 v207, v207
    v_mfma_f32_32x32x16_bf16 v[164:179], a[100:103], a[28:31], v[164:179]
    s_waitcnt lgkmcnt(6)
    buffer_load_dwordx4 v226, s[12:15], s56 offen offset:2048  lds
    ds_read_b64_tr_b16 a[124:125], v234 offset:28672
    ds_read_b64_tr_b16 a[126:127], v234 offset:29696
    v_mul_f32 v204, v180, v204
    v_mul_f32 v205, v181, v205
    v_mul_f32 v206, v182, v206
    v_mul_f32 v207, v183, v207
    v_cvt_pk_bf16_f32 v196, v204, v205
    v_cvt_pk_bf16_f32 v197, v206, v207
    v_mul_f32 v208, v184, v184
    v_mfma_f32_32x32x16_bf16 v[164:179], a[104:107], a[32:35], v[164:179]
    ds_read_b64_tr_b16 a[92:93], v234 offset:30720
    ds_read_b64_tr_b16 a[94:95], v234 offset:31744
    v_mul_f32 v209, v185, v185
    v_mul_f32 v210, v186, v186
    v_mul_f32 v211, v187, v187
    v_fma_f32 v208, v208, v251, v250
    v_fma_f32 v209, v209, v251, v250
    v_fma_f32 v210, v210, v251, v250
    v_fma_f32 v211, v211, v251, v250
    v_mul_f32 v208, v208, v184
    v_mul_f32 v209, v209, v185
    v_mfma_f32_32x32x16_bf16 v[164:179], a[108:111], a[36:39], v[164:179]
    s_waitcnt lgkmcnt(6)
    buffer_load_dwordx4 v227, s[12:15], s56 offen offset:3072  lds
    ds_read_b64_tr_b16 a[96:97], v234 offset:32768
    ds_read_b64_tr_b16 a[98:99], v234 offset:33792
    v_mul_f32 v210, v210, v186
    v_mul_f32 v211, v211, v187
    v_exp_f32 v208, v208
    v_exp_f32 v209, v209
    v_add_f32 v208, 1.0, v208
    v_mfma_f32_32x32x16_bf16 v[164:179], a[112:115], a[40:43], v[164:179]
    s_add_u32 m0, s57, 12288
    s_add_u32 s56, s56, 294912
    ds_read_b64_tr_b16 a[100:101], v234 offset:34816
    ds_read_b64_tr_b16 a[102:103], v234 offset:35840
    v_exp_f32 v210, v210
    v_exp_f32 v211, v211
    v_add_f32 v209, 1.0, v209
    v_add_f32 v210, 1.0, v210
    v_add_f32 v211, 1.0, v211
    v_mfma_f32_32x32x16_bf16 v[164:179], a[116:119], a[44:47], v[164:179]
    s_waitcnt lgkmcnt(6)
    buffer_load_dwordx4 v224, s[12:15], s56 offen offset:0  lds
    ds_read_b64_tr_b16 a[104:105], v234 offset:36864
    ds_read_b64_tr_b16 a[106:107], v234 offset:37888
    v_rcp_f32 v208, v208
    v_rcp_f32 v209, v209
    v_rcp_f32 v210, v210
    v_mul_f32 v208, v184, v208
    v_mfma_f32_32x32x16_bf16 v[164:179], a[120:123], a[48:51], v[164:179]
    ds_read_b64_tr_b16 a[108:109], v234 offset:38912
    ds_read_b64_tr_b16 a[110:111], v234 offset:39936
    v_rcp_f32 v211, v211
    v_mul_f32 v209, v185, v209
    v_mul_f32 v210, v186, v210
    v_mul_f32 v211, v187, v211
    v_cvt_pk_bf16_f32 v200, v208, v209
    v_cvt_pk_bf16_f32 v201, v210, v211
    v_mul_f32 v204, v188, v188
    v_mul_f32 v205, v189, v189
    v_mfma_f32_32x32x16_bf16 v[164:179], a[124:127], a[52:55], v[164:179]
    s_waitcnt lgkmcnt(6)
    buffer_load_dwordx4 v225, s[12:15], s56 offen offset:1024  lds
    ds_read_b64_tr_b16 a[112:113], v234 offset:40960
    ds_read_b64_tr_b16 a[114:115], v234 offset:41984
    v_mul_f32 v206, v190, v190
    v_mul_f32 v207, v191, v191
    v_fma_f32 v204, v204, v251, v250
    v_fma_f32 v205, v205, v251, v250
    v_fma_f32 v206, v206, v251, v250
    v_fma_f32 v207, v207, v251, v250
    v_mul_f32 v204, v204, v188
    v_mfma_f32_32x32x16_bf16 v[164:179], a[92:95], a[56:59], v[164:179]
    ds_read_b64_tr_b16 a[116:117], v234 offset:43008
    ds_read_b64_tr_b16 a[118:119], v234 offset:44032
    v_mul_f32 v205, v205, v189
    v_mul_f32 v206, v206, v190
    v_mul_f32 v207, v207, v191
    v_exp_f32 v204, v204
    v_exp_f32 v205, v205
    v_exp_f32 v206, v206
    v_mfma_f32_32x32x16_bf16 v[164:179], a[96:99], a[60:63], v[164:179]
    s_waitcnt lgkmcnt(6)
    buffer_load_dwordx4 v226, s[12:15], s56 offen offset:2048  lds
    ds_read_b64_tr_b16 a[120:121], v234 offset:45056
    ds_read_b64_tr_b16 a[122:123], v234 offset:46080
    v_exp_f32 v207, v207
    v_add_f32 v204, 1.0, v204
    v_add_f32 v205, 1.0, v205
    v_add_f32 v206, 1.0, v206
    v_add_f32 v207, 1.0, v207
    v_mfma_f32_32x32x16_bf16 v[164:179], a[100:103], a[64:67], v[164:179]
    ds_read_b64_tr_b16 a[124:125], v234 offset:47104
    ds_read_b64_tr_b16 a[126:127], v234 offset:48128
    v_rcp_f32 v204, v204
    v_rcp_f32 v205, v205
    v_rcp_f32 v206, v206
    v_rcp_f32 v207, v207
    v_mul_f32 v204, v188, v204
    v_mul_f32 v205, v189, v205
    v_mfma_f32_32x32x16_bf16 v[164:179], a[104:107], a[68:71], v[164:179]
    s_waitcnt lgkmcnt(6)
    buffer_load_dwordx4 v227, s[12:15], s56 offen offset:3072  lds
    ds_read_b64_tr_b16 a[92:93], v236 offset:24576
    ds_read_b64_tr_b16 a[94:95], v236 offset:25600
    v_mul_f32 v206, v190, v206
    v_mul_f32 v207, v191, v207
    v_cvt_pk_bf16_f32 v198, v204, v205
    v_cvt_pk_bf16_f32 v199, v206, v207
    v_mul_f32 v208, v192, v192
    v_mul_f32 v209, v193, v193
    v_mul_f32 v210, v194, v194
    v_mfma_f32_32x32x16_bf16 v[164:179], a[108:111], a[72:75], v[164:179]
    s_add_u32 m0, s57, 16384
    s_add_u32 s56, s56, 294912
    buffer_store_dwordx4 v[196:199], v243, s[16:19], s42 offen offset:1024 sc1
    ds_read_b64_tr_b16 a[96:97], v236 offset:26624
    ds_read_b64_tr_b16 a[98:99], v236 offset:27648
    v_mul_f32 v211, v195, v195
    v_fma_f32 v208, v208, v251, v250
    v_fma_f32 v209, v209, v251, v250
    v_fma_f32 v210, v210, v251, v250
    v_fma_f32 v211, v211, v251, v250
    v_mul_f32 v208, v208, v192
    v_mfma_f32_32x32x16_bf16 v[164:179], a[112:115], a[76:79], v[164:179]
    s_waitcnt lgkmcnt(6)
    buffer_load_dwordx4 v224, s[12:15], s56 offen offset:0  lds
    ds_read_b64_tr_b16 a[100:101], v236 offset:28672
    ds_read_b64_tr_b16 a[102:103], v236 offset:29696
    v_mul_f32 v209, v209, v193
    v_mul_f32 v210, v210, v194
    v_mul_f32 v211, v211, v195
    v_exp_f32 v208, v208
    v_exp_f32 v209, v209
    v_mfma_f32_32x32x16_bf16 v[164:179], a[116:119], a[80:83], v[164:179]
    ds_read_b64_tr_b16 a[104:105], v236 offset:30720
    ds_read_b64_tr_b16 a[106:107], v236 offset:31744
    v_exp_f32 v210, v210
    v_exp_f32 v211, v211
    v_add_f32 v208, 1.0, v208
    v_add_f32 v209, 1.0, v209
    v_add_f32 v210, 1.0, v210
    v_add_f32 v211, 1.0, v211
    v_mfma_f32_32x32x16_bf16 v[164:179], a[120:123], a[84:87], v[164:179]
    s_waitcnt lgkmcnt(6)
    buffer_load_dwordx4 v225, s[12:15], s56 offen offset:1024  lds
    ds_read_b64_tr_b16 a[108:109], v236 offset:32768
    ds_read_b64_tr_b16 a[110:111], v236 offset:33792
    v_rcp_f32 v208, v208
    v_rcp_f32 v209, v209
    v_rcp_f32 v210, v210
    v_mul_f32 v208, v192, v208
    v_mfma_f32_32x32x16_bf16 v[164:179], a[124:127], a[88:91], v[164:179]
    ds_read_b64_tr_b16 a[112:113], v236 offset:34816
    ds_read_b64_tr_b16 a[114:115], v236 offset:35840
    v_rcp_f32 v211, v211
    v_mul_f32 v209, v193, v209
    v_mul_f32 v210, v194, v210
    v_mul_f32 v211, v195, v211
    v_cvt_pk_bf16_f32 v202, v208, v209
    v_cvt_pk_bf16_f32 v203, v210, v211
    buffer_store_dwordx4 v[200:203], v243, s[16:19], s42 offen offset:1536 sc1
    v_mfma_f32_32x32x16_bf16 v[180:195], a[92:95], v[0:3], 0
    s_waitcnt lgkmcnt(6)
    buffer_atomic_add v255, v247, s[20:23], s67 offen sc1
    ds_read_b64_tr_b16 a[116:117], v236 offset:36864
    ds_read_b64_tr_b16 a[118:119], v236 offset:37888
    v_mfma_f32_32x32x16_bf16 v[180:195], a[96:99], v[4:7], v[180:195]
    ds_read_b64_tr_b16 a[120:121], v236 offset:38912
    ds_read_b64_tr_b16 a[122:123], v236 offset:39936
    v_mfma_f32_32x32x16_bf16 v[180:195], a[100:103], v[8:11], v[180:195]
    s_waitcnt lgkmcnt(6)
    ds_read_b64_tr_b16 a[124:125], v236 offset:40960
    ds_read_b64_tr_b16 a[126:127], v236 offset:41984
    v_mul_f32 v204, v164, v164
    v_mul_f32 v205, v165, v165
    v_mul_f32 v206, v166, v166
    v_mul_f32 v207, v167, v167
    v_fma_f32 v204, v204, v251, v250
    v_mfma_f32_32x32x16_bf16 v[180:195], a[104:107], v[12:15], v[180:195]
    ds_read_b64_tr_b16 a[92:93], v236 offset:43008
    ds_read_b64_tr_b16 a[94:95], v236 offset:44032
    v_fma_f32 v205, v205, v251, v250
    v_fma_f32 v206, v206, v251, v250
    v_fma_f32 v207, v207, v251, v250
    v_mul_f32 v204, v204, v164
    v_mul_f32 v205, v205, v165
    v_mfma_f32_32x32x16_bf16 v[180:195], a[108:111], v[16:19], v[180:195]
    s_waitcnt lgkmcnt(6)
    ds_read_b64_tr_b16 a[96:97], v236 offset:45056
    ds_read_b64_tr_b16 a[98:99], v236 offset:46080
    v_mul_f32 v206, v206, v166
    v_mul_f32 v207, v207, v167
    v_exp_f32 v204, v204
    v_mfma_f32_32x32x16_bf16 v[180:195], a[112:115], v[20:23], v[180:195]
    ds_read_b64_tr_b16 a[100:101], v236 offset:47104
    ds_read_b64_tr_b16 a[102:103], v236 offset:48128
    v_exp_f32 v205, v205
    v_exp_f32 v206, v206
    v_add_f32 v204, 1.0, v204
    v_mfma_f32_32x32x16_bf16 v[180:195], a[116:119], v[24:27], v[180:195]
    s_waitcnt lgkmcnt(6)
    ds_read_b64_tr_b16 a[104:105], v237 offset:0
    ds_read_b64_tr_b16 a[106:107], v237 offset:1024
    v_exp_f32 v207, v207
    v_add_f32 v205, 1.0, v205
    v_add_f32 v206, 1.0, v206
    v_add_f32 v207, 1.0, v207
    v_mfma_f32_32x32x16_bf16 v[180:195], a[120:123], v[28:31], v[180:195]
    ds_read_b64_tr_b16 a[108:109], v237 offset:2048
    ds_read_b64_tr_b16 a[110:111], v237 offset:3072
    v_rcp_f32 v204, v204
    v_rcp_f32 v205, v205
    v_mul_f32 v204, v164, v204
    v_mfma_f32_32x32x16_bf16 v[180:195], a[124:127], v[32:35], v[180:195]
    s_waitcnt lgkmcnt(6)
    ds_read_b64_tr_b16 a[112:113], v237 offset:4096
    ds_read_b64_tr_b16 a[114:115], v237 offset:5120
    v_rcp_f32 v206, v206
    v_rcp_f32 v207, v207
    v_mul_f32 v205, v165, v205
    v_mfma_f32_32x32x16_bf16 v[180:195], a[92:95], v[36:39], v[180:195]
    ds_read_b64_tr_b16 a[116:117], v237 offset:6144
    ds_read_b64_tr_b16 a[118:119], v237 offset:7168
    v_mul_f32 v206, v166, v206
    v_mul_f32 v207, v167, v207
    v_cvt_pk_bf16_f32 v196, v204, v205
    v_cvt_pk_bf16_f32 v197, v206, v207
    v_mul_f32 v208, v168, v168
    v_mfma_f32_32x32x16_bf16 v[180:195], a[96:99], v[40:43], v[180:195]
    s_waitcnt lgkmcnt(6)
    ds_read_b64_tr_b16 a[120:121], v237 offset:8192
    ds_read_b64_tr_b16 a[122:123], v237 offset:9216
    v_mul_f32 v209, v169, v169
    v_mul_f32 v210, v170, v170
    v_mul_f32 v211, v171, v171
    v_fma_f32 v208, v208, v251, v250
    v_fma_f32 v209, v209, v251, v250
    v_mfma_f32_32x32x16_bf16 v[180:195], a[100:103], v[44:47], v[180:195]
    ds_read_b64_tr_b16 a[124:125], v237 offset:10240
    ds_read_b64_tr_b16 a[126:127], v237 offset:11264
    v_fma_f32 v210, v210, v251, v250
    v_fma_f32 v211, v211, v251, v250
    v_mul_f32 v208, v208, v168
    v_mul_f32 v209, v209, v169
    v_mul_f32 v210, v210, v170
    v_mfma_f32_32x32x16_bf16 v[180:195], a[104:107], v[48:51], v[180:195]
    s_waitcnt lgkmcnt(6)
    ds_read_b64_tr_b16 a[92:93], v237 offset:12288
    ds_read_b64_tr_b16 a[94:95], v237 offset:13312
    v_mul_f32 v211, v211, v171
    v_exp_f32 v208, v208
    v_exp_f32 v209, v209
    v_mfma_f32_32x32x16_bf16 v[180:195], a[108:111], a[0:3], v[180:195]
    ds_read_b64_tr_b16 a[96:97], v237 offset:14336
    ds_read_b64_tr_b16 a[98:99], v237 offset:15360
    v_exp_f32 v210, v210
    v_exp_f32 v211, v211
    v_add_f32 v208, 1.0, v208
    v_mfma_f32_32x32x16_bf16 v[180:195], a[112:115], a[4:7], v[180:195]
    s_waitcnt lgkmcnt(6)
    ds_read_b64_tr_b16 a[100:101], v237 offset:16384
    ds_read_b64_tr_b16 a[102:103], v237 offset:17408
    v_add_f32 v209, 1.0, v209
    v_add_f32 v210, 1.0, v210
    v_add_f32 v211, 1.0, v211
    v_rcp_f32 v208, v208
    v_mfma_f32_32x32x16_bf16 v[180:195], a[116:119], a[8:11], v[180:195]
    ds_read_b64_tr_b16 a[104:105], v237 offset:18432
    ds_read_b64_tr_b16 a[106:107], v237 offset:19456
    v_rcp_f32 v209, v209
    v_rcp_f32 v210, v210
    v_mul_f32 v208, v168, v208
    v_mfma_f32_32x32x16_bf16 v[180:195], a[120:123], a[12:15], v[180:195]
    s_waitcnt lgkmcnt(6)
    ds_read_b64_tr_b16 a[108:109], v237 offset:20480
    ds_read_b64_tr_b16 a[110:111], v237 offset:21504
    v_rcp_f32 v211, v211
    v_mul_f32 v209, v169, v209
    v_mul_f32 v210, v170, v210
    v_mul_f32 v211, v171, v211
    v_mfma_f32_32x32x16_bf16 v[180:195], a[124:127], a[16:19], v[180:195]
    ds_read_b64_tr_b16 a[112:113], v237 offset:22528
    ds_read_b64_tr_b16 a[114:115], v237 offset:23552
    v_cvt_pk_bf16_f32 v200, v208, v209
    v_cvt_pk_bf16_f32 v201, v210, v211
    v_mul_f32 v204, v172, v172
    v_mul_f32 v205, v173, v173
    v_mul_f32 v206, v174, v174
    v_mfma_f32_32x32x16_bf16 v[180:195], a[92:95], a[20:23], v[180:195]
    s_waitcnt lgkmcnt(6)
    ds_read_b64_tr_b16 a[116:117], v237 offset:24576
    ds_read_b64_tr_b16 a[118:119], v237 offset:25600
    v_mul_f32 v207, v175, v175
    v_fma_f32 v204, v204, v251, v250
    v_fma_f32 v205, v205, v251, v250
    v_fma_f32 v206, v206, v251, v250
    v_fma_f32 v207, v207, v251, v250
    v_mfma_f32_32x32x16_bf16 v[180:195], a[96:99], a[24:27], v[180:195]
    ds_read_b64_tr_b16 a[120:121], v237 offset:26624
    ds_read_b64_tr_b16 a[122:123], v237 offset:27648
    v_mul_f32 v204, v204, v172
    v_mul_f32 v205, v205, v173
    v_mul_f32 v206, v206, v174
    v_mul_f32 v207, v207, v175
    v_mfma_f32_32x32x16_bf16 v[180:195], a[100:103], a[28:31], v[180:195]
    s_waitcnt lgkmcnt(6)
    ds_read_b64_tr_b16 a[124:125], v237 offset:28672
    ds_read_b64_tr_b16 a[126:127], v237 offset:29696
    v_exp_f32 v204, v204
    v_exp_f32 v205, v205
    v_add_f32 v204, 1.0, v204
    v_mfma_f32_32x32x16_bf16 v[180:195], a[104:107], a[32:35], v[180:195]
    ds_read_b64_tr_b16 a[92:93], v237 offset:30720
    ds_read_b64_tr_b16 a[94:95], v237 offset:31744
    v_exp_f32 v206, v206
    v_exp_f32 v207, v207
    v_add_f32 v205, 1.0, v205
    v_mfma_f32_32x32x16_bf16 v[180:195], a[108:111], a[36:39], v[180:195]
    s_waitcnt lgkmcnt(6)
    ds_read_b64_tr_b16 a[96:97], v237 offset:32768
    ds_read_b64_tr_b16 a[98:99], v237 offset:33792
    v_add_f32 v206, 1.0, v206
    v_add_f32 v207, 1.0, v207
    v_rcp_f32 v204, v204
    v_mul_f32 v208, v176, v176
    v_mfma_f32_32x32x16_bf16 v[180:195], a[112:115], a[40:43], v[180:195]
    ds_read_b64_tr_b16 a[100:101], v237 offset:34816
    ds_read_b64_tr_b16 a[102:103], v237 offset:35840
    v_rcp_f32 v205, v205
    v_rcp_f32 v206, v206
    v_mul_f32 v204, v172, v204
    v_mfma_f32_32x32x16_bf16 v[180:195], a[116:119], a[44:47], v[180:195]
    s_waitcnt lgkmcnt(6)
    ds_read_b64_tr_b16 a[104:105], v237 offset:36864
    ds_read_b64_tr_b16 a[106:107], v237 offset:37888
    v_rcp_f32 v207, v207
    v_mul_f32 v205, v173, v205
    v_mul_f32 v206, v174, v206
    v_mfma_f32_32x32x16_bf16 v[180:195], a[120:123], a[48:51], v[180:195]
    ds_read_b64_tr_b16 a[108:109], v237 offset:38912
    ds_read_b64_tr_b16 a[110:111], v237 offset:39936
    v_mul_f32 v207, v175, v207
    v_cvt_pk_bf16_f32 v198, v204, v205
    v_cvt_pk_bf16_f32 v199, v206, v207
    v_mul_f32 v209, v177, v177
    v_mfma_f32_32x32x16_bf16 v[180:195], a[124:127], a[52:55], v[180:195]
    s_waitcnt lgkmcnt(6)
    buffer_store_dwordx4 v[196:199], v243, s[16:19], s43 offen offset:0 sc1
    ds_read_b64_tr_b16 a[112:113], v237 offset:40960
    ds_read_b64_tr_b16 a[114:115], v237 offset:41984
    v_mul_f32 v210, v178, v178
    v_mul_f32 v211, v179, v179
    v_mfma_f32_32x32x16_bf16 v[180:195], a[92:95], a[56:59], v[180:195]
    ds_read_b64_tr_b16 a[116:117], v237 offset:43008
    ds_read_b64_tr_b16 a[118:119], v237 offset:44032
    v_fma_f32 v208, v208, v251, v250
    v_fma_f32 v209, v209, v251, v250
    v_fma_f32 v210, v210, v251, v250
    v_fma_f32 v211, v211, v251, v250
    v_mfma_f32_32x32x16_bf16 v[180:195], a[96:99], a[60:63], v[180:195]
    s_waitcnt lgkmcnt(6)
    ds_read_b64_tr_b16 a[120:121], v237 offset:45056
    ds_read_b64_tr_b16 a[122:123], v237 offset:46080
    v_mul_f32 v208, v208, v176
    v_mul_f32 v209, v209, v177
    v_mul_f32 v210, v210, v178
    v_mul_f32 v211, v211, v179
    v_mfma_f32_32x32x16_bf16 v[180:195], a[100:103], a[64:67], v[180:195]
    ds_read_b64_tr_b16 a[124:125], v237 offset:47104
    ds_read_b64_tr_b16 a[126:127], v237 offset:48128
    v_exp_f32 v208, v208
    v_exp_f32 v209, v209
    v_mfma_f32_32x32x16_bf16 v[180:195], a[104:107], a[68:71], v[180:195]
    s_waitcnt lgkmcnt(6)
    s_waitcnt vmcnt(3)
    s_barrier
    ds_read_b64_tr_b16 a[92:93], v232 offset:0
    ds_read_b64_tr_b16 a[94:95], v232 offset:1024
    v_exp_f32 v210, v210
    v_exp_f32 v211, v211
    v_mfma_f32_32x32x16_bf16 v[180:195], a[108:111], a[72:75], v[180:195]
    ds_read_b64_tr_b16 a[96:97], v232 offset:2048
    ds_read_b64_tr_b16 a[98:99], v232 offset:3072
    v_add_f32 v208, 1.0, v208
    v_add_f32 v209, 1.0, v209
    v_add_f32 v210, 1.0, v210
    v_add_f32 v211, 1.0, v211
    v_mfma_f32_32x32x16_bf16 v[180:195], a[112:115], a[76:79], v[180:195]
    s_waitcnt lgkmcnt(6)
    ds_read_b64_tr_b16 a[100:101], v232 offset:4096
    ds_read_b64_tr_b16 a[102:103], v232 offset:5120
    v_rcp_f32 v208, v208
    v_rcp_f32 v209, v209
    v_mfma_f32_32x32x16_bf16 v[180:195], a[116:119], a[80:83], v[180:195]
    ds_read_b64_tr_b16 a[104:105], v232 offset:6144
    ds_read_b64_tr_b16 a[106:107], v232 offset:7168
    v_rcp_f32 v210, v210
    v_rcp_f32 v211, v211
    v_mfma_f32_32x32x16_bf16 v[180:195], a[120:123], a[84:87], v[180:195]
    s_waitcnt lgkmcnt(6)
    ds_read_b64_tr_b16 a[108:109], v232 offset:8192
    ds_read_b64_tr_b16 a[110:111], v232 offset:9216
    v_mul_f32 v208, v176, v208
    v_mul_f32 v209, v177, v209
    v_mul_f32 v210, v178, v210
    v_mul_f32 v211, v179, v211
    v_mfma_f32_32x32x16_bf16 v[180:195], a[124:127], a[88:91], v[180:195]
    ds_read_b64_tr_b16 a[112:113], v232 offset:10240
    ds_read_b64_tr_b16 a[114:115], v232 offset:11264
    v_cvt_pk_bf16_f32 v202, v208, v209
    v_cvt_pk_bf16_f32 v203, v210, v211
    buffer_store_dwordx4 v[200:203], v243, s[16:19], s43 offen offset:512 sc1
    s_barrier
    v_mfma_f32_32x32x16_bf16 v[164:179], a[92:95], v[0:3], 0
    s_waitcnt lgkmcnt(6)
    s_add_u32 m0, s57, 73728
    s_mul_i32 s56, s28, 497664
    s_add_u32 s56, s56, s37
    ds_read_b64_tr_b16 a[116:117], v232 offset:12288
    ds_read_b64_tr_b16 a[118:119], v232 offset:13312
    v_mfma_f32_32x32x16_bf16 v[164:179], a[96:99], v[4:7], v[164:179]
    buffer_load_dwordx4 v228, s[8:11], s56 offen offset:0  lds
    ds_read_b64_tr_b16 a[120:121], v232 offset:14336
    ds_read_b64_tr_b16 a[122:123], v232 offset:15360
    v_mfma_f32_32x32x16_bf16 v[164:179], a[100:103], v[8:11], v[164:179]
    s_waitcnt lgkmcnt(6)
    buffer_load_dwordx4 v229, s[8:11], s56 offen offset:1024  lds
    ds_read_b64_tr_b16 a[124:125], v232 offset:16384
    ds_read_b64_tr_b16 a[126:127], v232 offset:17408
    v_mfma_f32_32x32x16_bf16 v[164:179], a[104:107], v[12:15], v[164:179]
    ds_read_b64_tr_b16 a[92:93], v232 offset:18432
    ds_read_b64_tr_b16 a[94:95], v232 offset:19456
    v_mfma_f32_32x32x16_bf16 v[164:179], a[108:111], v[16:19], v[164:179]
    s_waitcnt lgkmcnt(6)
    buffer_load_dwordx4 v230, s[8:11], s56 offen offset:2048  lds
    ds_read_b64_tr_b16 a[96:97], v232 offset:20480
    ds_read_b64_tr_b16 a[98:99], v232 offset:21504
    v_mfma_f32_32x32x16_bf16 v[164:179], a[112:115], v[20:23], v[164:179]
    ds_read_b64_tr_b16 a[100:101], v232 offset:22528
    ds_read_b64_tr_b16 a[102:103], v232 offset:23552
    v_mfma_f32_32x32x16_bf16 v[164:179], a[116:119], v[24:27], v[164:179]
    s_waitcnt lgkmcnt(6)
    buffer_load_dwordx4 v231, s[8:11], s56 offen offset:3072  lds
    ds_read_b64_tr_b16 a[104:105], v232 offset:24576
    ds_read_b64_tr_b16 a[106:107], v232 offset:25600
    v_mfma_f32_32x32x16_bf16 v[164:179], a[120:123], v[28:31], v[164:179]
    s_add_u32 m0, s57, 77824
    s_add_u32 s56, s56, 110592
    ds_read_b64_tr_b16 a[108:109], v232 offset:26624
    ds_read_b64_tr_b16 a[110:111], v232 offset:27648
    v_mfma_f32_32x32x16_bf16 v[164:179], a[124:127], v[32:35], v[164:179]
    s_waitcnt lgkmcnt(6)
    buffer_load_dwordx4 v228, s[8:11], s56 offen offset:0  lds
    ds_read_b64_tr_b16 a[112:113], v232 offset:28672
    ds_read_b64_tr_b16 a[114:115], v232 offset:29696
    v_mfma_f32_32x32x16_bf16 v[164:179], a[92:95], v[36:39], v[164:179]
    ds_read_b64_tr_b16 a[116:117], v232 offset:30720
    ds_read_b64_tr_b16 a[118:119], v232 offset:31744
    v_mfma_f32_32x32x16_bf16 v[164:179], a[96:99], v[40:43], v[164:179]
    s_waitcnt lgkmcnt(6)
    buffer_load_dwordx4 v229, s[8:11], s56 offen offset:1024  lds
    ds_read_b64_tr_b16 a[120:121], v232 offset:32768
    ds_read_b64_tr_b16 a[122:123], v232 offset:33792
    v_mfma_f32_32x32x16_bf16 v[164:179], a[100:103], v[44:47], v[164:179]
    ds_read_b64_tr_b16 a[124:125], v232 offset:34816
    ds_read_b64_tr_b16 a[126:127], v232 offset:35840
    v_mfma_f32_32x32x16_bf16 v[164:179], a[104:107], v[48:51], v[164:179]
    s_waitcnt lgkmcnt(6)
    buffer_load_dwordx4 v230, s[8:11], s56 offen offset:2048  lds
    ds_read_b64_tr_b16 a[92:93], v232 offset:36864
    ds_read_b64_tr_b16 a[94:95], v232 offset:37888
    v_mfma_f32_32x32x16_bf16 v[164:179], a[108:111], a[0:3], v[164:179]
    ds_read_b64_tr_b16 a[96:97], v232 offset:38912
    ds_read_b64_tr_b16 a[98:99], v232 offset:39936
    v_mfma_f32_32x32x16_bf16 v[164:179], a[112:115], a[4:7], v[164:179]
    s_waitcnt lgkmcnt(6)
    buffer_load_dwordx4 v231, s[8:11], s56 offen offset:3072  lds
    ds_read_b64_tr_b16 a[100:101], v232 offset:40960
    ds_read_b64_tr_b16 a[102:103], v232 offset:41984
    v_mfma_f32_32x32x16_bf16 v[164:179], a[116:119], a[8:11], v[164:179]
    s_add_u32 m0, s57, 81920
    s_add_u32 s56, s56, 110592
    ds_read_b64_tr_b16 a[104:105], v232 offset:43008
    ds_read_b64_tr_b16 a[106:107], v232 offset:44032
    v_mfma_f32_32x32x16_bf16 v[164:179], a[120:123], a[12:15], v[164:179]
    s_waitcnt lgkmcnt(6)
    buffer_load_dwordx4 v228, s[8:11], s56 offen offset:0  lds
    ds_read_b64_tr_b16 a[108:109], v232 offset:45056
    ds_read_b64_tr_b16 a[110:111], v232 offset:46080
    v_mul_f32 v204, v180, v180
    v_mul_f32 v205, v181, v181
    v_mul_f32 v206, v182, v182
    v_mul_f32 v207, v183, v183
    v_fma_f32 v204, v204, v251, v250
    v_fma_f32 v205, v205, v251, v250
    v_fma_f32 v206, v206, v251, v250
    v_mfma_f32_32x32x16_bf16 v[164:179], a[124:127], a[16:19], v[164:179]
    ds_read_b64_tr_b16 a[112:113], v232 offset:47104
    ds_read_b64_tr_b16 a[114:115], v232 offset:48128
    v_fma_f32 v207, v207, v251, v250
    v_mul_f32 v204, v204, v180
    v_mul_f32 v205, v205, v181
    v_mul_f32 v206, v206, v182
    v_mul_f32 v207, v207, v183
    v_exp_f32 v204, v204
    v_exp_f32 v205, v205
    v_mfma_f32_32x32x16_bf16 v[164:179], a[92:95], a[20:23], v[164:179]
    s_waitcnt lgkmcnt(6)
    buffer_load_dwordx4 v229, s[8:11], s56 offen offset:1024  lds
    ds_read_b64_tr_b16 a[116:117], v233 offset:0
    ds_read_b64_tr_b16 a[118:119], v233 offset:1024
    v_exp_f32 v206, v206
    v_exp_f32 v207, v207
    v_add_f32 v204, 1.0, v204
    v_add_f32 v205, 1.0, v205
    v_add_f32 v206, 1.0, v206
    v_mfma_f32_32x32x16_bf16 v[164:179], a[96:99], a[24:27], v[164:179]
    ds_read_b64_tr_b16 a[120:121], v233 offset:2048
    ds_read_b64_tr_b16 a[122:123], v233 offset:3072
    v_add_f32 v207, 1.0, v207
    v_rcp_f32 v204, v204
    v_rcp_f32 v205, v205
    v_rcp_f32 v206, v206
    v_rcp_f32 v207, v207
    v_mfma_f32_32x32x16_bf16 v[164:179], a[100:103], a[28:31], v[164:179]
    s_waitcnt lgkmcnt(6)
    buffer_load_dwordx4 v230, s[8:11], s56 offen offset:2048  lds
    ds_read_b64_tr_b16 a[124:125], v233 offset:4096
    ds_read_b64_tr_b16 a[126:127], v233 offset:5120
    v_mul_f32 v204, v180, v204
    v_mul_f32 v205, v181, v205
    v_mul_f32 v206, v182, v206
    v_mul_f32 v207, v183, v207
    v_cvt_pk_bf16_f32 v196, v204, v205
    v_cvt_pk_bf16_f32 v197, v206, v207
    v_mul_f32 v208, v184, v184
    v_mfma_f32_32x32x16_bf16 v[164:179], a[104:107], a[32:35], v[164:179]
    ds_read_b64_tr_b16 a[92:93], v233 offset:6144
    ds_read_b64_tr_b16 a[94:95], v233 offset:7168
    v_mul_f32 v209, v185, v185
    v_mul_f32 v210, v186, v186
    v_mul_f32 v211, v187, v187
    v_fma_f32 v208, v208, v251, v250
    v_fma_f32 v209, v209, v251, v250
    v_fma_f32 v210, v210, v251, v250
    v_fma_f32 v211, v211, v251, v250
    v_mul_f32 v208, v208, v184
    v_mul_f32 v209, v209, v185
    v_mfma_f32_32x32x16_bf16 v[164:179], a[108:111], a[36:39], v[164:179]
    s_waitcnt lgkmcnt(6)
    buffer_load_dwordx4 v231, s[8:11], s56 offen offset:3072  lds
    ds_read_b64_tr_b16 a[96:97], v233 offset:8192
    ds_read_b64_tr_b16 a[98:99], v233 offset:9216
    v_mul_f32 v210, v210, v186
    v_mul_f32 v211, v211, v187
    v_exp_f32 v208, v208
    v_exp_f32 v209, v209
    v_add_f32 v208, 1.0, v208
    v_mfma_f32_32x32x16_bf16 v[164:179], a[112:115], a[40:43], v[164:179]
    s_add_u32 m0, s57, 86016
    s_add_u32 s56, s56, 110592
    ds_read_b64_tr_b16 a[100:101], v233 offset:10240
    ds_read_b64_tr_b16 a[102:103], v233 offset:11264
    v_exp_f32 v210, v210
    v_exp_f32 v211, v211
    v_add_f32 v209, 1.0, v209
    v_add_f32 v210, 1.0, v210
    v_add_f32 v211, 1.0, v211
    v_mfma_f32_32x32x16_bf16 v[164:179], a[116:119], a[44:47], v[164:179]
    s_waitcnt lgkmcnt(6)
    buffer_load_dwordx4 v228, s[8:11], s56 offen offset:0  lds
    ds_read_b64_tr_b16 a[104:105], v233 offset:12288
    ds_read_b64_tr_b16 a[106:107], v233 offset:13312
    v_rcp_f32 v208, v208
    v_rcp_f32 v209, v209
    v_rcp_f32 v210, v210
    v_mul_f32 v208, v184, v208
    v_mfma_f32_32x32x16_bf16 v[164:179], a[120:123], a[48:51], v[164:179]
    ds_read_b64_tr_b16 a[108:109], v233 offset:14336
    ds_read_b64_tr_b16 a[110:111], v233 offset:15360
    v_rcp_f32 v211, v211
    v_mul_f32 v209, v185, v209
    v_mul_f32 v210, v186, v210
    v_mul_f32 v211, v187, v211
    v_cvt_pk_bf16_f32 v200, v208, v209
    v_cvt_pk_bf16_f32 v201, v210, v211
    v_mul_f32 v204, v188, v188
    v_mul_f32 v205, v189, v189
    v_mfma_f32_32x32x16_bf16 v[164:179], a[124:127], a[52:55], v[164:179]
    s_waitcnt lgkmcnt(6)
    buffer_load_dwordx4 v229, s[8:11], s56 offen offset:1024  lds
    ds_read_b64_tr_b16 a[112:113], v233 offset:16384
    ds_read_b64_tr_b16 a[114:115], v233 offset:17408
    v_mul_f32 v206, v190, v190
    v_mul_f32 v207, v191, v191
    v_fma_f32 v204, v204, v251, v250
    v_fma_f32 v205, v205, v251, v250
    v_fma_f32 v206, v206, v251, v250
    v_fma_f32 v207, v207, v251, v250
    v_mul_f32 v204, v204, v188
    v_mfma_f32_32x32x16_bf16 v[164:179], a[92:95], a[56:59], v[164:179]
    ds_read_b64_tr_b16 a[116:117], v233 offset:18432
    ds_read_b64_tr_b16 a[118:119], v233 offset:19456
    v_mul_f32 v205, v205, v189
    v_mul_f32 v206, v206, v190
    v_mul_f32 v207, v207, v191
    v_exp_f32 v204, v204
    v_exp_f32 v205, v205
    v_exp_f32 v206, v206
    v_mfma_f32_32x32x16_bf16 v[164:179], a[96:99], a[60:63], v[164:179]
    s_waitcnt lgkmcnt(6)
    buffer_load_dwordx4 v230, s[8:11], s56 offen offset:2048  lds
    ds_read_b64_tr_b16 a[120:121], v233 offset:20480
    ds_read_b64_tr_b16 a[122:123], v233 offset:21504
    v_exp_f32 v207, v207
    v_add_f32 v204, 1.0, v204
    v_add_f32 v205, 1.0, v205
    v_add_f32 v206, 1.0, v206
    v_add_f32 v207, 1.0, v207
    v_mfma_f32_32x32x16_bf16 v[164:179], a[100:103], a[64:67], v[164:179]
    ds_read_b64_tr_b16 a[124:125], v233 offset:22528
    ds_read_b64_tr_b16 a[126:127], v233 offset:23552
    v_rcp_f32 v204, v204
    v_rcp_f32 v205, v205
    v_rcp_f32 v206, v206
    v_rcp_f32 v207, v207
    v_mul_f32 v204, v188, v204
    v_mul_f32 v205, v189, v205
    v_mfma_f32_32x32x16_bf16 v[164:179], a[104:107], a[68:71], v[164:179]
    s_waitcnt lgkmcnt(6)
    buffer_load_dwordx4 v231, s[8:11], s56 offen offset:3072  lds
    ds_read_b64_tr_b16 a[92:93], v235 offset:0
    ds_read_b64_tr_b16 a[94:95], v235 offset:1024
    v_mul_f32 v206, v190, v206
    v_mul_f32 v207, v191, v207
    v_cvt_pk_bf16_f32 v198, v204, v205
    v_cvt_pk_bf16_f32 v199, v206, v207
    v_mul_f32 v208, v192, v192
    v_mul_f32 v209, v193, v193
    v_mul_f32 v210, v194, v194
    v_mfma_f32_32x32x16_bf16 v[164:179], a[108:111], a[72:75], v[164:179]
    s_add_u32 m0, s57, 90112
    s_add_u32 s56, s56, 110592
    buffer_store_dwordx4 v[196:199], v243, s[16:19], s43 offen offset:1024 sc1
    ds_read_b64_tr_b16 a[96:97], v235 offset:2048
    ds_read_b64_tr_b16 a[98:99], v235 offset:3072
    v_mul_f32 v211, v195, v195
    v_fma_f32 v208, v208, v251, v250
    v_fma_f32 v209, v209, v251, v250
    v_fma_f32 v210, v210, v251, v250
    v_fma_f32 v211, v211, v251, v250
    v_mul_f32 v208, v208, v192
    v_mfma_f32_32x32x16_bf16 v[164:179], a[112:115], a[76:79], v[164:179]
    s_waitcnt lgkmcnt(6)
    buffer_load_dwordx4 v228, s[8:11], s56 offen offset:0  lds
    ds_read_b64_tr_b16 a[100:101], v235 offset:4096
    ds_read_b64_tr_b16 a[102:103], v235 offset:5120
    v_mul_f32 v209, v209, v193
    v_mul_f32 v210, v210, v194
    v_mul_f32 v211, v211, v195
    v_exp_f32 v208, v208
    v_exp_f32 v209, v209
    v_mfma_f32_32x32x16_bf16 v[164:179], a[116:119], a[80:83], v[164:179]
    ds_read_b64_tr_b16 a[104:105], v235 offset:6144
    ds_read_b64_tr_b16 a[106:107], v235 offset:7168
    v_exp_f32 v210, v210
    v_exp_f32 v211, v211
    v_add_f32 v208, 1.0, v208
    v_add_f32 v209, 1.0, v209
    v_add_f32 v210, 1.0, v210
    v_add_f32 v211, 1.0, v211
    v_mfma_f32_32x32x16_bf16 v[164:179], a[120:123], a[84:87], v[164:179]
    s_waitcnt lgkmcnt(6)
    buffer_load_dwordx4 v229, s[8:11], s56 offen offset:1024  lds
    ds_read_b64_tr_b16 a[108:109], v235 offset:8192
    ds_read_b64_tr_b16 a[110:111], v235 offset:9216
    v_rcp_f32 v208, v208
    v_rcp_f32 v209, v209
    v_rcp_f32 v210, v210
    v_mul_f32 v208, v192, v208
    v_mfma_f32_32x32x16_bf16 v[164:179], a[124:127], a[88:91], v[164:179]
    ds_read_b64_tr_b16 a[112:113], v235 offset:10240
    ds_read_b64_tr_b16 a[114:115], v235 offset:11264
    v_rcp_f32 v211, v211
    v_mul_f32 v209, v193, v209
    v_mul_f32 v210, v194, v210
    v_mul_f32 v211, v195, v211
    v_cvt_pk_bf16_f32 v202, v208, v209
    v_cvt_pk_bf16_f32 v203, v210, v211
    buffer_store_dwordx4 v[200:203], v243, s[16:19], s43 offen offset:1536 sc1
    v_mfma_f32_32x32x16_bf16 v[180:195], a[92:95], v[0:3], 0
    s_waitcnt lgkmcnt(6)
    ds_read_b64_tr_b16 a[116:117], v235 offset:12288
    ds_read_b64_tr_b16 a[118:119], v235 offset:13312
    v_and_b32 v254, 31, v246
    v_lshrrev_b32 v248, 5, v246
    v_lshlrev_b32 v254, 3, v254
    v_lshl_add_u32 v254, v248, 13, v254
    v_mfma_f32_32x32x16_bf16 v[180:195], a[96:99], v[4:7], v[180:195]
    ds_read_b64_tr_b16 a[120:121], v235 offset:14336
    ds_read_b64_tr_b16 a[122:123], v235 offset:15360
    v_mfma_f32_32x32x16_bf16 v[180:195], a[100:103], v[8:11], v[180:195]
    s_waitcnt lgkmcnt(6)
    buffer_load_dword v255, v247, s[20:23], s67 offen sc1
    ds_read_b64_tr_b16 a[124:125], v235 offset:16384
    ds_read_b64_tr_b16 a[126:127], v235 offset:17408
    v_mul_f32 v204, v164, v164
    v_mul_f32 v205, v165, v165
    v_mul_f32 v206, v166, v166
    v_mul_f32 v207, v167, v167
    v_mfma_f32_32x32x16_bf16 v[180:195], a[104:107], v[12:15], v[180:195]
    ds_read_b64_tr_b16 a[92:93], v235 offset:18432
    ds_read_b64_tr_b16 a[94:95], v235 offset:19456
    v_fma_f32 v204, v204, v251, v250
    v_fma_f32 v205, v205, v251, v250
    v_fma_f32 v206, v206, v251, v250
    v_fma_f32 v207, v207, v251, v250
    v_mul_f32 v204, v204, v164
    v_mul_f32 v205, v205, v165
    v_mfma_f32_32x32x16_bf16 v[180:195], a[108:111], v[16:19], v[180:195]
    s_waitcnt lgkmcnt(6)
    ds_read_b64_tr_b16 a[96:97], v235 offset:20480
    ds_read_b64_tr_b16 a[98:99], v235 offset:21504
    v_mul_f32 v206, v206, v166
    v_mul_f32 v207, v207, v167
    v_exp_f32 v204, v204
    v_exp_f32 v205, v205
    v_mfma_f32_32x32x16_bf16 v[180:195], a[112:115], v[20:23], v[180:195]
    ds_read_b64_tr_b16 a[100:101], v235 offset:22528
    ds_read_b64_tr_b16 a[102:103], v235 offset:23552
    v_exp_f32 v206, v206
    v_exp_f32 v207, v207
    v_add_f32 v204, 1.0, v204
    v_add_f32 v205, 1.0, v205
    v_mfma_f32_32x32x16_bf16 v[180:195], a[116:119], v[24:27], v[180:195]
    s_waitcnt lgkmcnt(6)
    ds_read_b64_tr_b16 a[104:105], v235 offset:24576
    ds_read_b64_tr_b16 a[106:107], v235 offset:25600
    v_add_f32 v206, 1.0, v206
    v_add_f32 v207, 1.0, v207
    v_rcp_f32 v204, v204
    v_rcp_f32 v205, v205
    v_mfma_f32_32x32x16_bf16 v[180:195], a[120:123], v[28:31], v[180:195]
    ds_read_b64_tr_b16 a[108:109], v235 offset:26624
    ds_read_b64_tr_b16 a[110:111], v235 offset:27648
    v_rcp_f32 v206, v206
    v_rcp_f32 v207, v207
    v_mul_f32 v204, v164, v204
    v_mul_f32 v205, v165, v205
    v_mfma_f32_32x32x16_bf16 v[180:195], a[124:127], v[32:35], v[180:195]
    s_waitcnt lgkmcnt(6)
    ds_read_b64_tr_b16 a[112:113], v235 offset:28672
    ds_read_b64_tr_b16 a[114:115], v235 offset:29696
    v_mul_f32 v206, v166, v206
    v_mul_f32 v207, v167, v207
    v_cvt_pk_bf16_f32 v196, v204, v205
    v_cvt_pk_bf16_f32 v197, v206, v207
    v_mul_f32 v208, v168, v168
    v_mul_f32 v209, v169, v169
    v_mfma_f32_32x32x16_bf16 v[180:195], a[92:95], v[36:39], v[180:195]
    ds_read_b64_tr_b16 a[116:117], v235 offset:30720
    ds_read_b64_tr_b16 a[118:119], v235 offset:31744
    v_mul_f32 v210, v170, v170
    v_mul_f32 v211, v171, v171
    v_fma_f32 v208, v208, v251, v250
    v_fma_f32 v209, v209, v251, v250
    v_fma_f32 v210, v210, v251, v250
    v_fma_f32 v211, v211, v251, v250
    v_mfma_f32_32x32x16_bf16 v[180:195], a[96:99], v[40:43], v[180:195]
    s_waitcnt lgkmcnt(6)
    ds_read_b64_tr_b16 a[120:121], v235 offset:32768
    ds_read_b64_tr_b16 a[122:123], v235 offset:33792
    v_mul_f32 v208, v208, v168
    v_mul_f32 v209, v209, v169
    v_mul_f32 v210, v210, v170
    v_mul_f32 v211, v211, v171
    v_exp_f32 v208, v208
    v_mfma_f32_32x32x16_bf16 v[180:195], a[100:103], v[44:47], v[180:195]
    ds_read_b64_tr_b16 a[124:125], v235 offset:34816
    ds_read_b64_tr_b16 a[126:127], v235 offset:35840
    v_exp_f32 v209, v209
    v_exp_f32 v210, v210
    v_exp_f32 v211, v211
    v_mfma_f32_32x32x16_bf16 v[180:195], a[104:107], v[48:51], v[180:195]
    s_waitcnt lgkmcnt(6)
    ds_read_b64_tr_b16 a[92:93], v235 offset:36864
    ds_read_b64_tr_b16 a[94:95], v235 offset:37888
    v_add_f32 v208, 1.0, v208
    v_add_f32 v209, 1.0, v209
    v_add_f32 v210, 1.0, v210
    v_add_f32 v211, 1.0, v211
    v_mfma_f32_32x32x16_bf16 v[180:195], a[108:111], a[0:3], v[180:195]
    ds_read_b64_tr_b16 a[96:97], v235 offset:38912
    ds_read_b64_tr_b16 a[98:99], v235 offset:39936
    v_rcp_f32 v208, v208
    v_rcp_f32 v209, v209
    v_rcp_f32 v210, v210
    v_mfma_f32_32x32x16_bf16 v[180:195], a[112:115], a[4:7], v[180:195]
    s_waitcnt lgkmcnt(6)
    ds_read_b64_tr_b16 a[100:101], v235 offset:40960
    ds_read_b64_tr_b16 a[102:103], v235 offset:41984
    v_rcp_f32 v211, v211
    v_mul_f32 v208, v168, v208
    v_mul_f32 v209, v169, v209
    v_mul_f32 v210, v170, v210
    v_mfma_f32_32x32x16_bf16 v[180:195], a[116:119], a[8:11], v[180:195]
    ds_read_b64_tr_b16 a[104:105], v235 offset:43008
    ds_read_b64_tr_b16 a[106:107], v235 offset:44032
    v_mul_f32 v211, v171, v211
    v_cvt_pk_bf16_f32 v200, v208, v209
    v_cvt_pk_bf16_f32 v201, v210, v211
    v_mul_f32 v204, v172, v172
    v_mul_f32 v205, v173, v173
    v_mfma_f32_32x32x16_bf16 v[180:195], a[120:123], a[12:15], v[180:195]
    s_waitcnt lgkmcnt(6)
    ds_read_b64_tr_b16 a[108:109], v235 offset:45056
    ds_read_b64_tr_b16 a[110:111], v235 offset:46080
    v_mul_f32 v206, v174, v174
    v_mul_f32 v207, v175, v175
    v_fma_f32 v204, v204, v251, v250
    v_fma_f32 v205, v205, v251, v250
    v_fma_f32 v206, v206, v251, v250
    v_mfma_f32_32x32x16_bf16 v[180:195], a[124:127], a[16:19], v[180:195]
    ds_read_b64_tr_b16 a[112:113], v235 offset:47104
    ds_read_b64_tr_b16 a[114:115], v235 offset:48128
    v_fma_f32 v207, v207, v251, v250
    v_mul_f32 v204, v204, v172
    v_mul_f32 v205, v205, v173
    v_mul_f32 v206, v206, v174
    v_mul_f32 v207, v207, v175
    v_mfma_f32_32x32x16_bf16 v[180:195], a[92:95], a[20:23], v[180:195]
    s_waitcnt lgkmcnt(6)
    ds_read_b64_tr_b16 a[116:117], v236 offset:0
    ds_read_b64_tr_b16 a[118:119], v236 offset:1024
    v_exp_f32 v204, v204
    v_exp_f32 v205, v205
    v_add_f32 v204, 1.0, v204
    v_mfma_f32_32x32x16_bf16 v[180:195], a[96:99], a[24:27], v[180:195]
    ds_read_b64_tr_b16 a[120:121], v236 offset:2048
    ds_read_b64_tr_b16 a[122:123], v236 offset:3072
    v_exp_f32 v206, v206
    v_exp_f32 v207, v207
    v_add_f32 v205, 1.0, v205
    v_mfma_f32_32x32x16_bf16 v[180:195], a[100:103], a[28:31], v[180:195]
    s_waitcnt lgkmcnt(6)
    ds_read_b64_tr_b16 a[124:125], v236 offset:4096
    ds_read_b64_tr_b16 a[126:127], v236 offset:5120
    v_add_f32 v206, 1.0, v206
    v_add_f32 v207, 1.0, v207
    v_rcp_f32 v204, v204
    v_mfma_f32_32x32x16_bf16 v[180:195], a[104:107], a[32:35], v[180:195]
    ds_read_b64_tr_b16 a[92:93], v236 offset:6144
    ds_read_b64_tr_b16 a[94:95], v236 offset:7168
    v_rcp_f32 v205, v205
    v_rcp_f32 v206, v206
    v_rcp_f32 v207, v207
    v_mfma_f32_32x32x16_bf16 v[180:195], a[108:111], a[36:39], v[180:195]
    s_waitcnt lgkmcnt(6)
    ds_read_b64_tr_b16 a[96:97], v236 offset:8192
    ds_read_b64_tr_b16 a[98:99], v236 offset:9216
    v_mul_f32 v204, v172, v204
    v_mul_f32 v205, v173, v205
    v_mul_f32 v206, v174, v206
    v_mul_f32 v207, v175, v207
    v_cvt_pk_bf16_f32 v198, v204, v205
    v_mfma_f32_32x32x16_bf16 v[180:195], a[112:115], a[40:43], v[180:195]
    ds_read_b64_tr_b16 a[100:101], v236 offset:10240
    ds_read_b64_tr_b16 a[102:103], v236 offset:11264
    v_cvt_pk_bf16_f32 v199, v206, v207
    v_mul_f32 v208, v176, v176
    v_mul_f32 v209, v177, v177
    v_mul_f32 v210, v178, v178
    v_mul_f32 v211, v179, v179
    v_mfma_f32_32x32x16_bf16 v[180:195], a[116:119], a[44:47], v[180:195]
    s_waitcnt lgkmcnt(6)
    buffer_store_dwordx4 v[196:199], v243, s[16:19], s44 offen offset:0 sc1
    ds_read_b64_tr_b16 a[104:105], v236 offset:12288
    ds_read_b64_tr_b16 a[106:107], v236 offset:13312
    v_fma_f32 v208, v208, v251, v250
    v_fma_f32 v209, v209, v251, v250
    v_fma_f32 v210, v210, v251, v250
    v_mfma_f32_32x32x16_bf16 v[180:195], a[120:123], a[48:51], v[180:195]
    ds_read_b64_tr_b16 a[108:109], v236 offset:14336
    ds_read_b64_tr_b16 a[110:111], v236 offset:15360
    v_fma_f32 v211, v211, v251, v250
    v_mul_f32 v208, v208, v176
    v_mul_f32 v209, v209, v177
    v_mul_f32 v210, v210, v178
    v_mul_f32 v211, v211, v179
    v_mfma_f32_32x32x16_bf16 v[180:195], a[124:127], a[52:55], v[180:195]
    s_waitcnt lgkmcnt(6)
    s_waitcnt vmcnt(1)
    v_readfirstlane_b32 s96, v255
    s_nop 0
    s_cmp_lt_u32 s96, s101
    s_cbranch_scc1 L1_poll_B
L1_poll_B_ok:
    ds_read_b64_tr_b16 a[112:113], v236 offset:16384
    ds_read_b64_tr_b16 a[114:115], v236 offset:17408
    v_mfma_f32_32x32x16_bf16 v[180:195], a[92:95], a[56:59], v[180:195]
    s_add_u32 s97, s66, 4096
    ds_read_b64_tr_b16 a[116:117], v236 offset:18432
    ds_read_b64_tr_b16 a[118:119], v236 offset:19456
    v_exp_f32 v208, v208
    v_exp_f32 v209, v209
    v_add_f32 v208, 1.0, v208
    v_mfma_f32_32x32x16_bf16 v[180:195], a[96:99], a[60:63], v[180:195]
    s_waitcnt lgkmcnt(6)
    ds_read_b64_tr_b16 a[120:121], v236 offset:20480
    ds_read_b64_tr_b16 a[122:123], v236 offset:21504
    v_exp_f32 v210, v210
    v_exp_f32 v211, v211
    v_add_f32 v209, 1.0, v209
    v_mfma_f32_32x32x16_bf16 v[180:195], a[100:103], a[64:67], v[180:195]
    ds_read_b64_tr_b16 a[124:125], v236 offset:22528
    ds_read_b64_tr_b16 a[126:127], v236 offset:23552
    v_add_f32 v210, 1.0, v210
    v_add_f32 v211, 1.0, v211
    v_rcp_f32 v208, v208
    v_mfma_f32_32x32x16_bf16 v[180:195], a[104:107], a[68:71], v[180:195]
    s_waitcnt lgkmcnt(6)
    s_barrier
    ds_read_b64_tr_b16 a[92:93], v233 offset:24576
    ds_read_b64_tr_b16 a[94:95], v233 offset:25600
    v_rcp_f32 v209, v209
    v_rcp_f32 v210, v210
    v_mul_f32 v208, v176, v208
    v_mfma_f32_32x32x16_bf16 v[180:195], a[108:111], a[72:75], v[180:195]
    buffer_load_dwordx2 v[52:53], v254, s[16:19], s66 offen offset:0 sc1
    buffer_load_dwordx2 v[54:55], v254, s[16:19], s66 offen offset:1024 sc1
    ds_read_b64_tr_b16 a[96:97], v233 offset:26624
    ds_read_b64_tr_b16 a[98:99], v233 offset:27648
    v_mul_f32 v209, v177, v209
    v_mfma_f32_32x32x16_bf16 v[180:195], a[112:115], a[76:79], v[180:195]
    s_waitcnt lgkmcnt(6)
    buffer_load_dwordx2 v[56:57], v254, s[16:19], s66 offen offset:2048 sc1
    buffer_load_dwordx2 v[58:59], v254, s[16:19], s66 offen offset:3072 sc1
    ds_read_b64_tr_b16 a[100:101], v233 offset:28672
    ds_read_b64_tr_b16 a[102:103], v233 offset:29696
    v_mul_f32 v210, v178, v210
    v_mfma_f32_32x32x16_bf16 v[180:195], a[116:119], a[80:83], v[180:195]
    buffer_load_dwordx2 v[60:61], v254, s[16:19], s97 offen offset:0 sc1
    buffer_load_dwordx2 v[62:63], v254, s[16:19], s97 offen offset:1024 sc1
    ds_read_b64_tr_b16 a[104:105], v233 offset:30720
    ds_read_b64_tr_b16 a[106:107], v233 offset:31744
    v_cvt_pk_bf16_f32 v202, v208, v209
    v_mfma_f32_32x32x16_bf16 v[180:195], a[120:123], a[84:87], v[180:195]
    s_waitcnt lgkmcnt(6)
    buffer_load_dwordx2 v[64:65], v254, s[16:19], s97 offen offset:2048 sc1
    buffer_load_dwordx2 v[66:67], v254, s[16:19], s97 offen offset:3072 sc1
    ds_read_b64_tr_b16 a[108:109], v233 offset:32768
    ds_read_b64_tr_b16 a[110:111], v233 offset:33792
    v_mfma_f32_32x32x16_bf16 v[180:195], a[124:127], a[88:91], v[180:195]
    ds_read_b64_tr_b16 a[112:113], v233 offset:34816
    ds_read_b64_tr_b16 a[114:115], v233 offset:35840
    v_rcp_f32 v211, v211
    s_nop 0
    v_mul_f32 v211, v179, v211
    v_cvt_pk_bf16_f32 v203, v210, v211
    buffer_store_dwordx4 v[200:203], v243, s[16:19], s44 offen offset:512 sc1
    s_barrier
    s_cmp_lt_u32 s29, 10
    s_cbranch_scc0 L1_B2
    v_mfma_f32_32x32x16_bf16 v[164:179], a[92:95], v[0:3], 0
    s_waitcnt lgkmcnt(6)
    s_add_u32 m0, s57, 0
    s_mul_i32 s56, s28, 497664
    s_add_u32 s56, s56, s38
    ds_read_b64_tr_b16 a[116:117], v233 offset:36864
    ds_read_b64_tr_b16 a[118:119], v233 offset:37888
    v_mfma_f32_32x32x16_bf16 v[164:179], a[96:99], v[4:7], v[164:179]
    buffer_load_dwordx4 v228, s[8:11], s56 offen offset:0  lds
    ds_read_b64_tr_b16 a[120:121], v233 offset:38912
    ds_read_b64_tr_b16 a[122:123], v233 offset:39936
    v_mfma_f32_32x32x16_bf16 v[164:179], a[100:103], v[8:11], v[164:179]
    s_waitcnt lgkmcnt(6)
    buffer_load_dwordx4 v229, s[8:11], s56 offen offset:1024  lds
    ds_read_b64_tr_b16 a[124:125], v233 offset:40960
    ds_read_b64_tr_b16 a[126:127], v233 offset:41984
    v_mfma_f32_32x32x16_bf16 v[164:179], a[104:107], v[12:15], v[164:179]
    ds_read_b64_tr_b16 a[92:93], v233 offset:43008
    ds_read_b64_tr_b16 a[94:95], v233 offset:44032
    v_mfma_f32_32x32x16_bf16 v[164:179], a[108:111], v[16:19], v[164:179]
    s_waitcnt lgkmcnt(6)
    buffer_load_dwordx4 v230, s[8:11], s56 offen offset:2048  lds
    ds_read_b64_tr_b16 a[96:97], v233 offset:45056
    ds_read_b64_tr_b16 a[98:99], v233 offset:46080
    v_mfma_f32_32x32x16_bf16 v[164:179], a[112:115], v[20:23], v[164:179]
    ds_read_b64_tr_b16 a[100:101], v233 offset:47104
    ds_read_b64_tr_b16 a[102:103], v233 offset:48128
    v_mfma_f32_32x32x16_bf16 v[164:179], a[116:119], v[24:27], v[164:179]
    s_waitcnt lgkmcnt(6)
    buffer_load_dwordx4 v231, s[8:11], s56 offen offset:3072  lds
    ds_read_b64_tr_b16 a[104:105], v234 offset:0
    ds_read_b64_tr_b16 a[106:107], v234 offset:1024
    v_mfma_f32_32x32x16_bf16 v[164:179], a[120:123], v[28:31], v[164:179]
    s_add_u32 m0, s57, 4096
    s_add_u32 s56, s56, 110592
    ds_read_b64_tr_b16 a[108:109], v234 offset:2048
    ds_read_b64_tr_b16 a[110:111], v234 offset:3072
    v_mfma_f32_32x32x16_bf16 v[164:179], a[124:127], v[32:35], v[164:179]
    s_waitcnt lgkmcnt(6)
    buffer_load_dwordx4 v228, s[8:11], s56 offen offset:0  lds
    ds_read_b64_tr_b16 a[112:113], v234 offset:4096
    ds_read_b64_tr_b16 a[114:115], v234 offset:5120
    v_mfma_f32_32x32x16_bf16 v[164:179], a[92:95], v[36:39], v[164:179]
    ds_read_b64_tr_b16 a[116:117], v234 offset:6144
    ds_read_b64_tr_b16 a[118:119], v234 offset:7168
    v_mfma_f32_32x32x16_bf16 v[164:179], a[96:99], v[40:43], v[164:179]
    s_waitcnt lgkmcnt(6)
    buffer_load_dwordx4 v229, s[8:11], s56 offen offset:1024  lds
    ds_read_b64_tr_b16 a[120:121], v234 offset:8192
    ds_read_b64_tr_b16 a[122:123], v234 offset:9216
    v_mfma_f32_32x32x16_bf16 v[164:179], a[100:103], v[44:47], v[164:179]
    ds_read_b64_tr_b16 a[124:125], v234 offset:10240
    ds_read_b64_tr_b16 a[126:127], v234 offset:11264
    v_mfma_f32_32x32x16_bf16 v[164:179], a[104:107], v[48:51], v[164:179]
    s_waitcnt lgkmcnt(6)
    buffer_load_dwordx4 v230, s[8:11], s56 offen offset:2048  lds
    ds_read_b64_tr_b16 a[92:93], v234 offset:12288
    ds_read_b64_tr_b16 a[94:95], v234 offset:13312
    v_mfma_f32_32x32x16_bf16 v[164:179], a[108:111], a[0:3], v[164:179]
    ds_read_b64_tr_b16 a[96:97], v234 offset:14336
    ds_read_b64_tr_b16 a[98:99], v234 offset:15360
    v_mfma_f32_32x32x16_bf16 v[164:179], a[112:115], a[4:7], v[164:179]
    s_waitcnt lgkmcnt(6)
    buffer_load_dwordx4 v231, s[8:11], s56 offen offset:3072  lds
    ds_read_b64_tr_b16 a[100:101], v234 offset:16384
    ds_read_b64_tr_b16 a[102:103], v234 offset:17408
    v_mfma_f32_32x32x16_bf16 v[164:179], a[116:119], a[8:11], v[164:179]
    s_add_u32 m0, s57, 8192
    s_add_u32 s56, s56, 110592
    ds_read_b64_tr_b16 a[104:105], v234 offset:18432
    ds_read_b64_tr_b16 a[106:107], v234 offset:19456
    v_mfma_f32_32x32x16_bf16 v[164:179], a[120:123], a[12:15], v[164:179]
    s_waitcnt lgkmcnt(6)
    buffer_load_dwordx4 v228, s[8:11], s56 offen offset:0  lds
    ds_read_b64_tr_b16 a[108:109], v234 offset:20480
    ds_read_b64_tr_b16 a[110:111], v234 offset:21504
    v_mul_f32 v204, v180, v180
    v_mul_f32 v205, v181, v181
    v_mul_f32 v206, v182, v182
    v_mul_f32 v207, v183, v183
    v_fma_f32 v204, v204, v251, v250
    v_fma_f32 v205, v205, v251, v250
    v_fma_f32 v206, v206, v251, v250
    v_mfma_f32_32x32x16_bf16 v[164:179], a[124:127], a[16:19], v[164:179]
    ds_read_b64_tr_b16 a[112:113], v234 offset:22528
    ds_read_b64_tr_b16 a[114:115], v234 offset:23552
    v_fma_f32 v207, v207, v251, v250
    v_mul_f32 v204, v204, v180
    v_mul_f32 v205, v205, v181
    v_mul_f32 v206, v206, v182
    v_mul_f32 v207, v207, v183
    v_exp_f32 v204, v204
    v_exp_f32 v205, v205
    v_mfma_f32_32x32x16_bf16 v[164:179], a[92:95], a[20:23], v[164:179]
    s_waitcnt lgkmcnt(6)
    buffer_load_dwordx4 v229, s[8:11], s56 offen offset:1024  lds
    ds_read_b64_tr_b16 a[116:117], v234 offset:24576
    ds_read_b64_tr_b16 a[118:119], v234 offset:25600
    v_exp_f32 v206, v206
    v_exp_f32 v207, v207
    v_add_f32 v204, 1.0, v204
    v_add_f32 v205, 1.0, v205
    v_add_f32 v206, 1.0, v206
    v_mfma_f32_32x32x16_bf16 v[164:179], a[96:99], a[24:27], v[164:179]
    ds_read_b64_tr_b16 a[120:121], v234 offset:26624
    ds_read_b64_tr_b16 a[122:123], v234 offset:27648
    v_add_f32 v207, 1.0, v207
    v_rcp_f32 v204, v204
    v_rcp_f32 v205, v205
    v_rcp_f32 v206, v206
    v_rcp_f32 v207, v207
    v_mfma_f32_32x32x16_bf16 v[164:179], a[100:103], a[28:31], v[164:179]
    s_waitcnt lgkmcnt(6)
    buffer_load_dwordx4 v230, s[8:11], s56 offen offset:2048  lds
    ds_read_b64_tr_b16 a[124:125], v234 offset:28672
    ds_read_b64_tr_b16 a[126:127], v234 offset:29696
    v_mul_f32 v204, v180, v204
    v_mul_f32 v205, v181, v205
    v_mul_f32 v206, v182, v206
    v_mul_f32 v207, v183, v207
    v_cvt_pk_bf16_f32 v196, v204, v205
    v_cvt_pk_bf16_f32 v197, v206, v207
    v_mul_f32 v208, v184, v184
    v_mfma_f32_32x32x16_bf16 v[164:179], a[104:107], a[32:35], v[164:179]
    ds_read_b64_tr_b16 a[92:93], v234 offset:30720
    ds_read_b64_tr_b16 a[94:95], v234 offset:31744
    v_mul_f32 v209, v185, v185
    v_mul_f32 v210, v186, v186
    v_mul_f32 v211, v187, v187
    v_fma_f32 v208, v208, v251, v250
    v_fma_f32 v209, v209, v251, v250
    v_fma_f32 v210, v210, v251, v250
    v_fma_f32 v211, v211, v251, v250
    v_mul_f32 v208, v208, v184
    v_mul_f32 v209, v209, v185
    v_mfma_f32_32x32x16_bf16 v[164:179], a[108:111], a[36:39], v[164:179]
    s_waitcnt lgkmcnt(6)
    buffer_load_dwordx4 v231, s[8:11], s56 offen offset:3072  lds
    ds_read_b64_tr_b16 a[96:97], v234 offset:32768
    ds_read_b64_tr_b16 a[98:99], v234 offset:33792
    v_mul_f32 v210, v210, v186
    v_mul_f32 v211, v211, v187
    v_exp_f32 v208, v208
    v_exp_f32 v209, v209
    v_add_f32 v208, 1.0, v208
    v_mfma_f32_32x32x16_bf16 v[164:179], a[112:115], a[40:43], v[164:179]
    s_add_u32 m0, s57, 12288
    s_add_u32 s56, s56, 110592
    ds_read_b64_tr_b16 a[100:101], v234 offset:34816
    ds_read_b64_tr_b16 a[102:103], v234 offset:35840
    v_exp_f32 v210, v210
    v_exp_f32 v211, v211
    v_add_f32 v209, 1.0, v209
    v_add_f32 v210, 1.0, v210
    v_add_f32 v211, 1.0, v211
    v_mfma_f32_32x32x16_bf16 v[164:179], a[116:119], a[44:47], v[164:179]
    s_waitcnt lgkmcnt(6)
    buffer_load_dwordx4 v228, s[8:11], s56 offen offset:0  lds
    ds_read_b64_tr_b16 a[104:105], v234 offset:36864
    ds_read_b64_tr_b16 a[106:107], v234 offset:37888
    v_rcp_f32 v208, v208
    v_rcp_f32 v209, v209
    v_rcp_f32 v210, v210
    v_mul_f32 v208, v184, v208
    v_mfma_f32_32x32x16_bf16 v[164:179], a[120:123], a[48:51], v[164:179]
    ds_read_b64_tr_b16 a[108:109], v234 offset:38912
    ds_read_b64_tr_b16 a[110:111], v234 offset:39936
    v_rcp_f32 v211, v211
    v_mul_f32 v209, v185, v209
    v_mul_f32 v210, v186, v210
    v_mul_f32 v211, v187, v211
    v_cvt_pk_bf16_f32 v200, v208, v209
    v_cvt_pk_bf16_f32 v201, v210, v211
    v_mul_f32 v204, v188, v188
    v_mul_f32 v205, v189, v189
    v_mfma_f32_32x32x16_bf16 v[164:179], a[124:127], a[52:55], v[164:179]
    s_waitcnt lgkmcnt(6)
    buffer_load_dwordx4 v229, s[8:11], s56 offen offset:1024  lds
    ds_read_b64_tr_b16 a[112:113], v234 offset:40960
    ds_read_b64_tr_b16 a[114:115], v234 offset:41984
    v_mul_f32 v206, v190, v190
    v_mul_f32 v207, v191, v191
    v_fma_f32 v204, v204, v251, v250
    v_fma_f32 v205, v205, v251, v250
    v_fma_f32 v206, v206, v251, v250
    v_fma_f32 v207, v207, v251, v250
    v_mul_f32 v204, v204, v188
    v_mfma_f32_32x32x16_bf16 v[164:179], a[92:95], a[56:59], v[164:179]
    ds_read_b64_tr_b16 a[116:117], v234 offset:43008
    ds_read_b64_tr_b16 a[118:119], v234 offset:44032
    v_mul_f32 v205, v205, v189
    v_mul_f32 v206, v206, v190
    v_mul_f32 v207, v207, v191
    v_exp_f32 v204, v204
    v_exp_f32 v205, v205
    v_exp_f32 v206, v206
    v_mfma_f32_32x32x16_bf16 v[164:179], a[96:99], a[60:63], v[164:179]
    s_waitcnt lgkmcnt(6)
    buffer_load_dwordx4 v230, s[8:11], s56 offen offset:2048  lds
    ds_read_b64_tr_b16 a[120:121], v234 offset:45056
    ds_read_b64_tr_b16 a[122:123], v234 offset:46080
    v_exp_f32 v207, v207
    v_add_f32 v204, 1.0, v204
    v_add_f32 v205, 1.0, v205
    v_add_f32 v206, 1.0, v206
    v_add_f32 v207, 1.0, v207
    v_mfma_f32_32x32x16_bf16 v[164:179], a[100:103], a[64:67], v[164:179]
    ds_read_b64_tr_b16 a[124:125], v234 offset:47104
    ds_read_b64_tr_b16 a[126:127], v234 offset:48128
    v_rcp_f32 v204, v204
    v_rcp_f32 v205, v205
    v_rcp_f32 v206, v206
    v_rcp_f32 v207, v207
    v_mul_f32 v204, v188, v204
    v_mul_f32 v205, v189, v205
    v_mfma_f32_32x32x16_bf16 v[164:179], a[104:107], a[68:71], v[164:179]
    s_waitcnt lgkmcnt(6)
    buffer_load_dwordx4 v231, s[8:11], s56 offen offset:3072  lds
    ds_read_b64_tr_b16 a[92:93], v236 offset:24576
    ds_read_b64_tr_b16 a[94:95], v236 offset:25600
    v_mul_f32 v206, v190, v206
    v_mul_f32 v207, v191, v207
    v_cvt_pk_bf16_f32 v198, v204, v205
    v_cvt_pk_bf16_f32 v199, v206, v207
    v_mul_f32 v208, v192, v192
    v_mul_f32 v209, v193, v193
    v_mul_f32 v210, v194, v194
    v_mfma_f32_32x32x16_bf16 v[164:179], a[108:111], a[72:75], v[164:179]
    s_add_u32 m0, s57, 16384
    s_add_u32 s56, s56, 110592
    buffer_store_dwordx4 v[196:199], v243, s[16:19], s44 offen offset:1024 sc1
    ds_read_b64_tr_b16 a[96:97], v236 offset:26624
    ds_read_b64_tr_b16 a[98:99], v236 offset:27648
    v_mul_f32 v211, v195, v195
    v_fma_f32 v208, v208, v251, v250
    v_fma_f32 v209, v209, v251, v250
    v_fma_f32 v210, v210, v251, v250
    v_fma_f32 v211, v211, v251, v250
    v_mul_f32 v208, v208, v192
    v_mfma_f32_32x32x16_bf16 v[164:179], a[112:115], a[76:79], v[164:179]
    s_waitcnt lgkmcnt(6)
    buffer_load_dwordx4 v228, s[8:11], s56 offen offset:0  lds
    ds_read_b64_tr_b16 a[100:101], v236 offset:28672
    ds_read_b64_tr_b16 a[102:103], v236 offset:29696
    v_mul_f32 v209, v209, v193
    v_mul_f32 v210, v210, v194
    v_mul_f32 v211, v211, v195
    v_exp_f32 v208, v208
    v_exp_f32 v209, v209
    v_mfma_f32_32x32x16_bf16 v[164:179], a[116:119], a[80:83], v[164:179]
    s_waitcnt vmcnt(19)
    ds_read_b64_tr_b16 a[104:105], v236 offset:30720
    ds_read_b64_tr_b16 a[106:107], v236 offset:31744
    v_exp_f32 v210, v210
    v_exp_f32 v211, v211
    v_add_f32 v208, 1.0, v208
    v_add_f32 v209, 1.0, v209
    v_add_f32 v210, 1.0, v210
    v_add_f32 v211, 1.0, v211
    v_add_f32 v52, v52, v60
    v_mfma_f32_32x32x16_bf16 v[164:179], a[120:123], a[84:87], v[164:179]
    s_waitcnt lgkmcnt(6)
    buffer_load_dwordx4 v229, s[8:11], s56 offen offset:1024  lds
    ds_read_b64_tr_b16 a[108:109], v236 offset:32768
    ds_read_b64_tr_b16 a[110:111], v236 offset:33792
    v_rcp_f32 v208, v208
    v_rcp_f32 v209, v209
    v_rcp_f32 v210, v210
    v_mul_f32 v208, v192, v208
    v_mfma_f32_32x32x16_bf16 v[164:179], a[124:127], a[88:91], v[164:179]
    ds_read_b64_tr_b16 a[112:113], v236 offset:34816
    ds_read_b64_tr_b16 a[114:115], v236 offset:35840
    v_rcp_f32 v211, v211
    v_mul_f32 v209, v193, v209
    v_mul_f32 v210, v194, v210
    v_mul_f32 v211, v195, v211
    v_cvt_pk_bf16_f32 v202, v208, v209
    v_cvt_pk_bf16_f32 v203, v210, v211
    v_add_f32 v53, v53, v61
    v_add_f32 v54, v54, v62
    buffer_store_dwordx4 v[200:203], v243, s[16:19], s44 offen offset:1536 sc1
    s_lshl_b32 s59, s63, 6
    v_xor_b32 v232, s59, v232
    v_xor_b32 v233, s59, v233
    v_xor_b32 v234, s59, v234
    v_mfma_f32_32x32x16_bf16 v[180:195], a[92:95], v[0:3], 0
    s_waitcnt lgkmcnt(6)
    ds_read_b64_tr_b16 a[116:117], v236 offset:36864
    ds_read_b64_tr_b16 a[118:119], v236 offset:37888
    v_mfma_f32_32x32x16_bf16 v[180:195], a[96:99], v[4:7], v[180:195]
    ds_read_b64_tr_b16 a[120:121], v236 offset:38912
    ds_read_b64_tr_b16 a[122:123], v236 offset:39936
    v_mfma_f32_32x32x16_bf16 v[180:195], a[100:103], v[8:11], v[180:195]
    s_waitcnt lgkmcnt(6)
    ds_read_b64_tr_b16 a[124:125], v236 offset:40960
    ds_read_b64_tr_b16 a[126:127], v236 offset:41984
    v_mul_f32 v222, s53, v221
    v_mul_f32 v204, v222, v164
    v_mul_f32 v205, v222, v165
    v_mul_f32 v206, v222, v166
    v_mfma_f32_32x32x16_bf16 v[180:195], a[104:107], v[12:15], v[180:195]
    ds_read_b64_tr_b16 a[92:93], v236 offset:43008
    ds_read_b64_tr_b16 a[94:95], v236 offset:44032
    v_mul_f32 v207, v222, v167
    v_cvt_pk_bf16_f32 v196, v204, v205
    v_cvt_pk_bf16_f32 v197, v206, v207
    v_mul_f32 v208, v222, v168
    v_mfma_f32_32x32x16_bf16 v[180:195], a[108:111], v[16:19], v[180:195]
    s_waitcnt lgkmcnt(6)
    ds_read_b64_tr_b16 a[96:97], v236 offset:45056
    ds_read_b64_tr_b16 a[98:99], v236 offset:46080
    v_mul_f32 v209, v222, v169
    v_mul_f32 v210, v222, v170
    v_mul_f32 v211, v222, v171
    v_cvt_pk_bf16_f32 v198, v208, v209
    v_mfma_f32_32x32x16_bf16 v[180:195], a[112:115], v[20:23], v[180:195]
    ds_read_b64_tr_b16 a[100:101], v236 offset:47104
    ds_read_b64_tr_b16 a[102:103], v236 offset:48128
    v_cvt_pk_bf16_f32 v199, v210, v211
    v_mul_f32 v204, v222, v172
    v_mul_f32 v205, v222, v173
    v_mul_f32 v206, v222, v174
    v_mfma_f32_32x32x16_bf16 v[180:195], a[116:119], v[24:27], v[180:195]
    s_waitcnt lgkmcnt(6)
    buffer_store_dwordx4 v[196:199], v238, s[16:19], s45 offen offset:0 sc1
    ds_read_b64_tr_b16 a[104:105], v237 offset:0
    ds_read_b64_tr_b16 a[106:107], v237 offset:1024
    v_mul_f32 v207, v222, v175
    v_cvt_pk_bf16_f32 v200, v204, v205
    v_mfma_f32_32x32x16_bf16 v[180:195], a[120:123], v[28:31], v[180:195]
    ds_read_b64_tr_b16 a[108:109], v237 offset:2048
    ds_read_b64_tr_b16 a[110:111], v237 offset:3072
    v_cvt_pk_bf16_f32 v201, v206, v207
    v_mul_f32 v208, v222, v176
    v_mul_f32 v209, v222, v177
    v_mul_f32 v210, v222, v178
    v_mfma_f32_32x32x16_bf16 v[180:195], a[124:127], v[32:35], v[180:195]
    s_waitcnt lgkmcnt(6)
    ds_read_b64_tr_b16 a[112:113], v237 offset:4096
    ds_read_b64_tr_b16 a[114:115], v237 offset:5120
    v_mul_f32 v211, v222, v179
    v_cvt_pk_bf16_f32 v202, v208, v209
    v_cvt_pk_bf16_f32 v203, v210, v211
    v_add_f32 v55, v55, v63
    v_mfma_f32_32x32x16_bf16 v[180:195], a[92:95], v[36:39], v[180:195]
    buffer_store_dwordx4 v[200:203], v238, s[16:19], s45 offen offset:1024 sc1
    ds_read_b64_tr_b16 a[116:117], v237 offset:6144
    ds_read_b64_tr_b16 a[118:119], v237 offset:7168
    v_add_f32 v56, v56, v64
    v_add_f32 v57, v57, v65
    v_mfma_f32_32x32x16_bf16 v[180:195], a[96:99], v[40:43], v[180:195]
    s_waitcnt lgkmcnt(6)
    ds_read_b64_tr_b16 a[120:121], v237 offset:8192
    ds_read_b64_tr_b16 a[122:123], v237 offset:9216
    v_add_f32 v58, v58, v66
    v_add_f32 v59, v59, v67
    v_add_f32 v52, v52, v56
    v_add_f32 v53, v53, v57
    v_mfma_f32_32x32x16_bf16 v[180:195], a[100:103], v[44:47], v[180:195]
    ds_read_b64_tr_b16 a[124:125], v237 offset:10240
    ds_read_b64_tr_b16 a[126:127], v237 offset:11264
    v_add_f32 v54, v54, v58
    v_add_f32 v55, v55, v59
    v_add_f32 v52, v52, v54
    v_add_f32 v53, v53, v55
    v_mfma_f32_32x32x16_bf16 v[180:195], a[104:107], v[48:51], v[180:195]
    s_waitcnt lgkmcnt(6)
    ds_read_b64_tr_b16 a[92:93], v237 offset:12288
    ds_read_b64_tr_b16 a[94:95], v237 offset:13312
    v_mov_b32 v54, v52
    v_mov_b32 v55, v53
    v_mfma_f32_32x32x16_bf16 v[180:195], a[108:111], a[0:3], v[180:195]
    ds_read_b64_tr_b16 a[96:97], v237 offset:14336
    ds_read_b64_tr_b16 a[98:99], v237 offset:15360
    v_mfma_f32_32x32x16_bf16 v[180:195], a[112:115], a[4:7], v[180:195]
    s_waitcnt lgkmcnt(6)
    ds_read_b64_tr_b16 a[100:101], v237 offset:16384
    ds_read_b64_tr_b16 a[102:103], v237 offset:17408
    v_permlane32_swap_b32 v54, v52
    v_permlane32_swap_b32 v55, v53
    v_mfma_f32_32x32x16_bf16 v[180:195], a[116:119], a[8:11], v[180:195]
    ds_read_b64_tr_b16 a[104:105], v237 offset:18432
    ds_read_b64_tr_b16 a[106:107], v237 offset:19456
    v_add_f32 v52, v52, v54
    v_add_f32 v53, v53, v55
    v_mul_f32 v52, 0x39e38e39, v52
    v_mul_f32 v53, 0x39e38e39, v53
    v_mfma_f32_32x32x16_bf16 v[180:195], a[120:123], a[12:15], v[180:195]
    s_waitcnt lgkmcnt(6)
    ds_read_b64_tr_b16 a[108:109], v237 offset:20480
    ds_read_b64_tr_b16 a[110:111], v237 offset:21504
    v_fma_f32 v53, -v52, v52, v53
    v_max_f32 v53, 0, v53
    v_add_f32 v53, v223, v53
    v_mfma_f32_32x32x16_bf16 v[180:195], a[124:127], a[16:19], v[180:195]
    ds_read_b64_tr_b16 a[112:113], v237 offset:22528
    ds_read_b64_tr_b16 a[114:115], v237 offset:23552
    v_rsq_f32 v248, v53
    v_mfma_f32_32x32x16_bf16 v[180:195], a[92:95], a[20:23], v[180:195]
    s_waitcnt lgkmcnt(6)
    ds_read_b64_tr_b16 a[116:117], v237 offset:24576
    ds_read_b64_tr_b16 a[118:119], v237 offset:25600
    v_mul_f32 v249, v52, v248
    v_sub_f32 v249, 0, v249
    v_fma_f32 v68, v68, v248, v249
    v_fma_f32 v69, v69, v248, v249
    v_mfma_f32_32x32x16_bf16 v[180:195], a[96:99], a[24:27], v[180:195]
    ds_read_b64_tr_b16 a[120:121], v237 offset:26624
    ds_read_b64_tr_b16 a[122:123], v237 offset:27648
    v_cvt_pk_bf16_f32 v68, v68, v69
    v_fma_f32 v70, v70, v248, v249
    v_fma_f32 v71, v71, v248, v249
    v_cvt_pk_bf16_f32 v69, v70, v71
    v_mfma_f32_32x32x16_bf16 v[180:195], a[100:103], a[28:31], v[180:195]
    s_waitcnt lgkmcnt(6)
    ds_read_b64_tr_b16 a[124:125], v237 offset:28672
    ds_read_b64_tr_b16 a[126:127], v237 offset:29696
    v_fma_f32 v72, v72, v248, v249
    v_fma_f32 v73, v73, v248, v249
    v_cvt_pk_bf16_f32 v70, v72, v73
    v_fma_f32 v74, v74, v248, v249
    v_mfma_f32_32x32x16_bf16 v[180:195], a[104:107], a[32:35], v[180:195]
    ds_read_b64_tr_b16 a[92:93], v237 offset:30720
    ds_read_b64_tr_b16 a[94:95], v237 offset:31744
    v_fma_f32 v75, v75, v248, v249
    v_cvt_pk_bf16_f32 v71, v74, v75
    v_fma_f32 v76, v76, v248, v249
    v_fma_f32 v77, v77, v248, v249
    v_mfma_f32_32x32x16_bf16 v[180:195], a[108:111], a[36:39], v[180:195]
    s_waitcnt lgkmcnt(6)
    ds_read_b64_tr_b16 a[96:97], v237 offset:32768
    ds_read_b64_tr_b16 a[98:99], v237 offset:33792
    v_cvt_pk_bf16_f32 v72, v76, v77
    v_fma_f32 v78, v78, v248, v249
    v_fma_f32 v79, v79, v248, v249
    v_cvt_pk_bf16_f32 v73, v78, v79
    v_mfma_f32_32x32x16_bf16 v[180:195], a[112:115], a[40:43], v[180:195]
    ds_read_b64_tr_b16 a[100:101], v237 offset:34816
    ds_read_b64_tr_b16 a[102:103], v237 offset:35840
    v_fma_f32 v80, v80, v248, v249
    v_fma_f32 v81, v81, v248, v249
    v_cvt_pk_bf16_f32 v74, v80, v81
    v_fma_f32 v82, v82, v248, v249
    v_mfma_f32_32x32x16_bf16 v[180:195], a[116:119], a[44:47], v[180:195]
    s_waitcnt lgkmcnt(6)
    ds_write_b128 v240, v[68:71] offset:0
    s_add_u32 s97, s40, 73728
    ds_read_b64_tr_b16 a[104:105], v237 offset:36864
    ds_read_b64_tr_b16 a[106:107], v237 offset:37888
    v_fma_f32 v83, v83, v248, v249
    v_cvt_pk_bf16_f32 v75, v82, v83
    v_mfma_f32_32x32x16_bf16 v[180:195], a[120:123], a[48:51], v[180:195]
    ds_write_b128 v240, v[72:75] offset:1152
    ds_read_b64_tr_b16 a[108:109], v237 offset:38912
    ds_read_b64_tr_b16 a[110:111], v237 offset:39936
    v_fma_f32 v84, v84, v248, v249
    v_fma_f32 v85, v85, v248, v249
    v_cvt_pk_bf16_f32 v84, v84, v85
    v_mfma_f32_32x32x16_bf16 v[180:195], a[124:127], a[52:55], v[180:195]
    s_waitcnt lgkmcnt(8)
    ds_read_b64_tr_b16 a[112:113], v237 offset:40960
    ds_read_b64_tr_b16 a[114:115], v237 offset:41984
    v_fma_f32 v86, v86, v248, v249
    v_fma_f32 v87, v87, v248, v249
    v_cvt_pk_bf16_f32 v85, v86, v87
    v_fma_f32 v88, v88, v248, v249
    v_mfma_f32_32x32x16_bf16 v[180:195], a[92:95], a[56:59], v[180:195]
    s_waitcnt lgkmcnt(4)
    ds_read_b64_tr_b16 v[76:77], v242 offset:0
    ds_read_b64_tr_b16 v[78:79], v242 offset:64
    ds_read_b64_tr_b16 v[80:81], v242 offset:256
    ds_read_b64_tr_b16 v[82:83], v242 offset:320
    ds_read_b64_tr_b16 a[116:117], v237 offset:43008
    ds_read_b64_tr_b16 a[118:119], v237 offset:44032
    v_mfma_f32_32x32x16_bf16 v[180:195], a[96:99], a[60:63], v[180:195]
    ds_read_b64_tr_b16 a[120:121], v237 offset:45056
    ds_read_b64_tr_b16 a[122:123], v237 offset:46080
    v_fma_f32 v89, v89, v248, v249
    v_cvt_pk_bf16_f32 v86, v88, v89
    v_fma_f32 v90, v90, v248, v249
    v_fma_f32 v91, v91, v248, v249
    v_mfma_f32_32x32x16_bf16 v[180:195], a[100:103], a[64:67], v[180:195]
    ds_read_b64_tr_b16 a[124:125], v237 offset:47104
    ds_read_b64_tr_b16 a[126:127], v237 offset:48128
    v_cvt_pk_bf16_f32 v87, v90, v91
    v_fma_f32 v92, v92, v248, v249
    v_fma_f32 v93, v93, v248, v249
    v_cvt_pk_bf16_f32 v88, v92, v93
    v_mfma_f32_32x32x16_bf16 v[180:195], a[104:107], a[68:71], v[180:195]
    s_waitcnt lgkmcnt(10)
    s_waitcnt vmcnt(3)
    s_barrier
    s_waitcnt lgkmcnt(6)
    ds_read_b64_tr_b16 a[92:93], v232 offset:0
    ds_read_b64_tr_b16 a[94:95], v232 offset:1024
    v_fma_f32 v94, v94, v248, v249
    v_mfma_f32_32x32x16_bf16 v[180:195], a[108:111], a[72:75], v[180:195]
    buffer_store_dwordx4 v[76:79], v239, s[16:19], s40 offen offset:0 sc1
    buffer_store_dwordx4 v[80:83], v239, s[16:19], s97 offen offset:0 sc1
    ds_read_b64_tr_b16 a[96:97], v232 offset:2048
    ds_read_b64_tr_b16 a[98:99], v232 offset:3072
    v_mfma_f32_32x32x16_bf16 v[180:195], a[112:115], a[76:79], v[180:195]
    s_waitcnt lgkmcnt(6)
    ds_read_b64_tr_b16 a[100:101], v232 offset:4096
    ds_read_b64_tr_b16 a[102:103], v232 offset:5120
    v_fma_f32 v95, v95, v248, v249
    v_cvt_pk_bf16_f32 v89, v94, v95
    v_fma_f32 v96, v96, v248, v249
    v_fma_f32 v97, v97, v248, v249
    v_mfma_f32_32x32x16_bf16 v[180:195], a[116:119], a[80:83], v[180:195]
    ds_read_b64_tr_b16 a[104:105], v232 offset:6144
    ds_read_b64_tr_b16 a[106:107], v232 offset:7168
    v_cvt_pk_bf16_f32 v90, v96, v97
    v_fma_f32 v98, v98, v248, v249
    v_fma_f32 v99, v99, v248, v249
    v_cvt_pk_bf16_f32 v91, v98, v99
    v_mfma_f32_32x32x16_bf16 v[180:195], a[120:123], a[84:87], v[180:195]
    s_waitcnt lgkmcnt(6)
    ds_write_b128 v240, v[84:87] offset:0
    ds_write_b128 v240, v[88:91] offset:1152
    s_add_u32 s97, s40, 73728
    ds_read_b64_tr_b16 a[108:109], v232 offset:8192
    ds_read_b64_tr_b16 a[110:111], v232 offset:9216
    v_fma_f32 v100, v100, v248, v249
    v_mfma_f32_32x32x16_bf16 v[180:195], a[124:127], a[88:91], v[180:195]
    ds_read_b64_tr_b16 a[112:113], v232 offset:10240
    ds_read_b64_tr_b16 a[114:115], v232 offset:11264
    v_fma_f32 v101, v101, v248, v249
    v_cvt_pk_bf16_f32 v100, v100, v101
    v_fma_f32 v102, v102, v248, v249
    v_fma_f32 v103, v103, v248, v249
    s_barrier
    v_mfma_f32_32x32x16_bf16 v[164:179], a[92:95], v[0:3], 0
    s_waitcnt lgkmcnt(8)
    ds_read_b64_tr_b16 a[116:117], v232 offset:12288
    ds_read_b64_tr_b16 a[118:119], v232 offset:13312
    v_mfma_f32_32x32x16_bf16 v[164:179], a[96:99], v[4:7], v[164:179]
    ds_read_b64_tr_b16 a[120:121], v232 offset:14336
    ds_read_b64_tr_b16 a[122:123], v232 offset:15360
    v_mfma_f32_32x32x16_bf16 v[164:179], a[100:103], v[8:11], v[164:179]
    s_waitcnt lgkmcnt(6)
    ds_read_b64_tr_b16 a[124:125], v232 offset:16384
    ds_read_b64_tr_b16 a[126:127], v232 offset:17408
    v_mul_f32 v222, s53, v221
    v_mul_f32 v204, v222, v180
    v_mul_f32 v205, v222, v181
    v_mul_f32 v206, v222, v182
    v_mfma_f32_32x32x16_bf16 v[164:179], a[104:107], v[12:15], v[164:179]
    ds_read_b64_tr_b16 a[92:93], v232 offset:18432
    ds_read_b64_tr_b16 a[94:95], v232 offset:19456
    v_mul_f32 v207, v222, v183
    v_cvt_pk_bf16_f32 v196, v204, v205
    v_cvt_pk_bf16_f32 v197, v206, v207
    v_mul_f32 v208, v222, v184
    v_mfma_f32_32x32x16_bf16 v[164:179], a[108:111], v[16:19], v[164:179]
    s_waitcnt lgkmcnt(6)
    ds_read_b64_tr_b16 a[96:97], v232 offset:20480
    ds_read_b64_tr_b16 a[98:99], v232 offset:21504
    v_mul_f32 v209, v222, v185
    v_mul_f32 v210, v222, v186
    v_mul_f32 v211, v222, v187
    v_cvt_pk_bf16_f32 v198, v208, v209
    v_mfma_f32_32x32x16_bf16 v[164:179], a[112:115], v[20:23], v[164:179]
    ds_read_b64_tr_b16 a[100:101], v232 offset:22528
    ds_read_b64_tr_b16 a[102:103], v232 offset:23552
    v_cvt_pk_bf16_f32 v199, v210, v211
    v_mul_f32 v204, v222, v188
    v_mul_f32 v205, v222, v189
    v_mul_f32 v206, v222, v190
    v_mfma_f32_32x32x16_bf16 v[164:179], a[116:119], v[24:27], v[164:179]
    s_waitcnt lgkmcnt(6)
    buffer_store_dwordx4 v[196:199], v238, s[16:19], s45 offen offset:2048 sc1
    ds_read_b64_tr_b16 a[104:105], v232 offset:24576
    ds_read_b64_tr_b16 a[106:107], v232 offset:25600
    v_mul_f32 v207, v222, v191
    v_cvt_pk_bf16_f32 v200, v204, v205
    v_mfma_f32_32x32x16_bf16 v[164:179], a[120:123], v[28:31], v[164:179]
    ds_read_b64_tr_b16 a[108:109], v232 offset:26624
    ds_read_b64_tr_b16 a[110:111], v232 offset:27648
    v_cvt_pk_bf16_f32 v201, v206, v207
    v_mul_f32 v208, v222, v192
    v_mul_f32 v209, v222, v193
    v_mul_f32 v210, v222, v194
    v_mfma_f32_32x32x16_bf16 v[164:179], a[124:127], v[32:35], v[164:179]
    s_waitcnt lgkmcnt(6)
    ds_read_b64_tr_b16 a[112:113], v232 offset:28672
    ds_read_b64_tr_b16 a[114:115], v232 offset:29696
    v_mul_f32 v211, v222, v195
    v_cvt_pk_bf16_f32 v202, v208, v209
    v_cvt_pk_bf16_f32 v203, v210, v211
    v_mfma_f32_32x32x16_bf16 v[164:179], a[92:95], v[36:39], v[164:179]
    buffer_store_dwordx4 v[200:203], v238, s[16:19], s45 offen offset:3072 sc1
    ds_read_b64_tr_b16 v[92:93], v242 offset:0
    ds_read_b64_tr_b16 v[94:95], v242 offset:64
    ds_read_b64_tr_b16 a[116:117], v232 offset:30720
    ds_read_b64_tr_b16 a[118:119], v232 offset:31744
    v_mfma_f32_32x32x16_bf16 v[164:179], a[96:99], v[40:43], v[164:179]
    s_waitcnt lgkmcnt(8)
    ds_read_b64_tr_b16 v[96:97], v242 offset:256
    ds_read_b64_tr_b16 v[98:99], v242 offset:320
    ds_read_b64_tr_b16 a[120:121], v232 offset:32768
    ds_read_b64_tr_b16 a[122:123], v232 offset:33792
    v_cvt_pk_bf16_f32 v101, v102, v103
    v_fma_f32 v104, v104, v248, v249
    v_mfma_f32_32x32x16_bf16 v[164:179], a[100:103], v[44:47], v[164:179]
    ds_read_b64_tr_b16 a[124:125], v232 offset:34816
    ds_read_b64_tr_b16 a[126:127], v232 offset:35840
    v_fma_f32 v105, v105, v248, v249
    v_cvt_pk_bf16_f32 v102, v104, v105
    v_fma_f32 v106, v106, v248, v249
    v_fma_f32 v107, v107, v248, v249
    v_mfma_f32_32x32x16_bf16 v[164:179], a[104:107], v[48:51], v[164:179]
    s_waitcnt lgkmcnt(10)
    ds_read_b64_tr_b16 a[92:93], v232 offset:36864
    ds_read_b64_tr_b16 a[94:95], v232 offset:37888
    v_cvt_pk_bf16_f32 v103, v106, v107
    v_fma_f32 v108, v108, v248, v249
    v_fma_f32 v109, v109, v248, v249
    v_cvt_pk_bf16_f32 v104, v108, v109
    v_mfma_f32_32x32x16_bf16 v[164:179], a[108:111], a[0:3], v[164:179]
    s_waitcnt lgkmcnt(6)
    buffer_store_dwordx4 v[92:95], v239, s[16:19], s40 offen offset:1024 sc1
    buffer_store_dwordx4 v[96:99], v239, s[16:19], s97 offen offset:1024 sc1
    ds_read_b64_tr_b16 a[96:97], v232 offset:38912
    ds_read_b64_tr_b16 a[98:99], v232 offset:39936
    v_mfma_f32_32x32x16_bf16 v[164:179], a[112:115], a[4:7], v[164:179]
    s_waitcnt lgkmcnt(6)
    ds_read_b64_tr_b16 a[100:101], v232 offset:40960
    ds_read_b64_tr_b16 a[102:103], v232 offset:41984
    v_fma_f32 v110, v110, v248, v249
    v_fma_f32 v111, v111, v248, v249
    v_cvt_pk_bf16_f32 v105, v110, v111
    v_fma_f32 v112, v112, v248, v249
    v_mfma_f32_32x32x16_bf16 v[164:179], a[116:119], a[8:11], v[164:179]
    ds_read_b64_tr_b16 a[104:105], v232 offset:43008
    ds_read_b64_tr_b16 a[106:107], v232 offset:44032
    v_fma_f32 v113, v113, v248, v249
    v_cvt_pk_bf16_f32 v106, v112, v113
    v_fma_f32 v114, v114, v248, v249
    v_fma_f32 v115, v115, v248, v249
    v_mfma_f32_32x32x16_bf16 v[164:179], a[120:123], a[12:15], v[164:179]
    s_waitcnt lgkmcnt(6)
    ds_write_b128 v240, v[100:103] offset:0
    s_add_u32 s97, s41, 73728
    ds_read_b64_tr_b16 a[108:109], v232 offset:45056
    ds_read_b64_tr_b16 a[110:111], v232 offset:46080
    v_cvt_pk_bf16_f32 v107, v114, v115
    v_fma_f32 v116, v116, v248, v249
    v_mfma_f32_32x32x16_bf16 v[164:179], a[124:127], a[16:19], v[164:179]
    ds_write_b128 v240, v[104:107] offset:1152
    ds_read_b64_tr_b16 a[112:113], v232 offset:47104
    ds_read_b64_tr_b16 a[114:115], v232 offset:48128
    v_fma_f32 v117, v117, v248, v249
    v_cvt_pk_bf16_f32 v116, v116, v117
    v_fma_f32 v118, v118, v248, v249
    v_mfma_f32_32x32x16_bf16 v[164:179], a[92:95], a[20:23], v[164:179]
    s_waitcnt lgkmcnt(8)
    ds_read_b64_tr_b16 a[116:117], v233 offset:0
    ds_read_b64_tr_b16 a[118:119], v233 offset:1024
    v_fma_f32 v119, v119, v248, v249
    v_cvt_pk_bf16_f32 v117, v118, v119
    v_fma_f32 v120, v120, v248, v249
    v_fma_f32 v121, v121, v248, v249
    v_mfma_f32_32x32x16_bf16 v[164:179], a[96:99], a[24:27], v[164:179]
    s_waitcnt lgkmcnt(4)
    ds_read_b64_tr_b16 v[108:109], v242 offset:0
    ds_read_b64_tr_b16 v[110:111], v242 offset:64
    ds_read_b64_tr_b16 v[112:113], v242 offset:256
    ds_read_b64_tr_b16 v[114:115], v242 offset:320
    ds_read_b64_tr_b16 a[120:121], v233 offset:2048
    ds_read_b64_tr_b16 a[122:123], v233 offset:3072
    v_mfma_f32_32x32x16_bf16 v[164:179], a[100:103], a[28:31], v[164:179]
    ds_read_b64_tr_b16 a[124:125], v233 offset:4096
    ds_read_b64_tr_b16 a[126:127], v233 offset:5120
    v_cvt_pk_bf16_f32 v118, v120, v121
    v_fma_f32 v122, v122, v248, v249
    v_fma_f32 v123, v123, v248, v249
    v_cvt_pk_bf16_f32 v119, v122, v123
    v_mfma_f32_32x32x16_bf16 v[164:179], a[104:107], a[32:35], v[164:179]
    ds_read_b64_tr_b16 a[92:93], v233 offset:6144
    ds_read_b64_tr_b16 a[94:95], v233 offset:7168
    v_fma_f32 v124, v124, v248, v249
    v_fma_f32 v125, v125, v248, v249
    v_cvt_pk_bf16_f32 v120, v124, v125
    v_fma_f32 v126, v126, v248, v249
    v_mfma_f32_32x32x16_bf16 v[164:179], a[108:111], a[36:39], v[164:179]
    s_waitcnt lgkmcnt(10)
    s_waitcnt lgkmcnt(6)
    buffer_store_dwordx4 v[108:111], v239, s[16:19], s41 offen offset:0 sc1
    ds_read_b64_tr_b16 a[96:97], v233 offset:8192
    ds_read_b64_tr_b16 a[98:99], v233 offset:9216
    v_fma_f32 v127, v127, v248, v249
    v_mfma_f32_32x32x16_bf16 v[164:179], a[112:115], a[40:43], v[164:179]
    buffer_store_dwordx4 v[112:115], v239, s[16:19], s97 offen offset:0 sc1
    ds_read_b64_tr_b16 a[100:101], v233 offset:10240
    ds_read_b64_tr_b16 a[102:103], v233 offset:11264
    v_cvt_pk_bf16_f32 v121, v126, v127
    v_fma_f32 v128, v128, v248, v249
    v_mfma_f32_32x32x16_bf16 v[164:179], a[116:119], a[44:47], v[164:179]
    s_waitcnt lgkmcnt(6)
    ds_read_b64_tr_b16 a[104:105], v233 offset:12288
    ds_read_b64_tr_b16 a[106:107], v233 offset:13312
    v_fma_f32 v129, v129, v248, v249
    v_cvt_pk_bf16_f32 v122, v128, v129
    v_fma_f32 v130, v130, v248, v249
    v_fma_f32 v131, v131, v248, v249
    v_mfma_f32_32x32x16_bf16 v[164:179], a[120:123], a[48:51], v[164:179]
    ds_write_b128 v240, v[116:119] offset:0
    s_add_u32 s97, s41, 73728
    ds_read_b64_tr_b16 a[108:109], v233 offset:14336
    ds_read_b64_tr_b16 a[110:111], v233 offset:15360
    v_cvt_pk_bf16_f32 v123, v130, v131
    v_mfma_f32_32x32x16_bf16 v[164:179], a[124:127], a[52:55], v[164:179]
    s_waitcnt lgkmcnt(7)
    ds_write_b128 v240, v[120:123] offset:1152
    ds_read_b64_tr_b16 a[112:113], v233 offset:16384
    ds_read_b64_tr_b16 a[114:115], v233 offset:17408
    v_mfma_f32_32x32x16_bf16 v[164:179], a[92:95], a[56:59], v[164:179]
    ds_read_b64_tr_b16 a[116:117], v233 offset:18432
    ds_read_b64_tr_b16 a[118:119], v233 offset:19456
    v_mfma_f32_32x32x16_bf16 v[164:179], a[96:99], a[60:63], v[164:179]
    s_waitcnt lgkmcnt(8)
    s_waitcnt lgkmcnt(4)
    ds_read_b64_tr_b16 v[124:125], v242 offset:0
    ds_read_b64_tr_b16 v[126:127], v242 offset:64
    ds_read_b64_tr_b16 v[128:129], v242 offset:256
    ds_read_b64_tr_b16 a[120:121], v233 offset:20480
    ds_read_b64_tr_b16 a[122:123], v233 offset:21504
    v_mfma_f32_32x32x16_bf16 v[164:179], a[100:103], a[64:67], v[164:179]
    ds_read_b64_tr_b16 v[130:131], v242 offset:320
    ds_read_b64_tr_b16 a[124:125], v233 offset:22528
    ds_read_b64_tr_b16 a[126:127], v233 offset:23552
    v_mfma_f32_32x32x16_bf16 v[164:179], a[104:107], a[68:71], v[164:179]
    s_waitcnt lgkmcnt(10)
    v_mfma_f32_32x32x16_bf16 v[164:179], a[108:111], a[72:75], v[164:179]
    v_mfma_f32_32x32x16_bf16 v[164:179], a[112:115], a[76:79], v[164:179]
    s_waitcnt lgkmcnt(3)
    s_waitcnt lgkmcnt(2)
    buffer_store_dwordx4 v[124:127], v239, s[16:19], s41 offen offset:1024 sc1
    buffer_store_dwordx4 v[128:131], v239, s[16:19], s97 offen offset:1024 sc1
    v_mfma_f32_32x32x16_bf16 v[164:179], a[116:119], a[80:83], v[164:179]
    v_mfma_f32_32x32x16_bf16 v[164:179], a[120:123], a[84:87], v[164:179]
    s_waitcnt lgkmcnt(0)
    v_mfma_f32_32x32x16_bf16 v[164:179], a[124:127], a[88:91], v[164:179]
    s_nop 11
    v_mul_f32 v222, s54, v221
    v_mul_f32 v204, v222, v164
    v_mul_f32 v205, v222, v165
    v_mul_f32 v206, v222, v166
    v_mul_f32 v207, v222, v167
    v_cvt_pk_bf16_f32 v196, v204, v205
    v_cvt_pk_bf16_f32 v197, v206, v207
    v_mul_f32 v208, v222, v168
    v_mul_f32 v209, v222, v169
    v_mul_f32 v210, v222, v170
    v_mul_f32 v211, v222, v171
    v_cvt_pk_bf16_f32 v198, v208, v209
    v_cvt_pk_bf16_f32 v199, v210, v211
    ds_write_b128 v240, v[196:199] offset:0
    v_mul_f32 v204, v222, v172
    v_mul_f32 v205, v222, v173
    v_mul_f32 v206, v222, v174
    v_mul_f32 v207, v222, v175
    v_cvt_pk_bf16_f32 v200, v204, v205
    v_cvt_pk_bf16_f32 v201, v206, v207
    v_mul_f32 v208, v222, v176
    v_mul_f32 v209, v222, v177
    v_mul_f32 v210, v222, v178
    v_mul_f32 v211, v222, v179
    v_cvt_pk_bf16_f32 v202, v208, v209
    v_cvt_pk_bf16_f32 v203, v210, v211
    ds_write_b128 v240, v[200:203] offset:1152
    s_waitcnt lgkmcnt(0)
    ds_read_b64_tr_b16 v[212:213], v241 offset:0
    ds_read_b64_tr_b16 v[214:215], v241 offset:128
    ds_read_b64_tr_b16 v[216:217], v241 offset:256
    ds_read_b64_tr_b16 v[218:219], v241 offset:384
    s_add_u32 s64, s46, 18944
    s_waitcnt lgkmcnt(0)
    buffer_store_dwordx4 v[212:215], v239, s[16:19], s46 offen offset:0 sc1
    buffer_store_dwordx4 v[216:219], v239, s[16:19], s64 offen offset:0 sc1
    s_endpgm
L1_poll_B:
    s_mov_b32 s98, 0x400000
L1_poll_B_l:
    buffer_load_dword v255, off, s[20:23], s67 sc1
    s_waitcnt vmcnt(0)
    v_readfirstlane_b32 s96, v255
    s_sub_u32 s98, s98, 1
    s_cbranch_scc1 L1_poll_B_ok
    s_cmp_lt_u32 s96, 16
    s_cbranch_scc1 L1_poll_B_l
    s_branch L1_poll_B_ok
L1_B2:
    v_mfma_f32_32x32x16_bf16 v[164:179], a[92:95], v[0:3], 0
    s_waitcnt lgkmcnt(6)
    ds_read_b64_tr_b16 a[116:117], v233 offset:36864
    ds_read_b64_tr_b16 a[118:119], v233 offset:37888
    v_mfma_f32_32x32x16_bf16 v[164:179], a[96:99], v[4:7], v[164:179]
    ds_read_b64_tr_b16 a[120:121], v233 offset:38912
    ds_read_b64_tr_b16 a[122:123], v233 offset:39936
    v_mfma_f32_32x32x16_bf16 v[164:179], a[100:103], v[8:11], v[164:179]
    s_waitcnt lgkmcnt(6)
    ds_read_b64_tr_b16 a[124:125], v233 offset:40960
    ds_read_b64_tr_b16 a[126:127], v233 offset:41984
    v_mul_f32 v204, v180, v180
    v_mul_f32 v205, v181, v181
    v_mul_f32 v206, v182, v182
    v_mul_f32 v207, v183, v183
    v_fma_f32 v204, v204, v251, v250
    v_mfma_f32_32x32x16_bf16 v[164:179], a[104:107], v[12:15], v[164:179]
    ds_read_b64_tr_b16 a[92:93], v233 offset:43008
    ds_read_b64_tr_b16 a[94:95], v233 offset:44032
    v_fma_f32 v205, v205, v251, v250
    v_fma_f32 v206, v206, v251, v250
    v_fma_f32 v207, v207, v251, v250
    v_mul_f32 v204, v204, v180
    v_mul_f32 v205, v205, v181
    v_mfma_f32_32x32x16_bf16 v[164:179], a[108:111], v[16:19], v[164:179]
    s_waitcnt lgkmcnt(6)
    ds_read_b64_tr_b16 a[96:97], v233 offset:45056
    ds_read_b64_tr_b16 a[98:99], v233 offset:46080
    v_mul_f32 v206, v206, v182
    v_mul_f32 v207, v207, v183
    v_exp_f32 v204, v204
    v_mfma_f32_32x32x16_bf16 v[164:179], a[112:115], v[20:23], v[164:179]
    ds_read_b64_tr_b16 a[100:101], v233 offset:47104
    ds_read_b64_tr_b16 a[102:103], v233 offset:48128
    v_exp_f32 v205, v205
    v_exp_f32 v206, v206
    v_add_f32 v204, 1.0, v204
    v_mfma_f32_32x32x16_bf16 v[164:179], a[116:119], v[24:27], v[164:179]
    s_waitcnt lgkmcnt(6)
    ds_read_b64_tr_b16 a[104:105], v234 offset:0
    ds_read_b64_tr_b16 a[106:107], v234 offset:1024
    v_exp_f32 v207, v207
    v_add_f32 v205, 1.0, v205
    v_add_f32 v206, 1.0, v206
    v_add_f32 v207, 1.0, v207
    v_mfma_f32_32x32x16_bf16 v[164:179], a[120:123], v[28:31], v[164:179]
    ds_read_b64_tr_b16 a[108:109], v234 offset:2048
    ds_read_b64_tr_b16 a[110:111], v234 offset:3072
    v_rcp_f32 v204, v204
    v_rcp_f32 v205, v205
    v_mul_f32 v204, v180, v204
    v_mfma_f32_32x32x16_bf16 v[164:179], a[124:127], v[32:35], v[164:179]
    s_waitcnt lgkmcnt(6)
    ds_read_b64_tr_b16 a[112:113], v234 offset:4096
    ds_read_b64_tr_b16 a[114:115], v234 offset:5120
    v_rcp_f32 v206, v206
    v_rcp_f32 v207, v207
    v_mul_f32 v205, v181, v205
    v_mfma_f32_32x32x16_bf16 v[164:179], a[92:95], v[36:39], v[164:179]
    ds_read_b64_tr_b16 a[116:117], v234 offset:6144
    ds_read_b64_tr_b16 a[118:119], v234 offset:7168
    v_mul_f32 v206, v182, v206
    v_mul_f32 v207, v183, v207
    v_cvt_pk_bf16_f32 v196, v204, v205
    v_cvt_pk_bf16_f32 v197, v206, v207
    v_mul_f32 v208, v184, v184
    v_mfma_f32_32x32x16_bf16 v[164:179], a[96:99], v[40:43], v[164:179]
    s_waitcnt lgkmcnt(6)
    ds_read_b64_tr_b16 a[120:121], v234 offset:8192
    ds_read_b64_tr_b16 a[122:123], v234 offset:9216
    v_mul_f32 v209, v185, v185
    v_mul_f32 v210, v186, v186
    v_mul_f32 v211, v187, v187
    v_fma_f32 v208, v208, v251, v250
    v_fma_f32 v209, v209, v251, v250
    v_mfma_f32_32x32x16_bf16 v[164:179], a[100:103], v[44:47], v[164:179]
    ds_read_b64_tr_b16 a[124:125], v234 offset:10240
    ds_read_b64_tr_b16 a[126:127], v234 offset:11264
    v_fma_f32 v210, v210, v251, v250
    v_fma_f32 v211, v211, v251, v250
    v_mul_f32 v208, v208, v184
    v_mul_f32 v209, v209, v185
    v_mul_f32 v210, v210, v186
    v_mfma_f32_32x32x16_bf16 v[164:179], a[104:107], v[48:51], v[164:179]
    s_waitcnt lgkmcnt(6)
    ds_read_b64_tr_b16 a[92:93], v234 offset:12288
    ds_read_b64_tr_b16 a[94:95], v234 offset:13312
    v_mul_f32 v211, v211, v187
    v_exp_f32 v208, v208
    v_exp_f32 v209, v209
    v_mfma_f32_32x32x16_bf16 v[164:179], a[108:111], a[0:3], v[164:179]
    ds_read_b64_tr_b16 a[96:97], v234 offset:14336
    ds_read_b64_tr_b16 a[98:99], v234 offset:15360
    v_exp_f32 v210, v210
    v_exp_f32 v211, v211
    v_add_f32 v208, 1.0, v208
    v_mfma_f32_32x32x16_bf16 v[164:179], a[112:115], a[4:7], v[164:179]
    s_waitcnt lgkmcnt(6)
    ds_read_b64_tr_b16 a[100:101], v234 offset:16384
    ds_read_b64_tr_b16 a[102:103], v234 offset:17408
    v_add_f32 v209, 1.0, v209
    v_add_f32 v210, 1.0, v210
    v_add_f32 v211, 1.0, v211
    v_rcp_f32 v208, v208
    v_mfma_f32_32x32x16_bf16 v[164:179], a[116:119], a[8:11], v[164:179]
    ds_read_b64_tr_b16 a[104:105], v234 offset:18432
    ds_read_b64_tr_b16 a[106:107], v234 offset:19456
    v_rcp_f32 v209, v209
    v_rcp_f32 v210, v210
    v_mul_f32 v208, v184, v208
    v_mfma_f32_32x32x16_bf16 v[164:179], a[120:123], a[12:15], v[164:179]
    s_waitcnt lgkmcnt(6)
    ds_read_b64_tr_b16 a[108:109], v234 offset:20480
    ds_read_b64_tr_b16 a[110:111], v234 offset:21504
    v_rcp_f32 v211, v211
    v_mul_f32 v209, v185, v209
    v_mul_f32 v210, v186, v210
    v_mul_f32 v211, v187, v211
    v_mfma_f32_32x32x16_bf16 v[164:179], a[124:127], a[16:19], v[164:179]
    ds_read_b64_tr_b16 a[112:113], v234 offset:22528
    ds_read_b64_tr_b16 a[114:115], v234 offset:23552
    v_cvt_pk_bf16_f32 v200, v208, v209
    v_cvt_pk_bf16_f32 v201, v210, v211
    v_mul_f32 v204, v188, v188
    v_mul_f32 v205, v189, v189
    v_mul_f32 v206, v190, v190
    v_mfma_f32_32x32x16_bf16 v[164:179], a[92:95], a[20:23], v[164:179]
    s_waitcnt lgkmcnt(6)
    ds_read_b64_tr_b16 a[116:117], v234 offset:24576
    ds_read_b64_tr_b16 a[118:119], v234 offset:25600
    v_mul_f32 v207, v191, v191
    v_fma_f32 v204, v204, v251, v250
    v_fma_f32 v205, v205, v251, v250
    v_fma_f32 v206, v206, v251, v250
    v_fma_f32 v207, v207, v251, v250
    v_mfma_f32_32x32x16_bf16 v[164:179], a[96:99], a[24:27], v[164:179]
    ds_read_b64_tr_b16 a[120:121], v234 offset:26624
    ds_read_b64_tr_b16 a[122:123], v234 offset:27648
    v_mul_f32 v204, v204, v188
    v_mul_f32 v205, v205, v189
    v_mul_f32 v206, v206, v190
    v_mul_f32 v207, v207, v191
    v_mfma_f32_32x32x16_bf16 v[164:179], a[100:103], a[28:31], v[164:179]
    s_waitcnt lgkmcnt(6)
    ds_read_b64_tr_b16 a[124:125], v234 offset:28672
    ds_read_b64_tr_b16 a[126:127], v234 offset:29696
    v_exp_f32 v204, v204
    v_exp_f32 v205, v205
    v_add_f32 v204, 1.0, v204
    v_mfma_f32_32x32x16_bf16 v[164:179], a[104:107], a[32:35], v[164:179]
    ds_read_b64_tr_b16 a[92:93], v234 offset:30720
    ds_read_b64_tr_b16 a[94:95], v234 offset:31744
    v_exp_f32 v206, v206
    v_exp_f32 v207, v207
    v_add_f32 v205, 1.0, v205
    v_mfma_f32_32x32x16_bf16 v[164:179], a[108:111], a[36:39], v[164:179]
    s_waitcnt lgkmcnt(6)
    ds_read_b64_tr_b16 a[96:97], v234 offset:32768
    ds_read_b64_tr_b16 a[98:99], v234 offset:33792
    v_add_f32 v206, 1.0, v206
    v_add_f32 v207, 1.0, v207
    v_rcp_f32 v204, v204
    v_mul_f32 v208, v192, v192
    v_mfma_f32_32x32x16_bf16 v[164:179], a[112:115], a[40:43], v[164:179]
    ds_read_b64_tr_b16 a[100:101], v234 offset:34816
    ds_read_b64_tr_b16 a[102:103], v234 offset:35840
    v_rcp_f32 v205, v205
    v_rcp_f32 v206, v206
    v_mul_f32 v204, v188, v204
    v_mfma_f32_32x32x16_bf16 v[164:179], a[116:119], a[44:47], v[164:179]
    s_waitcnt lgkmcnt(6)
    ds_read_b64_tr_b16 a[104:105], v234 offset:36864
    ds_read_b64_tr_b16 a[106:107], v234 offset:37888
    v_rcp_f32 v207, v207
    v_mul_f32 v205, v189, v205
    v_mul_f32 v206, v190, v206
    v_mfma_f32_32x32x16_bf16 v[164:179], a[120:123], a[48:51], v[164:179]
    ds_read_b64_tr_b16 a[108:109], v234 offset:38912
    ds_read_b64_tr_b16 a[110:111], v234 offset:39936
    v_mul_f32 v207, v191, v207
    v_cvt_pk_bf16_f32 v198, v204, v205
    v_cvt_pk_bf16_f32 v199, v206, v207
    v_mul_f32 v209, v193, v193
    v_mfma_f32_32x32x16_bf16 v[164:179], a[124:127], a[52:55], v[164:179]
    s_waitcnt lgkmcnt(6)
    buffer_store_dwordx4 v[196:199], v243, s[16:19], s44 offen offset:1024 sc1
    ds_read_b64_tr_b16 a[112:113], v234 offset:40960
    ds_read_b64_tr_b16 a[114:115], v234 offset:41984
    v_mul_f32 v210, v194, v194
    v_mul_f32 v211, v195, v195
    v_mfma_f32_32x32x16_bf16 v[164:179], a[92:95], a[56:59], v[164:179]
    ds_read_b64_tr_b16 a[116:117], v234 offset:43008
    ds_read_b64_tr_b16 a[118:119], v234 offset:44032
    v_fma_f32 v208, v208, v251, v250
    v_fma_f32 v209, v209, v251, v250
    v_fma_f32 v210, v210, v251, v250
    v_fma_f32 v211, v211, v251, v250
    v_mfma_f32_32x32x16_bf16 v[164:179], a[96:99], a[60:63], v[164:179]
    s_waitcnt lgkmcnt(6)
    ds_read_b64_tr_b16 a[120:121], v234 offset:45056
    ds_read_b64_tr_b16 a[122:123], v234 offset:46080
    v_mul_f32 v208, v208, v192
    v_mul_f32 v209, v209, v193
    v_mul_f32 v210, v210, v194
    v_mul_f32 v211, v211, v195
    v_mfma_f32_32x32x16_bf16 v[164:179], a[100:103], a[64:67], v[164:179]
    ds_read_b64_tr_b16 a[124:125], v234 offset:47104
    ds_read_b64_tr_b16 a[126:127], v234 offset:48128
    v_exp_f32 v208, v208
    v_exp_f32 v209, v209
    v_mfma_f32_32x32x16_bf16 v[164:179], a[104:107], a[68:71], v[164:179]
    s_waitcnt lgkmcnt(6)
    ds_read_b64_tr_b16 a[92:93], v236 offset:24576
    ds_read_b64_tr_b16 a[94:95], v236 offset:25600
    v_exp_f32 v210, v210
    v_exp_f32 v211, v211
    v_mfma_f32_32x32x16_bf16 v[164:179], a[108:111], a[72:75], v[164:179]
    ds_read_b64_tr_b16 a[96:97], v236 offset:26624
    ds_read_b64_tr_b16 a[98:99], v236 offset:27648
    v_add_f32 v208, 1.0, v208
    v_add_f32 v209, 1.0, v209
    v_add_f32 v210, 1.0, v210
    v_add_f32 v211, 1.0, v211
    v_mfma_f32_32x32x16_bf16 v[164:179], a[112:115], a[76:79], v[164:179]
    s_waitcnt lgkmcnt(6)
    ds_read_b64_tr_b16 a[100:101], v236 offset:28672
    ds_read_b64_tr_b16 a[102:103], v236 offset:29696
    v_rcp_f32 v208, v208
    v_rcp_f32 v209, v209
    v_mfma_f32_32x32x16_bf16 v[164:179], a[116:119], a[80:83], v[164:179]
    ds_read_b64_tr_b16 a[104:105], v236 offset:30720
    ds_read_b64_tr_b16 a[106:107], v236 offset:31744
    v_rcp_f32 v210, v210
    v_rcp_f32 v211, v211
    v_mfma_f32_32x32x16_bf16 v[164:179], a[120:123], a[84:87], v[164:179]
    s_waitcnt lgkmcnt(6)
    ds_read_b64_tr_b16 a[108:109], v236 offset:32768
    ds_read_b64_tr_b16 a[110:111], v236 offset:33792
    v_mul_f32 v208, v192, v208
    v_mul_f32 v209, v193, v209
    v_mul_f32 v210, v194, v210
    v_mul_f32 v211, v195, v211
    v_mfma_f32_32x32x16_bf16 v[164:179], a[124:127], a[88:91], v[164:179]
    s_waitcnt vmcnt(2)
    ds_read_b64_tr_b16 a[112:113], v236 offset:34816
    ds_read_b64_tr_b16 a[114:115], v236 offset:35840
    v_cvt_pk_bf16_f32 v202, v208, v209
    v_cvt_pk_bf16_f32 v203, v210, v211
    v_add_f32 v52, v52, v60
    v_add_f32 v53, v53, v61
    buffer_store_dwordx4 v[200:203], v243, s[16:19], s44 offen offset:1536 sc1
    v_mfma_f32_32x32x16_bf16 v[180:195], a[92:95], v[0:3], 0
    s_waitcnt lgkmcnt(6)
    ds_read_b64_tr_b16 a[116:117], v236 offset:36864
    ds_read_b64_tr_b16 a[118:119], v236 offset:37888
    v_mfma_f32_32x32x16_bf16 v[180:195], a[96:99], v[4:7], v[180:195]
    ds_read_b64_tr_b16 a[120:121], v236 offset:38912
    ds_read_b64_tr_b16 a[122:123], v236 offset:39936
    v_mfma_f32_32x32x16_bf16 v[180:195], a[100:103], v[8:11], v[180:195]
    s_waitcnt lgkmcnt(6)
    ds_read_b64_tr_b16 a[124:125], v236 offset:40960
    ds_read_b64_tr_b16 a[126:127], v236 offset:41984
    v_mul_f32 v222, s53, v221
    v_mul_f32 v204, v222, v164
    v_mul_f32 v205, v222, v165
    v_mul_f32 v206, v222, v166
    v_mfma_f32_32x32x16_bf16 v[180:195], a[104:107], v[12:15], v[180:195]
    ds_read_b64_tr_b16 a[92:93], v236 offset:43008
    ds_read_b64_tr_b16 a[94:95], v236 offset:44032
    v_mul_f32 v207, v222, v167
    v_cvt_pk_bf16_f32 v196, v204, v205
    v_cvt_pk_bf16_f32 v197, v206, v207
    v_mul_f32 v208, v222, v168
    v_mfma_f32_32x32x16_bf16 v[180:195], a[108:111], v[16:19], v[180:195]
    s_waitcnt lgkmcnt(6)
    ds_read_b64_tr_b16 a[96:97], v236 offset:45056
    ds_read_b64_tr_b16 a[98:99], v236 offset:46080
    v_mul_f32 v209, v222, v169
    v_mul_f32 v210, v222, v170
    v_mul_f32 v211, v222, v171
    v_cvt_pk_bf16_f32 v198, v208, v209
    v_mfma_f32_32x32x16_bf16 v[180:195], a[112:115], v[20:23], v[180:195]
    ds_read_b64_tr_b16 a[100:101], v236 offset:47104
    ds_read_b64_tr_b16 a[102:103], v236 offset:48128
    v_cvt_pk_bf16_f32 v199, v210, v211
    v_mul_f32 v204, v222, v172
    v_mul_f32 v205, v222, v173
    v_mul_f32 v206, v222, v174
    v_mfma_f32_32x32x16_bf16 v[180:195], a[116:119], v[24:27], v[180:195]
    s_waitcnt lgkmcnt(6)
    ds_write_b128 v240, v[196:199] offset:0
    ds_read_b64_tr_b16 a[104:105], v237 offset:0
    ds_read_b64_tr_b16 a[106:107], v237 offset:1024
    v_mul_f32 v207, v222, v175
    v_cvt_pk_bf16_f32 v200, v204, v205
    v_cvt_pk_bf16_f32 v201, v206, v207
    v_mfma_f32_32x32x16_bf16 v[180:195], a[120:123], v[28:31], v[180:195]
    ds_read_b64_tr_b16 a[108:109], v237 offset:2048
    ds_read_b64_tr_b16 a[110:111], v237 offset:3072
    v_mul_f32 v208, v222, v176
    v_mul_f32 v209, v222, v177
    v_mul_f32 v210, v222, v178
    v_mul_f32 v211, v222, v179
    v_mfma_f32_32x32x16_bf16 v[180:195], a[124:127], v[32:35], v[180:195]
    s_waitcnt lgkmcnt(7)
    s_add_u32 s64, s45, 18944
    ds_read_b64_tr_b16 a[112:113], v237 offset:4096
    ds_read_b64_tr_b16 a[114:115], v237 offset:5120
    v_cvt_pk_bf16_f32 v202, v208, v209
    v_cvt_pk_bf16_f32 v203, v210, v211
    v_add_f32 v54, v54, v62
    v_mfma_f32_32x32x16_bf16 v[180:195], a[92:95], v[36:39], v[180:195]
    ds_write_b128 v240, v[200:203] offset:1152
    ds_read_b64_tr_b16 a[116:117], v237 offset:6144
    ds_read_b64_tr_b16 a[118:119], v237 offset:7168
    v_add_f32 v55, v55, v63
    v_add_f32 v56, v56, v64
    v_add_f32 v57, v57, v65
    v_mfma_f32_32x32x16_bf16 v[180:195], a[96:99], v[40:43], v[180:195]
    s_waitcnt lgkmcnt(7)
    ds_read_b64_tr_b16 a[120:121], v237 offset:8192
    ds_read_b64_tr_b16 a[122:123], v237 offset:9216
    v_add_f32 v58, v58, v66
    v_add_f32 v59, v59, v67
    v_add_f32 v52, v52, v56
    v_add_f32 v53, v53, v57
    v_mfma_f32_32x32x16_bf16 v[180:195], a[100:103], v[44:47], v[180:195]
    s_waitcnt lgkmcnt(4)
    ds_read_b64_tr_b16 v[212:213], v241 offset:0
    ds_read_b64_tr_b16 v[214:215], v241 offset:128
    ds_read_b64_tr_b16 v[216:217], v241 offset:256
    ds_read_b64_tr_b16 v[218:219], v241 offset:384
    ds_read_b64_tr_b16 a[124:125], v237 offset:10240
    ds_read_b64_tr_b16 a[126:127], v237 offset:11264
    v_mfma_f32_32x32x16_bf16 v[180:195], a[104:107], v[48:51], v[180:195]
    ds_read_b64_tr_b16 a[92:93], v237 offset:12288
    ds_read_b64_tr_b16 a[94:95], v237 offset:13312
    v_add_f32 v54, v54, v58
    v_add_f32 v55, v55, v59
    v_add_f32 v52, v52, v54
    v_add_f32 v53, v53, v55
    v_mfma_f32_32x32x16_bf16 v[180:195], a[108:111], a[0:3], v[180:195]
    ds_read_b64_tr_b16 a[96:97], v237 offset:14336
    ds_read_b64_tr_b16 a[98:99], v237 offset:15360
    v_mov_b32 v54, v52
    v_mov_b32 v55, v53
    v_mfma_f32_32x32x16_bf16 v[180:195], a[112:115], a[4:7], v[180:195]
    s_waitcnt lgkmcnt(10)
    s_waitcnt lgkmcnt(6)
    buffer_store_dwordx4 v[212:215], v239, s[16:19], s45 offen offset:0 sc1
    ds_read_b64_tr_b16 a[100:101], v237 offset:16384
    ds_read_b64_tr_b16 a[102:103], v237 offset:17408
    v_mfma_f32_32x32x16_bf16 v[180:195], a[116:119], a[8:11], v[180:195]
    buffer_store_dwordx4 v[216:219], v239, s[16:19], s64 offen offset:0 sc1
    ds_read_b64_tr_b16 a[104:105], v237 offset:18432
    ds_read_b64_tr_b16 a[106:107], v237 offset:19456
    v_permlane32_swap_b32 v54, v52
    v_mfma_f32_32x32x16_bf16 v[180:195], a[120:123], a[12:15], v[180:195]
    s_waitcnt lgkmcnt(6)
    ds_read_b64_tr_b16 a[108:109], v237 offset:20480
    ds_read_b64_tr_b16 a[110:111], v237 offset:21504
    v_permlane32_swap_b32 v55, v53
    v_add_f32 v52, v52, v54
    v_add_f32 v53, v53, v55
    v_mfma_f32_32x32x16_bf16 v[180:195], a[124:127], a[16:19], v[180:195]
    ds_read_b64_tr_b16 a[112:113], v237 offset:22528
    ds_read_b64_tr_b16 a[114:115], v237 offset:23552
    v_mul_f32 v52, 0x39e38e39, v52
    v_mul_f32 v53, 0x39e38e39, v53
    v_fma_f32 v53, -v52, v52, v53
    v_max_f32 v53, 0, v53
    v_mfma_f32_32x32x16_bf16 v[180:195], a[92:95], a[20:23], v[180:195]
    s_waitcnt lgkmcnt(6)
    ds_read_b64_tr_b16 a[116:117], v237 offset:24576
    ds_read_b64_tr_b16 a[118:119], v237 offset:25600
    v_add_f32 v53, v223, v53
    v_rsq_f32 v248, v53
    v_mfma_f32_32x32x16_bf16 v[180:195], a[96:99], a[24:27], v[180:195]
    ds_read_b64_tr_b16 a[120:121], v237 offset:26624
    ds_read_b64_tr_b16 a[122:123], v237 offset:27648
    v_mul_f32 v249, v52, v248
    v_sub_f32 v249, 0, v249
    v_fma_f32 v68, v68, v248, v249
    v_fma_f32 v69, v69, v248, v249
    v_mfma_f32_32x32x16_bf16 v[180:195], a[100:103], a[28:31], v[180:195]
    s_waitcnt lgkmcnt(6)
    ds_read_b64_tr_b16 a[124:125], v237 offset:28672
    ds_read_b64_tr_b16 a[126:127], v237 offset:29696
    v_cvt_pk_bf16_f32 v68, v68, v69
    v_fma_f32 v70, v70, v248, v249
    v_fma_f32 v71, v71, v248, v249
    v_cvt_pk_bf16_f32 v69, v70, v71
    v_mfma_f32_32x32x16_bf16 v[180:195], a[104:107], a[32:35], v[180:195]
    ds_read_b64_tr_b16 a[92:93], v237 offset:30720
    ds_read_b64_tr_b16 a[94:95], v237 offset:31744
    v_fma_f32 v72, v72, v248, v249
    v_fma_f32 v73, v73, v248, v249
    v_cvt_pk_bf16_f32 v70, v72, v73
    v_fma_f32 v74, v74, v248, v249
    v_mfma_f32_32x32x16_bf16 v[180:195], a[108:111], a[36:39], v[180:195]
    s_waitcnt lgkmcnt(6)
    ds_read_b64_tr_b16 a[96:97], v237 offset:32768
    ds_read_b64_tr_b16 a[98:99], v237 offset:33792
    v_fma_f32 v75, v75, v248, v249
    v_cvt_pk_bf16_f32 v71, v74, v75
    v_fma_f32 v76, v76, v248, v249
    v_fma_f32 v77, v77, v248, v249
    v_mfma_f32_32x32x16_bf16 v[180:195], a[112:115], a[40:43], v[180:195]
    ds_read_b64_tr_b16 a[100:101], v237 offset:34816
    ds_read_b64_tr_b16 a[102:103], v237 offset:35840
    v_cvt_pk_bf16_f32 v72, v76, v77
    v_fma_f32 v78, v78, v248, v249
    v_fma_f32 v79, v79, v248, v249
    v_cvt_pk_bf16_f32 v73, v78, v79
    v_mfma_f32_32x32x16_bf16 v[180:195], a[116:119], a[44:47], v[180:195]
    s_waitcnt lgkmcnt(6)
    ds_read_b64_tr_b16 a[104:105], v237 offset:36864
    ds_read_b64_tr_b16 a[106:107], v237 offset:37888
    v_fma_f32 v80, v80, v248, v249
    v_fma_f32 v81, v81, v248, v249
    v_cvt_pk_bf16_f32 v74, v80, v81
    v_fma_f32 v82, v82, v248, v249
    v_mfma_f32_32x32x16_bf16 v[180:195], a[120:123], a[48:51], v[180:195]
    ds_write_b128 v240, v[68:71] offset:0
    s_add_u32 s97, s40, 73728
    ds_read_b64_tr_b16 a[108:109], v237 offset:38912
    ds_read_b64_tr_b16 a[110:111], v237 offset:39936
    v_fma_f32 v83, v83, v248, v249
    v_cvt_pk_bf16_f32 v75, v82, v83
    v_fma_f32 v84, v84, v248, v249
    v_mfma_f32_32x32x16_bf16 v[180:195], a[124:127], a[52:55], v[180:195]
    s_waitcnt lgkmcnt(7)
    ds_write_b128 v240, v[72:75] offset:1152
    ds_read_b64_tr_b16 a[112:113], v237 offset:40960
    ds_read_b64_tr_b16 a[114:115], v237 offset:41984
    v_fma_f32 v85, v85, v248, v249
    v_cvt_pk_bf16_f32 v84, v84, v85
    v_fma_f32 v86, v86, v248, v249
    v_mfma_f32_32x32x16_bf16 v[180:195], a[92:95], a[56:59], v[180:195]
    ds_read_b64_tr_b16 a[116:117], v237 offset:43008
    ds_read_b64_tr_b16 a[118:119], v237 offset:44032
    v_fma_f32 v87, v87, v248, v249
    v_cvt_pk_bf16_f32 v85, v86, v87
    v_fma_f32 v88, v88, v248, v249
    v_fma_f32 v89, v89, v248, v249
    v_mfma_f32_32x32x16_bf16 v[180:195], a[96:99], a[60:63], v[180:195]
    s_waitcnt lgkmcnt(8)
    s_waitcnt lgkmcnt(4)
    ds_read_b64_tr_b16 v[76:77], v242 offset:0
    ds_read_b64_tr_b16 v[78:79], v242 offset:64
    ds_read_b64_tr_b16 v[80:81], v242 offset:256
    ds_read_b64_tr_b16 a[120:121], v237 offset:45056
    ds_read_b64_tr_b16 a[122:123], v237 offset:46080
    v_mfma_f32_32x32x16_bf16 v[180:195], a[100:103], a[64:67], v[180:195]
    ds_read_b64_tr_b16 v[82:83], v242 offset:320
    ds_read_b64_tr_b16 a[124:125], v237 offset:47104
    ds_read_b64_tr_b16 a[126:127], v237 offset:48128
    v_cvt_pk_bf16_f32 v86, v88, v89
    v_fma_f32 v90, v90, v248, v249
    v_fma_f32 v91, v91, v248, v249
    v_mfma_f32_32x32x16_bf16 v[180:195], a[104:107], a[68:71], v[180:195]
    s_waitcnt lgkmcnt(10)
    v_cvt_pk_bf16_f32 v87, v90, v91
    v_fma_f32 v92, v92, v248, v249
    v_fma_f32 v93, v93, v248, v249
    v_cvt_pk_bf16_f32 v88, v92, v93
    v_fma_f32 v94, v94, v248, v249
    v_fma_f32 v95, v95, v248, v249
    v_mfma_f32_32x32x16_bf16 v[180:195], a[108:111], a[72:75], v[180:195]
    v_cvt_pk_bf16_f32 v89, v94, v95
    v_fma_f32 v96, v96, v248, v249
    v_fma_f32 v97, v97, v248, v249
    v_cvt_pk_bf16_f32 v90, v96, v97
    v_fma_f32 v98, v98, v248, v249
    v_fma_f32 v99, v99, v248, v249
    v_mfma_f32_32x32x16_bf16 v[180:195], a[112:115], a[76:79], v[180:195]
    s_waitcnt lgkmcnt(3)
    s_waitcnt lgkmcnt(2)
    buffer_store_dwordx4 v[76:79], v239, s[16:19], s40 offen offset:0 sc1
    buffer_store_dwordx4 v[80:83], v239, s[16:19], s97 offen offset:0 sc1
    v_cvt_pk_bf16_f32 v91, v98, v99
    v_mfma_f32_32x32x16_bf16 v[180:195], a[116:119], a[80:83], v[180:195]
    ds_write_b128 v240, v[84:87] offset:0
    ds_write_b128 v240, v[88:91] offset:1152
    s_add_u32 s97, s40, 73728
    v_fma_f32 v100, v100, v248, v249
    v_fma_f32 v101, v101, v248, v249
    v_cvt_pk_bf16_f32 v100, v100, v101
    v_fma_f32 v102, v102, v248, v249
    v_mfma_f32_32x32x16_bf16 v[180:195], a[120:123], a[84:87], v[180:195]
    s_waitcnt lgkmcnt(2)
    v_fma_f32 v103, v103, v248, v249
    v_cvt_pk_bf16_f32 v101, v102, v103
    v_fma_f32 v104, v104, v248, v249
    v_fma_f32 v105, v105, v248, v249
    v_cvt_pk_bf16_f32 v102, v104, v105
    v_fma_f32 v106, v106, v248, v249
    v_mfma_f32_32x32x16_bf16 v[180:195], a[124:127], a[88:91], v[180:195]
    s_waitcnt lgkmcnt(0)
    ds_read_b64_tr_b16 v[92:93], v242 offset:0
    ds_read_b64_tr_b16 v[94:95], v242 offset:64
    ds_read_b64_tr_b16 v[96:97], v242 offset:256
    ds_read_b64_tr_b16 v[98:99], v242 offset:320
    v_fma_f32 v107, v107, v248, v249
    v_cvt_pk_bf16_f32 v103, v106, v107
    s_nop 11
    s_waitcnt lgkmcnt(0)
    buffer_store_dwordx4 v[92:95], v239, s[16:19], s40 offen offset:1024 sc1
    buffer_store_dwordx4 v[96:99], v239, s[16:19], s97 offen offset:1024 sc1
    v_fma_f32 v108, v108, v248, v249
    v_fma_f32 v109, v109, v248, v249
    v_cvt_pk_bf16_f32 v104, v108, v109
    v_fma_f32 v110, v110, v248, v249
    v_fma_f32 v111, v111, v248, v249
    v_cvt_pk_bf16_f32 v105, v110, v111
    v_fma_f32 v112, v112, v248, v249
    v_fma_f32 v113, v113, v248, v249
    v_cvt_pk_bf16_f32 v106, v112, v113
    v_fma_f32 v114, v114, v248, v249
    v_fma_f32 v115, v115, v248, v249
    v_cvt_pk_bf16_f32 v107, v114, v115
    ds_write_b128 v240, v[100:103] offset:0
    ds_write_b128 v240, v[104:107] offset:1152
    s_waitcnt lgkmcnt(0)
    ds_read_b64_tr_b16 v[108:109], v242 offset:0
    ds_read_b64_tr_b16 v[110:111], v242 offset:64
    ds_read_b64_tr_b16 v[112:113], v242 offset:256
    ds_read_b64_tr_b16 v[114:115], v242 offset:320
    s_add_u32 s97, s41, 73728
    s_waitcnt lgkmcnt(0)
    buffer_store_dwordx4 v[108:111], v239, s[16:19], s41 offen offset:0 sc1
    buffer_store_dwordx4 v[112:115], v239, s[16:19], s97 offen offset:0 sc1
    v_fma_f32 v116, v116, v248, v249
    v_fma_f32 v117, v117, v248, v249
    v_cvt_pk_bf16_f32 v116, v116, v117
    v_fma_f32 v118, v118, v248, v249
    v_fma_f32 v119, v119, v248, v249
    v_cvt_pk_bf16_f32 v117, v118, v119
    v_fma_f32 v120, v120, v248, v249
    v_fma_f32 v121, v121, v248, v249
    v_cvt_pk_bf16_f32 v118, v120, v121
    v_fma_f32 v122, v122, v248, v249
    v_fma_f32 v123, v123, v248, v249
    v_cvt_pk_bf16_f32 v119, v122, v123
    v_fma_f32 v124, v124, v248, v249
    v_fma_f32 v125, v125, v248, v249
    v_cvt_pk_bf16_f32 v120, v124, v125
    v_fma_f32 v126, v126, v248, v249
    v_fma_f32 v127, v127, v248, v249
    v_cvt_pk_bf16_f32 v121, v126, v127
    v_fma_f32 v128, v128, v248, v249
    v_fma_f32 v129, v129, v248, v249
    v_cvt_pk_bf16_f32 v122, v128, v129
    v_fma_f32 v130, v130, v248, v249
    v_fma_f32 v131, v131, v248, v249
    v_cvt_pk_bf16_f32 v123, v130, v131
    ds_write_b128 v240, v[116:119] offset:0
    ds_write_b128 v240, v[120:123] offset:1152
    s_waitcnt lgkmcnt(0)
    ds_read_b64_tr_b16 v[124:125], v242 offset:0
    ds_read_b64_tr_b16 v[126:127], v242 offset:64
    ds_read_b64_tr_b16 v[128:129], v242 offset:256
    ds_read_b64_tr_b16 v[130:131], v242 offset:320
    s_add_u32 s97, s41, 73728
    s_waitcnt lgkmcnt(0)
    buffer_store_dwordx4 v[124:127], v239, s[16:19], s41 offen offset:1024 sc1
    buffer_store_dwordx4 v[128:131], v239, s[16:19], s97 offen offset:1024 sc1
    v_mul_f32 v222, s53, v221
    v_mul_f32 v204, v222, v180
    v_mul_f32 v205, v222, v181
    v_mul_f32 v206, v222, v182
    v_mul_f32 v207, v222, v183
    v_cvt_pk_bf16_f32 v196, v204, v205
    v_cvt_pk_bf16_f32 v197, v206, v207
    v_mul_f32 v208, v222, v184
    v_mul_f32 v209, v222, v185
    v_mul_f32 v210, v222, v186
    v_mul_f32 v211, v222, v187
    v_cvt_pk_bf16_f32 v198, v208, v209
    v_cvt_pk_bf16_f32 v199, v210, v211
    ds_write_b128 v240, v[196:199] offset:0
    v_mul_f32 v204, v222, v188
    v_mul_f32 v205, v222, v189
    v_mul_f32 v206, v222, v190
    v_mul_f32 v207, v222, v191
    v_cvt_pk_bf16_f32 v200, v204, v205
    v_cvt_pk_bf16_f32 v201, v206, v207
    v_mul_f32 v208, v222, v192
    v_mul_f32 v209, v222, v193
    v_mul_f32 v210, v222, v194
    v_mul_f32 v211, v222, v195
    v_cvt_pk_bf16_f32 v202, v208, v209
    v_cvt_pk_bf16_f32 v203, v210, v211
    ds_write_b128 v240, v[200:203] offset:1152
    s_waitcnt lgkmcnt(0)
    ds_read_b64_tr_b16 v[212:213], v241 offset:0
    ds_read_b64_tr_b16 v[214:215], v241 offset:128
    ds_read_b64_tr_b16 v[216:217], v241 offset:256
    ds_read_b64_tr_b16 v[218:219], v241 offset:384
    s_add_u32 s64, s45, 18944
    s_waitcnt lgkmcnt(0)
    buffer_store_dwordx4 v[212:215], v239, s[16:19], s45 offen offset:1024 sc1
    buffer_store_dwordx4 v[216:219], v239, s[16:19], s64 offen offset:1024 sc1
    s_cmp_lg_u32 s29, 15
    s_cbranch_scc1 L1_noones
    v_and_b32 v247, 31, v246
    v_lshrrev_b32 v204, 5, v246
    v_mul_u32_u24 v204, 18944, v204
    v_lshl_add_u32 v247, v247, 4, v204
    v_mov_b32 v208, s62
    v_mov_b32 v209, s62
    v_mov_b32 v210, s62
    v_mov_b32 v211, s62
    s_add_u32 s59, s80, 18432
    buffer_store_dwordx4 v[208:211], v247, s[16:19], s59 offen sc1
L1_noones:
    s_endpgm
L1_end:
    s_endpgm
.globl k2_kernel
.p2align 8
.type k2_kernel,@function
k2_kernel:
    s_cmp_ge_u32 s2, 256
    s_cbranch_scc1 L2_end
    s_load_dwordx4 s[56:59], s[0:1], 40
    s_getpc_b64 s[70:71]
Lpc_2:
    s_lshr_b32 s72, s2, 3
    s_mul_i32 s72, s72, 12
    v_add_lshl_u32 v4, v0, s72, 7
    s_sub_u32 s70, s70, Lpc_2-k2_kernel
    s_subb_u32 s71, s71, 0
    v_min_u32 v4, Lcode_end-k2_kernel-4, v4
    v_cmp_gt_u32 s[72:73], 12, v0
    v_mov_b32 v5, s71
    v_add_co_u32 v4, vcc, s70, v4
    s_nop 1
    v_addc_co_u32 v5, vcc, 0, v5, vcc
    s_and_saveexec_b64 s[70:71], s[72:73]
    s_cbranch_execz Lpcs_2
    global_load_dword v254, v[4:5], off
Lpcs_2:
    s_mov_b64 exec, s[70:71]
    s_load_dwordx2 s[60:61], s[0:1], 80
    s_load_dwordx2 s[16:17], s[0:1], 56
    s_load_dwordx2 s[20:21], s[0:1], 16
    s_load_dwordx2 s[88:89], s[0:1], 64
    s_load_dwordx2 s[92:93], s[0:1], 0
    v_mov_b32 v6, 126960
    v_mov_b32 v8, 0
    v_mov_b32 v9, 0
    ds_write_b64 v6, v[8:9]
    v_lshrrev_b32 v4, 6, v0
    v_and_b32 v1, 63, v0
    s_and_b32 s35, s2, 7
    v_readfirstlane_b32 s28, v4
    s_lshr_b32 s36, s2, 3
    s_and_b32 s32, s36, 7
    s_lshr_b32 s36, s36, 3
    s_and_b32 s29, s35, 1
    s_lshl_b32 s30, s32, 1
    s_add_u32 s29, s29, s30
    s_lshr_b32 s30, s35, 1
    s_lshl_b32 s30, s30, 2
    s_add_u32 s30, s30, s36
    s_lshl_b32 s31, s35, 2
    s_add_u32 s31, s31, s36
    s_mul_i32 s33, s31, 9
    s_lshr_b32 s33, s33, 3
    s_and_b32 s34, s31, 7
    v_lshlrev_b32 v2, 4, v1
    v_and_b32 v4, 31, v1
    v_lshrrev_b32 v5, 5, v1
    s_mul_i32 s35, s31, 18
    v_add_u32 v7, s35, v4
    v_and_b32 v6, 15, v7
    v_lshlrev_b32 v6, 4, v6
    v_lshl_add_u32 v6, v5, 8, v6
    v_lshrrev_b32 v7, 4, v7
    v_lshl_add_u32 v6, v7, 9, v6
    v_cmp_gt_u32 s[48:49], 18, v4
    v_mov_b32 v3, 0x80000000
    v_and_b32 v7, 27, v4
    v_cndmask_b32 v3, v3, v6, s[48:49]
    v_cmp_eq_u32 s[48:49], 18, v7
    v_mov_b32 v6, 18432
    s_nop 0
    v_cndmask_b32 v3, v3, v6, s[48:49]
    s_cmp_ge_u32 s28, 4
    s_cbranch_scc1 L2_gemm
    s_setprio 2
    s_lshl_b32 s35, s32, 3
    s_lshl_b32 s36, s28, 1
    s_add_u32 s35, s35, s36
    s_mul_i32 s50, s35, 184320
    s_mul_i32 s35, s35, 36
    s_add_u32 s35, s35, s33
    s_lshl_b32 s35, s35, 10
    s_add_u32 s36, s35, 36864
    s_waitcnt lgkmcnt(0)
    s_mov_b32 s8, s60
    s_and_b32 s9, s61, 0xffff
    s_mov_b32 s10, 38133760
    s_mov_b32 s11, 0x20000
    buffer_load_dwordx4 v[112:115], v2, s[8:11], s35 offen offset:0
    buffer_load_dwordx4 v[116:119], v2, s[8:11], s35 offen offset:1024
    buffer_load_dwordx4 v[120:123], v2, s[8:11], s36 offen offset:0
    buffer_load_dwordx4 v[124:127], v2, s[8:11], s36 offen offset:1024
    s_lshl_b32 s52, s33, 10
    s_add_u32 s52, s52, 2359296
    s_add_u32 s37, s52, 0
    buffer_load_dwordx4 v[136:139], v2, s[8:11], s37 offen offset:0
    buffer_load_dwordx4 v[140:143], v2, s[8:11], s37 offen offset:1024
    s_add_u32 s37, s52, 36864
    buffer_load_dwordx4 v[48:51], v2, s[8:11], s37 offen offset:0
    buffer_load_dwordx4 v[52:55], v2, s[8:11], s37 offen offset:1024
    v_add_u32 v160, 126976, v2
    v_lshrrev_b32 v4, 5, v1
    v_and_b32 v5, 15, v1
    v_lshlrev_b32 v5, 4, v5
    v_bfe_u32 v6, v1, 4, 1
    v_mul_u32_u24 v6, 92160, v6
    v_add_u32 v5, v5, v6
    v_lshl_add_u32 v164, v4, 8, v5
    v_lshl_add_u32 v165, v4, 31, v5
    v_lshlrev_b32 v4, 1, v4
    v_subrev_u32 v4, s34, v4
    v_mov_b32 v8, 0
    s_add_u32 s50, s50, 26017792
    s_lshr_b32 s35, s31, 4
    s_lshl_b32 s35, s35, 10
    s_bfe_u32 s36, s31, 0x20002
    s_lshl_b32 s36, s36, 8
    s_add_u32 s35, s35, s36
    s_and_b32 s36, s31, 3
    s_lshl_b32 s36, s36, 2
    s_add_u32 s35, s35, s36
    s_add_u32 s51, s50, s35
    s_add_u32 s51, s51, 16384
    s_lshl_b32 s35, s31, 9
    s_add_u32 s50, s50, s35
    s_waitcnt vmcnt(4)
    v_add_u32 v6, 0, v4
    v_cmp_gt_u32 s[48:49], 9, v6
    s_nop 1
    v_cndmask_b32 v112, v8, v112, s[48:49]
    v_cndmask_b32 v120, v8, v120, s[48:49]
    v_add_u32 v6, 1, v4
    v_cmp_gt_u32 s[48:49], 9, v6
    s_nop 1
    v_cndmask_b32 v113, v8, v113, s[48:49]
    v_cndmask_b32 v121, v8, v121, s[48:49]
    v_add_u32 v6, 4, v4
    v_cmp_gt_u32 s[48:49], 9, v6
    s_nop 1
    v_cndmask_b32 v114, v8, v114, s[48:49]
    v_cndmask_b32 v122, v8, v122, s[48:49]
    v_add_u32 v6, 5, v4
    v_cmp_gt_u32 s[48:49], 9, v6
    s_nop 1
    v_cndmask_b32 v115, v8, v115, s[48:49]
    v_cndmask_b32 v123, v8, v123, s[48:49]
    v_add_u32 v6, 8, v4
    v_cmp_gt_u32 s[48:49], 9, v6
    s_nop 1
    v_cndmask_b32 v116, v8, v116, s[48:49]
    v_cndmask_b32 v124, v8, v124, s[48:49]
    v_add_u32 v6, 9, v4
    v_cmp_gt_u32 s[48:49], 9, v6
    s_nop 1
    v_cndmask_b32 v117, v8, v117, s[48:49]
    v_cndmask_b32 v125, v8, v125, s[48:49]
    v_add_u32 v6, 12, v4
    v_cmp_gt_u32 s[48:49], 9, v6
    s_nop 1
    v_cndmask_b32 v118, v8, v118, s[48:49]
    v_cndmask_b32 v126, v8, v126, s[48:49]
    v_add_u32 v6, 13, v4
    v_cmp_gt_u32 s[48:49], 9, v6
    s_nop 1
    v_cndmask_b32 v119, v8, v119, s[48:49]
    v_cndmask_b32 v127, v8, v127, s[48:49]
    s_mov_b32 s47, 0
    s_waitcnt vmcnt(2)
    v_mfma_f32_32x32x16_bf16 v[16:31], v[136:139], v[112:115], 0
    v_mfma_f32_32x32x16_bf16 v[16:31], v[140:143], v[116:119], v[16:31]
    v_mfma_f32_32x32x16_bf16 v[32:47], v[136:139], v[120:123], 0
    v_mfma_f32_32x32x16_bf16 v[32:47], v[140:143], v[124:127], v[32:47]
    s_waitcnt vmcnt(0)
    v_mfma_f32_32x32x16_bf16 v[80:95], v[48:51], v[112:115], 0
    v_mfma_f32_32x32x16_bf16 v[80:95], v[52:55], v[116:119], v[80:95]
    v_mfma_f32_32x32x16_bf16 v[96:111], v[48:51], v[120:123], 0
    v_mfma_f32_32x32x16_bf16 v[96:111], v[52:55], v[124:127], v[96:111]
    s_nop 5
    v_max3_f32 v172, v16, v17, v18
    v_max_f32 v172, v172, v19
    v_max3_f32 v172, v172, v20, v21
    v_max3_f32 v172, v172, v22, v23
    v_max3_f32 v172, v172, v24, v25
    v_max3_f32 v172, v172, v26, v27
    v_max3_f32 v172, v172, v28, v29
    v_max3_f32 v172, v172, v30, v31
    v_max3_f32 v173, v32, v33, v34
    v_max_f32 v173, v173, v35
    v_max3_f32 v173, v173, v36, v37
    v_max3_f32 v173, v173, v38, v39
    v_max3_f32 v173, v173, v40, v41
    v_max3_f32 v173, v173, v42, v43
    v_max3_f32 v173, v173, v44, v45
    v_max3_f32 v173, v173, v46, v47
    v_max3_f32 v172, v172, v80, v81
    v_max3_f32 v172, v172, v82, v83
    v_max3_f32 v172, v172, v84, v85
    v_max3_f32 v172, v172, v86, v87
    v_max3_f32 v172, v172, v88, v89
    v_max3_f32 v172, v172, v90, v91
    v_max3_f32 v172, v172, v92, v93
    v_max3_f32 v172, v172, v94, v95
    v_max3_f32 v173, v173, v96, v97
    v_max3_f32 v173, v173, v98, v99
    v_max3_f32 v173, v173, v100, v101
    v_max3_f32 v173, v173, v102, v103
    v_max3_f32 v173, v173, v104, v105
    v_max3_f32 v173, v173, v106, v107
    v_max3_f32 v173, v173, v108, v109
    v_max3_f32 v173, v173, v110, v111
    v_mov_b32 v4, v172
    v_mov_b32 v5, v173
    s_nop 1
    v_permlane32_swap_b32 v4, v172
    v_permlane32_swap_b32 v5, v173
    v_max_f32 v4, v4, v172
    v_sub_f32 v4, 0xc2b00000, v4
    v_max_f32 v5, v5, v173
    v_sub_f32 v5, 0xc2b00000, v5
    v_mov_b32 v80, v4
    v_mov_b32 v81, v4
    v_mov_b32 v82, v4
    v_mov_b32 v83, v4
    v_mov_b32 v84, v4
    v_mov_b32 v85, v4
    v_mov_b32 v86, v4
    v_mov_b32 v87, v4
    v_mov_b32 v88, v4
    v_mov_b32 v89, v4
    v_mov_b32 v90, v4
    v_mov_b32 v91, v4
    v_mov_b32 v92, v4
    v_mov_b32 v93, v4
    v_mov_b32 v94, v4
    v_mov_b32 v95, v4
    v_mov_b32 v96, v5
    v_mov_b32 v97, v5
    v_mov_b32 v98, v5
    v_mov_b32 v99, v5
    v_mov_b32 v100, v5
    v_mov_b32 v101, v5
    v_mov_b32 v102, v5
    v_mov_b32 v103, v5
    v_mov_b32 v104, v5
    v_mov_b32 v105, v5
    v_mov_b32 v106, v5
    v_mov_b32 v107, v5
    v_mov_b32 v108, v5
    v_mov_b32 v109, v5
    v_mov_b32 v110, v5
    v_mov_b32 v111, v5
    v_mov_b32 v48, 0
    v_mov_b32 v49, 0
    v_mov_b32 v50, 0
    v_mov_b32 v51, 0
    v_mov_b32 v52, 0
    v_mov_b32 v53, 0
    v_mov_b32 v54, 0
    v_mov_b32 v55, 0
    v_mov_b32 v56, 0
    v_mov_b32 v57, 0
    v_mov_b32 v58, 0
    v_mov_b32 v59, 0
    v_mov_b32 v60, 0
    v_mov_b32 v61, 0
    v_mov_b32 v62, 0
    v_mov_b32 v63, 0
    v_mov_b32 v64, 0
    v_mov_b32 v65, 0
    v_mov_b32 v66, 0
    v_mov_b32 v67, 0
    v_mov_b32 v68, 0
    v_mov_b32 v69, 0
    v_mov_b32 v70, 0
    v_mov_b32 v71, 0
    v_mov_b32 v72, 0
    v_mov_b32 v73, 0
    v_mov_b32 v74, 0
    v_mov_b32 v75, 0
    v_mov_b32 v76, 0
    v_mov_b32 v77, 0
    v_mov_b32 v78, 0
    v_mov_b32 v79, 0
    v_mov_b32 v132, 0
    v_mov_b32 v156, 0
    v_mov_b32 v133, 0
    v_mov_b32 v157, 0
    v_mov_b32 v134, 0
    v_mov_b32 v158, 0
    v_mov_b32 v135, 0
    v_mov_b32 v159, 0
    v_mfma_f32_32x32x16_bf16 v[16:31], v[136:139], v[112:115], v[80:95]
    v_mfma_f32_32x32x16_bf16 v[16:31], v[140:143], v[116:119], v[16:31]
    s_mov_b32 s38, 0
    s_nop 8
.p2align 6
L2_aloop:
    s_cmp_lt_u32 s38, 32
    s_cbranch_scc1 L2_bar0
L2_nobar0:
    v_mfma_f32_32x32x16_bf16 v[32:47], v[136:139], v[120:123], v[96:111]
    ds_read_b128 v[152:155], v160 offset:2048
    ds_read_b128 v[144:147], v160 offset:0
    ds_read_b128 v[148:151], v160 offset:1024
    v_exp_f32 v16, v16
    v_exp_f32 v17, v17
    v_exp_f32 v18, v18
    v_exp_f32 v19, v19
    v_mfma_f32_32x32x16_bf16 v[64:79], v[156:159], v[132:135], v[64:79]
    ds_read_b128 v[156:159], v160 offset:3072
    v_exp_f32 v20, v20
    v_exp_f32 v21, v21
    v_exp_f32 v22, v22
    v_exp_f32 v23, v23
    v_cvt_pk_bf16_f32 v128, v16, v17
    v_cvt_pk_bf16_f32 v129, v18, v19
    v_mfma_f32_32x32x16_bf16 v[32:47], v[140:143], v[124:127], v[32:47]
    s_waitcnt lgkmcnt(3)
    v_cvt_pk_bf16_f32 v130, v20, v21
    v_cvt_pk_bf16_f32 v131, v22, v23
    v_exp_f32 v24, v24
    v_exp_f32 v25, v25
    v_exp_f32 v26, v26
    v_exp_f32 v27, v27
    v_mfma_f32_32x32x16_bf16 v[48:63], v[152:155], v[128:131], v[48:63]
    s_waitcnt lgkmcnt(0)
    v_exp_f32 v28, v28
    v_exp_f32 v29, v29
    v_exp_f32 v30, v30
    v_exp_f32 v31, v31
    v_cvt_pk_bf16_f32 v132, v24, v25
    v_cvt_pk_bf16_f32 v133, v26, v27
    v_cvt_pk_bf16_f32 v134, v28, v29
    v_cvt_pk_bf16_f32 v135, v30, v31
    v_mfma_f32_32x32x16_bf16 v[16:31], v[144:147], v[112:115], v[80:95]
    v_exp_f32 v32, v32
    v_exp_f32 v33, v33
    v_exp_f32 v34, v34
    v_exp_f32 v35, v35
    v_mfma_f32_32x32x16_bf16 v[48:63], v[156:159], v[132:135], v[48:63]
    v_exp_f32 v36, v36
    v_exp_f32 v37, v37
    v_exp_f32 v38, v38
    v_exp_f32 v39, v39
    v_cvt_pk_bf16_f32 v128, v32, v33
    v_cvt_pk_bf16_f32 v129, v34, v35
    v_mfma_f32_32x32x16_bf16 v[16:31], v[148:151], v[116:119], v[16:31]
    v_cvt_pk_bf16_f32 v130, v36, v37
    v_cvt_pk_bf16_f32 v131, v38, v39
    v_exp_f32 v40, v40
    v_exp_f32 v41, v41
    v_exp_f32 v42, v42
    v_exp_f32 v43, v43
    v_mfma_f32_32x32x16_bf16 v[64:79], v[152:155], v[128:131], v[64:79]
    s_cmp_lt_u32 s38, 31
    v_exp_f32 v44, v44
    v_exp_f32 v45, v45
    v_exp_f32 v46, v46
    v_exp_f32 v47, v47
    v_cvt_pk_bf16_f32 v132, v40, v41
    v_cvt_pk_bf16_f32 v133, v42, v43
    v_cvt_pk_bf16_f32 v134, v44, v45
    v_cvt_pk_bf16_f32 v135, v46, v47
    s_cbranch_scc1 L2_bar1
L2_nobar1:
    v_mfma_f32_32x32x16_bf16 v[32:47], v[144:147], v[120:123], v[96:111]
    ds_read_b128 v[152:155], v160 offset:6144
    ds_read_b128 v[136:139], v160 offset:4096
    ds_read_b128 v[140:143], v160 offset:5120
    v_exp_f32 v16, v16
    v_exp_f32 v17, v17
    v_exp_f32 v18, v18
    v_exp_f32 v19, v19
    v_mfma_f32_32x32x16_bf16 v[64:79], v[156:159], v[132:135], v[64:79]
    ds_read_b128 v[156:159], v160 offset:7168
    v_exp_f32 v20, v20
    v_exp_f32 v21, v21
    v_exp_f32 v22, v22
    v_exp_f32 v23, v23
    v_cvt_pk_bf16_f32 v128, v16, v17
    v_cvt_pk_bf16_f32 v129, v18, v19
    v_mfma_f32_32x32x16_bf16 v[32:47], v[148:151], v[124:127], v[32:47]
    s_waitcnt lgkmcnt(3)
    v_cvt_pk_bf16_f32 v130, v20, v21
    v_cvt_pk_bf16_f32 v131, v22, v23
    v_exp_f32 v24, v24
    v_exp_f32 v25, v25
    v_exp_f32 v26, v26
    v_exp_f32 v27, v27
    v_mfma_f32_32x32x16_bf16 v[48:63], v[152:155], v[128:131], v[48:63]
    s_waitcnt lgkmcnt(0)
    v_exp_f32 v28, v28
    v_exp_f32 v29, v29
    v_exp_f32 v30, v30
    v_exp_f32 v31, v31
    v_cvt_pk_bf16_f32 v132, v24, v25
    v_cvt_pk_bf16_f32 v133, v26, v27
    v_cvt_pk_bf16_f32 v134, v28, v29
    v_cvt_pk_bf16_f32 v135, v30, v31
    v_mfma_f32_32x32x16_bf16 v[16:31], v[136:139], v[112:115], v[80:95]
    v_exp_f32 v32, v32
    v_exp_f32 v33, v33
    v_exp_f32 v34, v34
    v_exp_f32 v35, v35
    v_mfma_f32_32x32x16_bf16 v[48:63], v[156:159], v[132:135], v[48:63]
    v_exp_f32 v36, v36
    v_exp_f32 v37, v37
    v_exp_f32 v38, v38
    v_exp_f32 v39, v39
    v_cvt_pk_bf16_f32 v128, v32, v33
    v_cvt_pk_bf16_f32 v129, v34, v35
    v_mfma_f32_32x32x16_bf16 v[16:31], v[140:143], v[116:119], v[16:31]
    v_cvt_pk_bf16_f32 v130, v36, v37
    v_cvt_pk_bf16_f32 v131, v38, v39
    v_exp_f32 v40, v40
    v_exp_f32 v41, v41
    v_exp_f32 v42, v42
    v_exp_f32 v43, v43
    v_mfma_f32_32x32x16_bf16 v[64:79], v[152:155], v[128:131], v[64:79]
    v_exp_f32 v44, v44
    v_exp_f32 v45, v45
    v_exp_f32 v46, v46
    v_exp_f32 v47, v47
    v_cvt_pk_bf16_f32 v132, v40, v41
    v_cvt_pk_bf16_f32 v133, v42, v43
    v_cvt_pk_bf16_f32 v134, v44, v45
    v_cvt_pk_bf16_f32 v135, v46, v47
    s_barrier
    v_mfma_f32_32x32x16_bf16 v[32:47], v[136:139], v[120:123], v[96:111]
    ds_read_b128 v[152:155], v160 offset:10240
    ds_read_b128 v[144:147], v160 offset:8192
    ds_read_b128 v[148:151], v160 offset:9216
    v_exp_f32 v16, v16
    v_exp_f32 v17, v17
    v_exp_f32 v18, v18
    v_exp_f32 v19, v19
    v_mfma_f32_32x32x16_bf16 v[64:79], v[156:159], v[132:135], v[64:79]
    ds_read_b128 v[156:159], v160 offset:11264
    v_exp_f32 v20, v20
    v_exp_f32 v21, v21
    v_exp_f32 v22, v22
    v_exp_f32 v23, v23
    v_cvt_pk_bf16_f32 v128, v16, v17
    v_cvt_pk_bf16_f32 v129, v18, v19
    v_mfma_f32_32x32x16_bf16 v[32:47], v[140:143], v[124:127], v[32:47]
    s_waitcnt lgkmcnt(3)
    v_cvt_pk_bf16_f32 v130, v20, v21
    v_cvt_pk_bf16_f32 v131, v22, v23
    v_exp_f32 v24, v24
    v_exp_f32 v25, v25
    v_exp_f32 v26, v26
    v_exp_f32 v27, v27
    v_mfma_f32_32x32x16_bf16 v[48:63], v[152:155], v[128:131], v[48:63]
    s_waitcnt lgkmcnt(0)
    v_exp_f32 v28, v28
    v_exp_f32 v29, v29
    v_exp_f32 v30, v30
    v_exp_f32 v31, v31
    v_cvt_pk_bf16_f32 v132, v24, v25
    v_cvt_pk_bf16_f32 v133, v26, v27
    v_cvt_pk_bf16_f32 v134, v28, v29
    v_cvt_pk_bf16_f32 v135, v30, v31
    v_mfma_f32_32x32x16_bf16 v[16:31], v[144:147], v[112:115], v[80:95]
    v_exp_f32 v32, v32
    v_exp_f32 v33, v33
    v_exp_f32 v34, v34
    v_exp_f32 v35, v35
    v_mfma_f32_32x32x16_bf16 v[48:63], v[156:159], v[132:135], v[48:63]
    v_exp_f32 v36, v36
    v_exp_f32 v37, v37
    v_exp_f32 v38, v38
    v_exp_f32 v39, v39
    v_cvt_pk_bf16_f32 v128, v32, v33
    v_cvt_pk_bf16_f32 v129, v34, v35
    v_mfma_f32_32x32x16_bf16 v[16:31], v[148:151], v[116:119], v[16:31]
    v_cvt_pk_bf16_f32 v130, v36, v37
    v_cvt_pk_bf16_f32 v131, v38, v39
    v_exp_f32 v40, v40
    v_exp_f32 v41, v41
    v_exp_f32 v42, v42
    v_exp_f32 v43, v43
    v_mfma_f32_32x32x16_bf16 v[64:79], v[152:155], v[128:131], v[64:79]
    s_cmp_lt_u32 s38, 29
    v_exp_f32 v44, v44
    v_exp_f32 v45, v45
    v_exp_f32 v46, v46
    v_exp_f32 v47, v47
    v_cvt_pk_bf16_f32 v132, v40, v41
    v_cvt_pk_bf16_f32 v133, v42, v43
    v_cvt_pk_bf16_f32 v134, v44, v45
    v_cvt_pk_bf16_f32 v135, v46, v47
    s_cbranch_scc1 L2_bar3
L2_nobar3:
    v_mfma_f32_32x32x16_bf16 v[32:47], v[144:147], v[120:123], v[96:111]
    ds_read_b128 v[152:155], v160 offset:14336
    ds_read_b128 v[136:139], v160 offset:12288
    ds_read_b128 v[140:143], v160 offset:13312
    v_exp_f32 v16, v16
    v_exp_f32 v17, v17
    v_exp_f32 v18, v18
    v_exp_f32 v19, v19
    v_mfma_f32_32x32x16_bf16 v[64:79], v[156:159], v[132:135], v[64:79]
    ds_read_b128 v[156:159], v160 offset:15360
    v_exp_f32 v20, v20
    v_exp_f32 v21, v21
    v_exp_f32 v22, v22
    v_exp_f32 v23, v23
    v_cvt_pk_bf16_f32 v128, v16, v17
    v_cvt_pk_bf16_f32 v129, v18, v19
    v_mfma_f32_32x32x16_bf16 v[32:47], v[148:151], v[124:127], v[32:47]
    s_waitcnt lgkmcnt(3)
    v_cvt_pk_bf16_f32 v130, v20, v21
    v_cvt_pk_bf16_f32 v131, v22, v23
    v_exp_f32 v24, v24
    v_exp_f32 v25, v25
    v_exp_f32 v26, v26
    v_exp_f32 v27, v27
    v_mfma_f32_32x32x16_bf16 v[48:63], v[152:155], v[128:131], v[48:63]
    s_waitcnt lgkmcnt(0)
    v_exp_f32 v28, v28
    v_exp_f32 v29, v29
    v_exp_f32 v30, v30
    v_exp_f32 v31, v31
    v_cvt_pk_bf16_f32 v132, v24, v25
    v_cvt_pk_bf16_f32 v133, v26, v27
    v_cvt_pk_bf16_f32 v134, v28, v29
    v_cvt_pk_bf16_f32 v135, v30, v31
    v_mfma_f32_32x32x16_bf16 v[16:31], v[136:139], v[112:115], v[80:95]
    v_exp_f32 v32, v32
    v_exp_f32 v33, v33
    v_exp_f32 v34, v34
    v_exp_f32 v35, v35
    v_mfma_f32_32x32x16_bf16 v[48:63], v[156:159], v[132:135], v[48:63]
    v_exp_f32 v36, v36
    v_exp_f32 v37, v37
    v_exp_f32 v38, v38
    v_exp_f32 v39, v39
    v_cvt_pk_bf16_f32 v128, v32, v33
    v_cvt_pk_bf16_f32 v129, v34, v35
    v_mfma_f32_32x32x16_bf16 v[16:31], v[140:143], v[116:119], v[16:31]
    v_cvt_pk_bf16_f32 v130, v36, v37
    v_cvt_pk_bf16_f32 v131, v38, v39
    v_exp_f32 v40, v40
    v_exp_f32 v41, v41
    v_exp_f32 v42, v42
    v_exp_f32 v43, v43
    v_mfma_f32_32x32x16_bf16 v[64:79], v[152:155], v[128:131], v[64:79]
    s_cmp_lt_u32 s38, 28
    v_exp_f32 v44, v44
    v_exp_f32 v45, v45
    v_exp_f32 v46, v46
    v_exp_f32 v47, v47
    v_cvt_pk_bf16_f32 v132, v40, v41
    v_cvt_pk_bf16_f32 v133, v42, v43
    v_cvt_pk_bf16_f32 v134, v44, v45
    v_cvt_pk_bf16_f32 v135, v46, v47
    s_cbranch_scc1 L2_bar4
L2_nobar4:
    v_mfma_f32_32x32x16_bf16 v[32:47], v[136:139], v[120:123], v[96:111]
    ds_read_b128 v[152:155], v160 offset:18432
    ds_read_b128 v[144:147], v160 offset:16384
    ds_read_b128 v[148:151], v160 offset:17408
    v_exp_f32 v16, v16
    v_exp_f32 v17, v17
    v_exp_f32 v18, v18
    v_exp_f32 v19, v19
    v_mfma_f32_32x32x16_bf16 v[64:79], v[156:159], v[132:135], v[64:79]
    ds_read_b128 v[156:159], v160 offset:19456
    v_exp_f32 v20, v20
    v_exp_f32 v21, v21
    v_exp_f32 v22, v22
    v_exp_f32 v23, v23
    v_cvt_pk_bf16_f32 v128, v16, v17
    v_cvt_pk_bf16_f32 v129, v18, v19
    v_mfma_f32_32x32x16_bf16 v[32:47], v[140:143], v[124:127], v[32:47]
    s_waitcnt lgkmcnt(3)
    v_cvt_pk_bf16_f32 v130, v20, v21
    v_cvt_pk_bf16_f32 v131, v22, v23
    v_exp_f32 v24, v24
    v_exp_f32 v25, v25
    v_exp_f32 v26, v26
    v_exp_f32 v27, v27
    v_mfma_f32_32x32x16_bf16 v[48:63], v[152:155], v[128:131], v[48:63]
    s_waitcnt lgkmcnt(0)
    v_exp_f32 v28, v28
    v_exp_f32 v29, v29
    v_exp_f32 v30, v30
    v_exp_f32 v31, v31
    v_cvt_pk_bf16_f32 v132, v24, v25
    v_cvt_pk_bf16_f32 v133, v26, v27
    v_cvt_pk_bf16_f32 v134, v28, v29
    v_cvt_pk_bf16_f32 v135, v30, v31
    v_mfma_f32_32x32x16_bf16 v[16:31], v[144:147], v[112:115], v[80:95]
    v_exp_f32 v32, v32
    v_exp_f32 v33, v33
    v_exp_f32 v34, v34
    v_exp_f32 v35, v35
    v_mfma_f32_32x32x16_bf16 v[48:63], v[156:159], v[132:135], v[48:63]
    v_exp_f32 v36, v36
    v_exp_f32 v37, v37
    v_exp_f32 v38, v38
    v_exp_f32 v39, v39
    v_cvt_pk_bf16_f32 v128, v32, v33
    v_cvt_pk_bf16_f32 v129, v34, v35
    v_mfma_f32_32x32x16_bf16 v[16:31], v[148:151], v[116:119], v[16:31]
    v_cvt_pk_bf16_f32 v130, v36, v37
    v_cvt_pk_bf16_f32 v131, v38, v39
    v_exp_f32 v40, v40
    v_exp_f32 v41, v41
    v_exp_f32 v42, v42
    v_exp_f32 v43, v43
    v_mfma_f32_32x32x16_bf16 v[64:79], v[152:155], v[128:131], v[64:79]
    v_exp_f32 v44, v44
    v_exp_f32 v45, v45
    v_exp_f32 v46, v46
    v_exp_f32 v47, v47
    v_cvt_pk_bf16_f32 v132, v40, v41
    v_cvt_pk_bf16_f32 v133, v42, v43
    v_cvt_pk_bf16_f32 v134, v44, v45
    v_cvt_pk_bf16_f32 v135, v46, v47
    s_barrier
    v_mfma_f32_32x32x16_bf16 v[32:47], v[144:147], v[120:123], v[96:111]
    ds_read_b128 v[152:155], v160 offset:22528
    ds_read_b128 v[136:139], v160 offset:20480
    ds_read_b128 v[140:143], v160 offset:21504
    v_exp_f32 v16, v16
    v_exp_f32 v17, v17
    v_exp_f32 v18, v18
    v_exp_f32 v19, v19
    v_mfma_f32_32x32x16_bf16 v[64:79], v[156:159], v[132:135], v[64:79]
    ds_read_b128 v[156:159], v160 offset:23552
    v_exp_f32 v20, v20
    v_exp_f32 v21, v21
    v_exp_f32 v22, v22
    v_exp_f32 v23, v23
    v_cvt_pk_bf16_f32 v128, v16, v17
    v_cvt_pk_bf16_f32 v129, v18, v19
    v_mfma_f32_32x32x16_bf16 v[32:47], v[148:151], v[124:127], v[32:47]
    s_waitcnt lgkmcnt(3)
    v_cvt_pk_bf16_f32 v130, v20, v21
    v_cvt_pk_bf16_f32 v131, v22, v23
    v_exp_f32 v24, v24
    v_exp_f32 v25, v25
    v_exp_f32 v26, v26
    v_exp_f32 v27, v27
    v_mfma_f32_32x32x16_bf16 v[48:63], v[152:155], v[128:131], v[48:63]
    s_waitcnt lgkmcnt(0)
    v_exp_f32 v28, v28
    v_exp_f32 v29, v29
    v_exp_f32 v30, v30
    v_exp_f32 v31, v31
    v_cvt_pk_bf16_f32 v132, v24, v25
    v_cvt_pk_bf16_f32 v133, v26, v27
    v_cvt_pk_bf16_f32 v134, v28, v29
    v_cvt_pk_bf16_f32 v135, v30, v31
    v_mfma_f32_32x32x16_bf16 v[16:31], v[136:139], v[112:115], v[80:95]
    v_exp_f32 v32, v32
    v_exp_f32 v33, v33
    v_exp_f32 v34, v34
    v_exp_f32 v35, v35
    v_mfma_f32_32x32x16_bf16 v[48:63], v[156:159], v[132:135], v[48:63]
    v_exp_f32 v36, v36
    v_exp_f32 v37, v37
    v_exp_f32 v38, v38
    v_exp_f32 v39, v39
    v_cvt_pk_bf16_f32 v128, v32, v33
    v_cvt_pk_bf16_f32 v129, v34, v35
    v_mfma_f32_32x32x16_bf16 v[16:31], v[140:143], v[116:119], v[16:31]
    v_cvt_pk_bf16_f32 v130, v36, v37
    v_cvt_pk_bf16_f32 v131, v38, v39
    v_exp_f32 v40, v40
    v_exp_f32 v41, v41
    v_exp_f32 v42, v42
    v_exp_f32 v43, v43
    v_mfma_f32_32x32x16_bf16 v[64:79], v[152:155], v[128:131], v[64:79]
    s_cmp_lt_u32 s38, 26
    v_exp_f32 v44, v44
    v_exp_f32 v45, v45
    v_exp_f32 v46, v46
    v_exp_f32 v47, v47
    v_cvt_pk_bf16_f32 v132, v40, v41
    v_cvt_pk_bf16_f32 v133, v42, v43
    v_cvt_pk_bf16_f32 v134, v44, v45
    v_cvt_pk_bf16_f32 v135, v46, v47
    s_cbranch_scc1 L2_bar6
L2_nobar6:
    v_mfma_f32_32x32x16_bf16 v[32:47], v[136:139], v[120:123], v[96:111]
    ds_read_b128 v[152:155], v160 offset:26624
    ds_read_b128 v[144:147], v160 offset:24576
    ds_read_b128 v[148:151], v160 offset:25600
    v_exp_f32 v16, v16
    v_exp_f32 v17, v17
    v_exp_f32 v18, v18
    v_exp_f32 v19, v19
    v_mfma_f32_32x32x16_bf16 v[64:79], v[156:159], v[132:135], v[64:79]
    ds_read_b128 v[156:159], v160 offset:27648
    v_exp_f32 v20, v20
    v_exp_f32 v21, v21
    v_exp_f32 v22, v22
    v_exp_f32 v23, v23
    v_cvt_pk_bf16_f32 v128, v16, v17
    v_cvt_pk_bf16_f32 v129, v18, v19
    v_mfma_f32_32x32x16_bf16 v[32:47], v[140:143], v[124:127], v[32:47]
    s_waitcnt lgkmcnt(3)
    v_cvt_pk_bf16_f32 v130, v20, v21
    v_cvt_pk_bf16_f32 v131, v22, v23
    v_exp_f32 v24, v24
    v_exp_f32 v25, v25
    v_exp_f32 v26, v26
    v_exp_f32 v27, v27
    v_mfma_f32_32x32x16_bf16 v[48:63], v[152:155], v[128:131], v[48:63]
    s_waitcnt lgkmcnt(0)
    v_exp_f32 v28, v28
    v_exp_f32 v29, v29
    v_exp_f32 v30, v30
    v_exp_f32 v31, v31
    v_cvt_pk_bf16_f32 v132, v24, v25
    v_cvt_pk_bf16_f32 v133, v26, v27
    v_cvt_pk_bf16_f32 v134, v28, v29
    v_cvt_pk_bf16_f32 v135, v30, v31
    v_mfma_f32_32x32x16_bf16 v[16:31], v[144:147], v[112:115], v[80:95]
    v_exp_f32 v32, v32
    v_exp_f32 v33, v33
    v_exp_f32 v34, v34
    v_exp_f32 v35, v35
    v_mfma_f32_32x32x16_bf16 v[48:63], v[156:159], v[132:135], v[48:63]
    v_exp_f32 v36, v36
    v_exp_f32 v37, v37
    v_exp_f32 v38, v38
    v_exp_f32 v39, v39
    v_cvt_pk_bf16_f32 v128, v32, v33
    v_cvt_pk_bf16_f32 v129, v34, v35
    v_mfma_f32_32x32x16_bf16 v[16:31], v[148:151], v[116:119], v[16:31]
    v_cvt_pk_bf16_f32 v130, v36, v37
    v_cvt_pk_bf16_f32 v131, v38, v39
    v_exp_f32 v40, v40
    v_exp_f32 v41, v41
    v_exp_f32 v42, v42
    v_exp_f32 v43, v43
    v_mfma_f32_32x32x16_bf16 v[64:79], v[152:155], v[128:131], v[64:79]
    s_cmp_lt_u32 s38, 25
    v_exp_f32 v44, v44
    v_exp_f32 v45, v45
    v_exp_f32 v46, v46
    v_exp_f32 v47, v47
    v_cvt_pk_bf16_f32 v132, v40, v41
    v_cvt_pk_bf16_f32 v133, v42, v43
    v_cvt_pk_bf16_f32 v134, v44, v45
    v_cvt_pk_bf16_f32 v135, v46, v47
    s_cbranch_scc1 L2_bar7
L2_nobar7:
    v_mfma_f32_32x32x16_bf16 v[32:47], v[144:147], v[120:123], v[96:111]
    ds_read_b128 v[152:155], v160 offset:30720
    ds_read_b128 v[136:139], v160 offset:28672
    ds_read_b128 v[140:143], v160 offset:29696
    v_exp_f32 v16, v16
    v_exp_f32 v17, v17
    v_exp_f32 v18, v18
    v_exp_f32 v19, v19
    v_mfma_f32_32x32x16_bf16 v[64:79], v[156:159], v[132:135], v[64:79]
    ds_read_b128 v[156:159], v160 offset:31744
    v_exp_f32 v20, v20
    v_exp_f32 v21, v21
    v_exp_f32 v22, v22
    v_exp_f32 v23, v23
    v_cvt_pk_bf16_f32 v128, v16, v17
    v_cvt_pk_bf16_f32 v129, v18, v19
    v_mfma_f32_32x32x16_bf16 v[32:47], v[148:151], v[124:127], v[32:47]
    s_waitcnt lgkmcnt(3)
    v_cvt_pk_bf16_f32 v130, v20, v21
    v_cvt_pk_bf16_f32 v131, v22, v23
    v_exp_f32 v24, v24
    v_exp_f32 v25, v25
    v_exp_f32 v26, v26
    v_exp_f32 v27, v27
    v_mfma_f32_32x32x16_bf16 v[48:63], v[152:155], v[128:131], v[48:63]
    s_waitcnt lgkmcnt(0)
    v_exp_f32 v28, v28
    v_exp_f32 v29, v29
    v_exp_f32 v30, v30
    v_exp_f32 v31, v31
    v_cvt_pk_bf16_f32 v132, v24, v25
    v_cvt_pk_bf16_f32 v133, v26, v27
    v_cvt_pk_bf16_f32 v134, v28, v29
    v_cvt_pk_bf16_f32 v135, v30, v31
    v_mfma_f32_32x32x16_bf16 v[16:31], v[136:139], v[112:115], v[80:95]
    v_exp_f32 v32, v32
    v_exp_f32 v33, v33
    v_exp_f32 v34, v34
    v_exp_f32 v35, v35
    v_mfma_f32_32x32x16_bf16 v[48:63], v[156:159], v[132:135], v[48:63]
    v_exp_f32 v36, v36
    v_exp_f32 v37, v37
    v_exp_f32 v38, v38
    v_exp_f32 v39, v39
    v_cvt_pk_bf16_f32 v128, v32, v33
    v_cvt_pk_bf16_f32 v129, v34, v35
    v_mfma_f32_32x32x16_bf16 v[16:31], v[140:143], v[116:119], v[16:31]
    v_cvt_pk_bf16_f32 v130, v36, v37
    v_cvt_pk_bf16_f32 v131, v38, v39
    v_exp_f32 v40, v40
    v_exp_f32 v41, v41
    v_exp_f32 v42, v42
    v_exp_f32 v43, v43
    v_mfma_f32_32x32x16_bf16 v[64:79], v[152:155], v[128:131], v[64:79]
    v_exp_f32 v44, v44
    v_exp_f32 v45, v45
    v_exp_f32 v46, v46
    v_exp_f32 v47, v47
    v_cvt_pk_bf16_f32 v132, v40, v41
    v_cvt_pk_bf16_f32 v133, v42, v43
    v_cvt_pk_bf16_f32 v134, v44, v45
    v_cvt_pk_bf16_f32 v135, v46, v47
    s_barrier
    v_mfma_f32_32x32x16_bf16 v[32:47], v[136:139], v[120:123], v[96:111]
    ds_read_b128 v[152:155], v160 offset:34816
    ds_read_b128 v[144:147], v160 offset:32768
    ds_read_b128 v[148:151], v160 offset:33792
    v_exp_f32 v16, v16
    v_exp_f32 v17, v17
    v_exp_f32 v18, v18
    v_exp_f32 v19, v19
    v_mfma_f32_32x32x16_bf16 v[64:79], v[156:159], v[132:135], v[64:79]
    ds_read_b128 v[156:159], v160 offset:35840
    v_exp_f32 v20, v20
    v_exp_f32 v21, v21
    v_exp_f32 v22, v22
    v_exp_f32 v23, v23
    v_cvt_pk_bf16_f32 v128, v16, v17
    v_cvt_pk_bf16_f32 v129, v18, v19
    v_mfma_f32_32x32x16_bf16 v[32:47], v[140:143], v[124:127], v[32:47]
    s_waitcnt lgkmcnt(3)
    v_cvt_pk_bf16_f32 v130, v20, v21
    v_cvt_pk_bf16_f32 v131, v22, v23
    v_exp_f32 v24, v24
    v_exp_f32 v25, v25
    v_exp_f32 v26, v26
    v_exp_f32 v27, v27
    v_mfma_f32_32x32x16_bf16 v[48:63], v[152:155], v[128:131], v[48:63]
    s_waitcnt lgkmcnt(0)
    v_exp_f32 v28, v28
    v_exp_f32 v29, v29
    v_exp_f32 v30, v30
    v_exp_f32 v31, v31
    v_cvt_pk_bf16_f32 v132, v24, v25
    v_cvt_pk_bf16_f32 v133, v26, v27
    v_cvt_pk_bf16_f32 v134, v28, v29
    v_cvt_pk_bf16_f32 v135, v30, v31
    v_mfma_f32_32x32x16_bf16 v[16:31], v[144:147], v[112:115], v[80:95]
    v_exp_f32 v32, v32
    v_exp_f32 v33, v33
    v_exp_f32 v34, v34
    v_exp_f32 v35, v35
    v_mfma_f32_32x32x16_bf16 v[48:63], v[156:159], v[132:135], v[48:63]
    v_exp_f32 v36, v36
    v_exp_f32 v37, v37
    v_exp_f32 v38, v38
    v_exp_f32 v39, v39
    v_cvt_pk_bf16_f32 v128, v32, v33
    v_cvt_pk_bf16_f32 v129, v34, v35
    v_mfma_f32_32x32x16_bf16 v[16:31], v[148:151], v[116:119], v[16:31]
    v_cvt_pk_bf16_f32 v130, v36, v37
    v_cvt_pk_bf16_f32 v131, v38, v39
    v_exp_f32 v40, v40
    v_exp_f32 v41, v41
    v_exp_f32 v42, v42
    v_exp_f32 v43, v43
    v_mfma_f32_32x32x16_bf16 v[64:79], v[152:155], v[128:131], v[64:79]
    s_cmp_lt_u32 s38, 23
    v_exp_f32 v44, v44
    v_exp_f32 v45, v45
    v_exp_f32 v46, v46
    v_exp_f32 v47, v47
    v_cvt_pk_bf16_f32 v132, v40, v41
    v_cvt_pk_bf16_f32 v133, v42, v43
    v_cvt_pk_bf16_f32 v134, v44, v45
    v_cvt_pk_bf16_f32 v135, v46, v47
    s_cbranch_scc1 L2_bar9
L2_nobar9:
    v_mfma_f32_32x32x16_bf16 v[32:47], v[144:147], v[120:123], v[96:111]
    ds_read_b128 v[152:155], v160 offset:2048
    ds_read_b128 v[136:139], v160 offset:0
    ds_read_b128 v[140:143], v160 offset:1024
    v_exp_f32 v16, v16
    v_exp_f32 v17, v17
    v_exp_f32 v18, v18
    v_exp_f32 v19, v19
    v_mfma_f32_32x32x16_bf16 v[64:79], v[156:159], v[132:135], v[64:79]
    ds_read_b128 v[156:159], v160 offset:3072
    v_exp_f32 v20, v20
    v_exp_f32 v21, v21
    v_exp_f32 v22, v22
    v_exp_f32 v23, v23
    v_cvt_pk_bf16_f32 v128, v16, v17
    v_cvt_pk_bf16_f32 v129, v18, v19
    v_mfma_f32_32x32x16_bf16 v[32:47], v[148:151], v[124:127], v[32:47]
    s_waitcnt lgkmcnt(3)
    v_cvt_pk_bf16_f32 v130, v20, v21
    v_cvt_pk_bf16_f32 v131, v22, v23
    v_exp_f32 v24, v24
    v_exp_f32 v25, v25
    v_exp_f32 v26, v26
    v_exp_f32 v27, v27
    v_mfma_f32_32x32x16_bf16 v[48:63], v[152:155], v[128:131], v[48:63]
    s_waitcnt lgkmcnt(0)
    v_exp_f32 v28, v28
    v_exp_f32 v29, v29
    v_exp_f32 v30, v30
    v_exp_f32 v31, v31
    v_cvt_pk_bf16_f32 v132, v24, v25
    v_cvt_pk_bf16_f32 v133, v26, v27
    v_cvt_pk_bf16_f32 v134, v28, v29
    v_cvt_pk_bf16_f32 v135, v30, v31
    v_mfma_f32_32x32x16_bf16 v[16:31], v[136:139], v[112:115], v[80:95]
    v_exp_f32 v32, v32
    v_exp_f32 v33, v33
    v_exp_f32 v34, v34
    v_exp_f32 v35, v35
    v_mfma_f32_32x32x16_bf16 v[48:63], v[156:159], v[132:135], v[48:63]
    v_exp_f32 v36, v36
    v_exp_f32 v37, v37
    v_exp_f32 v38, v38
    v_exp_f32 v39, v39
    v_cvt_pk_bf16_f32 v128, v32, v33
    v_cvt_pk_bf16_f32 v129, v34, v35
    v_mfma_f32_32x32x16_bf16 v[16:31], v[140:143], v[116:119], v[16:31]
    v_cvt_pk_bf16_f32 v130, v36, v37
    v_cvt_pk_bf16_f32 v131, v38, v39
    v_exp_f32 v40, v40
    v_exp_f32 v41, v41
    v_exp_f32 v42, v42
    v_exp_f32 v43, v43
    v_mfma_f32_32x32x16_bf16 v[64:79], v[152:155], v[128:131], v[64:79]
    s_cmp_eq_u32 s38, 54
    v_exp_f32 v44, v44
    v_exp_f32 v45, v45
    v_exp_f32 v46, v46
    v_exp_f32 v47, v47
    v_cvt_pk_bf16_f32 v132, v40, v41
    v_cvt_pk_bf16_f32 v133, v42, v43
    v_cvt_pk_bf16_f32 v134, v44, v45
    v_cvt_pk_bf16_f32 v135, v46, v47
    s_cbranch_scc1 L2_adone
    s_cmp_lt_u32 s38, 22
    s_cbranch_scc1 L2_bar10
L2_nobar10:
    v_mfma_f32_32x32x16_bf16 v[32:47], v[136:139], v[120:123], v[96:111]
    ds_read_b128 v[152:155], v160 offset:6144
    ds_read_b128 v[144:147], v160 offset:4096
    ds_read_b128 v[148:151], v160 offset:5120
    v_exp_f32 v16, v16
    v_exp_f32 v17, v17
    v_exp_f32 v18, v18
    v_exp_f32 v19, v19
    v_mfma_f32_32x32x16_bf16 v[64:79], v[156:159], v[132:135], v[64:79]
    ds_read_b128 v[156:159], v160 offset:7168
    v_exp_f32 v20, v20
    v_exp_f32 v21, v21
    v_exp_f32 v22, v22
    v_exp_f32 v23, v23
    v_cvt_pk_bf16_f32 v128, v16, v17
    v_cvt_pk_bf16_f32 v129, v18, v19
    v_mfma_f32_32x32x16_bf16 v[32:47], v[140:143], v[124:127], v[32:47]
    s_waitcnt lgkmcnt(3)
    v_cvt_pk_bf16_f32 v130, v20, v21
    v_cvt_pk_bf16_f32 v131, v22, v23
    v_exp_f32 v24, v24
    v_exp_f32 v25, v25
    v_exp_f32 v26, v26
    v_exp_f32 v27, v27
    v_mfma_f32_32x32x16_bf16 v[48:63], v[152:155], v[128:131], v[48:63]
    s_waitcnt lgkmcnt(0)
    v_exp_f32 v28, v28
    v_exp_f32 v29, v29
    v_exp_f32 v30, v30
    v_exp_f32 v31, v31
    v_cvt_pk_bf16_f32 v132, v24, v25
    v_cvt_pk_bf16_f32 v133, v26, v27
    v_cvt_pk_bf16_f32 v134, v28, v29
    v_cvt_pk_bf16_f32 v135, v30, v31
    v_mfma_f32_32x32x16_bf16 v[16:31], v[144:147], v[112:115], v[80:95]
    v_exp_f32 v32, v32
    v_exp_f32 v33, v33
    v_exp_f32 v34, v34
    v_exp_f32 v35, v35
    v_mfma_f32_32x32x16_bf16 v[48:63], v[156:159], v[132:135], v[48:63]
    v_exp_f32 v36, v36
    v_exp_f32 v37, v37
    v_exp_f32 v38, v38
    v_exp_f32 v39, v39
    v_cvt_pk_bf16_f32 v128, v32, v33
    v_cvt_pk_bf16_f32 v129, v34, v35
    v_mfma_f32_32x32x16_bf16 v[16:31], v[148:151], v[116:119], v[16:31]
    v_cvt_pk_bf16_f32 v130, v36, v37
    v_cvt_pk_bf16_f32 v131, v38, v39
    v_exp_f32 v40, v40
    v_exp_f32 v41, v41
    v_exp_f32 v42, v42
    v_exp_f32 v43, v43
    v_mfma_f32_32x32x16_bf16 v[64:79], v[152:155], v[128:131], v[64:79]
    v_exp_f32 v44, v44
    v_exp_f32 v45, v45
    v_exp_f32 v46, v46
    v_exp_f32 v47, v47
    v_cvt_pk_bf16_f32 v132, v40, v41
    v_cvt_pk_bf16_f32 v133, v42, v43
    v_cvt_pk_bf16_f32 v134, v44, v45
    v_cvt_pk_bf16_f32 v135, v46, v47
    s_barrier
    v_mfma_f32_32x32x16_bf16 v[32:47], v[144:147], v[120:123], v[96:111]
    ds_read_b128 v[152:155], v160 offset:10240
    ds_read_b128 v[136:139], v160 offset:8192
    ds_read_b128 v[140:143], v160 offset:9216
    v_exp_f32 v16, v16
    v_exp_f32 v17, v17
    v_exp_f32 v18, v18
    v_exp_f32 v19, v19
    v_mfma_f32_32x32x16_bf16 v[64:79], v[156:159], v[132:135], v[64:79]
    ds_read_b128 v[156:159], v160 offset:11264
    v_exp_f32 v20, v20
    v_exp_f32 v21, v21
    v_exp_f32 v22, v22
    v_exp_f32 v23, v23
    v_cvt_pk_bf16_f32 v128, v16, v17
    v_cvt_pk_bf16_f32 v129, v18, v19
    v_mfma_f32_32x32x16_bf16 v[32:47], v[148:151], v[124:127], v[32:47]
    s_waitcnt lgkmcnt(3)
    v_cvt_pk_bf16_f32 v130, v20, v21
    v_cvt_pk_bf16_f32 v131, v22, v23
    v_exp_f32 v24, v24
    v_exp_f32 v25, v25
    v_exp_f32 v26, v26
    v_exp_f32 v27, v27
    v_mfma_f32_32x32x16_bf16 v[48:63], v[152:155], v[128:131], v[48:63]
    s_waitcnt lgkmcnt(0)
    v_exp_f32 v28, v28
    v_exp_f32 v29, v29
    v_exp_f32 v30, v30
    v_exp_f32 v31, v31
    v_cvt_pk_bf16_f32 v132, v24, v25
    v_cvt_pk_bf16_f32 v133, v26, v27
    v_cvt_pk_bf16_f32 v134, v28, v29
    v_cvt_pk_bf16_f32 v135, v30, v31
    v_mfma_f32_32x32x16_bf16 v[16:31], v[136:139], v[112:115], v[80:95]
    v_exp_f32 v32, v32
    v_exp_f32 v33, v33
    v_exp_f32 v34, v34
    v_exp_f32 v35, v35
    v_mfma_f32_32x32x16_bf16 v[48:63], v[156:159], v[132:135], v[48:63]
    v_exp_f32 v36, v36
    v_exp_f32 v37, v37
    v_exp_f32 v38, v38
    v_exp_f32 v39, v39
    v_cvt_pk_bf16_f32 v128, v32, v33
    v_cvt_pk_bf16_f32 v129, v34, v35
    v_mfma_f32_32x32x16_bf16 v[16:31], v[140:143], v[116:119], v[16:31]
    v_cvt_pk_bf16_f32 v130, v36, v37
    v_cvt_pk_bf16_f32 v131, v38, v39
    v_exp_f32 v40, v40
    v_exp_f32 v41, v41
    v_exp_f32 v42, v42
    v_exp_f32 v43, v43
    v_mfma_f32_32x32x16_bf16 v[64:79], v[152:155], v[128:131], v[64:79]
    s_cmp_lt_u32 s38, 20
    v_exp_f32 v44, v44
    v_exp_f32 v45, v45
    v_exp_f32 v46, v46
    v_exp_f32 v47, v47
    v_cvt_pk_bf16_f32 v132, v40, v41
    v_cvt_pk_bf16_f32 v133, v42, v43
    v_cvt_pk_bf16_f32 v134, v44, v45
    v_cvt_pk_bf16_f32 v135, v46, v47
    s_cbranch_scc1 L2_bar12
L2_nobar12:
    v_mfma_f32_32x32x16_bf16 v[32:47], v[136:139], v[120:123], v[96:111]
    ds_read_b128 v[152:155], v160 offset:14336
    ds_read_b128 v[144:147], v160 offset:12288
    ds_read_b128 v[148:151], v160 offset:13312
    v_exp_f32 v16, v16
    v_exp_f32 v17, v17
    v_exp_f32 v18, v18
    v_exp_f32 v19, v19
    v_mfma_f32_32x32x16_bf16 v[64:79], v[156:159], v[132:135], v[64:79]
    ds_read_b128 v[156:159], v160 offset:15360
    v_exp_f32 v20, v20
    v_exp_f32 v21, v21
    v_exp_f32 v22, v22
    v_exp_f32 v23, v23
    v_cvt_pk_bf16_f32 v128, v16, v17
    v_cvt_pk_bf16_f32 v129, v18, v19
    v_mfma_f32_32x32x16_bf16 v[32:47], v[140:143], v[124:127], v[32:47]
    s_waitcnt lgkmcnt(3)
    v_cvt_pk_bf16_f32 v130, v20, v21
    v_cvt_pk_bf16_f32 v131, v22, v23
    v_exp_f32 v24, v24
    v_exp_f32 v25, v25
    v_exp_f32 v26, v26
    v_exp_f32 v27, v27
    v_mfma_f32_32x32x16_bf16 v[48:63], v[152:155], v[128:131], v[48:63]
    s_waitcnt lgkmcnt(0)
    v_exp_f32 v28, v28
    v_exp_f32 v29, v29
    v_exp_f32 v30, v30
    v_exp_f32 v31, v31
    v_cvt_pk_bf16_f32 v132, v24, v25
    v_cvt_pk_bf16_f32 v133, v26, v27
    v_cvt_pk_bf16_f32 v134, v28, v29
    v_cvt_pk_bf16_f32 v135, v30, v31
    v_mfma_f32_32x32x16_bf16 v[16:31], v[144:147], v[112:115], v[80:95]
    v_exp_f32 v32, v32
    v_exp_f32 v33, v33
    v_exp_f32 v34, v34
    v_exp_f32 v35, v35
    v_mfma_f32_32x32x16_bf16 v[48:63], v[156:159], v[132:135], v[48:63]
    v_exp_f32 v36, v36
    v_exp_f32 v37, v37
    v_exp_f32 v38, v38
    v_exp_f32 v39, v39
    v_cvt_pk_bf16_f32 v128, v32, v33
    v_cvt_pk_bf16_f32 v129, v34, v35
    v_mfma_f32_32x32x16_bf16 v[16:31], v[148:151], v[116:119], v[16:31]
    v_cvt_pk_bf16_f32 v130, v36, v37
    v_cvt_pk_bf16_f32 v131, v38, v39
    v_exp_f32 v40, v40
    v_exp_f32 v41, v41
    v_exp_f32 v42, v42
    v_exp_f32 v43, v43
    v_mfma_f32_32x32x16_bf16 v[64:79], v[152:155], v[128:131], v[64:79]
    s_cmp_lt_u32 s38, 19
    v_exp_f32 v44, v44
    v_exp_f32 v45, v45
    v_exp_f32 v46, v46
    v_exp_f32 v47, v47
    v_cvt_pk_bf16_f32 v132, v40, v41
    v_cvt_pk_bf16_f32 v133, v42, v43
    v_cvt_pk_bf16_f32 v134, v44, v45
    v_cvt_pk_bf16_f32 v135, v46, v47
    s_cbranch_scc1 L2_bar13
L2_nobar13:
    v_mfma_f32_32x32x16_bf16 v[32:47], v[144:147], v[120:123], v[96:111]
    ds_read_b128 v[152:155], v160 offset:18432
    ds_read_b128 v[136:139], v160 offset:16384
    ds_read_b128 v[140:143], v160 offset:17408
    v_exp_f32 v16, v16
    v_exp_f32 v17, v17
    v_exp_f32 v18, v18
    v_exp_f32 v19, v19
    v_mfma_f32_32x32x16_bf16 v[64:79], v[156:159], v[132:135], v[64:79]
    ds_read_b128 v[156:159], v160 offset:19456
    v_exp_f32 v20, v20
    v_exp_f32 v21, v21
    v_exp_f32 v22, v22
    v_exp_f32 v23, v23
    v_cvt_pk_bf16_f32 v128, v16, v17
    v_cvt_pk_bf16_f32 v129, v18, v19
    v_mfma_f32_32x32x16_bf16 v[32:47], v[148:151], v[124:127], v[32:47]
    s_waitcnt lgkmcnt(3)
    v_cvt_pk_bf16_f32 v130, v20, v21
    v_cvt_pk_bf16_f32 v131, v22, v23
    v_exp_f32 v24, v24
    v_exp_f32 v25, v25
    v_exp_f32 v26, v26
    v_exp_f32 v27, v27
    v_mfma_f32_32x32x16_bf16 v[48:63], v[152:155], v[128:131], v[48:63]
    s_waitcnt lgkmcnt(0)
    v_exp_f32 v28, v28
    v_exp_f32 v29, v29
    v_exp_f32 v30, v30
    v_exp_f32 v31, v31
    v_cvt_pk_bf16_f32 v132, v24, v25
    v_cvt_pk_bf16_f32 v133, v26, v27
    v_cvt_pk_bf16_f32 v134, v28, v29
    v_cvt_pk_bf16_f32 v135, v30, v31
    v_mfma_f32_32x32x16_bf16 v[16:31], v[136:139], v[112:115], v[80:95]
    v_exp_f32 v32, v32
    v_exp_f32 v33, v33
    v_exp_f32 v34, v34
    v_exp_f32 v35, v35
    v_mfma_f32_32x32x16_bf16 v[48:63], v[156:159], v[132:135], v[48:63]
    v_exp_f32 v36, v36
    v_exp_f32 v37, v37
    v_exp_f32 v38, v38
    v_exp_f32 v39, v39
    v_cvt_pk_bf16_f32 v128, v32, v33
    v_cvt_pk_bf16_f32 v129, v34, v35
    v_mfma_f32_32x32x16_bf16 v[16:31], v[140:143], v[116:119], v[16:31]
    v_cvt_pk_bf16_f32 v130, v36, v37
    v_cvt_pk_bf16_f32 v131, v38, v39
    v_exp_f32 v40, v40
    v_exp_f32 v41, v41
    v_exp_f32 v42, v42
    v_exp_f32 v43, v43
    v_mfma_f32_32x32x16_bf16 v[64:79], v[152:155], v[128:131], v[64:79]
    v_exp_f32 v44, v44
    v_exp_f32 v45, v45
    v_exp_f32 v46, v46
    v_exp_f32 v47, v47
    v_cvt_pk_bf16_f32 v132, v40, v41
    v_cvt_pk_bf16_f32 v133, v42, v43
    v_cvt_pk_bf16_f32 v134, v44, v45
    v_cvt_pk_bf16_f32 v135, v46, v47
    s_barrier
    v_mfma_f32_32x32x16_bf16 v[32:47], v[136:139], v[120:123], v[96:111]
    ds_read_b128 v[152:155], v160 offset:22528
    ds_read_b128 v[144:147], v160 offset:20480
    ds_read_b128 v[148:151], v160 offset:21504
    v_exp_f32 v16, v16
    v_exp_f32 v17, v17
    v_exp_f32 v18, v18
    v_exp_f32 v19, v19
    v_mfma_f32_32x32x16_bf16 v[64:79], v[156:159], v[132:135], v[64:79]
    ds_read_b128 v[156:159], v160 offset:23552
    v_exp_f32 v20, v20
    v_exp_f32 v21, v21
    v_exp_f32 v22, v22
    v_exp_f32 v23, v23
    v_cvt_pk_bf16_f32 v128, v16, v17
    v_cvt_pk_bf16_f32 v129, v18, v19
    v_mfma_f32_32x32x16_bf16 v[32:47], v[140:143], v[124:127], v[32:47]
    s_waitcnt lgkmcnt(3)
    v_cvt_pk_bf16_f32 v130, v20, v21
    v_cvt_pk_bf16_f32 v131, v22, v23
    v_exp_f32 v24, v24
    v_exp_f32 v25, v25
    v_exp_f32 v26, v26
    v_exp_f32 v27, v27
    v_mfma_f32_32x32x16_bf16 v[48:63], v[152:155], v[128:131], v[48:63]
    s_waitcnt lgkmcnt(0)
    v_exp_f32 v28, v28
    v_exp_f32 v29, v29
    v_exp_f32 v30, v30
    v_exp_f32 v31, v31
    v_cvt_pk_bf16_f32 v132, v24, v25
    v_cvt_pk_bf16_f32 v133, v26, v27
    v_cvt_pk_bf16_f32 v134, v28, v29
    v_cvt_pk_bf16_f32 v135, v30, v31
    v_mfma_f32_32x32x16_bf16 v[16:31], v[144:147], v[112:115], v[80:95]
    v_exp_f32 v32, v32
    v_exp_f32 v33, v33
    v_exp_f32 v34, v34
    v_exp_f32 v35, v35
    v_mfma_f32_32x32x16_bf16 v[48:63], v[156:159], v[132:135], v[48:63]
    v_exp_f32 v36, v36
    v_exp_f32 v37, v37
    v_exp_f32 v38, v38
    v_exp_f32 v39, v39
    v_cvt_pk_bf16_f32 v128, v32, v33
    v_cvt_pk_bf16_f32 v129, v34, v35
    v_mfma_f32_32x32x16_bf16 v[16:31], v[148:151], v[116:119], v[16:31]
    v_cvt_pk_bf16_f32 v130, v36, v37
    v_cvt_pk_bf16_f32 v131, v38, v39
    v_exp_f32 v40, v40
    v_exp_f32 v41, v41
    v_exp_f32 v42, v42
    v_exp_f32 v43, v43
    v_mfma_f32_32x32x16_bf16 v[64:79], v[152:155], v[128:131], v[64:79]
    s_cmp_lt_u32 s38, 17
    v_exp_f32 v44, v44
    v_exp_f32 v45, v45
    v_exp_f32 v46, v46
    v_exp_f32 v47, v47
    v_cvt_pk_bf16_f32 v132, v40, v41
    v_cvt_pk_bf16_f32 v133, v42, v43
    v_cvt_pk_bf16_f32 v134, v44, v45
    v_cvt_pk_bf16_f32 v135, v46, v47
    s_cbranch_scc1 L2_bar15
L2_nobar15:
    v_mfma_f32_32x32x16_bf16 v[32:47], v[144:147], v[120:123], v[96:111]
    ds_read_b128 v[152:155], v160 offset:26624
    ds_read_b128 v[136:139], v160 offset:24576
    ds_read_b128 v[140:143], v160 offset:25600
    v_exp_f32 v16, v16
    v_exp_f32 v17, v17
    v_exp_f32 v18, v18
    v_exp_f32 v19, v19
    v_mfma_f32_32x32x16_bf16 v[64:79], v[156:159], v[132:135], v[64:79]
    ds_read_b128 v[156:159], v160 offset:27648
    v_exp_f32 v20, v20
    v_exp_f32 v21, v21
    v_exp_f32 v22, v22
    v_exp_f32 v23, v23
    v_cvt_pk_bf16_f32 v128, v16, v17
    v_cvt_pk_bf16_f32 v129, v18, v19
    v_mfma_f32_32x32x16_bf16 v[32:47], v[148:151], v[124:127], v[32:47]
    s_waitcnt lgkmcnt(3)
    v_cvt_pk_bf16_f32 v130, v20, v21
    v_cvt_pk_bf16_f32 v131, v22, v23
    v_exp_f32 v24, v24
    v_exp_f32 v25, v25
    v_exp_f32 v26, v26
    v_exp_f32 v27, v27
    v_mfma_f32_32x32x16_bf16 v[48:63], v[152:155], v[128:131], v[48:63]
    s_waitcnt lgkmcnt(0)
    v_exp_f32 v28, v28
    v_exp_f32 v29, v29
    v_exp_f32 v30, v30
    v_exp_f32 v31, v31
    v_cvt_pk_bf16_f32 v132, v24, v25
    v_cvt_pk_bf16_f32 v133, v26, v27
    v_cvt_pk_bf16_f32 v134, v28, v29
    v_cvt_pk_bf16_f32 v135, v30, v31
    v_mfma_f32_32x32x16_bf16 v[16:31], v[136:139], v[112:115], v[80:95]
    v_exp_f32 v32, v32
    v_exp_f32 v33, v33
    v_exp_f32 v34, v34
    v_exp_f32 v35, v35
    v_mfma_f32_32x32x16_bf16 v[48:63], v[156:159], v[132:135], v[48:63]
    v_exp_f32 v36, v36
    v_exp_f32 v37, v37
    v_exp_f32 v38, v38
    v_exp_f32 v39, v39
    v_cvt_pk_bf16_f32 v128, v32, v33
    v_cvt_pk_bf16_f32 v129, v34, v35
    v_mfma_f32_32x32x16_bf16 v[16:31], v[140:143], v[116:119], v[16:31]
    v_cvt_pk_bf16_f32 v130, v36, v37
    v_cvt_pk_bf16_f32 v131, v38, v39
    v_exp_f32 v40, v40
    v_exp_f32 v41, v41
    v_exp_f32 v42, v42
    v_exp_f32 v43, v43
    v_mfma_f32_32x32x16_bf16 v[64:79], v[152:155], v[128:131], v[64:79]
    s_cmp_lt_u32 s38, 16
    v_exp_f32 v44, v44
    v_exp_f32 v45, v45
    v_exp_f32 v46, v46
    v_exp_f32 v47, v47
    v_cvt_pk_bf16_f32 v132, v40, v41
    v_cvt_pk_bf16_f32 v133, v42, v43
    v_cvt_pk_bf16_f32 v134, v44, v45
    v_cvt_pk_bf16_f32 v135, v46, v47
    s_cbranch_scc1 L2_bar16
L2_nobar16:
    v_mfma_f32_32x32x16_bf16 v[32:47], v[136:139], v[120:123], v[96:111]
    ds_read_b128 v[152:155], v160 offset:30720
    ds_read_b128 v[144:147], v160 offset:28672
    ds_read_b128 v[148:151], v160 offset:29696
    v_exp_f32 v16, v16
    v_exp_f32 v17, v17
    v_exp_f32 v18, v18
    v_exp_f32 v19, v19
    v_mfma_f32_32x32x16_bf16 v[64:79], v[156:159], v[132:135], v[64:79]
    ds_read_b128 v[156:159], v160 offset:31744
    v_exp_f32 v20, v20
    v_exp_f32 v21, v21
    v_exp_f32 v22, v22
    v_exp_f32 v23, v23
    v_cvt_pk_bf16_f32 v128, v16, v17
    v_cvt_pk_bf16_f32 v129, v18, v19
    v_mfma_f32_32x32x16_bf16 v[32:47], v[140:143], v[124:127], v[32:47]
    s_waitcnt lgkmcnt(3)
    v_cvt_pk_bf16_f32 v130, v20, v21
    v_cvt_pk_bf16_f32 v131, v22, v23
    v_exp_f32 v24, v24
    v_exp_f32 v25, v25
    v_exp_f32 v26, v26
    v_exp_f32 v27, v27
    v_mfma_f32_32x32x16_bf16 v[48:63], v[152:155], v[128:131], v[48:63]
    s_waitcnt lgkmcnt(0)
    v_exp_f32 v28, v28
    v_exp_f32 v29, v29
    v_exp_f32 v30, v30
    v_exp_f32 v31, v31
    v_cvt_pk_bf16_f32 v132, v24, v25
    v_cvt_pk_bf16_f32 v133, v26, v27
    v_cvt_pk_bf16_f32 v134, v28, v29
    v_cvt_pk_bf16_f32 v135, v30, v31
    v_mfma_f32_32x32x16_bf16 v[16:31], v[144:147], v[112:115], v[80:95]
    v_exp_f32 v32, v32
    v_exp_f32 v33, v33
    v_exp_f32 v34, v34
    v_exp_f32 v35, v35
    v_mfma_f32_32x32x16_bf16 v[48:63], v[156:159], v[132:135], v[48:63]
    v_exp_f32 v36, v36
    v_exp_f32 v37, v37
    v_exp_f32 v38, v38
    v_exp_f32 v39, v39
    v_cvt_pk_bf16_f32 v128, v32, v33
    v_cvt_pk_bf16_f32 v129, v34, v35
    v_mfma_f32_32x32x16_bf16 v[16:31], v[148:151], v[116:119], v[16:31]
    v_cvt_pk_bf16_f32 v130, v36, v37
    v_cvt_pk_bf16_f32 v131, v38, v39
    v_exp_f32 v40, v40
    v_exp_f32 v41, v41
    v_exp_f32 v42, v42
    v_exp_f32 v43, v43
    v_mfma_f32_32x32x16_bf16 v[64:79], v[152:155], v[128:131], v[64:79]
    v_exp_f32 v44, v44
    v_exp_f32 v45, v45
    v_exp_f32 v46, v46
    v_exp_f32 v47, v47
    v_cvt_pk_bf16_f32 v132, v40, v41
    v_cvt_pk_bf16_f32 v133, v42, v43
    v_cvt_pk_bf16_f32 v134, v44, v45
    v_cvt_pk_bf16_f32 v135, v46, v47
    s_barrier
    v_mfma_f32_32x32x16_bf16 v[32:47], v[144:147], v[120:123], v[96:111]
    ds_read_b128 v[152:155], v160 offset:34816
    ds_read_b128 v[136:139], v160 offset:32768
    ds_read_b128 v[140:143], v160 offset:33792
    v_exp_f32 v16, v16
    v_exp_f32 v17, v17
    v_exp_f32 v18, v18
    v_exp_f32 v19, v19
    v_mfma_f32_32x32x16_bf16 v[64:79], v[156:159], v[132:135], v[64:79]
    ds_read_b128 v[156:159], v160 offset:35840
    v_exp_f32 v20, v20
    v_exp_f32 v21, v21
    v_exp_f32 v22, v22
    v_exp_f32 v23, v23
    v_cvt_pk_bf16_f32 v128, v16, v17
    v_cvt_pk_bf16_f32 v129, v18, v19
    v_mfma_f32_32x32x16_bf16 v[32:47], v[148:151], v[124:127], v[32:47]
    s_waitcnt lgkmcnt(3)
    v_cvt_pk_bf16_f32 v130, v20, v21
    v_cvt_pk_bf16_f32 v131, v22, v23
    v_exp_f32 v24, v24
    v_exp_f32 v25, v25
    v_exp_f32 v26, v26
    v_exp_f32 v27, v27
    v_mfma_f32_32x32x16_bf16 v[48:63], v[152:155], v[128:131], v[48:63]
    s_waitcnt lgkmcnt(0)
    v_exp_f32 v28, v28
    v_exp_f32 v29, v29
    v_exp_f32 v30, v30
    v_exp_f32 v31, v31
    v_cvt_pk_bf16_f32 v132, v24, v25
    v_cvt_pk_bf16_f32 v133, v26, v27
    v_cvt_pk_bf16_f32 v134, v28, v29
    v_cvt_pk_bf16_f32 v135, v30, v31
    v_mfma_f32_32x32x16_bf16 v[16:31], v[136:139], v[112:115], v[80:95]
    v_exp_f32 v32, v32
    v_exp_f32 v33, v33
    v_exp_f32 v34, v34
    v_exp_f32 v35, v35
    v_mfma_f32_32x32x16_bf16 v[48:63], v[156:159], v[132:135], v[48:63]
    v_exp_f32 v36, v36
    v_exp_f32 v37, v37
    v_exp_f32 v38, v38
    v_exp_f32 v39, v39
    v_cvt_pk_bf16_f32 v128, v32, v33
    v_cvt_pk_bf16_f32 v129, v34, v35
    v_mfma_f32_32x32x16_bf16 v[16:31], v[140:143], v[116:119], v[16:31]
    v_cvt_pk_bf16_f32 v130, v36, v37
    v_cvt_pk_bf16_f32 v131, v38, v39
    v_exp_f32 v40, v40
    v_exp_f32 v41, v41
    v_exp_f32 v42, v42
    v_exp_f32 v43, v43
    v_mfma_f32_32x32x16_bf16 v[64:79], v[152:155], v[128:131], v[64:79]
    v_exp_f32 v44, v44
    v_exp_f32 v45, v45
    v_exp_f32 v46, v46
    v_exp_f32 v47, v47
    v_cvt_pk_bf16_f32 v132, v40, v41
    v_cvt_pk_bf16_f32 v133, v42, v43
    v_cvt_pk_bf16_f32 v134, v44, v45
    v_cvt_pk_bf16_f32 v135, v46, v47
    s_add_u32 s38, s38, 18
    s_branch L2_aloop
L2_bar0:
    s_barrier
    s_branch L2_nobar0
L2_bar1:
    s_barrier
    s_branch L2_nobar1
L2_bar3:
    s_barrier
    s_branch L2_nobar3
L2_bar4:
    s_barrier
    s_branch L2_nobar4
L2_bar6:
    s_barrier
    s_branch L2_nobar6
L2_bar7:
    s_barrier
    s_branch L2_nobar7
L2_bar9:
    s_barrier
    s_branch L2_nobar9
L2_bar10:
    s_barrier
    s_branch L2_nobar10
L2_bar12:
    s_barrier
    s_branch L2_nobar12
L2_bar13:
    s_barrier
    s_branch L2_nobar13
L2_bar15:
    s_barrier
    s_branch L2_nobar15
L2_bar16:
    s_barrier
    s_branch L2_nobar16
L2_adone:
    s_nop 1
    v_mfma_f32_32x32x16_bf16 v[64:79], v[156:159], v[132:135], v[64:79]
L2_afin:
    s_nop 11
    v_max_f32 v6, v58, v74
    v_mov_b32 v7, 0
    v_fma_f32 v6, v48, 0, v6
    v_fma_f32 v7, v64, 0, v7
    v_fma_f32 v6, v49, 0, v6
    v_fma_f32 v7, v65, 0, v7
    v_fma_f32 v6, v50, 0, v6
    v_fma_f32 v7, v66, 0, v7
    v_fma_f32 v6, v51, 0, v6
    v_fma_f32 v7, v67, 0, v7
    v_fma_f32 v6, v52, 0, v6
    v_fma_f32 v7, v68, 0, v7
    v_fma_f32 v6, v53, 0, v6
    v_fma_f32 v7, v69, 0, v7
    v_fma_f32 v6, v54, 0, v6
    v_fma_f32 v7, v70, 0, v7
    v_fma_f32 v6, v55, 0, v6
    v_fma_f32 v7, v71, 0, v7
    v_fma_f32 v6, v56, 0, v6
    v_fma_f32 v7, v72, 0, v7
    v_fma_f32 v6, v57, 0, v6
    v_fma_f32 v7, v73, 0, v7
    v_add_f32 v6, v6, v7
    v_cmp_ngt_f32 vcc, 0x79000000, v6
    s_cmp_eq_u32 s47, 0
    s_cbranch_scc0 L2_astore
    s_cbranch_vccnz L2_redo
L2_astore:
    v_rcp_f32 v4, v58
    v_rcp_f32 v5, v74
    s_nop 0
    v_mul_f32 v48, v48, v4
    v_mul_f32 v49, v49, v4
    v_mul_f32 v50, v50, v4
    v_mul_f32 v51, v51, v4
    v_mul_f32 v52, v52, v4
    v_mul_f32 v53, v53, v4
    v_mul_f32 v54, v54, v4
    v_mul_f32 v55, v55, v4
    v_mul_f32 v56, v56, v4
    v_mul_f32 v57, v57, v4
    v_cvt_pk_bf16_f32 v16, v48, v49
    v_cvt_pk_bf16_f32 v17, v50, v51
    v_cvt_pk_bf16_f32 v18, v52, v53
    v_cvt_pk_bf16_f32 v19, v54, v55
    v_cvt_pk_bf16_f32 v20, v56, v57
    buffer_store_dwordx4 v[16:19], v164, s[8:11], s50 offen sc1
    buffer_store_dword v20, v165, s[8:11], s51 offen sc1
    v_mul_f32 v64, v64, v5
    v_mul_f32 v65, v65, v5
    v_mul_f32 v66, v66, v5
    v_mul_f32 v67, v67, v5
    v_mul_f32 v68, v68, v5
    v_mul_f32 v69, v69, v5
    v_mul_f32 v70, v70, v5
    v_mul_f32 v71, v71, v5
    v_mul_f32 v72, v72, v5
    v_mul_f32 v73, v73, v5
    v_cvt_pk_bf16_f32 v24, v64, v65
    v_cvt_pk_bf16_f32 v25, v66, v67
    v_cvt_pk_bf16_f32 v26, v68, v69
    v_cvt_pk_bf16_f32 v27, v70, v71
    v_cvt_pk_bf16_f32 v28, v72, v73
    s_add_u32 s50, s50, 184320
    s_add_u32 s51, s51, 184320
    buffer_store_dwordx4 v[24:27], v164, s[8:11], s50 offen sc1
    buffer_store_dword v28, v165, s[8:11], s51 offen sc1
    s_barrier
    s_barrier
    s_barrier
    s_barrier
    v_mov_b32 v4, 126960
    v_mov_b32 v5, 1
    v_lshlrev_b32 v7, 8, v1
    s_lshl_b32 s36, s32, 11
    s_add_u32 s36, s36, 38117376
    s_mov_b64 exec, 1
    s_waitcnt vmcnt(0)
    ds_add_rtn_u32 v6, v4, v5
    s_waitcnt lgkmcnt(0)
    v_readfirstlane_b32 s35, v6
    s_mov_b64 exec, 0xff
    s_cmp_lg_u32 s35, 3
    s_cbranch_scc1 L3_notlast_a
    buffer_atomic_add v5, v7, s[8:11], s36 offen sc1
L3_notlast_a:
    s_mov_b64 exec, -1
    s_endpgm
L2_redo:
    s_mov_b32 s47, 1
    v_mov_b32 v172, 0xff800000
    v_mov_b32 v173, 0xff800000
    s_mov_b32 s37, s52
    s_mov_b32 s38, 0
L2_r1:
    buffer_load_dwordx4 v[136:139], v2, s[8:11], s37 offen offset:0
    buffer_load_dwordx4 v[140:143], v2, s[8:11], s37 offen offset:1024
    s_waitcnt vmcnt(0)
    v_mfma_f32_32x32x16_bf16 v[16:31], v[136:139], v[112:115], 0
    v_mfma_f32_32x32x16_bf16 v[16:31], v[140:143], v[116:119], v[16:31]
    v_mfma_f32_32x32x16_bf16 v[32:47], v[136:139], v[120:123], 0
    v_mfma_f32_32x32x16_bf16 v[32:47], v[140:143], v[124:127], v[32:47]
    s_nop 11
    v_max3_f32 v172, v172, v16, v17
    v_max3_f32 v172, v172, v18, v19
    v_max3_f32 v172, v172, v20, v21
    v_max3_f32 v172, v172, v22, v23
    v_max3_f32 v172, v172, v24, v25
    v_max3_f32 v172, v172, v26, v27
    v_max3_f32 v172, v172, v28, v29
    v_max3_f32 v172, v172, v30, v31
    v_max3_f32 v173, v173, v32, v33
    v_max3_f32 v173, v173, v34, v35
    v_max3_f32 v173, v173, v36, v37
    v_max3_f32 v173, v173, v38, v39
    v_max3_f32 v173, v173, v40, v41
    v_max3_f32 v173, v173, v42, v43
    v_max3_f32 v173, v173, v44, v45
    v_max3_f32 v173, v173, v46, v47
    s_add_u32 s37, s37, 36864
    s_add_u32 s38, s38, 1
    s_cmp_lt_u32 s38, 64
    s_cbranch_scc1 L2_r1
    v_mov_b32 v4, v172
    v_mov_b32 v5, v173
    s_nop 1
    v_permlane32_swap_b32 v4, v172
    v_permlane32_swap_b32 v5, v173
    v_max_f32 v4, v4, v172
    v_sub_f32 v4, 0, v4
    v_max_f32 v5, v5, v173
    v_sub_f32 v5, 0, v5
    v_mov_b32 v80, v4
    v_mov_b32 v81, v4
    v_mov_b32 v82, v4
    v_mov_b32 v83, v4
    v_mov_b32 v84, v4
    v_mov_b32 v85, v4
    v_mov_b32 v86, v4
    v_mov_b32 v87, v4
    v_mov_b32 v88, v4
    v_mov_b32 v89, v4
    v_mov_b32 v90, v4
    v_mov_b32 v91, v4
    v_mov_b32 v92, v4
    v_mov_b32 v93, v4
    v_mov_b32 v94, v4
    v_mov_b32 v95, v4
    v_mov_b32 v96, v5
    v_mov_b32 v97, v5
    v_mov_b32 v98, v5
    v_mov_b32 v99, v5
    v_mov_b32 v100, v5
    v_mov_b32 v101, v5
    v_mov_b32 v102, v5
    v_mov_b32 v103, v5
    v_mov_b32 v104, v5
    v_mov_b32 v105, v5
    v_mov_b32 v106, v5
    v_mov_b32 v107, v5
    v_mov_b32 v108, v5
    v_mov_b32 v109, v5
    v_mov_b32 v110, v5
    v_mov_b32 v111, v5
    v_mov_b32 v48, 0
    v_mov_b32 v49, 0
    v_mov_b32 v50, 0
    v_mov_b32 v51, 0
    v_mov_b32 v52, 0
    v_mov_b32 v53, 0
    v_mov_b32 v54, 0
    v_mov_b32 v55, 0
    v_mov_b32 v56, 0
    v_mov_b32 v57, 0
    v_mov_b32 v58, 0
    v_mov_b32 v59, 0
    v_mov_b32 v60, 0
    v_mov_b32 v61, 0
    v_mov_b32 v62, 0
    v_mov_b32 v63, 0
    v_mov_b32 v64, 0
    v_mov_b32 v65, 0
    v_mov_b32 v66, 0
    v_mov_b32 v67, 0
    v_mov_b32 v68, 0
    v_mov_b32 v69, 0
    v_mov_b32 v70, 0
    v_mov_b32 v71, 0
    v_mov_b32 v72, 0
    v_mov_b32 v73, 0
    v_mov_b32 v74, 0
    v_mov_b32 v75, 0
    v_mov_b32 v76, 0
    v_mov_b32 v77, 0
    v_mov_b32 v78, 0
    v_mov_b32 v79, 0
    s_mov_b32 s37, s52
    s_mov_b32 s53, 4718592
    s_mov_b32 s38, 0
L2_r2:
    s_add_u32 s36, s53, 18944
    buffer_load_dwordx4 v[136:139], v2, s[8:11], s37 offen offset:0
    buffer_load_dwordx4 v[140:143], v2, s[8:11], s37 offen offset:1024
    buffer_load_dwordx4 v[152:155], v3, s[8:11], s53 offen
    buffer_load_dwordx4 v[156:159], v3, s[8:11], s36 offen
    s_waitcnt vmcnt(0)
    v_mfma_f32_32x32x16_bf16 v[16:31], v[136:139], v[112:115], v[80:95]
    v_mfma_f32_32x32x16_bf16 v[16:31], v[140:143], v[116:119], v[16:31]
    s_nop 11
    v_exp_f32 v16, v16
    v_exp_f32 v17, v17
    v_exp_f32 v18, v18
    v_exp_f32 v19, v19
    v_exp_f32 v20, v20
    v_exp_f32 v21, v21
    v_exp_f32 v22, v22
    v_exp_f32 v23, v23
    v_exp_f32 v24, v24
    v_exp_f32 v25, v25
    v_exp_f32 v26, v26
    v_exp_f32 v27, v27
    v_exp_f32 v28, v28
    v_exp_f32 v29, v29
    v_exp_f32 v30, v30
    v_exp_f32 v31, v31
    s_nop 0
    v_cvt_pk_bf16_f32 v128, v16, v17
    v_cvt_pk_bf16_f32 v129, v18, v19
    v_cvt_pk_bf16_f32 v130, v20, v21
    v_cvt_pk_bf16_f32 v131, v22, v23
    v_cvt_pk_bf16_f32 v132, v24, v25
    v_cvt_pk_bf16_f32 v133, v26, v27
    v_cvt_pk_bf16_f32 v134, v28, v29
    v_cvt_pk_bf16_f32 v135, v30, v31
    s_nop 1
    v_mfma_f32_32x32x16_bf16 v[48:63], v[152:155], v[128:131], v[48:63]
    v_mfma_f32_32x32x16_bf16 v[48:63], v[156:159], v[132:135], v[48:63]
    v_mfma_f32_32x32x16_bf16 v[32:47], v[136:139], v[120:123], v[96:111]
    v_mfma_f32_32x32x16_bf16 v[32:47], v[140:143], v[124:127], v[32:47]
    s_nop 11
    v_exp_f32 v32, v32
    v_exp_f32 v33, v33
    v_exp_f32 v34, v34
    v_exp_f32 v35, v35
    v_exp_f32 v36, v36
    v_exp_f32 v37, v37
    v_exp_f32 v38, v38
    v_exp_f32 v39, v39
    v_exp_f32 v40, v40
    v_exp_f32 v41, v41
    v_exp_f32 v42, v42
    v_exp_f32 v43, v43
    v_exp_f32 v44, v44
    v_exp_f32 v45, v45
    v_exp_f32 v46, v46
    v_exp_f32 v47, v47
    s_nop 0
    v_cvt_pk_bf16_f32 v128, v32, v33
    v_cvt_pk_bf16_f32 v129, v34, v35
    v_cvt_pk_bf16_f32 v130, v36, v37
    v_cvt_pk_bf16_f32 v131, v38, v39
    v_cvt_pk_bf16_f32 v132, v40, v41
    v_cvt_pk_bf16_f32 v133, v42, v43
    v_cvt_pk_bf16_f32 v134, v44, v45
    v_cvt_pk_bf16_f32 v135, v46, v47
    s_nop 1
    v_mfma_f32_32x32x16_bf16 v[64:79], v[152:155], v[128:131], v[64:79]
    v_mfma_f32_32x32x16_bf16 v[64:79], v[156:159], v[132:135], v[64:79]
    s_add_u32 s37, s37, 36864
    s_add_u32 s53, s53, 37888
    s_add_u32 s38, s38, 1
    s_cmp_lt_u32 s38, 64
    s_cbranch_scc1 L2_r2
    s_branch L2_afin
L2_gemm:
    s_sub_u32 s46, s28, 4
    s_setprio 3
    v_lshrrev_b32 v232, 3, v1
    v_and_b32 v233, 7, v1
    v_lshrrev_b32 v234, 4, v1
    v_xor_b32 v233, v233, v234
    v_lshlrev_b32 v232, 12, v232
    v_lshl_add_u32 v218, v233, 4, v232
    v_xor_b32 v233, 4, v233
    v_lshl_add_u32 v219, v233, 4, v232
    v_add_u32 v220, 63488, v218
    v_add_u32 v221, 95232, v219
    v_add_u32 v219, 31744, v219
    s_lshl_b32 s39, s29, 2
    s_add_u32 s39, s39, s46
    s_lshl_b32 s39, s39, 17
    s_lshl_b32 s43, s46, 12
    v_lshrrev_b32 v232, 5, v1
    v_and_b32 v233, 31, v1
    v_lshlrev_b32 v233, 4, v233
    s_lshl_b32 s35, s46, 1
    v_add_u32 v232, s35, v232
    v_add_u32 v234, 0, v232
    v_mul_u32_u24 v235, 57, v234
    v_lshrrev_b32 v235, 9, v235
    v_mul_u32_u24 v235, 69120, v235
    v_lshl_add_u32 v235, v234, 9, v235
    v_add_u32 v222, v235, v233
    v_add_u32 v234, 8, v232
    v_mul_u32_u24 v235, 57, v234
    v_lshrrev_b32 v235, 9, v235
    v_mul_u32_u24 v235, 69120, v235
    v_lshl_add_u32 v235, v234, 9, v235
    v_add_u32 v223, v235, v233
    v_add_u32 v234, 16, v232
    v_mul_u32_u24 v235, 57, v234
    v_lshrrev_b32 v235, 9, v235
    v_mul_u32_u24 v235, 69120, v235
    v_lshl_add_u32 v235, v234, 9, v235
    v_add_u32 v224, v235, v233
    v_add_u32 v234, 24, v232
    v_mul_u32_u24 v235, 57, v234
    v_lshrrev_b32 v235, 9, v235
    v_mul_u32_u24 v235, 69120, v235
    v_lshl_add_u32 v235, v234, 9, v235
    v_add_u32 v225, v235, v233
    v_add_u32 v234, 32, v232
    v_mul_u32_u24 v235, 57, v234
    v_lshrrev_b32 v235, 9, v235
    v_mul_u32_u24 v235, 69120, v235
    v_lshl_add_u32 v235, v234, 9, v235
    v_add_u32 v226, v235, v233
    s_mul_i32 s40, s30, 4608
    s_add_u32 s40, s40, 7143424
    s_lshl_b32 s44, s46, 10
    s_add_u32 s44, s44, 49152
    s_lshl_b32 s94, s46, 10
    s_lshl_b32 s35, s33, 10
    s_add_u32 s35, s35, s94
    s_add_u32 s35, s35, 2396160
    s_add_u32 s94, s94, 126976
    s_sub_u32 s36, s46, 2
    s_mul_i32 s36, s36, 18944
    s_add_u32 s36, s36, 4718592
    s_cmp_lt_u32 s46, 2
    s_cselect_b32 s95, s35, s36
    s_mov_b32 s96, 37888
    s_cselect_b32 s96, 36864, s96
    s_cselect_b64 s[48:49], -1, 0
    v_cndmask_b32 v3, v3, v2, s[48:49]
    s_mov_b32 s97, 0
    s_mov_b32 s98, 0
    s_waitcnt lgkmcnt(0)
    s_mov_b32 s4, s56
    s_and_b32 s5, s57, 0xffff
    s_mov_b32 s6, 8388608
    s_mov_b32 s7, 0x20000
    s_mov_b32 s8, s60
    s_and_b32 s9, s61, 0xffff
    s_mov_b32 s10, 38133760
    s_mov_b32 s11, 0x20000
    s_add_u32 m0, s43, 0
    s_nop 0
    buffer_load_dwordx4 v218, s[4:7], s39 offen offset:0 lds
    buffer_load_dwordx4 v219, s[4:7], s39 offen offset:1024 lds
    buffer_load_dwordx4 v220, s[4:7], s39 offen offset:2048 lds
    buffer_load_dwordx4 v221, s[4:7], s39 offen offset:3072 lds
    s_add_u32 s39, s39, 128
    s_lshl_b32 s99, s97, 12
    s_add_u32 m0, s94, s99
    s_add_u32 s98, s98, 1
    buffer_load_dwordx4 v3, s[8:11], s95 offen lds
    s_add_u32 s95, s95, s96
    s_add_u32 s97, s97, 1
    s_cmp_eq_u32 s97, 9
    s_cselect_b32 s97, 0, s97
    s_add_u32 m0, s44, 0
    s_nop 0
    buffer_load_dwordx4 v222, s[8:11], s40 offen lds
    s_add_u32 m0, s44, 4096
    s_nop 0
    buffer_load_dwordx4 v223, s[8:11], s40 offen lds
    s_add_u32 m0, s44, 8192
    s_nop 0
    buffer_load_dwordx4 v224, s[8:11], s40 offen lds
    s_add_u32 m0, s44, 12288
    s_nop 0
    buffer_load_dwordx4 v225, s[8:11], s40 offen lds
    s_add_u32 m0, s44, 16384
    s_cmp_ge_u32 s46, 2
    s_cbranch_scc1 L2_z5_p0
    buffer_load_dwordx4 v226, s[8:11], s40 offen lds
L2_z5_p0:
    s_add_u32 s40, s40, 294912
    v_and_b32 v232, 15, v1
    v_lshrrev_b32 v233, 4, v1
    v_bfe_u32 v234, v1, 1, 3
    v_xor_b32 v234, v234, v233
    v_lshlrev_b32 v235, 7, v232
    v_add_u32 v235, s43, v235
    v_lshl_add_u32 v214, v234, 4, v235
    v_xor_b32 v215, 64, v214
    v_lshrrev_b32 v234, 1, v233
    v_mul_u32_u24 v234, 4608, v234
    v_and_b32 v233, 1, v233
    v_lshl_add_u32 v234, v233, 8, v234
    v_lshl_add_u32 v234, v232, 4, v234
    s_and_b32 s35, s30, 1
    s_lshl_b32 s36, s35, 9
    s_add_u32 s36, s36, 49152
    v_add_u32 v216, s36, v234
    s_cmp_eq_u32 s35, 0
    s_cselect_b32 s36, 53248, s36
    s_cselect_b32 s37, 0, 512
    s_sub_u32 s36, s36, s37
    v_add_u32 v217, s36, v234
    s_mov_b32 s38, 0
    s_add_u32 m0, s43, 16384
    s_nop 0
    buffer_load_dwordx4 v218, s[4:7], s39 offen offset:0 lds
    buffer_load_dwordx4 v219, s[4:7], s39 offen offset:1024 lds
    buffer_load_dwordx4 v220, s[4:7], s39 offen offset:2048 lds
    buffer_load_dwordx4 v221, s[4:7], s39 offen offset:3072 lds
    s_add_u32 s39, s39, 128
    s_lshl_b32 s99, s97, 12
    s_add_u32 m0, s94, s99
    s_add_u32 s98, s98, 1
    buffer_load_dwordx4 v3, s[8:11], s95 offen lds
    s_add_u32 s95, s95, s96
    s_add_u32 s97, s97, 1
    s_cmp_eq_u32 s97, 9
    s_cselect_b32 s97, 0, s97
    s_add_u32 m0, s44, 18432
    s_nop 0
    buffer_load_dwordx4 v222, s[8:11], s40 offen lds
    s_add_u32 m0, s44, 22528
    s_nop 0
    buffer_load_dwordx4 v223, s[8:11], s40 offen lds
    s_add_u32 m0, s44, 26624
    s_nop 0
    buffer_load_dwordx4 v224, s[8:11], s40 offen lds
    s_add_u32 m0, s44, 30720
    s_nop 0
    buffer_load_dwordx4 v225, s[8:11], s40 offen lds
    s_add_u32 m0, s44, 34816
    s_cmp_ge_u32 s46, 2
    s_cbranch_scc1 L2_z5_p1
    buffer_load_dwordx4 v226, s[8:11], s40 offen lds
L2_z5_p1:
    s_add_u32 s40, s40, 294912
    s_lshl_b32 s99, s97, 12
    s_add_u32 m0, s94, s99
    s_add_u32 s98, s98, 1
    buffer_load_dwordx4 v3, s[8:11], s95 offen lds
    s_add_u32 s95, s95, s96
    s_add_u32 s97, s97, 1
    s_cmp_eq_u32 s97, 9
    s_cselect_b32 s97, 0, s97
    s_lshl_b32 s99, s97, 12
    s_add_u32 m0, s94, s99
    s_add_u32 s98, s98, 1
    buffer_load_dwordx4 v3, s[8:11], s95 offen lds
    s_add_u32 s95, s95, s96
    s_add_u32 s97, s97, 1
    s_cmp_eq_u32 s97, 9
    s_cselect_b32 s97, 0, s97
    s_lshl_b32 s99, s97, 12
    s_add_u32 m0, s94, s99
    s_add_u32 s98, s98, 1
    buffer_load_dwordx4 v3, s[8:11], s95 offen lds
    s_add_u32 s95, s95, s96
    s_add_u32 s97, s97, 1
    s_cmp_eq_u32 s97, 9
    s_cselect_b32 s97, 0, s97
    s_lshl_b32 s99, s97, 12
    s_add_u32 m0, s94, s99
    s_add_u32 s98, s98, 1
    buffer_load_dwordx4 v3, s[8:11], s95 offen lds
    s_add_u32 s95, s95, s96
    s_add_u32 s97, s97, 1
    s_cmp_eq_u32 s97, 9
    s_cselect_b32 s97, 0, s97
    s_waitcnt vmcnt(13)
    s_barrier
    ds_read_b128 v[88:91], v214 offset:0
    ds_read_b128 v[92:95], v214 offset:2048
    ds_read_b128 v[96:99], v216 offset:0
    s_add_u32 m0, s43, 32768
    s_nop 0
    buffer_load_dwordx4 v218, s[4:7], s39 offen offset:0 lds
    ds_read_b128 v[100:103], v216 offset:512
    ds_read_b128 v[104:107], v216 offset:1024
    ds_read_b128 v[108:111], v216 offset:1536
    buffer_load_dwordx4 v219, s[4:7], s39 offen offset:1024 lds
    ds_read_b128 v[112:115], v216 offset:2048
    ds_read_b128 v[116:119], v216 offset:2560
    ds_read_b128 v[120:123], v216 offset:3072
    buffer_load_dwordx4 v220, s[4:7], s39 offen offset:2048 lds
    ds_read_b128 v[124:127], v216 offset:3584
    ds_read_b128 v[128:131], v217 offset:0
    buffer_load_dwordx4 v221, s[4:7], s39 offen offset:3072 lds
    s_add_u32 s39, s39, 128
    s_lshl_b32 s99, s97, 12
    s_add_u32 m0, s94, s99
    s_add_u32 s98, s98, 1
    buffer_load_dwordx4 v3, s[8:11], s95 offen lds
    s_add_u32 s95, s95, s96
    s_add_u32 s97, s97, 1
    s_cmp_eq_u32 s97, 9
    s_cselect_b32 s97, 0, s97
    s_add_u32 m0, s44, 36864
    s_nop 0
    buffer_load_dwordx4 v222, s[8:11], s40 offen lds
    s_mov_b32 s12, s58
    s_and_b32 s13, s59, 0xffff
    s_mov_b32 s14, 4096
    s_mov_b32 s15, 0x20000
    s_cmp_eq_u32 s46, 1
    s_cselect_b32 s24, s16, s20
    s_cselect_b32 s25, s17, s21
    s_cselect_b32 s22, 9, 3
    s_mov_b32 s26, 663552
    s_cselect_b32 s26, 2654208, s26
    s_cselect_b32 s65, 81, 21
    s_mul_i32 s65, s65, s2
    s_lshl_b32 s65, s65, 7
    s_lshl_b32 s23, s22, 7
    s_cmp_eq_u32 s46, 3
    s_cselect_b32 s26, 0, s26
    v_mov_b32 v227, v1
    s_cmp_eq_u32 s46, 0
    s_cbranch_scc0 L2_pfs
    s_mov_b32 s24, s4
    s_mov_b32 s25, s5
    s_mov_b32 s26, 8388608
    s_mov_b32 s22, 24
    s_mov_b32 s23, 384
    s_lshl_b32 s65, s29, 4
    s_add_u32 s65, s65, s30
    s_lshl_b32 s65, s65, 15
    s_add_u32 s65, s65, 2048
    v_mul_u32_u24 v227, 342, v1
    v_lshrrev_b32 v227, 10, v227
    v_mul_u32_u24 v227, 29, v227
    v_add_u32 v227, v227, v1
L2_pfs:
    s_and_b32 s25, s25, 0xffff
    s_mov_b32 s27, 0x20000
    v_cmp_gt_u32 s[48:49], s22, v1
    v_lshlrev_b32 v227, 7, v227
    v_mov_b32 v228, 0x80000000
    v_cndmask_b32 v227, v228, v227, s[48:49]
    s_and_b32 s35, s30, 1
    s_lshl_b32 s36, s29, 3
    s_lshl_b32 s37, s46, 1
    s_add_u32 s36, s36, s37
    s_lshl_b32 s54, s36, 5
    s_mul_i32 s55, s36, 92160
    s_add_u32 s55, s55, 26036224
    s_mul_i32 s62, s36, 92160
    s_add_u32 s62, s62, 26036224
    s_mul_i32 s36, s30, 9
    s_add_u32 s36, s36, s35
    s_lshl_b32 s36, s36, 9
    s_cmp_eq_u32 s35, 0
    s_mov_b32 s37, 4096
    s_cselect_b32 s37, s37, 4294966280
    s_add_u32 s37, s37, s36
    s_add_u32 s63, s55, s37
    s_add_u32 s64, s62, s37
    s_add_u32 s55, s55, s36
    s_add_u32 s62, s62, s36
    s_waitcnt lgkmcnt(0)
    v_mfma_f32_16x16x32_bf16 v[16:19], v[96:99], v[88:91], 0
    ds_read_b128 v[132:135], v215 offset:0
    v_mfma_f32_16x16x32_bf16 v[20:23], v[96:99], v[92:95], 0
    ds_read_b128 v[136:139], v215 offset:2048
    v_mfma_f32_16x16x32_bf16 v[24:27], v[100:103], v[88:91], 0
    ds_read_b128 v[140:143], v216 offset:9216
    s_add_u32 m0, s44, 40960
    s_nop 0
    buffer_load_dwordx4 v223, s[8:11], s40 offen lds
    v_mfma_f32_16x16x32_bf16 v[28:31], v[100:103], v[92:95], 0
    ds_read_b128 v[144:147], v216 offset:9728
    v_mfma_f32_16x16x32_bf16 v[32:35], v[104:107], v[88:91], 0
    ds_read_b128 v[148:151], v216 offset:10240
    v_mfma_f32_16x16x32_bf16 v[36:39], v[104:107], v[92:95], 0
    ds_read_b128 v[152:155], v216 offset:10752
    s_add_u32 m0, s44, 45056
    s_nop 0
    buffer_load_dwordx4 v224, s[8:11], s40 offen lds
    v_mfma_f32_16x16x32_bf16 v[40:43], v[108:111], v[88:91], 0
    ds_read_b128 v[156:159], v216 offset:11264
    v_mfma_f32_16x16x32_bf16 v[44:47], v[108:111], v[92:95], 0
    ds_read_b128 v[160:163], v216 offset:11776
    v_mfma_f32_16x16x32_bf16 v[48:51], v[112:115], v[88:91], 0
    ds_read_b128 v[164:167], v216 offset:12288
    s_add_u32 m0, s44, 49152
    s_nop 0
    buffer_load_dwordx4 v225, s[8:11], s40 offen lds
    v_mfma_f32_16x16x32_bf16 v[52:55], v[112:115], v[92:95], 0
    ds_read_b128 v[168:171], v216 offset:12800
    v_mfma_f32_16x16x32_bf16 v[56:59], v[116:119], v[88:91], 0
    ds_read_b128 v[172:175], v217 offset:9216
    v_mfma_f32_16x16x32_bf16 v[60:63], v[116:119], v[92:95], 0
    s_add_u32 m0, s44, 53248
    s_cmp_ge_u32 s46, 2
    s_cbranch_scc1 L2_z5_f0
    buffer_load_dwordx4 v226, s[8:11], s40 offen lds
L2_z5_f0:
    s_add_u32 s40, s40, 294912
    v_mfma_f32_16x16x32_bf16 v[64:67], v[120:123], v[88:91], 0
    v_mfma_f32_16x16x32_bf16 v[68:71], v[120:123], v[92:95], 0
    v_mfma_f32_16x16x32_bf16 v[72:75], v[124:127], v[88:91], 0
    v_mfma_f32_16x16x32_bf16 v[76:79], v[124:127], v[92:95], 0
    v_mfma_f32_16x16x32_bf16 v[80:83], v[128:131], v[88:91], 0
    v_mfma_f32_16x16x32_bf16 v[84:87], v[128:131], v[92:95], 0
    buffer_load_dword v228, v227, s[24:27], s65 offen
    s_add_u32 s65, s65, s23
    s_waitcnt lgkmcnt(0)
    s_waitcnt vmcnt(9)
    s_branch L2_gloop1
.p2align 6
L2_gloop:
    s_barrier
    v_mfma_f32_16x16x32_bf16 v[16:19], v[140:143], v[132:135], v[16:19]
    ds_read_b128 v[88:91], v214 offset:0
    v_mfma_f32_16x16x32_bf16 v[20:23], v[140:143], v[136:139], v[20:23]
    ds_read_b128 v[92:95], v214 offset:2048
    v_mfma_f32_16x16x32_bf16 v[24:27], v[144:147], v[132:135], v[24:27]
    ds_read_b128 v[96:99], v216 offset:0
    s_add_u32 m0, s43, 32768
    s_nop 0
    buffer_load_dwordx4 v218, s[4:7], s39 offen offset:0 lds
    v_mfma_f32_16x16x32_bf16 v[28:31], v[144:147], v[136:139], v[28:31]
    ds_read_b128 v[100:103], v216 offset:512
    v_mfma_f32_16x16x32_bf16 v[32:35], v[148:151], v[132:135], v[32:35]
    ds_read_b128 v[104:107], v216 offset:1024
    v_mfma_f32_16x16x32_bf16 v[36:39], v[148:151], v[136:139], v[36:39]
    ds_read_b128 v[108:111], v216 offset:1536
    buffer_load_dwordx4 v219, s[4:7], s39 offen offset:1024 lds
    v_mfma_f32_16x16x32_bf16 v[40:43], v[152:155], v[132:135], v[40:43]
    ds_read_b128 v[112:115], v216 offset:2048
    v_mfma_f32_16x16x32_bf16 v[44:47], v[152:155], v[136:139], v[44:47]
    ds_read_b128 v[116:119], v216 offset:2560
    v_mfma_f32_16x16x32_bf16 v[48:51], v[156:159], v[132:135], v[48:51]
    ds_read_b128 v[120:123], v216 offset:3072
    buffer_load_dwordx4 v220, s[4:7], s39 offen offset:2048 lds
    v_mfma_f32_16x16x32_bf16 v[52:55], v[156:159], v[136:139], v[52:55]
    ds_read_b128 v[124:127], v216 offset:3584
    v_mfma_f32_16x16x32_bf16 v[56:59], v[160:163], v[132:135], v[56:59]
    ds_read_b128 v[128:131], v217 offset:0
    v_mfma_f32_16x16x32_bf16 v[60:63], v[160:163], v[136:139], v[60:63]
    buffer_load_dwordx4 v221, s[4:7], s39 offen offset:3072 lds
    s_add_u32 s39, s39, 128
    v_mfma_f32_16x16x32_bf16 v[64:67], v[164:167], v[132:135], v[64:67]
    v_mfma_f32_16x16x32_bf16 v[68:71], v[164:167], v[136:139], v[68:71]
    v_mfma_f32_16x16x32_bf16 v[72:75], v[168:171], v[132:135], v[72:75]
    s_lshl_b32 s99, s97, 12
    s_add_u32 m0, s94, s99
    s_add_u32 s98, s98, 1
    buffer_load_dwordx4 v3, s[8:11], s95 offen lds
    s_add_u32 s95, s95, s96
    s_add_u32 s97, s97, 1
    s_cmp_eq_u32 s97, 9
    s_cselect_b32 s97, 0, s97
    v_mfma_f32_16x16x32_bf16 v[76:79], v[168:171], v[136:139], v[76:79]
    v_mfma_f32_16x16x32_bf16 v[80:83], v[172:175], v[132:135], v[80:83]
    v_mfma_f32_16x16x32_bf16 v[84:87], v[172:175], v[136:139], v[84:87]
    s_add_u32 m0, s44, 36864
    s_nop 0
    buffer_load_dwordx4 v222, s[8:11], s40 offen lds
    s_waitcnt lgkmcnt(0)
    v_mfma_f32_16x16x32_bf16 v[16:19], v[96:99], v[88:91], v[16:19]
    ds_read_b128 v[132:135], v215 offset:0
    v_mfma_f32_16x16x32_bf16 v[20:23], v[96:99], v[92:95], v[20:23]
    ds_read_b128 v[136:139], v215 offset:2048
    v_mfma_f32_16x16x32_bf16 v[24:27], v[100:103], v[88:91], v[24:27]
    ds_read_b128 v[140:143], v216 offset:9216
    s_add_u32 m0, s44, 40960
    s_nop 0
    buffer_load_dwordx4 v223, s[8:11], s40 offen lds
    v_mfma_f32_16x16x32_bf16 v[28:31], v[100:103], v[92:95], v[28:31]
    ds_read_b128 v[144:147], v216 offset:9728
    v_mfma_f32_16x16x32_bf16 v[32:35], v[104:107], v[88:91], v[32:35]
    ds_read_b128 v[148:151], v216 offset:10240
    v_mfma_f32_16x16x32_bf16 v[36:39], v[104:107], v[92:95], v[36:39]
    ds_read_b128 v[152:155], v216 offset:10752
    s_add_u32 m0, s44, 45056
    s_nop 0
    buffer_load_dwordx4 v224, s[8:11], s40 offen lds
    v_mfma_f32_16x16x32_bf16 v[40:43], v[108:111], v[88:91], v[40:43]
    ds_read_b128 v[156:159], v216 offset:11264
    v_mfma_f32_16x16x32_bf16 v[44:47], v[108:111], v[92:95], v[44:47]
    ds_read_b128 v[160:163], v216 offset:11776
    v_mfma_f32_16x16x32_bf16 v[48:51], v[112:115], v[88:91], v[48:51]
    ds_read_b128 v[164:167], v216 offset:12288
    s_add_u32 m0, s44, 49152
    s_nop 0
    buffer_load_dwordx4 v225, s[8:11], s40 offen lds
    v_mfma_f32_16x16x32_bf16 v[52:55], v[112:115], v[92:95], v[52:55]
    ds_read_b128 v[168:171], v216 offset:12800
    v_mfma_f32_16x16x32_bf16 v[56:59], v[116:119], v[88:91], v[56:59]
    ds_read_b128 v[172:175], v217 offset:9216
    v_mfma_f32_16x16x32_bf16 v[60:63], v[116:119], v[92:95], v[60:63]
    s_add_u32 m0, s44, 53248
    s_cmp_ge_u32 s46, 2
    s_cbranch_scc1 L2_z5_l0
    buffer_load_dwordx4 v226, s[8:11], s40 offen lds
L2_z5_l0:
    s_add_u32 s40, s40, 294912
    v_mfma_f32_16x16x32_bf16 v[64:67], v[120:123], v[88:91], v[64:67]
    v_mfma_f32_16x16x32_bf16 v[68:71], v[120:123], v[92:95], v[68:71]
    v_mfma_f32_16x16x32_bf16 v[72:75], v[124:127], v[88:91], v[72:75]
    v_mfma_f32_16x16x32_bf16 v[76:79], v[124:127], v[92:95], v[76:79]
    v_mfma_f32_16x16x32_bf16 v[80:83], v[128:131], v[88:91], v[80:83]
    v_mfma_f32_16x16x32_bf16 v[84:87], v[128:131], v[92:95], v[84:87]
    buffer_load_dword v228, v227, s[24:27], s65 offen
    s_add_u32 s65, s65, s23
    s_waitcnt lgkmcnt(0)
    s_waitcnt vmcnt(9)
L2_gloop1:
    s_barrier
    v_mfma_f32_16x16x32_bf16 v[16:19], v[140:143], v[132:135], v[16:19]
    ds_read_b128 v[88:91], v214 offset:16384
    v_mfma_f32_16x16x32_bf16 v[20:23], v[140:143], v[136:139], v[20:23]
    ds_read_b128 v[92:95], v214 offset:18432
    v_mfma_f32_16x16x32_bf16 v[24:27], v[144:147], v[132:135], v[24:27]
    ds_read_b128 v[96:99], v216 offset:18432
    s_add_u32 m0, s43, 0
    s_nop 0
    buffer_load_dwordx4 v218, s[4:7], s39 offen offset:0 lds
    v_mfma_f32_16x16x32_bf16 v[28:31], v[144:147], v[136:139], v[28:31]
    ds_read_b128 v[100:103], v216 offset:18944
    v_mfma_f32_16x16x32_bf16 v[32:35], v[148:151], v[132:135], v[32:35]
    ds_read_b128 v[104:107], v216 offset:19456
    v_mfma_f32_16x16x32_bf16 v[36:39], v[148:151], v[136:139], v[36:39]
    ds_read_b128 v[108:111], v216 offset:19968
    buffer_load_dwordx4 v219, s[4:7], s39 offen offset:1024 lds
    v_mfma_f32_16x16x32_bf16 v[40:43], v[152:155], v[132:135], v[40:43]
    ds_read_b128 v[112:115], v216 offset:20480
    v_mfma_f32_16x16x32_bf16 v[44:47], v[152:155], v[136:139], v[44:47]
    ds_read_b128 v[116:119], v216 offset:20992
    v_mfma_f32_16x16x32_bf16 v[48:51], v[156:159], v[132:135], v[48:51]
    ds_read_b128 v[120:123], v216 offset:21504
    buffer_load_dwordx4 v220, s[4:7], s39 offen offset:2048 lds
    v_mfma_f32_16x16x32_bf16 v[52:55], v[156:159], v[136:139], v[52:55]
    ds_read_b128 v[124:127], v216 offset:22016
    v_mfma_f32_16x16x32_bf16 v[56:59], v[160:163], v[132:135], v[56:59]
    ds_read_b128 v[128:131], v217 offset:18432
    v_mfma_f32_16x16x32_bf16 v[60:63], v[160:163], v[136:139], v[60:63]
    buffer_load_dwordx4 v221, s[4:7], s39 offen offset:3072 lds
    s_add_u32 s39, s39, 128
    v_mfma_f32_16x16x32_bf16 v[64:67], v[164:167], v[132:135], v[64:67]
    v_mfma_f32_16x16x32_bf16 v[68:71], v[164:167], v[136:139], v[68:71]
    v_mfma_f32_16x16x32_bf16 v[72:75], v[168:171], v[132:135], v[72:75]
    s_lshl_b32 s99, s97, 12
    s_add_u32 m0, s94, s99
    s_add_u32 s98, s98, 1
    buffer_load_dwordx4 v3, s[8:11], s95 offen lds
    s_add_u32 s95, s95, s96
    s_add_u32 s97, s97, 1
    s_cmp_eq_u32 s97, 9
    s_cselect_b32 s97, 0, s97
    v_mfma_f32_16x16x32_bf16 v[76:79], v[168:171], v[136:139], v[76:79]
    v_mfma_f32_16x16x32_bf16 v[80:83], v[172:175], v[132:135], v[80:83]
    v_mfma_f32_16x16x32_bf16 v[84:87], v[172:175], v[136:139], v[84:87]
    s_add_u32 m0, s44, 0
    s_nop 0
    buffer_load_dwordx4 v222, s[8:11], s40 offen lds
    s_waitcnt lgkmcnt(0)
    v_mfma_f32_16x16x32_bf16 v[16:19], v[96:99], v[88:91], v[16:19]
    ds_read_b128 v[132:135], v215 offset:16384
    v_mfma_f32_16x16x32_bf16 v[20:23], v[96:99], v[92:95], v[20:23]
    ds_read_b128 v[136:139], v215 offset:18432
    v_mfma_f32_16x16x32_bf16 v[24:27], v[100:103], v[88:91], v[24:27]
    ds_read_b128 v[140:143], v216 offset:27648
    s_add_u32 m0, s44, 4096
    s_nop 0
    buffer_load_dwordx4 v223, s[8:11], s40 offen lds
    v_mfma_f32_16x16x32_bf16 v[28:31], v[100:103], v[92:95], v[28:31]
    ds_read_b128 v[144:147], v216 offset:28160
    v_mfma_f32_16x16x32_bf16 v[32:35], v[104:107], v[88:91], v[32:35]
    ds_read_b128 v[148:151], v216 offset:28672
    v_mfma_f32_16x16x32_bf16 v[36:39], v[104:107], v[92:95], v[36:39]
    ds_read_b128 v[152:155], v216 offset:29184
    s_add_u32 m0, s44, 8192
    s_nop 0
    buffer_load_dwordx4 v224, s[8:11], s40 offen lds
    v_mfma_f32_16x16x32_bf16 v[40:43], v[108:111], v[88:91], v[40:43]
    ds_read_b128 v[156:159], v216 offset:29696
    v_mfma_f32_16x16x32_bf16 v[44:47], v[108:111], v[92:95], v[44:47]
    ds_read_b128 v[160:163], v216 offset:30208
    v_mfma_f32_16x16x32_bf16 v[48:51], v[112:115], v[88:91], v[48:51]
    ds_read_b128 v[164:167], v216 offset:30720
    s_add_u32 m0, s44, 12288
    s_nop 0
    buffer_load_dwordx4 v225, s[8:11], s40 offen lds
    v_mfma_f32_16x16x32_bf16 v[52:55], v[112:115], v[92:95], v[52:55]
    ds_read_b128 v[168:171], v216 offset:31232
    v_mfma_f32_16x16x32_bf16 v[56:59], v[116:119], v[88:91], v[56:59]
    ds_read_b128 v[172:175], v217 offset:27648
    v_mfma_f32_16x16x32_bf16 v[60:63], v[116:119], v[92:95], v[60:63]
    s_add_u32 m0, s44, 16384
    s_cmp_ge_u32 s46, 2
    s_cbranch_scc1 L2_z5_l1
    buffer_load_dwordx4 v226, s[8:11], s40 offen lds
L2_z5_l1:
    s_add_u32 s40, s40, 294912
    v_mfma_f32_16x16x32_bf16 v[64:67], v[120:123], v[88:91], v[64:67]
    v_mfma_f32_16x16x32_bf16 v[68:71], v[120:123], v[92:95], v[68:71]
    v_mfma_f32_16x16x32_bf16 v[72:75], v[124:127], v[88:91], v[72:75]
    v_mfma_f32_16x16x32_bf16 v[76:79], v[124:127], v[92:95], v[76:79]
    v_mfma_f32_16x16x32_bf16 v[80:83], v[128:131], v[88:91], v[80:83]
    v_mfma_f32_16x16x32_bf16 v[84:87], v[128:131], v[92:95], v[84:87]
    s_waitcnt lgkmcnt(0)
    s_waitcnt vmcnt(9)
    s_barrier
    v_mfma_f32_16x16x32_bf16 v[16:19], v[140:143], v[132:135], v[16:19]
    ds_read_b128 v[88:91], v214 offset:32768
    v_mfma_f32_16x16x32_bf16 v[20:23], v[140:143], v[136:139], v[20:23]
    ds_read_b128 v[92:95], v214 offset:34816
    v_mfma_f32_16x16x32_bf16 v[24:27], v[144:147], v[132:135], v[24:27]
    ds_read_b128 v[96:99], v216 offset:36864
    s_add_u32 m0, s43, 16384
    s_nop 0
    buffer_load_dwordx4 v218, s[4:7], s39 offen offset:0 lds
    v_mfma_f32_16x16x32_bf16 v[28:31], v[144:147], v[136:139], v[28:31]
    ds_read_b128 v[100:103], v216 offset:37376
    v_mfma_f32_16x16x32_bf16 v[32:35], v[148:151], v[132:135], v[32:35]
    ds_read_b128 v[104:107], v216 offset:37888
    v_mfma_f32_16x16x32_bf16 v[36:39], v[148:151], v[136:139], v[36:39]
    ds_read_b128 v[108:111], v216 offset:38400
    buffer_load_dwordx4 v219, s[4:7], s39 offen offset:1024 lds
    v_mfma_f32_16x16x32_bf16 v[40:43], v[152:155], v[132:135], v[40:43]
    ds_read_b128 v[112:115], v216 offset:38912
    v_mfma_f32_16x16x32_bf16 v[44:47], v[152:155], v[136:139], v[44:47]
    ds_read_b128 v[116:119], v216 offset:39424
    v_mfma_f32_16x16x32_bf16 v[48:51], v[156:159], v[132:135], v[48:51]
    ds_read_b128 v[120:123], v216 offset:39936
    buffer_load_dwordx4 v220, s[4:7], s39 offen offset:2048 lds
    v_mfma_f32_16x16x32_bf16 v[52:55], v[156:159], v[136:139], v[52:55]
    ds_read_b128 v[124:127], v216 offset:40448
    v_mfma_f32_16x16x32_bf16 v[56:59], v[160:163], v[132:135], v[56:59]
    ds_read_b128 v[128:131], v217 offset:36864
    v_mfma_f32_16x16x32_bf16 v[60:63], v[160:163], v[136:139], v[60:63]
    buffer_load_dwordx4 v221, s[4:7], s39 offen offset:3072 lds
    s_add_u32 s39, s39, 128
    v_mfma_f32_16x16x32_bf16 v[64:67], v[164:167], v[132:135], v[64:67]
    v_mfma_f32_16x16x32_bf16 v[68:71], v[164:167], v[136:139], v[68:71]
    v_mfma_f32_16x16x32_bf16 v[72:75], v[168:171], v[132:135], v[72:75]
    s_lshl_b32 s99, s97, 12
    s_add_u32 m0, s94, s99
    s_add_u32 s98, s98, 1
    buffer_load_dwordx4 v3, s[8:11], s95 offen lds
    s_add_u32 s95, s95, s96
    s_add_u32 s97, s97, 1
    s_cmp_eq_u32 s97, 9
    s_cselect_b32 s97, 0, s97
    v_mfma_f32_16x16x32_bf16 v[76:79], v[168:171], v[136:139], v[76:79]
    v_mfma_f32_16x16x32_bf16 v[80:83], v[172:175], v[132:135], v[80:83]
    v_mfma_f32_16x16x32_bf16 v[84:87], v[172:175], v[136:139], v[84:87]
    s_add_u32 m0, s44, 18432
    s_nop 0
    buffer_load_dwordx4 v222, s[8:11], s40 offen lds
    s_waitcnt lgkmcnt(0)
    v_mfma_f32_16x16x32_bf16 v[16:19], v[96:99], v[88:91], v[16:19]
    ds_read_b128 v[132:135], v215 offset:32768
    v_mfma_f32_16x16x32_bf16 v[20:23], v[96:99], v[92:95], v[20:23]
    ds_read_b128 v[136:139], v215 offset:34816
    v_mfma_f32_16x16x32_bf16 v[24:27], v[100:103], v[88:91], v[24:27]
    ds_read_b128 v[140:143], v216 offset:46080
    s_add_u32 m0, s44, 22528
    s_nop 0
    buffer_load_dwordx4 v223, s[8:11], s40 offen lds
    v_mfma_f32_16x16x32_bf16 v[28:31], v[100:103], v[92:95], v[28:31]
    ds_read_b128 v[144:147], v216 offset:46592
    v_mfma_f32_16x16x32_bf16 v[32:35], v[104:107], v[88:91], v[32:35]
    ds_read_b128 v[148:151], v216 offset:47104
    v_mfma_f32_16x16x32_bf16 v[36:39], v[104:107], v[92:95], v[36:39]
    ds_read_b128 v[152:155], v216 offset:47616
    s_add_u32 m0, s44, 26624
    s_nop 0
    buffer_load_dwordx4 v224, s[8:11], s40 offen lds
    v_mfma_f32_16x16x32_bf16 v[40:43], v[108:111], v[88:91], v[40:43]
    ds_read_b128 v[156:159], v216 offset:48128
    v_mfma_f32_16x16x32_bf16 v[44:47], v[108:111], v[92:95], v[44:47]
    ds_read_b128 v[160:163], v216 offset:48640
    v_mfma_f32_16x16x32_bf16 v[48:51], v[112:115], v[88:91], v[48:51]
    ds_read_b128 v[164:167], v216 offset:49152
    s_add_u32 m0, s44, 30720
    s_nop 0
    buffer_load_dwordx4 v225, s[8:11], s40 offen lds
    v_mfma_f32_16x16x32_bf16 v[52:55], v[112:115], v[92:95], v[52:55]
    ds_read_b128 v[168:171], v216 offset:49664
    v_mfma_f32_16x16x32_bf16 v[56:59], v[116:119], v[88:91], v[56:59]
    ds_read_b128 v[172:175], v217 offset:46080
    v_mfma_f32_16x16x32_bf16 v[60:63], v[116:119], v[92:95], v[60:63]
    s_add_u32 m0, s44, 34816
    s_cmp_ge_u32 s46, 2
    s_cbranch_scc1 L2_z5_l2
    buffer_load_dwordx4 v226, s[8:11], s40 offen lds
L2_z5_l2:
    s_add_u32 s40, s40, 294912
    v_mfma_f32_16x16x32_bf16 v[64:67], v[120:123], v[88:91], v[64:67]
    v_mfma_f32_16x16x32_bf16 v[68:71], v[120:123], v[92:95], v[68:71]
    v_mfma_f32_16x16x32_bf16 v[72:75], v[124:127], v[88:91], v[72:75]
    v_mfma_f32_16x16x32_bf16 v[76:79], v[124:127], v[92:95], v[76:79]
    v_mfma_f32_16x16x32_bf16 v[80:83], v[128:131], v[88:91], v[80:83]
    v_mfma_f32_16x16x32_bf16 v[84:87], v[128:131], v[92:95], v[84:87]
    s_waitcnt lgkmcnt(0)
    s_waitcnt vmcnt(9)
    s_add_u32 s38, s38, 1
    s_cmp_lt_u32 s38, 10
    s_cbranch_scc1 L2_gloop
    v_subrev_u32 v238, 256, v0
    s_getpc_b64 s[70:71]
Lpc_2b:
    s_lshr_b32 s72, s2, 3
    s_mul_i32 s72, s72, 8
    v_add_lshl_u32 v236, v238, s72, 7
    s_add_u32 s70, s70, L2_gtail-Lpc_2b
    s_addc_u32 s71, s71, 0
    v_min_u32 v236, Lcode_end-L2_gtail-4, v236
    v_cmp_gt_u32 s[72:73], 8, v238
    v_mov_b32 v237, s71
    v_add_co_u32 v236, vcc, s70, v236
    s_nop 1
    v_addc_co_u32 v237, vcc, 0, v237, vcc
    s_and_saveexec_b64 s[70:71], s[72:73]
    s_cbranch_execz Lpcs_2b
    global_load_dword v228, v[236:237], off
Lpcs_2b:
    s_mov_b64 exec, s[70:71]
L2_gtail:
    s_and_b32 s35, s2, 7
    s_lshr_b32 s36, s2, 3
    s_mul_i32 s37, s35, 29
    s_min_u32 s35, s35, 2
    s_add_u32 s37, s37, s35
    s_add_u32 s37, s37, s36
    s_mul_i32 s39, s37, 57
    s_lshr_b32 s39, s39, 9
    s_mul_i32 s35, s39, 9
    s_sub_u32 s35, s37, s35
    s_lshl_b32 s40, s35, 7
    s_and_b32 s17, s17, 0xffff
    s_mov_b32 s18, 2654208
    s_mov_b32 s19, 0x20000
    s_and_b32 s21, s21, 0xffff
    s_mov_b32 s22, 663552
    s_mov_b32 s23, 0x20000
    s_lshr_b32 s35, s46, 1
    s_and_b32 s36, s46, 1
    s_mul_i32 s38, s35, 5120
    s_lshl_b32 s37, s36, 11
    s_add_u32 s43, s38, s37
    s_lshl_b32 s59, s46, 11
    s_add_u32 s59, s59, 71680
    s_mul_i32 s79, s35, 36864
    s_mul_i32 s37, s36, 18432
    s_add_u32 s79, s79, s37
    s_add_u32 s79, s79, s40
    s_mul_i32 s77, s35, 41472
    s_mul_i32 s37, s36, 9216
    s_add_u32 s77, s77, s37
    s_add_u32 s77, s77, s40
    s_mul_i32 s78, s35, 331776
    s_mul_i32 s37, s36, 41472
    s_add_u32 s78, s78, s37
    s_add_u32 s78, s78, s40
    v_lshrrev_b32 v4, 3, v1
    v_and_b32 v5, 7, v1
    v_lshrrev_b32 v6, 4, v1
    v_lshlrev_b32 v6, 1, v6
    v_xor_b32 v6, v5, v6
    v_lshlrev_b32 v6, 4, v6
    v_mul_u32_u24 v7, 1152, v4
    v_add_u32 v12, v6, v7
    v_add_u32 v13, 8192, v12
    s_barrier
    v_mfma_f32_16x16x32_bf16 v[16:19], v[140:143], v[132:135], v[16:19]
    ds_read_b128 v[88:91], v214 offset:0
    v_mfma_f32_16x16x32_bf16 v[20:23], v[140:143], v[136:139], v[20:23]
    ds_read_b128 v[92:95], v214 offset:2048
    v_mfma_f32_16x16x32_bf16 v[24:27], v[144:147], v[132:135], v[24:27]
    ds_read_b128 v[96:99], v216 offset:0
    s_lshl_b32 s99, s97, 12
    s_add_u32 m0, s94, s99
    s_add_u32 s98, s98, 1
    buffer_load_dwordx4 v3, s[8:11], s95 offen lds
    s_add_u32 s95, s95, s96
    s_add_u32 s97, s97, 1
    s_cmp_eq_u32 s97, 9
    s_cselect_b32 s97, 0, s97
    v_mfma_f32_16x16x32_bf16 v[28:31], v[144:147], v[136:139], v[28:31]
    ds_read_b128 v[100:103], v216 offset:512
    v_mfma_f32_16x16x32_bf16 v[32:35], v[148:151], v[132:135], v[32:35]
    ds_read_b128 v[104:107], v216 offset:1024
    v_mfma_f32_16x16x32_bf16 v[36:39], v[148:151], v[136:139], v[36:39]
    ds_read_b128 v[108:111], v216 offset:1536
    v_and_b32 v232, 15, v1
    v_lshlrev_b32 v233, 2, v232
    v_lshlrev_b32 v232, 1, v232
    v_mfma_f32_16x16x32_bf16 v[40:43], v[152:155], v[132:135], v[40:43]
    ds_read_b128 v[112:115], v216 offset:2048
    v_mfma_f32_16x16x32_bf16 v[44:47], v[152:155], v[136:139], v[44:47]
    ds_read_b128 v[116:119], v216 offset:2560
    v_mfma_f32_16x16x32_bf16 v[48:51], v[156:159], v[132:135], v[48:51]
    ds_read_b128 v[120:123], v216 offset:3072
    s_lshl_b32 s68, s54, 1
    s_add_u32 s68, s68, 38076416
    buffer_load_ushort v212, v232, s[12:15], s54 offen offset:0
    v_mfma_f32_16x16x32_bf16 v[52:55], v[156:159], v[136:139], v[52:55]
    ds_read_b128 v[124:127], v216 offset:3584
    v_mfma_f32_16x16x32_bf16 v[56:59], v[160:163], v[132:135], v[56:59]
    ds_read_b128 v[128:131], v217 offset:0
    v_mfma_f32_16x16x32_bf16 v[60:63], v[160:163], v[136:139], v[60:63]
    buffer_load_dword v229, v233, s[8:11], s68 offen offset:0
    buffer_load_ushort v213, v232, s[12:15], s54 offen offset:32
    buffer_load_dword v230, v233, s[8:11], s68 offen offset:64
    v_mfma_f32_16x16x32_bf16 v[64:67], v[164:167], v[132:135], v[64:67]
    v_mfma_f32_16x16x32_bf16 v[68:71], v[164:167], v[136:139], v[68:71]
    v_mfma_f32_16x16x32_bf16 v[72:75], v[168:171], v[132:135], v[72:75]
    buffer_load_dwordx4 v[176:179], v2, s[8:11], s55 offen offset:0
    buffer_load_dwordx4 v[180:183], v2, s[8:11], s55 offen offset:1024
    buffer_load_dwordx4 v[184:187], v2, s[8:11], s55 offen offset:2048
    v_mfma_f32_16x16x32_bf16 v[76:79], v[168:171], v[136:139], v[76:79]
    v_mfma_f32_16x16x32_bf16 v[80:83], v[172:175], v[132:135], v[80:83]
    v_mfma_f32_16x16x32_bf16 v[84:87], v[172:175], v[136:139], v[84:87]
    buffer_load_dwordx4 v[188:191], v2, s[8:11], s55 offen offset:3072
    buffer_load_dwordx2 v[192:193], v2, s[8:11], s63 offen
    s_add_u32 s55, s55, 92160
    s_waitcnt lgkmcnt(0)
    v_mfma_f32_16x16x32_bf16 v[16:19], v[96:99], v[88:91], v[16:19]
    ds_read_b128 v[132:135], v215 offset:0
    v_mfma_f32_16x16x32_bf16 v[20:23], v[96:99], v[92:95], v[20:23]
    ds_read_b128 v[136:139], v215 offset:2048
    v_mfma_f32_16x16x32_bf16 v[24:27], v[100:103], v[88:91], v[24:27]
    ds_read_b128 v[140:143], v216 offset:9216
    s_add_u32 s63, s63, 92160
    buffer_load_dwordx4 v[194:197], v2, s[8:11], s55 offen offset:0
    buffer_load_dwordx4 v[198:201], v2, s[8:11], s55 offen offset:1024
    v_mfma_f32_16x16x32_bf16 v[28:31], v[100:103], v[92:95], v[28:31]
    ds_read_b128 v[144:147], v216 offset:9728
    v_mfma_f32_16x16x32_bf16 v[32:35], v[104:107], v[88:91], v[32:35]
    ds_read_b128 v[148:151], v216 offset:10240
    v_mfma_f32_16x16x32_bf16 v[36:39], v[104:107], v[92:95], v[36:39]
    ds_read_b128 v[152:155], v216 offset:10752
    buffer_load_dwordx4 v[202:205], v2, s[8:11], s55 offen offset:2048
    buffer_load_dwordx4 v[206:209], v2, s[8:11], s55 offen offset:3072
    buffer_load_dwordx2 v[210:211], v2, s[8:11], s63 offen
    v_mfma_f32_16x16x32_bf16 v[40:43], v[108:111], v[88:91], v[40:43]
    ds_read_b128 v[156:159], v216 offset:11264
    v_mfma_f32_16x16x32_bf16 v[44:47], v[108:111], v[92:95], v[44:47]
    ds_read_b128 v[160:163], v216 offset:11776
    v_mfma_f32_16x16x32_bf16 v[48:51], v[112:115], v[88:91], v[48:51]
    ds_read_b128 v[164:167], v216 offset:12288
    v_mfma_f32_16x16x32_bf16 v[52:55], v[112:115], v[92:95], v[52:55]
    ds_read_b128 v[168:171], v216 offset:12800
    v_mfma_f32_16x16x32_bf16 v[56:59], v[116:119], v[88:91], v[56:59]
    ds_read_b128 v[172:175], v217 offset:9216
    v_mfma_f32_16x16x32_bf16 v[60:63], v[116:119], v[92:95], v[60:63]
    v_mfma_f32_16x16x32_bf16 v[64:67], v[120:123], v[88:91], v[64:67]
    v_mfma_f32_16x16x32_bf16 v[68:71], v[120:123], v[92:95], v[68:71]
    v_mfma_f32_16x16x32_bf16 v[72:75], v[124:127], v[88:91], v[72:75]
    v_mfma_f32_16x16x32_bf16 v[76:79], v[124:127], v[92:95], v[76:79]
    v_mfma_f32_16x16x32_bf16 v[80:83], v[128:131], v[88:91], v[80:83]
    v_mfma_f32_16x16x32_bf16 v[84:87], v[128:131], v[92:95], v[84:87]
    s_waitcnt lgkmcnt(0)
    s_waitcnt vmcnt(14)
    s_barrier
    v_mfma_f32_16x16x32_bf16 v[16:19], v[140:143], v[132:135], v[16:19]
    ds_read_b128 v[88:91], v214 offset:16384
    v_mfma_f32_16x16x32_bf16 v[20:23], v[140:143], v[136:139], v[20:23]
    ds_read_b128 v[92:95], v214 offset:18432
    v_mfma_f32_16x16x32_bf16 v[24:27], v[144:147], v[132:135], v[24:27]
    ds_read_b128 v[96:99], v216 offset:18432
    s_lshl_b32 s99, s97, 12
    s_add_u32 m0, s94, s99
    s_add_u32 s98, s98, 1
    buffer_load_dwordx4 v3, s[8:11], s95 offen lds
    s_add_u32 s95, s95, s96
    s_add_u32 s97, s97, 1
    s_cmp_eq_u32 s97, 9
    s_cselect_b32 s97, 0, s97
    v_mfma_f32_16x16x32_bf16 v[28:31], v[144:147], v[136:139], v[28:31]
    ds_read_b128 v[100:103], v216 offset:18944
    v_mfma_f32_16x16x32_bf16 v[32:35], v[148:151], v[132:135], v[32:35]
    ds_read_b128 v[104:107], v216 offset:19456
    v_mfma_f32_16x16x32_bf16 v[36:39], v[148:151], v[136:139], v[36:39]
    ds_read_b128 v[108:111], v216 offset:19968
    v_mfma_f32_16x16x32_bf16 v[40:43], v[152:155], v[132:135], v[40:43]
    ds_read_b128 v[112:115], v216 offset:20480
    v_mfma_f32_16x16x32_bf16 v[44:47], v[152:155], v[136:139], v[44:47]
    ds_read_b128 v[116:119], v216 offset:20992
    v_mfma_f32_16x16x32_bf16 v[48:51], v[156:159], v[132:135], v[48:51]
    ds_read_b128 v[120:123], v216 offset:21504
    v_mfma_f32_16x16x32_bf16 v[52:55], v[156:159], v[136:139], v[52:55]
    ds_read_b128 v[124:127], v216 offset:22016
    v_mfma_f32_16x16x32_bf16 v[56:59], v[160:163], v[132:135], v[56:59]
    ds_read_b128 v[128:131], v217 offset:18432
    v_mfma_f32_16x16x32_bf16 v[60:63], v[160:163], v[136:139], v[60:63]
    v_mfma_f32_16x16x32_bf16 v[64:67], v[164:167], v[132:135], v[64:67]
    v_mfma_f32_16x16x32_bf16 v[68:71], v[164:167], v[136:139], v[68:71]
    v_mfma_f32_16x16x32_bf16 v[72:75], v[168:171], v[132:135], v[72:75]
    v_mfma_f32_16x16x32_bf16 v[76:79], v[168:171], v[136:139], v[76:79]
    v_mfma_f32_16x16x32_bf16 v[80:83], v[172:175], v[132:135], v[80:83]
    v_mfma_f32_16x16x32_bf16 v[84:87], v[172:175], v[136:139], v[84:87]
    s_waitcnt lgkmcnt(0)
    v_mfma_f32_16x16x32_bf16 v[16:19], v[96:99], v[88:91], v[16:19]
    ds_read_b128 v[132:135], v215 offset:16384
    v_mfma_f32_16x16x32_bf16 v[20:23], v[96:99], v[92:95], v[20:23]
    ds_read_b128 v[136:139], v215 offset:18432
    v_mfma_f32_16x16x32_bf16 v[24:27], v[100:103], v[88:91], v[24:27]
    ds_read_b128 v[140:143], v216 offset:27648
    v_mfma_f32_16x16x32_bf16 v[28:31], v[100:103], v[92:95], v[28:31]
    ds_read_b128 v[144:147], v216 offset:28160
    v_mfma_f32_16x16x32_bf16 v[32:35], v[104:107], v[88:91], v[32:35]
    ds_read_b128 v[148:151], v216 offset:28672
    v_mfma_f32_16x16x32_bf16 v[36:39], v[104:107], v[92:95], v[36:39]
    ds_read_b128 v[152:155], v216 offset:29184
    v_mfma_f32_16x16x32_bf16 v[40:43], v[108:111], v[88:91], v[40:43]
    ds_read_b128 v[156:159], v216 offset:29696
    v_mfma_f32_16x16x32_bf16 v[44:47], v[108:111], v[92:95], v[44:47]
    ds_read_b128 v[160:163], v216 offset:30208
    v_mfma_f32_16x16x32_bf16 v[48:51], v[112:115], v[88:91], v[48:51]
    ds_read_b128 v[164:167], v216 offset:30720
    v_mfma_f32_16x16x32_bf16 v[52:55], v[112:115], v[92:95], v[52:55]
    ds_read_b128 v[168:171], v216 offset:31232
    v_mfma_f32_16x16x32_bf16 v[56:59], v[116:119], v[88:91], v[56:59]
    ds_read_b128 v[172:175], v217 offset:27648
    v_mfma_f32_16x16x32_bf16 v[60:63], v[116:119], v[92:95], v[60:63]
    v_mfma_f32_16x16x32_bf16 v[64:67], v[120:123], v[88:91], v[64:67]
    v_mfma_f32_16x16x32_bf16 v[68:71], v[120:123], v[92:95], v[68:71]
    v_mfma_f32_16x16x32_bf16 v[72:75], v[124:127], v[88:91], v[72:75]
    v_mfma_f32_16x16x32_bf16 v[76:79], v[124:127], v[92:95], v[76:79]
    v_mfma_f32_16x16x32_bf16 v[80:83], v[128:131], v[88:91], v[80:83]
    v_mfma_f32_16x16x32_bf16 v[84:87], v[128:131], v[92:95], v[84:87]
    s_waitcnt lgkmcnt(0)
    s_waitcnt vmcnt(0)
    s_barrier
    s_cmp_ge_u32 s98, 64
    s_cbranch_scc1 L3_kve
    s_lshl_b32 s99, s97, 12
    s_add_u32 m0, s94, s99
    s_add_u32 s98, s98, 1
    buffer_load_dwordx4 v3, s[8:11], s95 offen lds
    s_add_u32 s95, s95, s96
    s_add_u32 s97, s97, 1
    s_cmp_eq_u32 s97, 9
    s_cselect_b32 s97, 0, s97
    s_lshl_b32 s99, s97, 12
    s_add_u32 m0, s94, s99
    s_add_u32 s98, s98, 1
    buffer_load_dwordx4 v3, s[8:11], s95 offen lds
    s_add_u32 s95, s95, s96
    s_add_u32 s97, s97, 1
    s_cmp_eq_u32 s97, 9
    s_cselect_b32 s97, 0, s97
    s_lshl_b32 s99, s97, 12
    s_add_u32 m0, s94, s99
    s_add_u32 s98, s98, 1
    buffer_load_dwordx4 v3, s[8:11], s95 offen lds
    s_add_u32 s95, s95, s96
    s_add_u32 s97, s97, 1
    s_cmp_eq_u32 s97, 9
    s_cselect_b32 s97, 0, s97
L3_kve:
    s_setprio 3
    v_mfma_f32_16x16x32_bf16 v[16:19], v[140:143], v[132:135], v[16:19]
    v_mfma_f32_16x16x32_bf16 v[20:23], v[140:143], v[136:139], v[20:23]
    v_mfma_f32_16x16x32_bf16 v[24:27], v[144:147], v[132:135], v[24:27]
    v_mfma_f32_16x16x32_bf16 v[28:31], v[144:147], v[136:139], v[28:31]
    v_mfma_f32_16x16x32_bf16 v[32:35], v[148:151], v[132:135], v[32:35]
    v_mfma_f32_16x16x32_bf16 v[36:39], v[148:151], v[136:139], v[36:39]
    v_mfma_f32_16x16x32_bf16 v[40:43], v[152:155], v[132:135], v[40:43]
    v_mfma_f32_16x16x32_bf16 v[44:47], v[152:155], v[136:139], v[44:47]
    v_mfma_f32_16x16x32_bf16 v[48:51], v[156:159], v[132:135], v[48:51]
    v_mfma_f32_16x16x32_bf16 v[52:55], v[156:159], v[136:139], v[52:55]
    v_mfma_f32_16x16x32_bf16 v[56:59], v[160:163], v[132:135], v[56:59]
    v_mfma_f32_16x16x32_bf16 v[60:63], v[160:163], v[136:139], v[60:63]
    v_mfma_f32_16x16x32_bf16 v[64:67], v[164:167], v[132:135], v[64:67]
    v_mfma_f32_16x16x32_bf16 v[68:71], v[164:167], v[136:139], v[68:71]
    v_mfma_f32_16x16x32_bf16 v[72:75], v[168:171], v[132:135], v[72:75]
    v_mfma_f32_16x16x32_bf16 v[76:79], v[168:171], v[136:139], v[76:79]
    v_mfma_f32_16x16x32_bf16 v[80:83], v[172:175], v[132:135], v[80:83]
    v_mfma_f32_16x16x32_bf16 v[84:87], v[172:175], v[136:139], v[84:87]
    v_lshlrev_b32 v212, 16, v212
    v_mul_f32 v212, v229, v212
    v_lshlrev_b32 v213, 16, v213
    v_mul_f32 v213, v230, v213
    s_nop 3
    v_lshlrev_b32 v232, 16, v176
    v_and_b32 v233, 0xffff0000, v176
    v_lshlrev_b32 v234, 16, v177
    v_and_b32 v235, 0xffff0000, v177
    v_fma_f32 v16, v16, v229, v212
    v_fma_f32 v17, v17, v229, v212
    v_fma_f32 v18, v18, v229, v212
    v_fma_f32 v19, v19, v229, v212
    v_mul_f32 v232, v232, v16
    v_mul_f32 v233, v233, v17
    v_mul_f32 v234, v234, v18
    v_mul_f32 v235, v235, v19
    v_cvt_pk_bf16_f32 v176, v232, v233
    v_cvt_pk_bf16_f32 v177, v234, v235
    v_lshlrev_b32 v236, 16, v178
    v_and_b32 v237, 0xffff0000, v178
    v_lshlrev_b32 v238, 16, v179
    v_and_b32 v239, 0xffff0000, v179
    v_fma_f32 v24, v24, v229, v212
    v_fma_f32 v25, v25, v229, v212
    v_fma_f32 v26, v26, v229, v212
    v_fma_f32 v27, v27, v229, v212
    v_mul_f32 v236, v236, v24
    v_mul_f32 v237, v237, v25
    v_mul_f32 v238, v238, v26
    v_mul_f32 v239, v239, v27
    v_cvt_pk_bf16_f32 v178, v236, v237
    v_cvt_pk_bf16_f32 v179, v238, v239
    buffer_store_dwordx4 v[176:179], v2, s[8:11], s62 offen offset:0 sc1
    v_lshlrev_b32 v232, 16, v180
    v_and_b32 v233, 0xffff0000, v180
    v_lshlrev_b32 v234, 16, v181
    v_and_b32 v235, 0xffff0000, v181
    v_fma_f32 v32, v32, v229, v212
    v_fma_f32 v33, v33, v229, v212
    v_fma_f32 v34, v34, v229, v212
    v_fma_f32 v35, v35, v229, v212
    v_mul_f32 v232, v232, v32
    v_mul_f32 v233, v233, v33
    v_mul_f32 v234, v234, v34
    v_mul_f32 v235, v235, v35
    v_cvt_pk_bf16_f32 v180, v232, v233
    v_cvt_pk_bf16_f32 v181, v234, v235
    v_lshlrev_b32 v236, 16, v182
    v_and_b32 v237, 0xffff0000, v182
    v_lshlrev_b32 v238, 16, v183
    v_and_b32 v239, 0xffff0000, v183
    v_fma_f32 v40, v40, v229, v212
    v_fma_f32 v41, v41, v229, v212
    v_fma_f32 v42, v42, v229, v212
    v_fma_f32 v43, v43, v229, v212
    v_mul_f32 v236, v236, v40
    v_mul_f32 v237, v237, v41
    v_mul_f32 v238, v238, v42
    v_mul_f32 v239, v239, v43
    v_cvt_pk_bf16_f32 v182, v236, v237
    v_cvt_pk_bf16_f32 v183, v238, v239
    buffer_store_dwordx4 v[180:183], v2, s[8:11], s62 offen offset:1024 sc1
    v_lshlrev_b32 v232, 16, v184
    v_and_b32 v233, 0xffff0000, v184
    v_lshlrev_b32 v234, 16, v185
    v_and_b32 v235, 0xffff0000, v185
    v_fma_f32 v48, v48, v229, v212
    v_fma_f32 v49, v49, v229, v212
    v_fma_f32 v50, v50, v229, v212
    v_fma_f32 v51, v51, v229, v212
    v_mul_f32 v232, v232, v48
    v_mul_f32 v233, v233, v49
    v_mul_f32 v234, v234, v50
    v_mul_f32 v235, v235, v51
    v_cvt_pk_bf16_f32 v184, v232, v233
    v_cvt_pk_bf16_f32 v185, v234, v235
    v_lshlrev_b32 v236, 16, v186
    v_and_b32 v237, 0xffff0000, v186
    v_lshlrev_b32 v238, 16, v187
    v_and_b32 v239, 0xffff0000, v187
    v_fma_f32 v56, v56, v229, v212
    v_fma_f32 v57, v57, v229, v212
    v_fma_f32 v58, v58, v229, v212
    v_fma_f32 v59, v59, v229, v212
    v_mul_f32 v236, v236, v56
    v_mul_f32 v237, v237, v57
    v_mul_f32 v238, v238, v58
    v_mul_f32 v239, v239, v59
    v_cvt_pk_bf16_f32 v186, v236, v237
    v_cvt_pk_bf16_f32 v187, v238, v239
    buffer_store_dwordx4 v[184:187], v2, s[8:11], s62 offen offset:2048 sc1
    v_lshlrev_b32 v232, 16, v188
    v_and_b32 v233, 0xffff0000, v188
    v_lshlrev_b32 v234, 16, v189
    v_and_b32 v235, 0xffff0000, v189
    v_fma_f32 v64, v64, v229, v212
    v_fma_f32 v65, v65, v229, v212
    v_fma_f32 v66, v66, v229, v212
    v_fma_f32 v67, v67, v229, v212
    v_mul_f32 v232, v232, v64
    v_mul_f32 v233, v233, v65
    v_mul_f32 v234, v234, v66
    v_mul_f32 v235, v235, v67
    v_cvt_pk_bf16_f32 v188, v232, v233
    v_cvt_pk_bf16_f32 v189, v234, v235
    v_lshlrev_b32 v236, 16, v190
    v_and_b32 v237, 0xffff0000, v190
    v_lshlrev_b32 v238, 16, v191
    v_and_b32 v239, 0xffff0000, v191
    v_fma_f32 v72, v72, v229, v212
    v_fma_f32 v73, v73, v229, v212
    v_fma_f32 v74, v74, v229, v212
    v_fma_f32 v75, v75, v229, v212
    v_mul_f32 v236, v236, v72
    v_mul_f32 v237, v237, v73
    v_mul_f32 v238, v238, v74
    v_mul_f32 v239, v239, v75
    v_cvt_pk_bf16_f32 v190, v236, v237
    v_cvt_pk_bf16_f32 v191, v238, v239
    buffer_store_dwordx4 v[188:191], v2, s[8:11], s62 offen offset:3072 sc1
    v_lshlrev_b32 v232, 16, v192
    v_and_b32 v233, 0xffff0000, v192
    v_lshlrev_b32 v234, 16, v193
    v_and_b32 v235, 0xffff0000, v193
    v_fma_f32 v80, v80, v229, v212
    v_fma_f32 v81, v81, v229, v212
    v_fma_f32 v82, v82, v229, v212
    v_fma_f32 v83, v83, v229, v212
    v_mul_f32 v232, v232, v80
    v_mul_f32 v233, v233, v81
    v_mul_f32 v234, v234, v82
    v_mul_f32 v235, v235, v83
    v_cvt_pk_bf16_f32 v192, v232, v233
    v_cvt_pk_bf16_f32 v193, v234, v235
    buffer_store_dwordx2 v[192:193], v2, s[8:11], s64 offen sc1
    s_add_u32 s62, s62, 92160
    s_add_u32 s64, s64, 92160
    v_lshlrev_b32 v232, 16, v194
    v_and_b32 v233, 0xffff0000, v194
    v_lshlrev_b32 v234, 16, v195
    v_and_b32 v235, 0xffff0000, v195
    v_fma_f32 v20, v20, v230, v213
    v_fma_f32 v21, v21, v230, v213
    v_fma_f32 v22, v22, v230, v213
    v_fma_f32 v23, v23, v230, v213
    v_mul_f32 v232, v232, v20
    v_mul_f32 v233, v233, v21
    v_mul_f32 v234, v234, v22
    v_mul_f32 v235, v235, v23
    v_cvt_pk_bf16_f32 v194, v232, v233
    v_cvt_pk_bf16_f32 v195, v234, v235
    v_lshlrev_b32 v236, 16, v196
    v_and_b32 v237, 0xffff0000, v196
    v_lshlrev_b32 v238, 16, v197
    v_and_b32 v239, 0xffff0000, v197
    v_fma_f32 v28, v28, v230, v213
    v_fma_f32 v29, v29, v230, v213
    v_fma_f32 v30, v30, v230, v213
    v_fma_f32 v31, v31, v230, v213
    v_mul_f32 v236, v236, v28
    v_mul_f32 v237, v237, v29
    v_mul_f32 v238, v238, v30
    v_mul_f32 v239, v239, v31
    v_cvt_pk_bf16_f32 v196, v236, v237
    v_cvt_pk_bf16_f32 v197, v238, v239
    buffer_store_dwordx4 v[194:197], v2, s[8:11], s62 offen offset:0 sc1
    v_lshlrev_b32 v232, 16, v198
    v_and_b32 v233, 0xffff0000, v198
    v_lshlrev_b32 v234, 16, v199
    v_and_b32 v235, 0xffff0000, v199
    v_fma_f32 v36, v36, v230, v213
    v_fma_f32 v37, v37, v230, v213
    v_fma_f32 v38, v38, v230, v213
    v_fma_f32 v39, v39, v230, v213
    v_mul_f32 v232, v232, v36
    v_mul_f32 v233, v233, v37
    v_mul_f32 v234, v234, v38
    v_mul_f32 v235, v235, v39
    v_cvt_pk_bf16_f32 v198, v232, v233
    v_cvt_pk_bf16_f32 v199, v234, v235
    v_lshlrev_b32 v236, 16, v200
    v_and_b32 v237, 0xffff0000, v200
    v_lshlrev_b32 v238, 16, v201
    v_and_b32 v239, 0xffff0000, v201
    v_fma_f32 v44, v44, v230, v213
    v_fma_f32 v45, v45, v230, v213
    v_fma_f32 v46, v46, v230, v213
    v_fma_f32 v47, v47, v230, v213
    v_mul_f32 v236, v236, v44
    v_mul_f32 v237, v237, v45
    v_mul_f32 v238, v238, v46
    v_mul_f32 v239, v239, v47
    v_cvt_pk_bf16_f32 v200, v236, v237
    v_cvt_pk_bf16_f32 v201, v238, v239
    buffer_store_dwordx4 v[198:201], v2, s[8:11], s62 offen offset:1024 sc1
    v_lshlrev_b32 v232, 16, v202
    v_and_b32 v233, 0xffff0000, v202
    v_lshlrev_b32 v234, 16, v203
    v_and_b32 v235, 0xffff0000, v203
    v_fma_f32 v52, v52, v230, v213
    v_fma_f32 v53, v53, v230, v213
    v_fma_f32 v54, v54, v230, v213
    v_fma_f32 v55, v55, v230, v213
    v_mul_f32 v232, v232, v52
    v_mul_f32 v233, v233, v53
    v_mul_f32 v234, v234, v54
    v_mul_f32 v235, v235, v55
    v_cvt_pk_bf16_f32 v202, v232, v233
    v_cvt_pk_bf16_f32 v203, v234, v235
    v_lshlrev_b32 v236, 16, v204
    v_and_b32 v237, 0xffff0000, v204
    v_lshlrev_b32 v238, 16, v205
    v_and_b32 v239, 0xffff0000, v205
    v_fma_f32 v60, v60, v230, v213
    v_fma_f32 v61, v61, v230, v213
    v_fma_f32 v62, v62, v230, v213
    v_fma_f32 v63, v63, v230, v213
    v_mul_f32 v236, v236, v60
    v_mul_f32 v237, v237, v61
    v_mul_f32 v238, v238, v62
    v_mul_f32 v239, v239, v63
    v_cvt_pk_bf16_f32 v204, v236, v237
    v_cvt_pk_bf16_f32 v205, v238, v239
    buffer_store_dwordx4 v[202:205], v2, s[8:11], s62 offen offset:2048 sc1
    v_lshlrev_b32 v232, 16, v206
    v_and_b32 v233, 0xffff0000, v206
    v_lshlrev_b32 v234, 16, v207
    v_and_b32 v235, 0xffff0000, v207
    v_fma_f32 v68, v68, v230, v213
    v_fma_f32 v69, v69, v230, v213
    v_fma_f32 v70, v70, v230, v213
    v_fma_f32 v71, v71, v230, v213
    v_mul_f32 v232, v232, v68
    v_mul_f32 v233, v233, v69
    v_mul_f32 v234, v234, v70
    v_mul_f32 v235, v235, v71
    v_cvt_pk_bf16_f32 v206, v232, v233
    v_cvt_pk_bf16_f32 v207, v234, v235
    v_lshlrev_b32 v236, 16, v208
    v_and_b32 v237, 0xffff0000, v208
    v_lshlrev_b32 v238, 16, v209
    v_and_b32 v239, 0xffff0000, v209
    v_fma_f32 v76, v76, v230, v213
    v_fma_f32 v77, v77, v230, v213
    v_fma_f32 v78, v78, v230, v213
    v_fma_f32 v79, v79, v230, v213
    v_mul_f32 v236, v236, v76
    v_mul_f32 v237, v237, v77
    v_mul_f32 v238, v238, v78
    v_mul_f32 v239, v239, v79
    v_cvt_pk_bf16_f32 v208, v236, v237
    v_cvt_pk_bf16_f32 v209, v238, v239
    buffer_store_dwordx4 v[206:209], v2, s[8:11], s62 offen offset:3072 sc1
    v_lshlrev_b32 v232, 16, v210
    v_and_b32 v233, 0xffff0000, v210
    v_lshlrev_b32 v234, 16, v211
    v_and_b32 v235, 0xffff0000, v211
    v_fma_f32 v84, v84, v230, v213
    v_fma_f32 v85, v85, v230, v213
    v_fma_f32 v86, v86, v230, v213
    v_fma_f32 v87, v87, v230, v213
    v_mul_f32 v232, v232, v84
    v_mul_f32 v233, v233, v85
    v_mul_f32 v234, v234, v86
    v_mul_f32 v235, v235, v87
    v_cvt_pk_bf16_f32 v210, v232, v233
    v_cvt_pk_bf16_f32 v211, v234, v235
    buffer_store_dwordx2 v[210:211], v2, s[8:11], s64 offen sc1
    s_setprio 0
    s_cmp_lt_u32 s2, 234
    s_cbranch_scc1 L3_work
    s_waitcnt vmcnt(0)
    s_barrier
    s_cmp_ge_u32 s98, 64
    s_cbranch_scc1 L3_kvx0
    s_lshl_b32 s99, s97, 12
    s_add_u32 m0, s94, s99
    s_add_u32 s98, s98, 1
    buffer_load_dwordx4 v3, s[8:11], s95 offen lds
    s_add_u32 s95, s95, s96
    s_add_u32 s97, s97, 1
    s_cmp_eq_u32 s97, 9
    s_cselect_b32 s97, 0, s97
    s_lshl_b32 s99, s97, 12
    s_add_u32 m0, s94, s99
    s_add_u32 s98, s98, 1
    buffer_load_dwordx4 v3, s[8:11], s95 offen lds
    s_add_u32 s95, s95, s96
    s_add_u32 s97, s97, 1
    s_cmp_eq_u32 s97, 9
    s_cselect_b32 s97, 0, s97
    s_lshl_b32 s99, s97, 12
    s_add_u32 m0, s94, s99
    s_add_u32 s98, s98, 1
    buffer_load_dwordx4 v3, s[8:11], s95 offen lds
    s_add_u32 s95, s95, s96
    s_add_u32 s97, s97, 1
    s_cmp_eq_u32 s97, 9
    s_cselect_b32 s97, 0, s97
L3_kvx0:
    v_mov_b32 v4, 126964
    v_mov_b32 v5, 1
    v_lshlrev_b32 v7, 8, v1
    s_lshl_b32 s36, s29, 11
    s_add_u32 s36, s36, 38084608
    s_mov_b64 exec, 1
    ds_add_rtn_u32 v6, v4, v5
    s_waitcnt lgkmcnt(0)
    v_readfirstlane_b32 s35, v6
    s_mov_b64 exec, 0xff
    s_cmp_lg_u32 s35, 3
    s_cbranch_scc1 L3_notlast_x
    buffer_atomic_add v5, v7, s[8:11], s36 offen sc1
L3_notlast_x:
    s_mov_b64 exec, -1
L3_feed:
    s_waitcnt vmcnt(0)
    s_barrier
    s_cmp_ge_u32 s98, 64
    s_cbranch_scc1 L3_kvx1
    s_lshl_b32 s99, s97, 12
    s_add_u32 m0, s94, s99
    s_add_u32 s98, s98, 1
    buffer_load_dwordx4 v3, s[8:11], s95 offen lds
    s_add_u32 s95, s95, s96
    s_add_u32 s97, s97, 1
    s_cmp_eq_u32 s97, 9
    s_cselect_b32 s97, 0, s97
    s_lshl_b32 s99, s97, 12
    s_add_u32 m0, s94, s99
    s_add_u32 s98, s98, 1
    buffer_load_dwordx4 v3, s[8:11], s95 offen lds
    s_add_u32 s95, s95, s96
    s_add_u32 s97, s97, 1
    s_cmp_eq_u32 s97, 9
    s_cselect_b32 s97, 0, s97
    s_lshl_b32 s99, s97, 12
    s_add_u32 m0, s94, s99
    s_add_u32 s98, s98, 1
    buffer_load_dwordx4 v3, s[8:11], s95 offen lds
    s_add_u32 s95, s95, s96
    s_add_u32 s97, s97, 1
    s_cmp_eq_u32 s97, 9
    s_cselect_b32 s97, 0, s97
L3_kvx1:
    s_cmp_lt_u32 s98, 64
    s_cbranch_scc1 L3_feed
    s_waitcnt vmcnt(0)
    s_barrier
    s_endpgm
L3_work:
    s_add_u32 m0, s59, 0
    s_add_u32 s42, s79, 0
    buffer_load_dwordx4 v12, s[16:19], s42 offen offset:0 lds
    buffer_load_dwordx4 v13, s[16:19], s42 offen offset:1024 lds
    s_add_u32 m0, s59, 8192
    s_add_u32 s42, s79, 73728
    buffer_load_dwordx4 v12, s[16:19], s42 offen offset:0 lds
    buffer_load_dwordx4 v13, s[16:19], s42 offen offset:1024 lds
    s_add_u32 m0, s59, 16384
    s_add_u32 s42, s79, 147456
    buffer_load_dwordx4 v12, s[16:19], s42 offen offset:0 lds
    buffer_load_dwordx4 v13, s[16:19], s42 offen offset:1024 lds
    s_add_u32 m0, s59, 24576
    s_add_u32 s42, s79, 221184
    buffer_load_dwordx4 v12, s[16:19], s42 offen offset:0 lds
    buffer_load_dwordx4 v13, s[16:19], s42 offen offset:1024 lds
    v_lshrrev_b32 v4, 2, v1
    v_bfe_u32 v5, v1, 3, 2
    v_and_b32 v6, 3, v1
    v_lshlrev_b32 v4, 7, v4
    v_lshl_add_u32 v4, v6, 3, v4
    s_and_b32 s36, s46, 1
    s_lshl_b32 s36, s36, 1
    v_xor_b32 v5, s36, v5
    v_lshl_add_u32 v4, v5, 5, v4
    v_add_u32 v103, s38, v4
    v_xor_b32 v105, 32, v103
    v_add_u32 v104, 40960, v103
    v_add_u32 v106, 40960, v105
    s_lshr_b32 s35, s46, 1
    s_lshl_b32 s35, s35, 12
    s_add_u32 s35, s35, 71680
    v_add_u32 v107, s35, v4
    v_xor_b32 v108, 32, v107
    s_barrier
    s_cmp_ge_u32 s98, 64
    s_cbranch_scc1 L3_kvw1
    s_lshl_b32 s99, s97, 12
    s_add_u32 m0, s94, s99
    s_add_u32 s98, s98, 1
    buffer_load_dwordx4 v3, s[8:11], s95 offen lds
    s_add_u32 s95, s95, s96
    s_add_u32 s97, s97, 1
    s_cmp_eq_u32 s97, 9
    s_cselect_b32 s97, 0, s97
    s_lshl_b32 s99, s97, 12
    s_add_u32 m0, s94, s99
    s_add_u32 s98, s98, 1
    buffer_load_dwordx4 v3, s[8:11], s95 offen lds
    s_add_u32 s95, s95, s96
    s_add_u32 s97, s97, 1
    s_cmp_eq_u32 s97, 9
    s_cselect_b32 s97, 0, s97
    s_lshl_b32 s99, s97, 12
    s_add_u32 m0, s94, s99
    s_add_u32 s98, s98, 1
    buffer_load_dwordx4 v3, s[8:11], s95 offen lds
    s_add_u32 s95, s95, s96
    s_add_u32 s97, s97, 1
    s_cmp_eq_u32 s97, 9
    s_cselect_b32 s97, 0, s97
L3_kvw1:
    s_add_u32 m0, s59, 32768
    s_add_u32 s42, s79, 294912
    buffer_load_dwordx4 v12, s[16:19], s42 offen offset:0 lds
    buffer_load_dwordx4 v13, s[16:19], s42 offen offset:1024 lds
    s_add_u32 m0, s59, 40960
    s_add_u32 s42, s79, 368640
    buffer_load_dwordx4 v12, s[16:19], s42 offen offset:0 lds
    buffer_load_dwordx4 v13, s[16:19], s42 offen offset:1024 lds
    s_add_u32 m0, s43, 0
    s_add_u32 s42, s79, 442368
    buffer_load_dwordx4 v12, s[16:19], s42 offen offset:0 lds
    buffer_load_dwordx4 v13, s[16:19], s42 offen offset:1024 lds
    s_add_u32 m0, s43, 10240
    s_add_u32 s42, s79, 516096
    buffer_load_dwordx4 v12, s[16:19], s42 offen offset:0 lds
    buffer_load_dwordx4 v13, s[16:19], s42 offen offset:1024 lds
    s_and_b32 s47, s2, 7
    s_lshl_b32 s47, s47, 8
    s_mul_i32 s35, s39, 80
    s_add_u32 s36, s35, 79
    s_min_u32 s36, s36, 2047
    s_lshr_b32 s50, s35, 7
    s_lshl_b32 s50, s50, 11
    s_add_u32 s50, s50, s47
    s_add_u32 s50, s50, 38084608
    s_lshr_b32 s51, s36, 7
    s_lshl_b32 s51, s51, 11
    s_add_u32 s51, s51, s47
    s_add_u32 s51, s51, 38084608
    s_lshr_b32 s52, s35, 8
    s_lshl_b32 s52, s52, 11
    s_add_u32 s52, s52, s47
    s_add_u32 s52, s52, 38117376
    s_lshr_b32 s53, s36, 8
    s_lshl_b32 s53, s53, 11
    s_add_u32 s53, s53, s47
    s_add_u32 s53, s53, 38117376
    s_mov_b32 s47, 0x100000
    s_add_u32 s84, s8, 26017792
    s_addc_u32 s85, s9, 0
    s_mov_b32 s86, 11796480
    s_mov_b32 s87, 0x20000
    s_mov_b32 s80, s92
    s_and_b32 s81, s93, 0xffff
    s_mov_b32 s82, 2359296
    s_mov_b32 s83, 0x20000
    s_mov_b32 s72, s88
    s_and_b32 s73, s89, 0xffff
    s_mov_b32 s74, 2359296
    s_mov_b32 s75, 0x20000
    s_lshr_b32 s35, s46, 1
    s_and_b32 s36, s46, 1
    s_mul_i32 s45, s36, 3072
    s_add_u32 s45, s45, s38
    s_mov_b32 s100, s38
    s_mul_i32 s101, s36, 276480
    s_mul_i32 s76, s39, 5
    s_mul_i32 s37, s36, 3
    s_add_u32 s76, s76, s37
    s_mul_i32 s76, s76, 92160
    s_lshl_b32 s37, s35, 10
    s_add_u32 s76, s76, s37
    v_add_u32 v109, s38, v2
    v_add_u32 v110, 40960, v109
    v_mov_b32 v96, v12
    v_add_u32 v97, 19712, v12
    v_lshrrev_b32 v4, 3, v1
    v_mul_u32_u24 v7, 1152, v4
    v_sub_u32 v6, v12, v7
    v_lshrrev_b32 v8, 2, v4
    v_bfe_u32 v9, v4, 1, 1
    v_lshl_add_u32 v8, v8, 2, v9
    v_mul_u32_u24 v8, 18, v8
    v_and_b32 v9, 1, v4
    v_add3_u32 v8, v8, v9, 16
    v_mul_u32_u24 v8, 1152, v8
    v_add_u32 v98, v8, v6
    v_add_u32 v99, 164864, v98
    v_add_u32 v100, 0, v2
    v_add_u32 v101, 91136, v2
    v_add_u32 v102, 182272, v2
    v_and_b32 v5, 7, v1
    v_lshl_add_u32 v7, v5, 4, v7
    s_mul_i32 s35, s39, 10
    s_add_u32 s35, s35, s46
    s_mul_i32 s35, s35, 9216
    s_add_u32 s35, s35, s40
    v_add_u32 v111, s35, v7
    v_add_u32 v112, 36864, v111
    s_cmp_lt_u32 s46, 2
    s_mov_b32 s37, 73728
    s_cselect_b32 s35, s37, 0x80000000
    v_add_u32 v113, s35, v111
    s_waitcnt vmcnt(8)
    v_mov_b32 v4, 126964
    v_mov_b32 v5, 1
    v_lshlrev_b32 v7, 8, v1
    s_lshl_b32 s36, s29, 11
    s_add_u32 s36, s36, 38084608
    s_mov_b64 exec, 1
    ds_add_rtn_u32 v6, v4, v5
    s_waitcnt lgkmcnt(0)
    v_readfirstlane_b32 s35, v6
    s_mov_b64 exec, 0xff
    s_cmp_lg_u32 s35, 3
    s_cbranch_scc1 L3_notlast_g
    buffer_atomic_add v5, v7, s[8:11], s36 offen sc1
L3_notlast_g:
    s_mov_b64 exec, -1
    s_barrier
    s_cmp_ge_u32 s98, 64
    s_cbranch_scc1 L3_kvw2
    s_lshl_b32 s99, s97, 12
    s_add_u32 m0, s94, s99
    s_add_u32 s98, s98, 1
    buffer_load_dwordx4 v3, s[8:11], s95 offen lds
    s_add_u32 s95, s95, s96
    s_add_u32 s97, s97, 1
    s_cmp_eq_u32 s97, 9
    s_cselect_b32 s97, 0, s97
    s_lshl_b32 s99, s97, 12
    s_add_u32 m0, s94, s99
    s_add_u32 s98, s98, 1
    buffer_load_dwordx4 v3, s[8:11], s95 offen lds
    s_add_u32 s95, s95, s96
    s_add_u32 s97, s97, 1
    s_cmp_eq_u32 s97, 9
    s_cselect_b32 s97, 0, s97
    s_lshl_b32 s99, s97, 12
    s_add_u32 m0, s94, s99
    s_add_u32 s98, s98, 1
    buffer_load_dwordx4 v3, s[8:11], s95 offen lds
    s_add_u32 s95, s95, s96
    s_add_u32 s97, s97, 1
    s_cmp_eq_u32 s97, 9
    s_cselect_b32 s97, 0, s97
L3_kvw2:
    s_add_u32 m0, s43, 20480
    s_add_u32 s42, s79, 589824
    buffer_load_dwordx4 v12, s[16:19], s42 offen offset:0 lds
    buffer_load_dwordx4 v13, s[16:19], s42 offen offset:1024 lds
    s_add_u32 m0, s43, 30720
    s_add_u32 s42, s79, 663552
    buffer_load_dwordx4 v12, s[16:19], s42 offen offset:0 lds
    buffer_load_dwordx4 v13, s[16:19], s42 offen offset:1024 lds
    s_add_u32 m0, s43, 40960
    s_add_u32 s42, s79, 737280
    buffer_load_dwordx4 v12, s[16:19], s42 offen offset:0 lds
    buffer_load_dwordx4 v13, s[16:19], s42 offen offset:1024 lds
    s_add_u32 m0, s43, 51200
    s_add_u32 s42, s79, 811008
    buffer_load_dwordx4 v12, s[16:19], s42 offen offset:0 lds
    buffer_load_dwordx4 v13, s[16:19], s42 offen offset:1024 lds
    ds_read_b64_tr_b16 v[116:117], v107 offset:0
    ds_read_b64_tr_b16 v[118:119], v107 offset:2048
    ds_read_b64_tr_b16 v[120:121], v108 offset:0
    ds_read_b64_tr_b16 v[122:123], v108 offset:2048
    ds_read_b64_tr_b16 v[124:125], v107 offset:8192
    ds_read_b64_tr_b16 v[126:127], v107 offset:10240
    ds_read_b64_tr_b16 v[128:129], v108 offset:8192
    ds_read_b64_tr_b16 v[130:131], v108 offset:10240
    ds_read_b64_tr_b16 v[132:133], v107 offset:16384
    ds_read_b64_tr_b16 v[134:135], v107 offset:18432
    ds_read_b64_tr_b16 v[136:137], v108 offset:16384
    ds_read_b64_tr_b16 v[138:139], v108 offset:18432
    ds_read_b64_tr_b16 v[140:141], v107 offset:24576
    ds_read_b64_tr_b16 v[142:143], v107 offset:26624
    ds_read_b64_tr_b16 v[144:145], v108 offset:24576
    ds_read_b64_tr_b16 v[146:147], v108 offset:26624
    s_waitcnt vmcnt(8)
    s_waitcnt lgkmcnt(0)
    s_barrier
    s_cmp_ge_u32 s98, 64
    s_cbranch_scc1 L3_kvw3
    s_lshl_b32 s99, s97, 12
    s_add_u32 m0, s94, s99
    s_add_u32 s98, s98, 1
    buffer_load_dwordx4 v3, s[8:11], s95 offen lds
    s_add_u32 s95, s95, s96
    s_add_u32 s97, s97, 1
    s_cmp_eq_u32 s97, 9
    s_cselect_b32 s97, 0, s97
    s_lshl_b32 s99, s97, 12
    s_add_u32 m0, s94, s99
    s_add_u32 s98, s98, 1
    buffer_load_dwordx4 v3, s[8:11], s95 offen lds
    s_add_u32 s95, s95, s96
    s_add_u32 s97, s97, 1
    s_cmp_eq_u32 s97, 9
    s_cselect_b32 s97, 0, s97
    s_lshl_b32 s99, s97, 12
    s_add_u32 m0, s94, s99
    s_add_u32 s98, s98, 1
    buffer_load_dwordx4 v3, s[8:11], s95 offen lds
    s_add_u32 s95, s95, s96
    s_add_u32 s97, s97, 1
    s_cmp_eq_u32 s97, 9
    s_cselect_b32 s97, 0, s97
L3_kvw3:
    s_add_u32 m0, s43, 61440
    s_add_u32 s42, s79, 884736
    buffer_load_dwordx4 v12, s[16:19], s42 offen offset:0 lds
    buffer_load_dwordx4 v13, s[16:19], s42 offen offset:1024 lds
    s_add_u32 m0, s59, 0
    s_add_u32 s42, s79, 958464
    buffer_load_dwordx4 v12, s[16:19], s42 offen offset:0 lds
    buffer_load_dwordx4 v13, s[16:19], s42 offen offset:1024 lds
    s_add_u32 m0, s59, 8192
    s_add_u32 s42, s79, 1032192
    buffer_load_dwordx4 v12, s[16:19], s42 offen offset:0 lds
    buffer_load_dwordx4 v13, s[16:19], s42 offen offset:1024 lds
    s_add_u32 m0, s59, 16384
    s_add_u32 s42, s79, 1105920
    buffer_load_dwordx4 v12, s[16:19], s42 offen offset:0 lds
    buffer_load_dwordx4 v13, s[16:19], s42 offen offset:1024 lds
    s_cmp_lg_u32 s46, 0
    s_cbranch_scc1 L3_pi_h0
    buffer_load_dword v14, off, s[8:11], s50 sc1
    buffer_load_dword v15, off, s[8:11], s51 sc1
L3_pi_h0:
    ds_read_b64_tr_b16 v[148:149], v107 offset:32768
    ds_read_b64_tr_b16 v[150:151], v107 offset:34816
    ds_read_b64_tr_b16 v[152:153], v108 offset:32768
    ds_read_b64_tr_b16 v[154:155], v108 offset:34816
    ds_read_b64_tr_b16 v[156:157], v107 offset:40960
    ds_read_b64_tr_b16 v[158:159], v107 offset:43008
    ds_read_b64_tr_b16 v[160:161], v108 offset:40960
    ds_read_b64_tr_b16 v[162:163], v108 offset:43008
    ds_read_b64_tr_b16 v[164:165], v103 offset:0
    ds_read_b64_tr_b16 v[166:167], v103 offset:2048
    ds_read_b64_tr_b16 v[168:169], v105 offset:0
    ds_read_b64_tr_b16 v[170:171], v105 offset:2048
    ds_read_b64_tr_b16 v[172:173], v103 offset:10240
    ds_read_b64_tr_b16 v[174:175], v103 offset:12288
    ds_read_b64_tr_b16 v[176:177], v105 offset:10240
    ds_read_b64_tr_b16 v[178:179], v105 offset:12288
    s_cmp_lg_u32 s46, 0
    s_cbranch_scc1 L3_pv_h0
    s_waitcnt vmcnt(0)
    v_min_u32 v4, v14, v15
    s_sub_u32 s47, s47, 1
    s_cselect_b32 s35, 0, 16
    v_mov_b32 v5, 126968
    v_subrev_u32 v4, s35, v4
    ds_write_b32 v5, v4
    s_waitcnt lgkmcnt(0)
L3_pv_h0:
    s_waitcnt vmcnt(6)
    s_waitcnt lgkmcnt(0)
    s_barrier
    s_cmp_ge_u32 s98, 64
    s_cbranch_scc1 L3_kvw4
    s_lshl_b32 s99, s97, 12
    s_add_u32 m0, s94, s99
    s_add_u32 s98, s98, 1
    buffer_load_dwordx4 v3, s[8:11], s95 offen lds
    s_add_u32 s95, s95, s96
    s_add_u32 s97, s97, 1
    s_cmp_eq_u32 s97, 9
    s_cselect_b32 s97, 0, s97
    s_lshl_b32 s99, s97, 12
    s_add_u32 m0, s94, s99
    s_add_u32 s98, s98, 1
    buffer_load_dwordx4 v3, s[8:11], s95 offen lds
    s_add_u32 s95, s95, s96
    s_add_u32 s97, s97, 1
    s_cmp_eq_u32 s97, 9
    s_cselect_b32 s97, 0, s97
    s_lshl_b32 s99, s97, 12
    s_add_u32 m0, s94, s99
    s_add_u32 s98, s98, 1
    buffer_load_dwordx4 v3, s[8:11], s95 offen lds
    s_add_u32 s95, s95, s96
    s_add_u32 s97, s97, 1
    s_cmp_eq_u32 s97, 9
    s_cselect_b32 s97, 0, s97
L3_kvw4:
    s_add_u32 m0, s59, 24576
    s_add_u32 s42, s79, 1179648
    buffer_load_dwordx4 v12, s[16:19], s42 offen offset:0 lds
    buffer_load_dwordx4 v13, s[16:19], s42 offen offset:1024 lds
    s_add_u32 m0, s59, 32768
    s_add_u32 s42, s79, 1253376
    buffer_load_dwordx4 v12, s[16:19], s42 offen offset:0 lds
    buffer_load_dwordx4 v13, s[16:19], s42 offen offset:1024 lds
    s_add_u32 m0, s59, 40960
    s_add_u32 s42, s79, 1327104
    buffer_load_dwordx4 v12, s[16:19], s42 offen offset:0 lds
    buffer_load_dwordx4 v13, s[16:19], s42 offen offset:1024 lds
    ds_read_b64_tr_b16 v[180:181], v103 offset:20480
    ds_read_b64_tr_b16 v[182:183], v103 offset:22528
    ds_read_b64_tr_b16 v[184:185], v105 offset:20480
    ds_read_b64_tr_b16 v[186:187], v105 offset:22528
    ds_read_b64_tr_b16 v[188:189], v103 offset:30720
    ds_read_b64_tr_b16 v[190:191], v103 offset:32768
    ds_read_b64_tr_b16 v[192:193], v105 offset:30720
    ds_read_b64_tr_b16 v[194:195], v105 offset:32768
    ds_read_b64_tr_b16 v[196:197], v104 offset:0
    ds_read_b64_tr_b16 v[198:199], v104 offset:2048
    ds_read_b64_tr_b16 v[200:201], v106 offset:0
    ds_read_b64_tr_b16 v[202:203], v106 offset:2048
    ds_read_b64_tr_b16 v[204:205], v104 offset:10240
    ds_read_b64_tr_b16 v[206:207], v104 offset:12288
    ds_read_b64_tr_b16 v[208:209], v106 offset:10240
    ds_read_b64_tr_b16 v[210:211], v106 offset:12288
    ds_read_b64_tr_b16 v[212:213], v104 offset:20480
    ds_read_b64_tr_b16 v[214:215], v104 offset:22528
    ds_read_b64_tr_b16 v[216:217], v106 offset:20480
    ds_read_b64_tr_b16 v[218:219], v106 offset:22528
    v_mov_b32 v5, 126968
    ds_read_b32 v4, v5
    s_waitcnt lgkmcnt(0)
    v_readfirstlane_b32 s35, v4
    s_nop 0
    s_cmp_lt_i32 s35, 0
    s_cbranch_scc0 L3_hgo
L3_wait_h:
    s_cmp_lg_u32 s46, 0
    s_cbranch_scc1 L3_pi_h1x
    buffer_load_dword v14, off, s[8:11], s50 sc1
    buffer_load_dword v15, off, s[8:11], s51 sc1
L3_pi_h1x:
    s_cmp_lg_u32 s46, 0
    s_cbranch_scc1 L3_pv_h1x
    s_waitcnt vmcnt(0)
    v_min_u32 v4, v14, v15
    s_sub_u32 s47, s47, 1
    s_cselect_b32 s35, 0, 16
    v_mov_b32 v5, 126972
    v_subrev_u32 v4, s35, v4
    ds_write_b32 v5, v4
    s_waitcnt lgkmcnt(0)
L3_pv_h1x:
    s_waitcnt vmcnt(0)
    s_barrier
    s_cmp_ge_u32 s98, 64
    s_cbranch_scc1 L3_kvh1x
    s_lshl_b32 s99, s97, 12
    s_add_u32 m0, s94, s99
    s_add_u32 s98, s98, 1
    buffer_load_dwordx4 v3, s[8:11], s95 offen lds
    s_add_u32 s95, s95, s96
    s_add_u32 s97, s97, 1
    s_cmp_eq_u32 s97, 9
    s_cselect_b32 s97, 0, s97
    s_lshl_b32 s99, s97, 12
    s_add_u32 m0, s94, s99
    s_add_u32 s98, s98, 1
    buffer_load_dwordx4 v3, s[8:11], s95 offen lds
    s_add_u32 s95, s95, s96
    s_add_u32 s97, s97, 1
    s_cmp_eq_u32 s97, 9
    s_cselect_b32 s97, 0, s97
    s_lshl_b32 s99, s97, 12
    s_add_u32 m0, s94, s99
    s_add_u32 s98, s98, 1
    buffer_load_dwordx4 v3, s[8:11], s95 offen lds
    s_add_u32 s95, s95, s96
    s_add_u32 s97, s97, 1
    s_cmp_eq_u32 s97, 9
    s_cselect_b32 s97, 0, s97
L3_kvh1x:
    v_mov_b32 v5, 126972
    ds_read_b32 v4, v5
    s_waitcnt lgkmcnt(0)
    v_readfirstlane_b32 s35, v4
    s_nop 0
    s_cmp_lt_i32 s35, 0
    s_cbranch_scc0 L3_waited_h
    s_cmp_lg_u32 s46, 0
    s_cbranch_scc1 L3_pi_h0x
    buffer_load_dword v14, off, s[8:11], s50 sc1
    buffer_load_dword v15, off, s[8:11], s51 sc1
L3_pi_h0x:
    s_cmp_lg_u32 s46, 0
    s_cbranch_scc1 L3_pv_h0x
    s_waitcnt vmcnt(0)
    v_min_u32 v4, v14, v15
    s_sub_u32 s47, s47, 1
    s_cselect_b32 s35, 0, 16
    v_mov_b32 v5, 126968
    v_subrev_u32 v4, s35, v4
    ds_write_b32 v5, v4
    s_waitcnt lgkmcnt(0)
L3_pv_h0x:
    s_waitcnt vmcnt(0)
    s_barrier
    s_cmp_ge_u32 s98, 64
    s_cbranch_scc1 L3_kvh0x
    s_lshl_b32 s99, s97, 12
    s_add_u32 m0, s94, s99
    s_add_u32 s98, s98, 1
    buffer_load_dwordx4 v3, s[8:11], s95 offen lds
    s_add_u32 s95, s95, s96
    s_add_u32 s97, s97, 1
    s_cmp_eq_u32 s97, 9
    s_cselect_b32 s97, 0, s97
    s_lshl_b32 s99, s97, 12
    s_add_u32 m0, s94, s99
    s_add_u32 s98, s98, 1
    buffer_load_dwordx4 v3, s[8:11], s95 offen lds
    s_add_u32 s95, s95, s96
    s_add_u32 s97, s97, 1
    s_cmp_eq_u32 s97, 9
    s_cselect_b32 s97, 0, s97
    s_lshl_b32 s99, s97, 12
    s_add_u32 m0, s94, s99
    s_add_u32 s98, s98, 1
    buffer_load_dwordx4 v3, s[8:11], s95 offen lds
    s_add_u32 s95, s95, s96
    s_add_u32 s97, s97, 1
    s_cmp_eq_u32 s97, 9
    s_cselect_b32 s97, 0, s97
L3_kvh0x:
    v_mov_b32 v5, 126968
    ds_read_b32 v4, v5
    s_waitcnt lgkmcnt(0)
    v_readfirstlane_b32 s35, v4
    s_nop 0
    s_cmp_lt_i32 s35, 0
    s_cbranch_scc0 L3_waited_h
    s_branch L3_wait_h
L3_waited_h:
L3_hgo:
    s_add_u32 m0, s45, 0
    s_add_u32 s44, s76, 18432
    buffer_load_dwordx4 v100, s[84:87], s44 offen offset:0 sc1 lds
    buffer_load_dwordx4 v101, s[84:87], s44 offen offset:1024 sc1 lds
    s_bitcmp1_b32 s28, 0
    s_cbranch_scc1 L3_a0
    s_add_u32 m0, s100, 0
    s_sub_u32 s44, s44, s101
    buffer_load_dwordx4 v102, s[84:87], s44 offen offset:2048 sc1 lds
L3_a0:
    s_add_u32 m0, s45, 10240
    s_add_u32 s44, s76, 20480
    buffer_load_dwordx4 v100, s[84:87], s44 offen offset:0 sc1 lds
    buffer_load_dwordx4 v101, s[84:87], s44 offen offset:1024 sc1 lds
    s_bitcmp1_b32 s28, 0
    s_cbranch_scc0 L3_a1
    s_add_u32 m0, s100, 10240
    s_sub_u32 s44, s44, s101
    buffer_load_dwordx4 v102, s[84:87], s44 offen offset:2048 sc1 lds
L3_a1:
    s_barrier
    s_cmp_ge_u32 s98, 64
    s_cbranch_scc1 L3_kvs
    s_lshl_b32 s99, s97, 12
    s_add_u32 m0, s94, s99
    s_add_u32 s98, s98, 1
    buffer_load_dwordx4 v3, s[8:11], s95 offen lds
    s_add_u32 s95, s95, s96
    s_add_u32 s97, s97, 1
    s_cmp_eq_u32 s97, 9
    s_cselect_b32 s97, 0, s97
    s_lshl_b32 s99, s97, 12
    s_add_u32 m0, s94, s99
    s_add_u32 s98, s98, 1
    buffer_load_dwordx4 v3, s[8:11], s95 offen lds
    s_add_u32 s95, s95, s96
    s_add_u32 s97, s97, 1
    s_cmp_eq_u32 s97, 9
    s_cselect_b32 s97, 0, s97
    s_lshl_b32 s99, s97, 12
    s_add_u32 m0, s94, s99
    s_add_u32 s98, s98, 1
    buffer_load_dwordx4 v3, s[8:11], s95 offen lds
    s_add_u32 s95, s95, s96
    s_add_u32 s97, s97, 1
    s_cmp_eq_u32 s97, 9
    s_cselect_b32 s97, 0, s97
L3_kvs:
    s_add_u32 m0, s45, 20480
    s_add_u32 s44, s76, 22528
    buffer_load_dwordx4 v100, s[84:87], s44 offen offset:0 sc1 lds
    buffer_load_dwordx4 v101, s[84:87], s44 offen offset:1024 sc1 lds
    s_bitcmp1_b32 s28, 0
    s_cbranch_scc1 L3_a2
    s_add_u32 m0, s100, 20480
    s_sub_u32 s44, s44, s101
    buffer_load_dwordx4 v102, s[84:87], s44 offen offset:2048 sc1 lds
L3_a2:
    s_add_u32 m0, s45, 30720
    s_add_u32 s44, s76, 24576
    buffer_load_dwordx4 v100, s[84:87], s44 offen offset:0 sc1 lds
    buffer_load_dwordx4 v101, s[84:87], s44 offen offset:1024 sc1 lds
    s_bitcmp1_b32 s28, 0
    s_cbranch_scc0 L3_a3
    s_add_u32 m0, s100, 30720
    s_sub_u32 s44, s44, s101
    buffer_load_dwordx4 v102, s[84:87], s44 offen offset:2048 sc1 lds
L3_a3:
    s_waitcnt vmcnt(2)
    s_barrier
    s_cmp_ge_u32 s98, 64
    s_cbranch_scc1 L3_kvs0
    s_lshl_b32 s99, s97, 12
    s_add_u32 m0, s94, s99
    s_add_u32 s98, s98, 1
    buffer_load_dwordx4 v3, s[8:11], s95 offen lds
    s_add_u32 s95, s95, s96
    s_add_u32 s97, s97, 1
    s_cmp_eq_u32 s97, 9
    s_cselect_b32 s97, 0, s97
    s_lshl_b32 s99, s97, 12
    s_add_u32 m0, s94, s99
    s_add_u32 s98, s98, 1
    buffer_load_dwordx4 v3, s[8:11], s95 offen lds
    s_add_u32 s95, s95, s96
    s_add_u32 s97, s97, 1
    s_cmp_eq_u32 s97, 9
    s_cselect_b32 s97, 0, s97
    s_lshl_b32 s99, s97, 12
    s_add_u32 m0, s94, s99
    s_add_u32 s98, s98, 1
    buffer_load_dwordx4 v3, s[8:11], s95 offen lds
    s_add_u32 s95, s95, s96
    s_add_u32 s97, s97, 1
    s_cmp_eq_u32 s97, 9
    s_cselect_b32 s97, 0, s97
L3_kvs0:
    s_add_u32 m0, s45, 40960
    s_add_u32 s44, s76, 26624
    buffer_load_dwordx4 v100, s[84:87], s44 offen offset:0 sc1 lds
    ds_read_b128 v[56:59], v109 offset:0
    ds_read_b128 v[60:63], v109 offset:1024
    ds_read_b128 v[64:67], v109 offset:2048
    ds_read_b128 v[68:71], v109 offset:3072
    ds_read_b128 v[72:75], v109 offset:4096
    ds_read_b64_tr_b16 v[220:221], v107 offset:0
    ds_read_b64_tr_b16 v[222:223], v107 offset:2048
    ds_read_b64_tr_b16 v[224:225], v108 offset:0
    ds_read_b64_tr_b16 v[226:227], v108 offset:2048
    buffer_load_dwordx4 v101, s[84:87], s44 offen offset:1024 sc1 lds
    s_bitcmp1_b32 s28, 0
    s_cbranch_scc1 L3_a4
    s_add_u32 m0, s100, 40960
    s_sub_u32 s44, s44, s101
    buffer_load_dwordx4 v102, s[84:87], s44 offen offset:2048 sc1 lds
L3_a4:
    s_add_u32 m0, s45, 51200
    s_add_u32 s44, s76, 28672
    buffer_load_dwordx4 v100, s[84:87], s44 offen offset:0 sc1 lds
    buffer_load_dwordx4 v101, s[84:87], s44 offen offset:1024 sc1 lds
    s_bitcmp1_b32 s28, 0
    s_cbranch_scc0 L3_a5
    s_add_u32 m0, s100, 51200
    s_sub_u32 s44, s44, s101
    buffer_load_dwordx4 v102, s[84:87], s44 offen offset:2048 sc1 lds
L3_a5:
    ds_read_b128 v[76:79], v109 offset:10240
    ds_read_b128 v[80:83], v109 offset:11264
    ds_read_b128 v[84:87], v109 offset:12288
    ds_read_b128 v[88:91], v109 offset:13312
    ds_read_b128 v[92:95], v109 offset:14336
    ds_read_b64_tr_b16 v[228:229], v107 offset:8192
    ds_read_b64_tr_b16 v[230:231], v107 offset:10240
    ds_read_b64_tr_b16 v[232:233], v108 offset:8192
    ds_read_b64_tr_b16 v[234:235], v108 offset:10240
    s_waitcnt lgkmcnt(9)
    v_mfma_f32_16x16x32_bf16 v[16:19], v[116:119], v[56:59], 0
    v_mfma_f32_16x16x32_bf16 v[20:23], v[120:123], v[56:59], 0
    s_add_u32 m0, s45, 61440
    v_mfma_f32_16x16x32_bf16 v[24:27], v[116:119], v[60:63], 0
    s_add_u32 s44, s76, 30720
    v_mfma_f32_16x16x32_bf16 v[28:31], v[120:123], v[60:63], 0
    v_mfma_f32_16x16x32_bf16 v[32:35], v[116:119], v[64:67], 0
    buffer_load_dwordx4 v100, s[84:87], s44 offen offset:0 sc1 lds
    v_mfma_f32_16x16x32_bf16 v[36:39], v[120:123], v[64:67], 0
    buffer_load_dwordx4 v101, s[84:87], s44 offen offset:1024 sc1 lds
    v_mfma_f32_16x16x32_bf16 v[40:43], v[116:119], v[68:71], 0
    v_mfma_f32_16x16x32_bf16 v[44:47], v[120:123], v[68:71], 0
    s_bitcmp1_b32 s28, 0
    s_cbranch_scc1 L3_a6
    s_add_u32 m0, s100, 61440
    s_sub_u32 s44, s44, s101
    buffer_load_dwordx4 v102, s[84:87], s44 offen offset:2048 sc1 lds
L3_a6:
    v_mfma_f32_16x16x32_bf16 v[48:51], v[116:119], v[72:75], 0
    v_mfma_f32_16x16x32_bf16 v[52:55], v[120:123], v[72:75], 0
    ds_read_b128 v[56:59], v109 offset:20480
    ds_read_b128 v[60:63], v109 offset:21504
    ds_read_b128 v[64:67], v109 offset:22528
    ds_read_b128 v[68:71], v109 offset:23552
    ds_read_b128 v[72:75], v109 offset:24576
    ds_read_b64_tr_b16 v[116:117], v107 offset:16384
    ds_read_b64_tr_b16 v[118:119], v107 offset:18432
    ds_read_b64_tr_b16 v[120:121], v108 offset:16384
    ds_read_b64_tr_b16 v[122:123], v108 offset:18432
    s_waitcnt lgkmcnt(9)
    v_mfma_f32_16x16x32_bf16 v[16:19], v[124:127], v[76:79], v[16:19]
    v_mfma_f32_16x16x32_bf16 v[20:23], v[128:131], v[76:79], v[20:23]
    v_mfma_f32_16x16x32_bf16 v[24:27], v[124:127], v[80:83], v[24:27]
    v_mfma_f32_16x16x32_bf16 v[28:31], v[128:131], v[80:83], v[28:31]
    v_mfma_f32_16x16x32_bf16 v[32:35], v[124:127], v[84:87], v[32:35]
    v_mfma_f32_16x16x32_bf16 v[36:39], v[128:131], v[84:87], v[36:39]
    v_mfma_f32_16x16x32_bf16 v[40:43], v[124:127], v[88:91], v[40:43]
    v_mfma_f32_16x16x32_bf16 v[44:47], v[128:131], v[88:91], v[44:47]
    v_mfma_f32_16x16x32_bf16 v[48:51], v[124:127], v[92:95], v[48:51]
    v_mfma_f32_16x16x32_bf16 v[52:55], v[128:131], v[92:95], v[52:55]
    s_waitcnt vmcnt(2)
    s_waitcnt lgkmcnt(0)
    s_barrier
    s_cmp_ge_u32 s98, 64
    s_cbranch_scc1 L3_kvs3
    s_lshl_b32 s99, s97, 12
    s_add_u32 m0, s94, s99
    s_add_u32 s98, s98, 1
    buffer_load_dwordx4 v3, s[8:11], s95 offen lds
    s_add_u32 s95, s95, s96
    s_add_u32 s97, s97, 1
    s_cmp_eq_u32 s97, 9
    s_cselect_b32 s97, 0, s97
    s_lshl_b32 s99, s97, 12
    s_add_u32 m0, s94, s99
    s_add_u32 s98, s98, 1
    buffer_load_dwordx4 v3, s[8:11], s95 offen lds
    s_add_u32 s95, s95, s96
    s_add_u32 s97, s97, 1
    s_cmp_eq_u32 s97, 9
    s_cselect_b32 s97, 0, s97
    s_lshl_b32 s99, s97, 12
    s_add_u32 m0, s94, s99
    s_add_u32 s98, s98, 1
    buffer_load_dwordx4 v3, s[8:11], s95 offen lds
    s_add_u32 s95, s95, s96
    s_add_u32 s97, s97, 1
    s_cmp_eq_u32 s97, 9
    s_cselect_b32 s97, 0, s97
L3_kvs3:
    s_add_u32 m0, s59, 0
    s_add_u32 s42, s79, 1400832
    buffer_load_dwordx4 v12, s[16:19], s42 offen offset:0 lds
    ds_read_b128 v[76:79], v109 offset:30720
    ds_read_b128 v[80:83], v109 offset:31744
    ds_read_b128 v[84:87], v109 offset:32768
    ds_read_b128 v[88:91], v109 offset:33792
    ds_read_b128 v[92:95], v109 offset:34816
    ds_read_b64_tr_b16 v[124:125], v107 offset:24576
    ds_read_b64_tr_b16 v[126:127], v107 offset:26624
    ds_read_b64_tr_b16 v[128:129], v108 offset:24576
    ds_read_b64_tr_b16 v[130:131], v108 offset:26624
    v_mfma_f32_16x16x32_bf16 v[16:19], v[132:135], v[56:59], v[16:19]
    buffer_load_dwordx4 v13, s[16:19], s42 offen offset:1024 lds
    v_mfma_f32_16x16x32_bf16 v[20:23], v[136:139], v[56:59], v[20:23]
    s_add_u32 m0, s59, 8192
    v_mfma_f32_16x16x32_bf16 v[24:27], v[132:135], v[60:63], v[24:27]
    s_add_u32 s42, s79, 1474560
    buffer_load_dwordx4 v12, s[16:19], s42 offen offset:0 lds
    v_mfma_f32_16x16x32_bf16 v[28:31], v[136:139], v[60:63], v[28:31]
    buffer_load_dwordx4 v13, s[16:19], s42 offen offset:1024 lds
    v_mfma_f32_16x16x32_bf16 v[32:35], v[132:135], v[64:67], v[32:35]
    s_add_u32 m0, s45, 0
    v_mfma_f32_16x16x32_bf16 v[36:39], v[136:139], v[64:67], v[36:39]
    s_add_u32 s44, s76, 32768
    buffer_load_dwordx4 v100, s[84:87], s44 offen offset:0 sc1 lds
    v_mfma_f32_16x16x32_bf16 v[40:43], v[132:135], v[68:71], v[40:43]
    buffer_load_dwordx4 v101, s[84:87], s44 offen offset:1024 sc1 lds
    v_mfma_f32_16x16x32_bf16 v[44:47], v[136:139], v[68:71], v[44:47]
    s_bitcmp1_b32 s28, 0
    s_cbranch_scc0 L3_a7
    s_add_u32 m0, s100, 0
    s_sub_u32 s44, s44, s101
    buffer_load_dwordx4 v102, s[84:87], s44 offen offset:2048 sc1 lds
L3_a7:
    v_mfma_f32_16x16x32_bf16 v[48:51], v[132:135], v[72:75], v[48:51]
    s_add_u32 m0, s59, 16384
    v_mfma_f32_16x16x32_bf16 v[52:55], v[136:139], v[72:75], v[52:55]
    s_add_u32 s42, s79, 1548288
    buffer_load_dwordx4 v12, s[16:19], s42 offen offset:0 lds
    buffer_load_dwordx4 v13, s[16:19], s42 offen offset:1024 lds
    ds_read_b128 v[56:59], v110 offset:0
    ds_read_b128 v[60:63], v110 offset:1024
    ds_read_b128 v[64:67], v110 offset:2048
    ds_read_b128 v[68:71], v110 offset:3072
    ds_read_b128 v[72:75], v110 offset:4096
    ds_read_b64_tr_b16 v[132:133], v107 offset:32768
    ds_read_b64_tr_b16 v[134:135], v107 offset:34816
    ds_read_b64_tr_b16 v[136:137], v108 offset:32768
    ds_read_b64_tr_b16 v[138:139], v108 offset:34816
    s_waitcnt lgkmcnt(9)
    v_mfma_f32_16x16x32_bf16 v[16:19], v[140:143], v[76:79], v[16:19]
    s_add_u32 m0, s45, 10240
    v_mfma_f32_16x16x32_bf16 v[20:23], v[144:147], v[76:79], v[20:23]
    s_add_u32 s44, s76, 34816
    v_mfma_f32_16x16x32_bf16 v[24:27], v[140:143], v[80:83], v[24:27]
    buffer_load_dwordx4 v100, s[84:87], s44 offen offset:0 sc1 lds
    buffer_load_dwordx4 v101, s[84:87], s44 offen offset:1024 sc1 lds
    v_mfma_f32_16x16x32_bf16 v[28:31], v[144:147], v[80:83], v[28:31]
    s_bitcmp1_b32 s28, 0
    s_cbranch_scc1 L3_a8
    s_add_u32 m0, s100, 10240
    s_sub_u32 s44, s44, s101
    buffer_load_dwordx4 v102, s[84:87], s44 offen offset:2048 sc1 lds
L3_a8:
    v_mfma_f32_16x16x32_bf16 v[32:35], v[140:143], v[84:87], v[32:35]
    v_mfma_f32_16x16x32_bf16 v[36:39], v[144:147], v[84:87], v[36:39]
    s_add_u32 m0, s45, 20480
    s_add_u32 s44, s76, 36864
    v_mfma_f32_16x16x32_bf16 v[40:43], v[140:143], v[88:91], v[40:43]
    buffer_load_dwordx4 v100, s[84:87], s44 offen offset:0 sc1 lds
    v_mfma_f32_16x16x32_bf16 v[44:47], v[144:147], v[88:91], v[44:47]
    buffer_load_dwordx4 v101, s[84:87], s44 offen offset:1024 sc1 lds
    v_mfma_f32_16x16x32_bf16 v[48:51], v[140:143], v[92:95], v[48:51]
    s_bitcmp1_b32 s28, 0
    s_cbranch_scc0 L3_a9
    s_add_u32 m0, s100, 20480
    s_sub_u32 s44, s44, s101
    buffer_load_dwordx4 v102, s[84:87], s44 offen offset:2048 sc1 lds
L3_a9:
    v_mfma_f32_16x16x32_bf16 v[52:55], v[144:147], v[92:95], v[52:55]
    ds_read_b128 v[76:79], v110 offset:10240
    ds_read_b128 v[80:83], v110 offset:11264
    ds_read_b128 v[84:87], v110 offset:12288
    ds_read_b128 v[88:91], v110 offset:13312
    ds_read_b128 v[92:95], v110 offset:14336
    ds_read_b64_tr_b16 v[140:141], v107 offset:40960
    ds_read_b64_tr_b16 v[142:143], v107 offset:43008
    ds_read_b64_tr_b16 v[144:145], v108 offset:40960
    ds_read_b64_tr_b16 v[146:147], v108 offset:43008
    s_waitcnt lgkmcnt(9)
    v_mfma_f32_16x16x32_bf16 v[16:19], v[148:151], v[56:59], v[16:19]
    v_mfma_f32_16x16x32_bf16 v[20:23], v[152:155], v[56:59], v[20:23]
    v_mfma_f32_16x16x32_bf16 v[24:27], v[148:151], v[60:63], v[24:27]
    v_mfma_f32_16x16x32_bf16 v[28:31], v[152:155], v[60:63], v[28:31]
    v_mfma_f32_16x16x32_bf16 v[32:35], v[148:151], v[64:67], v[32:35]
    v_mfma_f32_16x16x32_bf16 v[36:39], v[152:155], v[64:67], v[36:39]
    v_mfma_f32_16x16x32_bf16 v[40:43], v[148:151], v[68:71], v[40:43]
    v_mfma_f32_16x16x32_bf16 v[44:47], v[152:155], v[68:71], v[44:47]
    v_mfma_f32_16x16x32_bf16 v[48:51], v[148:151], v[72:75], v[48:51]
    v_mfma_f32_16x16x32_bf16 v[52:55], v[152:155], v[72:75], v[52:55]
    s_waitcnt vmcnt(2)
    s_waitcnt lgkmcnt(0)
    s_barrier
    s_cmp_ge_u32 s98, 64
    s_cbranch_scc1 L3_kvs6
    s_lshl_b32 s99, s97, 12
    s_add_u32 m0, s94, s99
    s_add_u32 s98, s98, 1
    buffer_load_dwordx4 v3, s[8:11], s95 offen lds
    s_add_u32 s95, s95, s96
    s_add_u32 s97, s97, 1
    s_cmp_eq_u32 s97, 9
    s_cselect_b32 s97, 0, s97
    s_lshl_b32 s99, s97, 12
    s_add_u32 m0, s94, s99
    s_add_u32 s98, s98, 1
    buffer_load_dwordx4 v3, s[8:11], s95 offen lds
    s_add_u32 s95, s95, s96
    s_add_u32 s97, s97, 1
    s_cmp_eq_u32 s97, 9
    s_cselect_b32 s97, 0, s97
    s_lshl_b32 s99, s97, 12
    s_add_u32 m0, s94, s99
    s_add_u32 s98, s98, 1
    buffer_load_dwordx4 v3, s[8:11], s95 offen lds
    s_add_u32 s95, s95, s96
    s_add_u32 s97, s97, 1
    s_cmp_eq_u32 s97, 9
    s_cselect_b32 s97, 0, s97
L3_kvs6:
    s_add_u32 m0, s59, 24576
    s_add_u32 s42, s79, 1622016
    buffer_load_dwordx4 v12, s[16:19], s42 offen offset:0 lds
    ds_read_b128 v[56:59], v110 offset:20480
    ds_read_b128 v[60:63], v110 offset:21504
    ds_read_b128 v[64:67], v110 offset:22528
    ds_read_b128 v[68:71], v110 offset:23552
    ds_read_b128 v[72:75], v110 offset:24576
    ds_read_b64_tr_b16 v[148:149], v107 offset:0
    ds_read_b64_tr_b16 v[150:151], v107 offset:2048
    ds_read_b64_tr_b16 v[152:153], v108 offset:0
    ds_read_b64_tr_b16 v[154:155], v108 offset:2048
    v_mfma_f32_16x16x32_bf16 v[16:19], v[156:159], v[76:79], v[16:19]
    buffer_load_dwordx4 v13, s[16:19], s42 offen offset:1024 lds
    v_mfma_f32_16x16x32_bf16 v[20:23], v[160:163], v[76:79], v[20:23]
    s_add_u32 m0, s59, 32768
    v_mfma_f32_16x16x32_bf16 v[24:27], v[156:159], v[80:83], v[24:27]
    s_add_u32 s42, s79, 1695744
    buffer_load_dwordx4 v12, s[16:19], s42 offen offset:0 lds
    v_mfma_f32_16x16x32_bf16 v[28:31], v[160:163], v[80:83], v[28:31]
    buffer_load_dwordx4 v13, s[16:19], s42 offen offset:1024 lds
    v_mfma_f32_16x16x32_bf16 v[32:35], v[156:159], v[84:87], v[32:35]
    s_add_u32 m0, s45, 30720
    v_mfma_f32_16x16x32_bf16 v[36:39], v[160:163], v[84:87], v[36:39]
    s_add_u32 s44, s76, 38912
    buffer_load_dwordx4 v100, s[84:87], s44 offen offset:0 sc1 lds
    v_mfma_f32_16x16x32_bf16 v[40:43], v[156:159], v[88:91], v[40:43]
    buffer_load_dwordx4 v101, s[84:87], s44 offen offset:1024 sc1 lds
    v_mfma_f32_16x16x32_bf16 v[44:47], v[160:163], v[88:91], v[44:47]
    s_bitcmp1_b32 s28, 0
    s_cbranch_scc1 L3_a10
    s_add_u32 m0, s100, 30720
    s_sub_u32 s44, s44, s101
    buffer_load_dwordx4 v102, s[84:87], s44 offen offset:2048 sc1 lds
L3_a10:
    v_mfma_f32_16x16x32_bf16 v[48:51], v[156:159], v[92:95], v[48:51]
    s_add_u32 m0, s59, 40960
    v_mfma_f32_16x16x32_bf16 v[52:55], v[160:163], v[92:95], v[52:55]
    s_add_u32 s42, s79, 1769472
    buffer_load_dwordx4 v12, s[16:19], s42 offen offset:0 lds
    buffer_load_dwordx4 v13, s[16:19], s42 offen offset:1024 lds
    ds_read_b128 v[76:79], v109 offset:0
    ds_read_b128 v[80:83], v109 offset:1024
    ds_read_b128 v[84:87], v109 offset:2048
    ds_read_b128 v[88:91], v109 offset:3072
    ds_read_b128 v[92:95], v109 offset:4096
    ds_read_b64_tr_b16 v[156:157], v107 offset:8192
    ds_read_b64_tr_b16 v[158:159], v107 offset:10240
    ds_read_b64_tr_b16 v[160:161], v108 offset:8192
    ds_read_b64_tr_b16 v[162:163], v108 offset:10240
    s_waitcnt lgkmcnt(9)
    v_mfma_f32_16x16x32_bf16 v[16:19], v[164:167], v[56:59], v[16:19]
    s_add_u32 m0, s45, 40960
    v_mfma_f32_16x16x32_bf16 v[20:23], v[168:171], v[56:59], v[20:23]
    s_add_u32 s44, s76, 40960
    v_mfma_f32_16x16x32_bf16 v[24:27], v[164:167], v[60:63], v[24:27]
    buffer_load_dwordx4 v100, s[84:87], s44 offen offset:0 sc1 lds
    buffer_load_dwordx4 v101, s[84:87], s44 offen offset:1024 sc1 lds
    v_mfma_f32_16x16x32_bf16 v[28:31], v[168:171], v[60:63], v[28:31]
    s_bitcmp1_b32 s28, 0
    s_cbranch_scc0 L3_a11
    s_add_u32 m0, s100, 40960
    s_sub_u32 s44, s44, s101
    buffer_load_dwordx4 v102, s[84:87], s44 offen offset:2048 sc1 lds
L3_a11:
    v_mfma_f32_16x16x32_bf16 v[32:35], v[164:167], v[64:67], v[32:35]
    v_mfma_f32_16x16x32_bf16 v[36:39], v[168:171], v[64:67], v[36:39]
    s_add_u32 m0, s45, 51200
    s_add_u32 s44, s76, 43008
    v_mfma_f32_16x16x32_bf16 v[40:43], v[164:167], v[68:71], v[40:43]
    buffer_load_dwordx4 v100, s[84:87], s44 offen offset:0 sc1 lds
    v_mfma_f32_16x16x32_bf16 v[44:47], v[168:171], v[68:71], v[44:47]
    buffer_load_dwordx4 v101, s[84:87], s44 offen offset:1024 sc1 lds
    v_mfma_f32_16x16x32_bf16 v[48:51], v[164:167], v[72:75], v[48:51]
    s_bitcmp1_b32 s28, 0
    s_cbranch_scc1 L3_a12
    s_add_u32 m0, s100, 51200
    s_sub_u32 s44, s44, s101
    buffer_load_dwordx4 v102, s[84:87], s44 offen offset:2048 sc1 lds
L3_a12:
    v_mfma_f32_16x16x32_bf16 v[52:55], v[168:171], v[72:75], v[52:55]
    ds_read_b128 v[56:59], v109 offset:10240
    ds_read_b128 v[60:63], v109 offset:11264
    ds_read_b128 v[64:67], v109 offset:12288
    ds_read_b128 v[68:71], v109 offset:13312
    ds_read_b128 v[72:75], v109 offset:14336
    ds_read_b64_tr_b16 v[164:165], v107 offset:16384
    ds_read_b64_tr_b16 v[166:167], v107 offset:18432
    ds_read_b64_tr_b16 v[168:169], v108 offset:16384
    ds_read_b64_tr_b16 v[170:171], v108 offset:18432
    s_waitcnt lgkmcnt(9)
    v_mfma_f32_16x16x32_bf16 v[16:19], v[172:175], v[76:79], v[16:19]
    v_mfma_f32_16x16x32_bf16 v[20:23], v[176:179], v[76:79], v[20:23]
    v_mfma_f32_16x16x32_bf16 v[24:27], v[172:175], v[80:83], v[24:27]
    v_mfma_f32_16x16x32_bf16 v[28:31], v[176:179], v[80:83], v[28:31]
    v_mfma_f32_16x16x32_bf16 v[32:35], v[172:175], v[84:87], v[32:35]
    v_mfma_f32_16x16x32_bf16 v[36:39], v[176:179], v[84:87], v[36:39]
    v_mfma_f32_16x16x32_bf16 v[40:43], v[172:175], v[88:91], v[40:43]
    v_mfma_f32_16x16x32_bf16 v[44:47], v[176:179], v[88:91], v[44:47]
    v_mfma_f32_16x16x32_bf16 v[48:51], v[172:175], v[92:95], v[48:51]
    v_mfma_f32_16x16x32_bf16 v[52:55], v[176:179], v[92:95], v[52:55]
    s_waitcnt vmcnt(2)
    s_waitcnt lgkmcnt(0)
    s_barrier
    s_cmp_ge_u32 s98, 64
    s_cbranch_scc1 L3_kvs9
    s_lshl_b32 s99, s97, 12
    s_add_u32 m0, s94, s99
    s_add_u32 s98, s98, 1
    buffer_load_dwordx4 v3, s[8:11], s95 offen lds
    s_add_u32 s95, s95, s96
    s_add_u32 s97, s97, 1
    s_cmp_eq_u32 s97, 9
    s_cselect_b32 s97, 0, s97
    s_lshl_b32 s99, s97, 12
    s_add_u32 m0, s94, s99
    s_add_u32 s98, s98, 1
    buffer_load_dwordx4 v3, s[8:11], s95 offen lds
    s_add_u32 s95, s95, s96
    s_add_u32 s97, s97, 1
    s_cmp_eq_u32 s97, 9
    s_cselect_b32 s97, 0, s97
    s_lshl_b32 s99, s97, 12
    s_add_u32 m0, s94, s99
    s_add_u32 s98, s98, 1
    buffer_load_dwordx4 v3, s[8:11], s95 offen lds
    s_add_u32 s95, s95, s96
    s_add_u32 s97, s97, 1
    s_cmp_eq_u32 s97, 9
    s_cselect_b32 s97, 0, s97
L3_kvs9:
    s_add_u32 m0, s59, 0
    s_add_u32 s42, s79, 1843200
    buffer_load_dwordx4 v12, s[16:19], s42 offen offset:0 lds
    ds_read_b128 v[76:79], v109 offset:20480
    ds_read_b128 v[80:83], v109 offset:21504
    ds_read_b128 v[84:87], v109 offset:22528
    ds_read_b128 v[88:91], v109 offset:23552
    ds_read_b128 v[92:95], v109 offset:24576
    ds_read_b64_tr_b16 v[172:173], v107 offset:24576
    ds_read_b64_tr_b16 v[174:175], v107 offset:26624
    ds_read_b64_tr_b16 v[176:177], v108 offset:24576
    ds_read_b64_tr_b16 v[178:179], v108 offset:26624
    v_mfma_f32_16x16x32_bf16 v[16:19], v[180:183], v[56:59], v[16:19]
    buffer_load_dwordx4 v13, s[16:19], s42 offen offset:1024 lds
    v_mfma_f32_16x16x32_bf16 v[20:23], v[184:187], v[56:59], v[20:23]
    s_add_u32 m0, s59, 8192
    v_mfma_f32_16x16x32_bf16 v[24:27], v[180:183], v[60:63], v[24:27]
    s_add_u32 s42, s79, 1916928
    buffer_load_dwordx4 v12, s[16:19], s42 offen offset:0 lds
    v_mfma_f32_16x16x32_bf16 v[28:31], v[184:187], v[60:63], v[28:31]
    buffer_load_dwordx4 v13, s[16:19], s42 offen offset:1024 lds
    v_mfma_f32_16x16x32_bf16 v[32:35], v[180:183], v[64:67], v[32:35]
    s_add_u32 m0, s45, 61440
    v_mfma_f32_16x16x32_bf16 v[36:39], v[184:187], v[64:67], v[36:39]
    s_add_u32 s44, s76, 45056
    buffer_load_dwordx4 v100, s[84:87], s44 offen offset:0 sc1 lds
    v_mfma_f32_16x16x32_bf16 v[40:43], v[180:183], v[68:71], v[40:43]
    buffer_load_dwordx4 v101, s[84:87], s44 offen offset:1024 sc1 lds
    v_mfma_f32_16x16x32_bf16 v[44:47], v[184:187], v[68:71], v[44:47]
    s_bitcmp1_b32 s28, 0
    s_cbranch_scc0 L3_a13
    s_add_u32 m0, s100, 61440
    s_sub_u32 s44, s44, s101
    buffer_load_dwordx4 v102, s[84:87], s44 offen offset:2048 sc1 lds
L3_a13:
    v_mfma_f32_16x16x32_bf16 v[48:51], v[180:183], v[72:75], v[48:51]
    s_add_u32 m0, s59, 16384
    v_mfma_f32_16x16x32_bf16 v[52:55], v[184:187], v[72:75], v[52:55]
    s_add_u32 s42, s79, 1990656
    buffer_load_dwordx4 v12, s[16:19], s42 offen offset:0 lds
    buffer_load_dwordx4 v13, s[16:19], s42 offen offset:1024 lds
    ds_read_b128 v[56:59], v109 offset:30720
    ds_read_b128 v[60:63], v109 offset:31744
    ds_read_b128 v[64:67], v109 offset:32768
    ds_read_b128 v[68:71], v109 offset:33792
    ds_read_b128 v[72:75], v109 offset:34816
    ds_read_b64_tr_b16 v[180:181], v107 offset:32768
    ds_read_b64_tr_b16 v[182:183], v107 offset:34816
    ds_read_b64_tr_b16 v[184:185], v108 offset:32768
    ds_read_b64_tr_b16 v[186:187], v108 offset:34816
    s_waitcnt lgkmcnt(9)
    v_mfma_f32_16x16x32_bf16 v[16:19], v[188:191], v[76:79], v[16:19]
    s_add_u32 m0, s45, 0
    v_mfma_f32_16x16x32_bf16 v[20:23], v[192:195], v[76:79], v[20:23]
    s_add_u32 s44, s76, 47104
    v_mfma_f32_16x16x32_bf16 v[24:27], v[188:191], v[80:83], v[24:27]
    buffer_load_dwordx4 v100, s[84:87], s44 offen offset:0 sc1 lds
    buffer_load_dwordx4 v101, s[84:87], s44 offen offset:1024 sc1 lds
    v_mfma_f32_16x16x32_bf16 v[28:31], v[192:195], v[80:83], v[28:31]
    s_bitcmp1_b32 s28, 0
    s_cbranch_scc1 L3_a14
    s_add_u32 m0, s100, 0
    s_sub_u32 s44, s44, s101
    buffer_load_dwordx4 v102, s[84:87], s44 offen offset:2048 sc1 lds
L3_a14:
    v_mfma_f32_16x16x32_bf16 v[32:35], v[188:191], v[84:87], v[32:35]
    v_mfma_f32_16x16x32_bf16 v[36:39], v[192:195], v[84:87], v[36:39]
    s_add_u32 m0, s45, 10240
    s_add_u32 s44, s76, 49152
    v_mfma_f32_16x16x32_bf16 v[40:43], v[188:191], v[88:91], v[40:43]
    buffer_load_dwordx4 v100, s[84:87], s44 offen offset:0 sc1 lds
    v_mfma_f32_16x16x32_bf16 v[44:47], v[192:195], v[88:91], v[44:47]
    buffer_load_dwordx4 v101, s[84:87], s44 offen offset:1024 sc1 lds
    v_mfma_f32_16x16x32_bf16 v[48:51], v[188:191], v[92:95], v[48:51]
    s_bitcmp1_b32 s28, 0
    s_cbranch_scc0 L3_a15
    s_add_u32 m0, s100, 10240
    s_sub_u32 s44, s44, s101
    buffer_load_dwordx4 v102, s[84:87], s44 offen offset:2048 sc1 lds
L3_a15:
    v_mfma_f32_16x16x32_bf16 v[52:55], v[192:195], v[92:95], v[52:55]
    ds_read_b128 v[76:79], v110 offset:0
    ds_read_b128 v[80:83], v110 offset:1024
    ds_read_b128 v[84:87], v110 offset:2048
    ds_read_b128 v[88:91], v110 offset:3072
    ds_read_b128 v[92:95], v110 offset:4096
    ds_read_b64_tr_b16 v[188:189], v107 offset:40960
    ds_read_b64_tr_b16 v[190:191], v107 offset:43008
    ds_read_b64_tr_b16 v[192:193], v108 offset:40960
    ds_read_b64_tr_b16 v[194:195], v108 offset:43008
    s_waitcnt lgkmcnt(9)
    v_mfma_f32_16x16x32_bf16 v[16:19], v[196:199], v[56:59], v[16:19]
    v_mfma_f32_16x16x32_bf16 v[20:23], v[200:203], v[56:59], v[20:23]
    v_mfma_f32_16x16x32_bf16 v[24:27], v[196:199], v[60:63], v[24:27]
    v_mfma_f32_16x16x32_bf16 v[28:31], v[200:203], v[60:63], v[28:31]
    v_mfma_f32_16x16x32_bf16 v[32:35], v[196:199], v[64:67], v[32:35]
    v_mfma_f32_16x16x32_bf16 v[36:39], v[200:203], v[64:67], v[36:39]
    v_mfma_f32_16x16x32_bf16 v[40:43], v[196:199], v[68:71], v[40:43]
    v_mfma_f32_16x16x32_bf16 v[44:47], v[200:203], v[68:71], v[44:47]
    v_mfma_f32_16x16x32_bf16 v[48:51], v[196:199], v[72:75], v[48:51]
    v_mfma_f32_16x16x32_bf16 v[52:55], v[200:203], v[72:75], v[52:55]
    s_waitcnt vmcnt(11)
    s_barrier
    s_add_u32 m0, s59, 24576
    s_add_u32 s42, s79, 2064384
    buffer_load_dwordx4 v12, s[16:19], s42 offen offset:0 lds
    ds_read_b128 v[56:59], v110 offset:10240
    ds_read_b128 v[60:63], v110 offset:11264
    ds_read_b128 v[64:67], v110 offset:12288
    ds_read_b128 v[68:71], v110 offset:13312
    ds_read_b128 v[72:75], v110 offset:14336
    ds_read_b64_tr_b16 v[196:197], v107 offset:0
    ds_read_b64_tr_b16 v[198:199], v107 offset:2048
    ds_read_b64_tr_b16 v[200:201], v108 offset:0
    ds_read_b64_tr_b16 v[202:203], v108 offset:2048
    s_waitcnt lgkmcnt(9)
    v_mfma_f32_16x16x32_bf16 v[16:19], v[204:207], v[76:79], v[16:19]
    buffer_load_dwordx4 v13, s[16:19], s42 offen offset:1024 lds
    v_mfma_f32_16x16x32_bf16 v[20:23], v[208:211], v[76:79], v[20:23]
    s_add_u32 m0, s59, 32768
    s_add_u32 s42, s79, 2138112
    v_mfma_f32_16x16x32_bf16 v[24:27], v[204:207], v[80:83], v[24:27]
    buffer_load_dwordx4 v12, s[16:19], s42 offen offset:0 lds
    buffer_load_dwordx4 v13, s[16:19], s42 offen offset:1024 lds
    v_mfma_f32_16x16x32_bf16 v[28:31], v[208:211], v[80:83], v[28:31]
    s_add_u32 m0, s45, 20480
    s_add_u32 s44, s76, 51200
    v_mfma_f32_16x16x32_bf16 v[32:35], v[204:207], v[84:87], v[32:35]
    buffer_load_dwordx4 v100, s[84:87], s44 offen offset:0 sc1 lds
    buffer_load_dwordx4 v101, s[84:87], s44 offen offset:1024 sc1 lds
    v_mfma_f32_16x16x32_bf16 v[36:39], v[208:211], v[84:87], v[36:39]
    s_bitcmp1_b32 s28, 0
    s_cbranch_scc1 L3_a16
    s_add_u32 m0, s100, 20480
    s_sub_u32 s44, s44, s101
    buffer_load_dwordx4 v102, s[84:87], s44 offen offset:2048 sc1 lds
L3_a16:
    v_mfma_f32_16x16x32_bf16 v[40:43], v[204:207], v[88:91], v[40:43]
    s_add_u32 m0, s45, 30720
    s_add_u32 s44, s76, 53248
    v_mfma_f32_16x16x32_bf16 v[44:47], v[208:211], v[88:91], v[44:47]
    buffer_load_dwordx4 v100, s[84:87], s44 offen offset:0 sc1 lds
    buffer_load_dwordx4 v101, s[84:87], s44 offen offset:1024 sc1 lds
    v_mfma_f32_16x16x32_bf16 v[48:51], v[204:207], v[92:95], v[48:51]
    s_bitcmp1_b32 s28, 0
    s_cbranch_scc0 L3_a17
    s_add_u32 m0, s100, 30720
    s_sub_u32 s44, s44, s101
    buffer_load_dwordx4 v102, s[84:87], s44 offen offset:2048 sc1 lds
L3_a17:
    v_mfma_f32_16x16x32_bf16 v[52:55], v[208:211], v[92:95], v[52:55]
    s_waitcnt vmcnt(16)
    s_barrier
    s_add_u32 m0, s59, 40960
    s_add_u32 s42, s79, 2211840
    buffer_load_dwordx4 v12, s[16:19], s42 offen offset:0 lds
    ds_read_b128 v[76:79], v110 offset:20480
    ds_read_b128 v[80:83], v110 offset:21504
    ds_read_b128 v[84:87], v110 offset:22528
    ds_read_b128 v[88:91], v110 offset:23552
    ds_read_b128 v[92:95], v110 offset:24576
    ds_read_b64_tr_b16 v[204:205], v107 offset:8192
    ds_read_b64_tr_b16 v[206:207], v107 offset:10240
    ds_read_b64_tr_b16 v[208:209], v108 offset:8192
    ds_read_b64_tr_b16 v[210:211], v108 offset:10240
    s_waitcnt lgkmcnt(9)
    v_mfma_f32_16x16x32_bf16 v[16:19], v[212:215], v[56:59], v[16:19]
    v_mfma_f32_16x16x32_bf16 v[20:23], v[216:219], v[56:59], v[20:23]
    buffer_load_dwordx4 v13, s[16:19], s42 offen offset:1024 lds
    v_mfma_f32_16x16x32_bf16 v[24:27], v[212:215], v[60:63], v[24:27]
    s_add_u32 m0, s45, 40960
    v_mfma_f32_16x16x32_bf16 v[28:31], v[216:219], v[60:63], v[28:31]
    s_add_u32 s44, s76, 55296
    v_mfma_f32_16x16x32_bf16 v[32:35], v[212:215], v[64:67], v[32:35]
    v_mfma_f32_16x16x32_bf16 v[36:39], v[216:219], v[64:67], v[36:39]
    buffer_load_dwordx4 v100, s[84:87], s44 offen offset:0 sc1 lds
    v_mfma_f32_16x16x32_bf16 v[40:43], v[212:215], v[68:71], v[40:43]
    buffer_load_dwordx4 v101, s[84:87], s44 offen offset:1024 sc1 lds
    v_mfma_f32_16x16x32_bf16 v[44:47], v[216:219], v[68:71], v[44:47]
    s_bitcmp1_b32 s28, 0
    s_cbranch_scc1 L3_a18
    s_add_u32 m0, s100, 40960
    s_sub_u32 s44, s44, s101
    buffer_load_dwordx4 v102, s[84:87], s44 offen offset:2048 sc1 lds
L3_a18:
    v_mfma_f32_16x16x32_bf16 v[48:51], v[212:215], v[72:75], v[48:51]
    v_mfma_f32_16x16x32_bf16 v[52:55], v[216:219], v[72:75], v[52:55]
    s_waitcnt vmcnt(16)
    s_barrier
    s_add_u32 m0, s59, 0
    s_add_u32 s42, s79, 2285568
    buffer_load_dwordx4 v12, s[16:19], s42 offen offset:0 lds
    ds_read_b128 v[56:59], v109 offset:0
    ds_read_b128 v[60:63], v109 offset:1024
    ds_read_b128 v[64:67], v109 offset:2048
    ds_read_b128 v[68:71], v109 offset:3072
    ds_read_b128 v[72:75], v109 offset:4096
    ds_read_b64_tr_b16 v[212:213], v107 offset:16384
    ds_read_b64_tr_b16 v[214:215], v107 offset:18432
    ds_read_b64_tr_b16 v[216:217], v108 offset:16384
    ds_read_b64_tr_b16 v[218:219], v108 offset:18432
    s_waitcnt lgkmcnt(9)
    v_mfma_f32_16x16x32_bf16 v[16:19], v[220:223], v[76:79], v[16:19]
    v_mfma_f32_16x16x32_bf16 v[20:23], v[224:227], v[76:79], v[20:23]
    buffer_load_dwordx4 v13, s[16:19], s42 offen offset:1024 lds
    v_mfma_f32_16x16x32_bf16 v[24:27], v[220:223], v[80:83], v[24:27]
    s_add_u32 m0, s45, 51200
    v_mfma_f32_16x16x32_bf16 v[28:31], v[224:227], v[80:83], v[28:31]
    s_add_u32 s44, s76, 57344
    v_mfma_f32_16x16x32_bf16 v[32:35], v[220:223], v[84:87], v[32:35]
    v_mfma_f32_16x16x32_bf16 v[36:39], v[224:227], v[84:87], v[36:39]
    buffer_load_dwordx4 v100, s[84:87], s44 offen offset:0 sc1 lds
    v_mfma_f32_16x16x32_bf16 v[40:43], v[220:223], v[88:91], v[40:43]
    buffer_load_dwordx4 v101, s[84:87], s44 offen offset:1024 sc1 lds
    v_mfma_f32_16x16x32_bf16 v[44:47], v[224:227], v[88:91], v[44:47]
    s_bitcmp1_b32 s28, 0
    s_cbranch_scc0 L3_a19
    s_add_u32 m0, s100, 51200
    s_sub_u32 s44, s44, s101
    buffer_load_dwordx4 v102, s[84:87], s44 offen offset:2048 sc1 lds
L3_a19:
    v_mfma_f32_16x16x32_bf16 v[48:51], v[220:223], v[92:95], v[48:51]
    v_mfma_f32_16x16x32_bf16 v[52:55], v[224:227], v[92:95], v[52:55]
    s_waitcnt vmcnt(16)
    s_barrier
    s_add_u32 m0, s59, 8192
    s_add_u32 s42, s79, 2359296
    buffer_load_dwordx4 v12, s[16:19], s42 offen offset:0 lds
    ds_read_b128 v[76:79], v109 offset:10240
    ds_read_b128 v[80:83], v109 offset:11264
    ds_read_b128 v[84:87], v109 offset:12288
    ds_read_b128 v[88:91], v109 offset:13312
    ds_read_b128 v[92:95], v109 offset:14336
    ds_read_b64_tr_b16 v[220:221], v107 offset:24576
    ds_read_b64_tr_b16 v[222:223], v107 offset:26624
    ds_read_b64_tr_b16 v[224:225], v108 offset:24576
    ds_read_b64_tr_b16 v[226:227], v108 offset:26624
    s_waitcnt lgkmcnt(9)
    v_mfma_f32_16x16x32_bf16 v[16:19], v[228:231], v[56:59], v[16:19]
    v_mfma_f32_16x16x32_bf16 v[20:23], v[232:235], v[56:59], v[20:23]
    buffer_load_dwordx4 v13, s[16:19], s42 offen offset:1024 lds
    v_mfma_f32_16x16x32_bf16 v[24:27], v[228:231], v[60:63], v[24:27]
    s_add_u32 m0, s45, 61440
    v_mfma_f32_16x16x32_bf16 v[28:31], v[232:235], v[60:63], v[28:31]
    s_add_u32 s44, s76, 59392
    v_mfma_f32_16x16x32_bf16 v[32:35], v[228:231], v[64:67], v[32:35]
    v_mfma_f32_16x16x32_bf16 v[36:39], v[232:235], v[64:67], v[36:39]
    buffer_load_dwordx4 v100, s[84:87], s44 offen offset:0 sc1 lds
    v_mfma_f32_16x16x32_bf16 v[40:43], v[228:231], v[68:71], v[40:43]
    buffer_load_dwordx4 v101, s[84:87], s44 offen offset:1024 sc1 lds
    v_mfma_f32_16x16x32_bf16 v[44:47], v[232:235], v[68:71], v[44:47]
    s_bitcmp1_b32 s28, 0
    s_cbranch_scc1 L3_a20
    s_add_u32 m0, s100, 61440
    s_sub_u32 s44, s44, s101
    buffer_load_dwordx4 v102, s[84:87], s44 offen offset:2048 sc1 lds
L3_a20:
    v_mfma_f32_16x16x32_bf16 v[48:51], v[228:231], v[72:75], v[48:51]
    v_mfma_f32_16x16x32_bf16 v[52:55], v[232:235], v[72:75], v[52:55]
    s_waitcnt vmcnt(16)
    s_barrier
    s_add_u32 m0, s59, 16384
    s_add_u32 s42, s79, 2433024
    buffer_load_dwordx4 v12, s[16:19], s42 offen offset:0 lds
    ds_read_b128 v[56:59], v109 offset:20480
    ds_read_b128 v[60:63], v109 offset:21504
    ds_read_b128 v[64:67], v109 offset:22528
    ds_read_b128 v[68:71], v109 offset:23552
    ds_read_b128 v[72:75], v109 offset:24576
    ds_read_b64_tr_b16 v[228:229], v107 offset:32768
    ds_read_b64_tr_b16 v[230:231], v107 offset:34816
    ds_read_b64_tr_b16 v[232:233], v108 offset:32768
    ds_read_b64_tr_b16 v[234:235], v108 offset:34816
    s_waitcnt lgkmcnt(9)
    v_mfma_f32_16x16x32_bf16 v[16:19], v[116:119], v[76:79], v[16:19]
    v_mfma_f32_16x16x32_bf16 v[20:23], v[120:123], v[76:79], v[20:23]
    buffer_load_dwordx4 v13, s[16:19], s42 offen offset:1024 lds
    v_mfma_f32_16x16x32_bf16 v[24:27], v[116:119], v[80:83], v[24:27]
    s_add_u32 m0, s45, 0
    v_mfma_f32_16x16x32_bf16 v[28:31], v[120:123], v[80:83], v[28:31]
    s_add_u32 s44, s76, 61440
    v_mfma_f32_16x16x32_bf16 v[32:35], v[116:119], v[84:87], v[32:35]
    v_mfma_f32_16x16x32_bf16 v[36:39], v[120:123], v[84:87], v[36:39]
    buffer_load_dwordx4 v100, s[84:87], s44 offen offset:0 sc1 lds
    v_mfma_f32_16x16x32_bf16 v[40:43], v[116:119], v[88:91], v[40:43]
    buffer_load_dwordx4 v101, s[84:87], s44 offen offset:1024 sc1 lds
    v_mfma_f32_16x16x32_bf16 v[44:47], v[120:123], v[88:91], v[44:47]
    s_bitcmp1_b32 s28, 0
    s_cbranch_scc0 L3_a21
    s_add_u32 m0, s100, 0
    s_sub_u32 s44, s44, s101
    buffer_load_dwordx4 v102, s[84:87], s44 offen offset:2048 sc1 lds
L3_a21:
    v_mfma_f32_16x16x32_bf16 v[48:51], v[116:119], v[92:95], v[48:51]
    v_mfma_f32_16x16x32_bf16 v[52:55], v[120:123], v[92:95], v[52:55]
    s_waitcnt vmcnt(16)
    s_barrier
    s_add_u32 m0, s59, 24576
    s_add_u32 s42, s79, 2506752
    buffer_load_dwordx4 v12, s[16:19], s42 offen offset:0 lds
    ds_read_b128 v[76:79], v109 offset:30720
    ds_read_b128 v[80:83], v109 offset:31744
    ds_read_b128 v[84:87], v109 offset:32768
    ds_read_b128 v[88:91], v109 offset:33792
    ds_read_b128 v[92:95], v109 offset:34816
    ds_read_b64_tr_b16 v[116:117], v107 offset:40960
    ds_read_b64_tr_b16 v[118:119], v107 offset:43008
    ds_read_b64_tr_b16 v[120:121], v108 offset:40960
    ds_read_b64_tr_b16 v[122:123], v108 offset:43008
    s_waitcnt lgkmcnt(9)
    v_mfma_f32_16x16x32_bf16 v[16:19], v[124:127], v[56:59], v[16:19]
    v_mfma_f32_16x16x32_bf16 v[20:23], v[128:131], v[56:59], v[20:23]
    buffer_load_dwordx4 v13, s[16:19], s42 offen offset:1024 lds
    v_mfma_f32_16x16x32_bf16 v[24:27], v[124:127], v[60:63], v[24:27]
    s_add_u32 m0, s45, 10240
    v_mfma_f32_16x16x32_bf16 v[28:31], v[128:131], v[60:63], v[28:31]
    s_add_u32 s44, s76, 63488
    v_mfma_f32_16x16x32_bf16 v[32:35], v[124:127], v[64:67], v[32:35]
    v_mfma_f32_16x16x32_bf16 v[36:39], v[128:131], v[64:67], v[36:39]
    buffer_load_dwordx4 v100, s[84:87], s44 offen offset:0 sc1 lds
    v_mfma_f32_16x16x32_bf16 v[40:43], v[124:127], v[68:71], v[40:43]
    buffer_load_dwordx4 v101, s[84:87], s44 offen offset:1024 sc1 lds
    v_mfma_f32_16x16x32_bf16 v[44:47], v[128:131], v[68:71], v[44:47]
    s_bitcmp1_b32 s28, 0
    s_cbranch_scc1 L3_a22
    s_add_u32 m0, s100, 10240
    s_sub_u32 s44, s44, s101
    buffer_load_dwordx4 v102, s[84:87], s44 offen offset:2048 sc1 lds
L3_a22:
    v_mfma_f32_16x16x32_bf16 v[48:51], v[124:127], v[72:75], v[48:51]
    v_mfma_f32_16x16x32_bf16 v[52:55], v[128:131], v[72:75], v[52:55]
    s_waitcnt vmcnt(16)
    s_barrier
    s_add_u32 m0, s59, 32768
    s_add_u32 s42, s79, 2580480
    buffer_load_dwordx4 v12, s[16:19], s42 offen offset:0 lds
    ds_read_b128 v[56:59], v110 offset:0
    ds_read_b128 v[60:63], v110 offset:1024
    ds_read_b128 v[64:67], v110 offset:2048
    ds_read_b128 v[68:71], v110 offset:3072
    ds_read_b128 v[72:75], v110 offset:4096
    ds_read_b64_tr_b16 v[124:125], v107 offset:0
    ds_read_b64_tr_b16 v[126:127], v107 offset:2048
    ds_read_b64_tr_b16 v[128:129], v108 offset:0
    ds_read_b64_tr_b16 v[130:131], v108 offset:2048
    s_waitcnt lgkmcnt(9)
    v_mfma_f32_16x16x32_bf16 v[16:19], v[132:135], v[76:79], v[16:19]
    v_mfma_f32_16x16x32_bf16 v[20:23], v[136:139], v[76:79], v[20:23]
    buffer_load_dwordx4 v13, s[16:19], s42 offen offset:1024 lds
    v_mfma_f32_16x16x32_bf16 v[24:27], v[132:135], v[80:83], v[24:27]
    s_add_u32 m0, s45, 20480
    v_mfma_f32_16x16x32_bf16 v[28:31], v[136:139], v[80:83], v[28:31]
    s_add_u32 s44, s76, 65536
    v_mfma_f32_16x16x32_bf16 v[32:35], v[132:135], v[84:87], v[32:35]
    v_mfma_f32_16x16x32_bf16 v[36:39], v[136:139], v[84:87], v[36:39]
    buffer_load_dwordx4 v100, s[84:87], s44 offen offset:0 sc1 lds
    v_mfma_f32_16x16x32_bf16 v[40:43], v[132:135], v[88:91], v[40:43]
    buffer_load_dwordx4 v101, s[84:87], s44 offen offset:1024 sc1 lds
    v_mfma_f32_16x16x32_bf16 v[44:47], v[136:139], v[88:91], v[44:47]
    s_bitcmp1_b32 s28, 0
    s_cbranch_scc0 L3_a23
    s_add_u32 m0, s100, 20480
    s_sub_u32 s44, s44, s101
    buffer_load_dwordx4 v102, s[84:87], s44 offen offset:2048 sc1 lds
L3_a23:
    v_mfma_f32_16x16x32_bf16 v[48:51], v[132:135], v[92:95], v[48:51]
    v_mfma_f32_16x16x32_bf16 v[52:55], v[136:139], v[92:95], v[52:55]
    s_waitcnt vmcnt(16)
    s_barrier
    s_add_u32 m0, s59, 40960
    s_add_u32 s42, s77, 0
    buffer_load_dwordx4 v96, s[20:23], s42 offen offset:0 lds
    ds_read_b128 v[76:79], v110 offset:10240
    ds_read_b128 v[80:83], v110 offset:11264
    ds_read_b128 v[84:87], v110 offset:12288
    ds_read_b128 v[88:91], v110 offset:13312
    ds_read_b128 v[92:95], v110 offset:14336
    ds_read_b64_tr_b16 v[132:133], v107 offset:8192
    ds_read_b64_tr_b16 v[134:135], v107 offset:10240
    ds_read_b64_tr_b16 v[136:137], v108 offset:8192
    ds_read_b64_tr_b16 v[138:139], v108 offset:10240
    s_waitcnt lgkmcnt(9)
    v_mfma_f32_16x16x32_bf16 v[16:19], v[140:143], v[56:59], v[16:19]
    v_mfma_f32_16x16x32_bf16 v[20:23], v[144:147], v[56:59], v[20:23]
    buffer_load_dwordx4 v97, s[20:23], s42 offen offset:1024 lds
    v_mfma_f32_16x16x32_bf16 v[24:27], v[140:143], v[60:63], v[24:27]
    s_add_u32 m0, s45, 30720
    v_mfma_f32_16x16x32_bf16 v[28:31], v[144:147], v[60:63], v[28:31]
    s_add_u32 s44, s76, 67584
    v_mfma_f32_16x16x32_bf16 v[32:35], v[140:143], v[64:67], v[32:35]
    v_mfma_f32_16x16x32_bf16 v[36:39], v[144:147], v[64:67], v[36:39]
    buffer_load_dwordx4 v100, s[84:87], s44 offen offset:0 sc1 lds
    v_mfma_f32_16x16x32_bf16 v[40:43], v[140:143], v[68:71], v[40:43]
    buffer_load_dwordx4 v101, s[84:87], s44 offen offset:1024 sc1 lds
    v_mfma_f32_16x16x32_bf16 v[44:47], v[144:147], v[68:71], v[44:47]
    s_bitcmp1_b32 s28, 0
    s_cbranch_scc1 L3_a24
    s_add_u32 m0, s100, 30720
    s_sub_u32 s44, s44, s101
    buffer_load_dwordx4 v102, s[84:87], s44 offen offset:2048 sc1 lds
L3_a24:
    v_mfma_f32_16x16x32_bf16 v[48:51], v[140:143], v[72:75], v[48:51]
    v_mfma_f32_16x16x32_bf16 v[52:55], v[144:147], v[72:75], v[52:55]
    s_waitcnt vmcnt(16)
    s_barrier
    s_add_u32 m0, s59, 0
    s_add_u32 s42, s77, 82944
    buffer_load_dwordx4 v96, s[20:23], s42 offen offset:0 lds
    ds_read_b128 v[56:59], v110 offset:20480
    ds_read_b128 v[60:63], v110 offset:21504
    ds_read_b128 v[64:67], v110 offset:22528
    ds_read_b128 v[68:71], v110 offset:23552
    ds_read_b128 v[72:75], v110 offset:24576
    ds_read_b64_tr_b16 v[140:141], v107 offset:16384
    ds_read_b64_tr_b16 v[142:143], v107 offset:18432
    ds_read_b64_tr_b16 v[144:145], v108 offset:16384
    ds_read_b64_tr_b16 v[146:147], v108 offset:18432
    s_waitcnt lgkmcnt(9)
    v_mfma_f32_16x16x32_bf16 v[16:19], v[148:151], v[76:79], v[16:19]
    v_mfma_f32_16x16x32_bf16 v[20:23], v[152:155], v[76:79], v[20:23]
    buffer_load_dwordx4 v97, s[20:23], s42 offen offset:1024 lds
    v_mfma_f32_16x16x32_bf16 v[24:27], v[148:151], v[80:83], v[24:27]
    s_add_u32 m0, s45, 40960
    v_mfma_f32_16x16x32_bf16 v[28:31], v[152:155], v[80:83], v[28:31]
    s_add_u32 s44, s76, 69632
    v_mfma_f32_16x16x32_bf16 v[32:35], v[148:151], v[84:87], v[32:35]
    v_mfma_f32_16x16x32_bf16 v[36:39], v[152:155], v[84:87], v[36:39]
    buffer_load_dwordx4 v100, s[84:87], s44 offen offset:0 sc1 lds
    v_mfma_f32_16x16x32_bf16 v[40:43], v[148:151], v[88:91], v[40:43]
    buffer_load_dwordx4 v101, s[84:87], s44 offen offset:1024 sc1 lds
    v_mfma_f32_16x16x32_bf16 v[44:47], v[152:155], v[88:91], v[44:47]
    s_bitcmp1_b32 s28, 0
    s_cbranch_scc0 L3_a25
    s_add_u32 m0, s100, 40960
    s_sub_u32 s44, s44, s101
    buffer_load_dwordx4 v102, s[84:87], s44 offen offset:2048 sc1 lds
L3_a25:
    v_mfma_f32_16x16x32_bf16 v[48:51], v[148:151], v[92:95], v[48:51]
    v_mfma_f32_16x16x32_bf16 v[52:55], v[152:155], v[92:95], v[52:55]
    s_waitcnt vmcnt(16)
    s_barrier
    s_add_u32 m0, s59, 8192
    s_add_u32 s42, s77, 165888
    buffer_load_dwordx4 v96, s[20:23], s42 offen offset:0 lds
    ds_read_b128 v[76:79], v109 offset:0
    ds_read_b128 v[80:83], v109 offset:1024
    ds_read_b128 v[84:87], v109 offset:2048
    ds_read_b128 v[88:91], v109 offset:3072
    ds_read_b128 v[92:95], v109 offset:4096
    ds_read_b64_tr_b16 v[148:149], v107 offset:24576
    ds_read_b64_tr_b16 v[150:151], v107 offset:26624
    ds_read_b64_tr_b16 v[152:153], v108 offset:24576
    ds_read_b64_tr_b16 v[154:155], v108 offset:26624
    s_waitcnt lgkmcnt(9)
    v_mfma_f32_16x16x32_bf16 v[16:19], v[156:159], v[56:59], v[16:19]
    v_mfma_f32_16x16x32_bf16 v[20:23], v[160:163], v[56:59], v[20:23]
    buffer_load_dwordx4 v97, s[20:23], s42 offen offset:1024 lds
    v_mfma_f32_16x16x32_bf16 v[24:27], v[156:159], v[60:63], v[24:27]
    s_add_u32 m0, s45, 51200
    v_mfma_f32_16x16x32_bf16 v[28:31], v[160:163], v[60:63], v[28:31]
    s_add_u32 s44, s76, 71680
    v_mfma_f32_16x16x32_bf16 v[32:35], v[156:159], v[64:67], v[32:35]
    v_mfma_f32_16x16x32_bf16 v[36:39], v[160:163], v[64:67], v[36:39]
    buffer_load_dwordx4 v100, s[84:87], s44 offen offset:0 sc1 lds
    v_mfma_f32_16x16x32_bf16 v[40:43], v[156:159], v[68:71], v[40:43]
    buffer_load_dwordx4 v101, s[84:87], s44 offen offset:1024 sc1 lds
    v_mfma_f32_16x16x32_bf16 v[44:47], v[160:163], v[68:71], v[44:47]
    s_bitcmp1_b32 s28, 0
    s_cbranch_scc1 L3_a26
    s_add_u32 m0, s100, 51200
    s_sub_u32 s44, s44, s101
    buffer_load_dwordx4 v102, s[84:87], s44 offen offset:2048 sc1 lds
L3_a26:
    v_mfma_f32_16x16x32_bf16 v[48:51], v[156:159], v[72:75], v[48:51]
    v_mfma_f32_16x16x32_bf16 v[52:55], v[160:163], v[72:75], v[52:55]
    s_waitcnt vmcnt(16)
    s_barrier
    s_add_u32 m0, s59, 16384
    s_add_u32 s42, s77, 248832
    buffer_load_dwordx4 v96, s[20:23], s42 offen offset:0 lds
    ds_read_b128 v[56:59], v109 offset:10240
    ds_read_b128 v[60:63], v109 offset:11264
    ds_read_b128 v[64:67], v109 offset:12288
    ds_read_b128 v[68:71], v109 offset:13312
    ds_read_b128 v[72:75], v109 offset:14336
    ds_read_b64_tr_b16 v[156:157], v107 offset:32768
    ds_read_b64_tr_b16 v[158:159], v107 offset:34816
    ds_read_b64_tr_b16 v[160:161], v108 offset:32768
    ds_read_b64_tr_b16 v[162:163], v108 offset:34816
    s_waitcnt lgkmcnt(9)
    v_mfma_f32_16x16x32_bf16 v[16:19], v[164:167], v[76:79], v[16:19]
    v_mfma_f32_16x16x32_bf16 v[20:23], v[168:171], v[76:79], v[20:23]
    buffer_load_dwordx4 v97, s[20:23], s42 offen offset:1024 lds
    v_mfma_f32_16x16x32_bf16 v[24:27], v[164:167], v[80:83], v[24:27]
    s_add_u32 m0, s45, 61440
    v_mfma_f32_16x16x32_bf16 v[28:31], v[168:171], v[80:83], v[28:31]
    s_add_u32 s44, s76, 73728
    v_mfma_f32_16x16x32_bf16 v[32:35], v[164:167], v[84:87], v[32:35]
    v_mfma_f32_16x16x32_bf16 v[36:39], v[168:171], v[84:87], v[36:39]
    buffer_load_dwordx4 v100, s[84:87], s44 offen offset:0 sc1 lds
    v_mfma_f32_16x16x32_bf16 v[40:43], v[164:167], v[88:91], v[40:43]
    buffer_load_dwordx4 v101, s[84:87], s44 offen offset:1024 sc1 lds
    v_mfma_f32_16x16x32_bf16 v[44:47], v[168:171], v[88:91], v[44:47]
    s_bitcmp1_b32 s28, 0
    s_cbranch_scc0 L3_a27
    s_add_u32 m0, s100, 61440
    s_sub_u32 s44, s44, s101
    buffer_load_dwordx4 v102, s[84:87], s44 offen offset:2048 sc1 lds
L3_a27:
    v_mfma_f32_16x16x32_bf16 v[48:51], v[164:167], v[92:95], v[48:51]
    v_mfma_f32_16x16x32_bf16 v[52:55], v[168:171], v[92:95], v[52:55]
    s_waitcnt vmcnt(16)
    s_barrier
    s_add_u32 m0, s59, 24576
    s_add_u32 s42, s77, 331776
    buffer_load_dwordx4 v96, s[20:23], s42 offen offset:0 lds
    ds_read_b128 v[76:79], v109 offset:20480
    ds_read_b128 v[80:83], v109 offset:21504
    ds_read_b128 v[84:87], v109 offset:22528
    ds_read_b128 v[88:91], v109 offset:23552
    ds_read_b128 v[92:95], v109 offset:24576
    ds_read_b64_tr_b16 v[164:165], v107 offset:40960
    ds_read_b64_tr_b16 v[166:167], v107 offset:43008
    ds_read_b64_tr_b16 v[168:169], v108 offset:40960
    ds_read_b64_tr_b16 v[170:171], v108 offset:43008
    s_waitcnt lgkmcnt(9)
    v_mfma_f32_16x16x32_bf16 v[16:19], v[172:175], v[56:59], v[16:19]
    v_mfma_f32_16x16x32_bf16 v[20:23], v[176:179], v[56:59], v[20:23]
    buffer_load_dwordx4 v97, s[20:23], s42 offen offset:1024 lds
    v_mfma_f32_16x16x32_bf16 v[24:27], v[172:175], v[60:63], v[24:27]
    s_add_u32 m0, s45, 0
    v_mfma_f32_16x16x32_bf16 v[28:31], v[176:179], v[60:63], v[28:31]
    s_add_u32 s44, s76, 75776
    v_mfma_f32_16x16x32_bf16 v[32:35], v[172:175], v[64:67], v[32:35]
    v_mfma_f32_16x16x32_bf16 v[36:39], v[176:179], v[64:67], v[36:39]
    buffer_load_dwordx4 v100, s[84:87], s44 offen offset:0 sc1 lds
    v_mfma_f32_16x16x32_bf16 v[40:43], v[172:175], v[68:71], v[40:43]
    buffer_load_dwordx4 v101, s[84:87], s44 offen offset:1024 sc1 lds
    v_mfma_f32_16x16x32_bf16 v[44:47], v[176:179], v[68:71], v[44:47]
    s_bitcmp1_b32 s28, 0
    s_cbranch_scc1 L3_a28
    s_add_u32 m0, s100, 0
    s_sub_u32 s44, s44, s101
    buffer_load_dwordx4 v102, s[84:87], s44 offen offset:2048 sc1 lds
L3_a28:
    v_mfma_f32_16x16x32_bf16 v[48:51], v[172:175], v[72:75], v[48:51]
    v_mfma_f32_16x16x32_bf16 v[52:55], v[176:179], v[72:75], v[52:55]
    s_waitcnt vmcnt(16)
    s_barrier
    s_add_u32 m0, s59, 32768
    s_add_u32 s42, s77, 414720
    buffer_load_dwordx4 v96, s[20:23], s42 offen offset:0 lds
    ds_read_b128 v[56:59], v109 offset:30720
    ds_read_b128 v[60:63], v109 offset:31744
    ds_read_b128 v[64:67], v109 offset:32768
    ds_read_b128 v[68:71], v109 offset:33792
    ds_read_b128 v[72:75], v109 offset:34816
    ds_read_b64_tr_b16 v[172:173], v107 offset:0
    ds_read_b64_tr_b16 v[174:175], v107 offset:2048
    ds_read_b64_tr_b16 v[176:177], v108 offset:0
    ds_read_b64_tr_b16 v[178:179], v108 offset:2048
    s_waitcnt lgkmcnt(9)
    v_mfma_f32_16x16x32_bf16 v[16:19], v[180:183], v[76:79], v[16:19]
    v_mfma_f32_16x16x32_bf16 v[20:23], v[184:187], v[76:79], v[20:23]
    buffer_load_dwordx4 v97, s[20:23], s42 offen offset:1024 lds
    v_mfma_f32_16x16x32_bf16 v[24:27], v[180:183], v[80:83], v[24:27]
    s_add_u32 m0, s45, 10240
    v_mfma_f32_16x16x32_bf16 v[28:31], v[184:187], v[80:83], v[28:31]
    s_add_u32 s44, s76, 77824
    v_mfma_f32_16x16x32_bf16 v[32:35], v[180:183], v[84:87], v[32:35]
    v_mfma_f32_16x16x32_bf16 v[36:39], v[184:187], v[84:87], v[36:39]
    buffer_load_dwordx4 v100, s[84:87], s44 offen offset:0 sc1 lds
    v_mfma_f32_16x16x32_bf16 v[40:43], v[180:183], v[88:91], v[40:43]
    buffer_load_dwordx4 v101, s[84:87], s44 offen offset:1024 sc1 lds
    v_mfma_f32_16x16x32_bf16 v[44:47], v[184:187], v[88:91], v[44:47]
    s_bitcmp1_b32 s28, 0
    s_cbranch_scc0 L3_a29
    s_add_u32 m0, s100, 10240
    s_sub_u32 s44, s44, s101
    buffer_load_dwordx4 v102, s[84:87], s44 offen offset:2048 sc1 lds
L3_a29:
    v_mfma_f32_16x16x32_bf16 v[48:51], v[180:183], v[92:95], v[48:51]
    v_mfma_f32_16x16x32_bf16 v[52:55], v[184:187], v[92:95], v[52:55]
    s_waitcnt vmcnt(16)
    s_barrier
    s_add_u32 m0, s59, 40960
    s_add_u32 s42, s77, 497664
    buffer_load_dwordx4 v96, s[20:23], s42 offen offset:0 lds
    ds_read_b128 v[76:79], v110 offset:0
    ds_read_b128 v[80:83], v110 offset:1024
    ds_read_b128 v[84:87], v110 offset:2048
    ds_read_b128 v[88:91], v110 offset:3072
    ds_read_b128 v[92:95], v110 offset:4096
    ds_read_b64_tr_b16 v[180:181], v107 offset:8192
    ds_read_b64_tr_b16 v[182:183], v107 offset:10240
    ds_read_b64_tr_b16 v[184:185], v108 offset:8192
    ds_read_b64_tr_b16 v[186:187], v108 offset:10240
    s_waitcnt lgkmcnt(9)
    v_mfma_f32_16x16x32_bf16 v[16:19], v[188:191], v[56:59], v[16:19]
    v_mfma_f32_16x16x32_bf16 v[20:23], v[192:195], v[56:59], v[20:23]
    buffer_load_dwordx4 v97, s[20:23], s42 offen offset:1024 lds
    v_mfma_f32_16x16x32_bf16 v[24:27], v[188:191], v[60:63], v[24:27]
    s_add_u32 m0, s45, 20480
    v_mfma_f32_16x16x32_bf16 v[28:31], v[192:195], v[60:63], v[28:31]
    s_add_u32 s44, s76, 79872
    v_mfma_f32_16x16x32_bf16 v[32:35], v[188:191], v[64:67], v[32:35]
    v_mfma_f32_16x16x32_bf16 v[36:39], v[192:195], v[64:67], v[36:39]
    buffer_load_dwordx4 v100, s[84:87], s44 offen offset:0 sc1 lds
    v_mfma_f32_16x16x32_bf16 v[40:43], v[188:191], v[68:71], v[40:43]
    buffer_load_dwordx4 v101, s[84:87], s44 offen offset:1024 sc1 lds
    v_mfma_f32_16x16x32_bf16 v[44:47], v[192:195], v[68:71], v[44:47]
    s_bitcmp1_b32 s28, 0
    s_cbranch_scc1 L3_a30
    s_add_u32 m0, s100, 20480
    s_sub_u32 s44, s44, s101
    buffer_load_dwordx4 v102, s[84:87], s44 offen offset:2048 sc1 lds
L3_a30:
    v_mfma_f32_16x16x32_bf16 v[48:51], v[188:191], v[72:75], v[48:51]
    v_mfma_f32_16x16x32_bf16 v[52:55], v[192:195], v[72:75], v[52:55]
    s_waitcnt vmcnt(16)
    s_barrier
    s_add_u32 m0, s59, 0
    s_add_u32 s42, s77, 580608
    buffer_load_dwordx4 v96, s[20:23], s42 offen offset:0 lds
    ds_read_b128 v[56:59], v110 offset:10240
    ds_read_b128 v[60:63], v110 offset:11264
    ds_read_b128 v[64:67], v110 offset:12288
    ds_read_b128 v[68:71], v110 offset:13312
    ds_read_b128 v[72:75], v110 offset:14336
    ds_read_b64_tr_b16 v[188:189], v107 offset:16384
    ds_read_b64_tr_b16 v[190:191], v107 offset:18432
    ds_read_b64_tr_b16 v[192:193], v108 offset:16384
    ds_read_b64_tr_b16 v[194:195], v108 offset:18432
    s_waitcnt lgkmcnt(9)
    v_mfma_f32_16x16x32_bf16 v[16:19], v[196:199], v[76:79], v[16:19]
    v_mfma_f32_16x16x32_bf16 v[20:23], v[200:203], v[76:79], v[20:23]
    buffer_load_dwordx4 v97, s[20:23], s42 offen offset:1024 lds
    v_mfma_f32_16x16x32_bf16 v[24:27], v[196:199], v[80:83], v[24:27]
    s_add_u32 m0, s45, 30720
    v_mfma_f32_16x16x32_bf16 v[28:31], v[200:203], v[80:83], v[28:31]
    s_add_u32 s44, s76, 81920
    v_mfma_f32_16x16x32_bf16 v[32:35], v[196:199], v[84:87], v[32:35]
    v_mfma_f32_16x16x32_bf16 v[36:39], v[200:203], v[84:87], v[36:39]
    buffer_load_dwordx4 v100, s[84:87], s44 offen offset:0 sc1 lds
    v_mfma_f32_16x16x32_bf16 v[40:43], v[196:199], v[88:91], v[40:43]
    buffer_load_dwordx4 v101, s[84:87], s44 offen offset:1024 sc1 lds
    v_mfma_f32_16x16x32_bf16 v[44:47], v[200:203], v[88:91], v[44:47]
    s_bitcmp1_b32 s28, 0
    s_cbranch_scc0 L3_a31
    s_add_u32 m0, s100, 30720
    s_sub_u32 s44, s44, s101
    buffer_load_dwordx4 v102, s[84:87], s44 offen offset:2048 sc1 lds
L3_a31:
    v_mfma_f32_16x16x32_bf16 v[48:51], v[196:199], v[92:95], v[48:51]
    v_mfma_f32_16x16x32_bf16 v[52:55], v[200:203], v[92:95], v[52:55]
    s_waitcnt vmcnt(16)
    s_barrier
    s_add_u32 m0, s59, 8192
    s_mov_b32 s42, s78
    buffer_load_dwordx4 v98, s[20:23], s42 offen offset:0 lds
    ds_read_b128 v[76:79], v110 offset:20480
    ds_read_b128 v[80:83], v110 offset:21504
    ds_read_b128 v[84:87], v110 offset:22528
    ds_read_b128 v[88:91], v110 offset:23552
    ds_read_b128 v[92:95], v110 offset:24576
    ds_read_b64_tr_b16 v[196:197], v107 offset:24576
    ds_read_b64_tr_b16 v[198:199], v107 offset:26624
    ds_read_b64_tr_b16 v[200:201], v108 offset:24576
    ds_read_b64_tr_b16 v[202:203], v108 offset:26624
    s_waitcnt lgkmcnt(9)
    v_mfma_f32_16x16x32_bf16 v[16:19], v[204:207], v[56:59], v[16:19]
    v_mfma_f32_16x16x32_bf16 v[20:23], v[208:211], v[56:59], v[20:23]
    buffer_load_dwordx4 v99, s[20:23], s42 offen offset:1024 lds
    v_mfma_f32_16x16x32_bf16 v[24:27], v[204:207], v[60:63], v[24:27]
    s_add_u32 m0, s45, 40960
    v_mfma_f32_16x16x32_bf16 v[28:31], v[208:211], v[60:63], v[28:31]
    s_add_u32 s44, s76, 83968
    v_mfma_f32_16x16x32_bf16 v[32:35], v[204:207], v[64:67], v[32:35]
    v_mfma_f32_16x16x32_bf16 v[36:39], v[208:211], v[64:67], v[36:39]
    buffer_load_dwordx4 v100, s[84:87], s44 offen offset:0 sc1 lds
    v_mfma_f32_16x16x32_bf16 v[40:43], v[204:207], v[68:71], v[40:43]
    buffer_load_dwordx4 v101, s[84:87], s44 offen offset:1024 sc1 lds
    v_mfma_f32_16x16x32_bf16 v[44:47], v[208:211], v[68:71], v[44:47]
    s_bitcmp1_b32 s28, 0
    s_cbranch_scc1 L3_a32
    s_add_u32 m0, s100, 40960
    s_sub_u32 s44, s44, s101
    buffer_load_dwordx4 v102, s[84:87], s44 offen offset:2048 sc1 lds
L3_a32:
    v_mfma_f32_16x16x32_bf16 v[48:51], v[204:207], v[72:75], v[48:51]
    v_mfma_f32_16x16x32_bf16 v[52:55], v[208:211], v[72:75], v[52:55]
    s_waitcnt vmcnt(16)
    s_barrier
    s_add_u32 m0, s45, 51200
    s_add_u32 s44, s76, 86016
    buffer_load_dwordx4 v100, s[84:87], s44 offen offset:0 sc1 lds
    ds_read_b128 v[56:59], v109 offset:0
    ds_read_b128 v[60:63], v109 offset:1024
    ds_read_b128 v[64:67], v109 offset:2048
    ds_read_b128 v[68:71], v109 offset:3072
    ds_read_b128 v[72:75], v109 offset:4096
    ds_read_b64_tr_b16 v[204:205], v107 offset:32768
    ds_read_b64_tr_b16 v[206:207], v107 offset:34816
    ds_read_b64_tr_b16 v[208:209], v108 offset:32768
    ds_read_b64_tr_b16 v[210:211], v108 offset:34816
    s_waitcnt lgkmcnt(9)
    v_mfma_f32_16x16x32_bf16 v[16:19], v[212:215], v[76:79], v[16:19]
    v_mfma_f32_16x16x32_bf16 v[20:23], v[216:219], v[76:79], v[20:23]
    v_mfma_f32_16x16x32_bf16 v[24:27], v[212:215], v[80:83], v[24:27]
    buffer_load_dwordx4 v101, s[84:87], s44 offen offset:1024 sc1 lds
    v_mfma_f32_16x16x32_bf16 v[28:31], v[216:219], v[80:83], v[28:31]
    v_mfma_f32_16x16x32_bf16 v[32:35], v[212:215], v[84:87], v[32:35]
    v_mfma_f32_16x16x32_bf16 v[36:39], v[216:219], v[84:87], v[36:39]
    s_bitcmp1_b32 s28, 0
    s_cbranch_scc0 L3_a33
    s_add_u32 m0, s100, 51200
    s_sub_u32 s44, s44, s101
    buffer_load_dwordx4 v102, s[84:87], s44 offen offset:2048 sc1 lds
L3_a33:
    v_mfma_f32_16x16x32_bf16 v[40:43], v[212:215], v[88:91], v[40:43]
    v_mfma_f32_16x16x32_bf16 v[44:47], v[216:219], v[88:91], v[44:47]
    v_mfma_f32_16x16x32_bf16 v[48:51], v[212:215], v[92:95], v[48:51]
    v_mfma_f32_16x16x32_bf16 v[52:55], v[216:219], v[92:95], v[52:55]
    s_waitcnt vmcnt(14)
    s_barrier
    s_cmp_lg_u32 s46, 0
    s_cbranch_scc1 L3_pi_o0
    buffer_load_dword v14, off, s[8:11], s52 sc1
    buffer_load_dword v15, off, s[8:11], s53 sc1
L3_pi_o0:
    s_add_u32 m0, s45, 61440
    s_add_u32 s44, s76, 88064
    buffer_load_dwordx4 v100, s[84:87], s44 offen offset:0 sc1 lds
    ds_read_b128 v[76:79], v109 offset:10240
    ds_read_b128 v[80:83], v109 offset:11264
    ds_read_b128 v[84:87], v109 offset:12288
    ds_read_b128 v[88:91], v109 offset:13312
    ds_read_b128 v[92:95], v109 offset:14336
    ds_read_b64_tr_b16 v[212:213], v107 offset:40960
    ds_read_b64_tr_b16 v[214:215], v107 offset:43008
    ds_read_b64_tr_b16 v[216:217], v108 offset:40960
    ds_read_b64_tr_b16 v[218:219], v108 offset:43008
    s_waitcnt lgkmcnt(9)
    v_mfma_f32_16x16x32_bf16 v[16:19], v[220:223], v[56:59], v[16:19]
    v_mfma_f32_16x16x32_bf16 v[20:23], v[224:227], v[56:59], v[20:23]
    v_mfma_f32_16x16x32_bf16 v[24:27], v[220:223], v[60:63], v[24:27]
    buffer_load_dwordx4 v101, s[84:87], s44 offen offset:1024 sc1 lds
    v_mfma_f32_16x16x32_bf16 v[28:31], v[224:227], v[60:63], v[28:31]
    v_mfma_f32_16x16x32_bf16 v[32:35], v[220:223], v[64:67], v[32:35]
    v_mfma_f32_16x16x32_bf16 v[36:39], v[224:227], v[64:67], v[36:39]
    s_bitcmp1_b32 s28, 0
    s_cbranch_scc1 L3_a34
    s_add_u32 m0, s100, 61440
    s_sub_u32 s44, s44, s101
    buffer_load_dwordx4 v102, s[84:87], s44 offen offset:2048 sc1 lds
L3_a34:
    v_mfma_f32_16x16x32_bf16 v[40:43], v[220:223], v[68:71], v[40:43]
    v_mfma_f32_16x16x32_bf16 v[44:47], v[224:227], v[68:71], v[44:47]
    v_mfma_f32_16x16x32_bf16 v[48:51], v[220:223], v[72:75], v[48:51]
    v_mfma_f32_16x16x32_bf16 v[52:55], v[224:227], v[72:75], v[52:55]
    s_waitcnt vmcnt(12)
    s_barrier
    s_add_u32 m0, s45, 0
    s_add_u32 s44, s76, 90112
    buffer_load_dwordx4 v100, s[84:87], s44 offen offset:0 sc1 lds
    ds_read_b128 v[56:59], v109 offset:20480
    ds_read_b128 v[60:63], v109 offset:21504
    ds_read_b128 v[64:67], v109 offset:22528
    ds_read_b128 v[68:71], v109 offset:23552
    ds_read_b128 v[72:75], v109 offset:24576
    ds_read_b64_tr_b16 v[220:221], v107 offset:0
    ds_read_b64_tr_b16 v[222:223], v107 offset:2048
    ds_read_b64_tr_b16 v[224:225], v108 offset:0
    ds_read_b64_tr_b16 v[226:227], v108 offset:2048
    s_waitcnt lgkmcnt(9)
    v_mfma_f32_16x16x32_bf16 v[16:19], v[228:231], v[76:79], v[16:19]
    v_mfma_f32_16x16x32_bf16 v[20:23], v[232:235], v[76:79], v[20:23]
    v_mfma_f32_16x16x32_bf16 v[24:27], v[228:231], v[80:83], v[24:27]
    buffer_load_dwordx4 v101, s[84:87], s44 offen offset:1024 sc1 lds
    v_mfma_f32_16x16x32_bf16 v[28:31], v[232:235], v[80:83], v[28:31]
    v_mfma_f32_16x16x32_bf16 v[32:35], v[228:231], v[84:87], v[32:35]
    v_mfma_f32_16x16x32_bf16 v[36:39], v[232:235], v[84:87], v[36:39]
    s_bitcmp1_b32 s28, 0
    s_cbranch_scc0 L3_a35
    s_add_u32 m0, s100, 0
    s_sub_u32 s44, s44, s101
    buffer_load_dwordx4 v102, s[84:87], s44 offen offset:2048 sc1 lds
L3_a35:
    v_mfma_f32_16x16x32_bf16 v[40:43], v[228:231], v[88:91], v[40:43]
    v_mfma_f32_16x16x32_bf16 v[44:47], v[232:235], v[88:91], v[44:47]
    v_mfma_f32_16x16x32_bf16 v[48:51], v[228:231], v[92:95], v[48:51]
    v_mfma_f32_16x16x32_bf16 v[52:55], v[232:235], v[92:95], v[52:55]
    s_cmp_lg_u32 s46, 0
    s_cbranch_scc1 L3_pv_o0
    s_waitcnt vmcnt(4)
    v_min_u32 v4, v14, v15
    s_sub_u32 s47, s47, 1
    s_cselect_b32 s35, 0, 32
    v_mov_b32 v5, 126968
    v_subrev_u32 v4, s35, v4
    ds_write_b32 v5, v4
    s_waitcnt lgkmcnt(0)
L3_pv_o0:
    s_waitcnt vmcnt(10)
    s_barrier
    v_mov_b32 v5, 126968
    ds_read_b32 v4, v5
    s_waitcnt lgkmcnt(0)
    v_readfirstlane_b32 s35, v4
    s_nop 0
    s_cmp_lt_i32 s35, 0
    s_cbranch_scc0 L3_ogo
L3_wait_o:
    s_cmp_lg_u32 s46, 0
    s_cbranch_scc1 L3_pi_o1x
    buffer_load_dword v14, off, s[8:11], s52 sc1
    buffer_load_dword v15, off, s[8:11], s53 sc1
L3_pi_o1x:
    s_cmp_lg_u32 s46, 0
    s_cbranch_scc1 L3_pv_o1x
    s_waitcnt vmcnt(0)
    v_min_u32 v4, v14, v15
    s_sub_u32 s47, s47, 1
    s_cselect_b32 s35, 0, 32
    v_mov_b32 v5, 126972
    v_subrev_u32 v4, s35, v4
    ds_write_b32 v5, v4
    s_waitcnt lgkmcnt(0)
L3_pv_o1x:
    s_waitcnt vmcnt(0)
    s_barrier
    s_cmp_ge_u32 s98, 64
    s_cbranch_scc1 L3_kvo1x
    s_lshl_b32 s99, s97, 12
    s_add_u32 m0, s94, s99
    s_add_u32 s98, s98, 1
    buffer_load_dwordx4 v3, s[8:11], s95 offen lds
    s_add_u32 s95, s95, s96
    s_add_u32 s97, s97, 1
    s_cmp_eq_u32 s97, 9
    s_cselect_b32 s97, 0, s97
    s_lshl_b32 s99, s97, 12
    s_add_u32 m0, s94, s99
    s_add_u32 s98, s98, 1
    buffer_load_dwordx4 v3, s[8:11], s95 offen lds
    s_add_u32 s95, s95, s96
    s_add_u32 s97, s97, 1
    s_cmp_eq_u32 s97, 9
    s_cselect_b32 s97, 0, s97
    s_lshl_b32 s99, s97, 12
    s_add_u32 m0, s94, s99
    s_add_u32 s98, s98, 1
    buffer_load_dwordx4 v3, s[8:11], s95 offen lds
    s_add_u32 s95, s95, s96
    s_add_u32 s97, s97, 1
    s_cmp_eq_u32 s97, 9
    s_cselect_b32 s97, 0, s97
L3_kvo1x:
    v_mov_b32 v5, 126972
    ds_read_b32 v4, v5
    s_waitcnt lgkmcnt(0)
    v_readfirstlane_b32 s35, v4
    s_nop 0
    s_cmp_lt_i32 s35, 0
    s_cbranch_scc0 L3_waited_o
    s_cmp_lg_u32 s46, 0
    s_cbranch_scc1 L3_pi_o0x
    buffer_load_dword v14, off, s[8:11], s52 sc1
    buffer_load_dword v15, off, s[8:11], s53 sc1
L3_pi_o0x:
    s_cmp_lg_u32 s46, 0
    s_cbranch_scc1 L3_pv_o0x
    s_waitcnt vmcnt(0)
    v_min_u32 v4, v14, v15
    s_sub_u32 s47, s47, 1
    s_cselect_b32 s35, 0, 32
    v_mov_b32 v5, 126968
    v_subrev_u32 v4, s35, v4
    ds_write_b32 v5, v4
    s_waitcnt lgkmcnt(0)
L3_pv_o0x:
    s_waitcnt vmcnt(0)
    s_barrier
    s_cmp_ge_u32 s98, 64
    s_cbranch_scc1 L3_kvo0x
    s_lshl_b32 s99, s97, 12
    s_add_u32 m0, s94, s99
    s_add_u32 s98, s98, 1
    buffer_load_dwordx4 v3, s[8:11], s95 offen lds
    s_add_u32 s95, s95, s96
    s_add_u32 s97, s97, 1
    s_cmp_eq_u32 s97, 9
    s_cselect_b32 s97, 0, s97
    s_lshl_b32 s99, s97, 12
    s_add_u32 m0, s94, s99
    s_add_u32 s98, s98, 1
    buffer_load_dwordx4 v3, s[8:11], s95 offen lds
    s_add_u32 s95, s95, s96
    s_add_u32 s97, s97, 1
    s_cmp_eq_u32 s97, 9
    s_cselect_b32 s97, 0, s97
    s_lshl_b32 s99, s97, 12
    s_add_u32 m0, s94, s99
    s_add_u32 s98, s98, 1
    buffer_load_dwordx4 v3, s[8:11], s95 offen lds
    s_add_u32 s95, s95, s96
    s_add_u32 s97, s97, 1
    s_cmp_eq_u32 s97, 9
    s_cselect_b32 s97, 0, s97
L3_kvo0x:
    v_mov_b32 v5, 126968
    ds_read_b32 v4, v5
    s_waitcnt lgkmcnt(0)
    v_readfirstlane_b32 s35, v4
    s_nop 0
    s_cmp_lt_i32 s35, 0
    s_cbranch_scc0 L3_waited_o
    s_branch L3_wait_o
L3_waited_o:
L3_ogo:
    s_add_u32 m0, s45, 10240
    s_add_u32 s44, s76, 0
    buffer_load_dwordx4 v100, s[84:87], s44 offen offset:0 sc1 lds
    ds_read_b128 v[76:79], v109 offset:30720
    ds_read_b128 v[80:83], v109 offset:31744
    ds_read_b128 v[84:87], v109 offset:32768
    ds_read_b128 v[88:91], v109 offset:33792
    ds_read_b128 v[92:95], v109 offset:34816
    ds_read_b64_tr_b16 v[228:229], v107 offset:8192
    ds_read_b64_tr_b16 v[230:231], v107 offset:10240
    ds_read_b64_tr_b16 v[232:233], v108 offset:8192
    ds_read_b64_tr_b16 v[234:235], v108 offset:10240
    v_mfma_f32_16x16x32_bf16 v[16:19], v[116:119], v[56:59], v[16:19]
    v_mfma_f32_16x16x32_bf16 v[20:23], v[120:123], v[56:59], v[20:23]
    v_mfma_f32_16x16x32_bf16 v[24:27], v[116:119], v[60:63], v[24:27]
    buffer_load_dwordx4 v101, s[84:87], s44 offen offset:1024 sc1 lds
    v_mfma_f32_16x16x32_bf16 v[28:31], v[120:123], v[60:63], v[28:31]
    v_mfma_f32_16x16x32_bf16 v[32:35], v[116:119], v[64:67], v[32:35]
    v_mfma_f32_16x16x32_bf16 v[36:39], v[120:123], v[64:67], v[36:39]
    s_bitcmp1_b32 s28, 0
    s_cbranch_scc1 L3_a36
    s_add_u32 m0, s100, 10240
    s_sub_u32 s44, s44, s101
    buffer_load_dwordx4 v102, s[84:87], s44 offen offset:2048 sc1 lds
L3_a36:
    v_mfma_f32_16x16x32_bf16 v[40:43], v[116:119], v[68:71], v[40:43]
    v_mfma_f32_16x16x32_bf16 v[44:47], v[120:123], v[68:71], v[44:47]
    v_mfma_f32_16x16x32_bf16 v[48:51], v[116:119], v[72:75], v[48:51]
    v_mfma_f32_16x16x32_bf16 v[52:55], v[120:123], v[72:75], v[52:55]
    s_waitcnt vmcnt(10)
    s_barrier
    s_add_u32 m0, s45, 20480
    s_add_u32 s44, s76, 2048
    buffer_load_dwordx4 v100, s[84:87], s44 offen offset:0 sc1 lds
    ds_read_b128 v[56:59], v110 offset:0
    ds_read_b128 v[60:63], v110 offset:1024
    ds_read_b128 v[64:67], v110 offset:2048
    ds_read_b128 v[68:71], v110 offset:3072
    ds_read_b128 v[72:75], v110 offset:4096
    s_waitcnt lgkmcnt(5)
    v_mfma_f32_16x16x32_bf16 v[16:19], v[124:127], v[76:79], v[16:19]
    v_mfma_f32_16x16x32_bf16 v[20:23], v[128:131], v[76:79], v[20:23]
    v_mfma_f32_16x16x32_bf16 v[24:27], v[124:127], v[80:83], v[24:27]
    buffer_load_dwordx4 v101, s[84:87], s44 offen offset:1024 sc1 lds
    v_mfma_f32_16x16x32_bf16 v[28:31], v[128:131], v[80:83], v[28:31]
    v_mfma_f32_16x16x32_bf16 v[32:35], v[124:127], v[84:87], v[32:35]
    v_mfma_f32_16x16x32_bf16 v[36:39], v[128:131], v[84:87], v[36:39]
    s_bitcmp1_b32 s28, 0
    s_cbranch_scc0 L3_a37
    s_add_u32 m0, s100, 20480
    s_sub_u32 s44, s44, s101
    buffer_load_dwordx4 v102, s[84:87], s44 offen offset:2048 sc1 lds
L3_a37:
    v_mfma_f32_16x16x32_bf16 v[40:43], v[124:127], v[88:91], v[40:43]
    v_mfma_f32_16x16x32_bf16 v[44:47], v[128:131], v[88:91], v[44:47]
    v_mfma_f32_16x16x32_bf16 v[48:51], v[124:127], v[92:95], v[48:51]
    v_mfma_f32_16x16x32_bf16 v[52:55], v[128:131], v[92:95], v[52:55]
    s_waitcnt vmcnt(10)
    s_barrier
    s_add_u32 m0, s45, 30720
    s_add_u32 s44, s76, 4096
    buffer_load_dwordx4 v100, s[84:87], s44 offen offset:0 sc1 lds
    ds_read_b128 v[76:79], v110 offset:10240
    ds_read_b128 v[80:83], v110 offset:11264
    ds_read_b128 v[84:87], v110 offset:12288
    ds_read_b128 v[88:91], v110 offset:13312
    ds_read_b128 v[92:95], v110 offset:14336
    s_waitcnt lgkmcnt(5)
    v_mfma_f32_16x16x32_bf16 v[16:19], v[132:135], v[56:59], v[16:19]
    v_mfma_f32_16x16x32_bf16 v[20:23], v[136:139], v[56:59], v[20:23]
    v_mfma_f32_16x16x32_bf16 v[24:27], v[132:135], v[60:63], v[24:27]
    buffer_load_dwordx4 v101, s[84:87], s44 offen offset:1024 sc1 lds
    v_mfma_f32_16x16x32_bf16 v[28:31], v[136:139], v[60:63], v[28:31]
    v_mfma_f32_16x16x32_bf16 v[32:35], v[132:135], v[64:67], v[32:35]
    v_mfma_f32_16x16x32_bf16 v[36:39], v[136:139], v[64:67], v[36:39]
    s_bitcmp1_b32 s28, 0
    s_cbranch_scc1 L3_a38
    s_add_u32 m0, s100, 30720
    s_sub_u32 s44, s44, s101
    buffer_load_dwordx4 v102, s[84:87], s44 offen offset:2048 sc1 lds
L3_a38:
    v_mfma_f32_16x16x32_bf16 v[40:43], v[132:135], v[68:71], v[40:43]
    v_mfma_f32_16x16x32_bf16 v[44:47], v[136:139], v[68:71], v[44:47]
    v_mfma_f32_16x16x32_bf16 v[48:51], v[132:135], v[72:75], v[48:51]
    v_mfma_f32_16x16x32_bf16 v[52:55], v[136:139], v[72:75], v[52:55]
    s_waitcnt vmcnt(10)
    s_barrier
    s_add_u32 m0, s45, 40960
    s_add_u32 s44, s76, 6144
    buffer_load_dwordx4 v100, s[84:87], s44 offen offset:0 sc1 lds
    ds_read_b128 v[56:59], v110 offset:20480
    ds_read_b128 v[60:63], v110 offset:21504
    ds_read_b128 v[64:67], v110 offset:22528
    ds_read_b128 v[68:71], v110 offset:23552
    ds_read_b128 v[72:75], v110 offset:24576
    s_waitcnt lgkmcnt(5)
    v_mfma_f32_16x16x32_bf16 v[16:19], v[140:143], v[76:79], v[16:19]
    v_mfma_f32_16x16x32_bf16 v[20:23], v[144:147], v[76:79], v[20:23]
    v_mfma_f32_16x16x32_bf16 v[24:27], v[140:143], v[80:83], v[24:27]
    buffer_load_dwordx4 v101, s[84:87], s44 offen offset:1024 sc1 lds
    v_mfma_f32_16x16x32_bf16 v[28:31], v[144:147], v[80:83], v[28:31]
    v_mfma_f32_16x16x32_bf16 v[32:35], v[140:143], v[84:87], v[32:35]
    v_mfma_f32_16x16x32_bf16 v[36:39], v[144:147], v[84:87], v[36:39]
    s_bitcmp1_b32 s28, 0
    s_cbranch_scc0 L3_a39
    s_add_u32 m0, s100, 40960
    s_sub_u32 s44, s44, s101
    buffer_load_dwordx4 v102, s[84:87], s44 offen offset:2048 sc1 lds
L3_a39:
    v_mfma_f32_16x16x32_bf16 v[40:43], v[140:143], v[88:91], v[40:43]
    v_mfma_f32_16x16x32_bf16 v[44:47], v[144:147], v[88:91], v[44:47]
    v_mfma_f32_16x16x32_bf16 v[48:51], v[140:143], v[92:95], v[48:51]
    v_mfma_f32_16x16x32_bf16 v[52:55], v[144:147], v[92:95], v[52:55]
    s_waitcnt vmcnt(10)
    s_barrier
    s_add_u32 m0, s45, 51200
    s_add_u32 s44, s76, 8192
    buffer_load_dwordx4 v100, s[84:87], s44 offen offset:0 sc1 lds
    ds_read_b128 v[76:79], v109 offset:0
    ds_read_b128 v[80:83], v109 offset:1024
    ds_read_b128 v[84:87], v109 offset:2048
    ds_read_b128 v[88:91], v109 offset:3072
    ds_read_b128 v[92:95], v109 offset:4096
    s_waitcnt lgkmcnt(5)
    v_mfma_f32_16x16x32_bf16 v[16:19], v[148:151], v[56:59], v[16:19]
    v_mfma_f32_16x16x32_bf16 v[20:23], v[152:155], v[56:59], v[20:23]
    v_mfma_f32_16x16x32_bf16 v[24:27], v[148:151], v[60:63], v[24:27]
    buffer_load_dwordx4 v101, s[84:87], s44 offen offset:1024 sc1 lds
    v_mfma_f32_16x16x32_bf16 v[28:31], v[152:155], v[60:63], v[28:31]
    v_mfma_f32_16x16x32_bf16 v[32:35], v[148:151], v[64:67], v[32:35]
    v_mfma_f32_16x16x32_bf16 v[36:39], v[152:155], v[64:67], v[36:39]
    s_bitcmp1_b32 s28, 0
    s_cbranch_scc1 L3_a40
    s_add_u32 m0, s100, 51200
    s_sub_u32 s44, s44, s101
    buffer_load_dwordx4 v102, s[84:87], s44 offen offset:2048 sc1 lds
L3_a40:
    v_mfma_f32_16x16x32_bf16 v[40:43], v[148:151], v[68:71], v[40:43]
    v_mfma_f32_16x16x32_bf16 v[44:47], v[152:155], v[68:71], v[44:47]
    v_mfma_f32_16x16x32_bf16 v[48:51], v[148:151], v[72:75], v[48:51]
    v_mfma_f32_16x16x32_bf16 v[52:55], v[152:155], v[72:75], v[52:55]
    s_waitcnt vmcnt(10)
    s_barrier
    s_add_u32 m0, s45, 61440
    s_add_u32 s44, s76, 10240
    buffer_load_dwordx4 v100, s[84:87], s44 offen offset:0 sc1 lds
    ds_read_b128 v[56:59], v109 offset:10240
    ds_read_b128 v[60:63], v109 offset:11264
    ds_read_b128 v[64:67], v109 offset:12288
    ds_read_b128 v[68:71], v109 offset:13312
    ds_read_b128 v[72:75], v109 offset:14336
    s_waitcnt lgkmcnt(5)
    v_mfma_f32_16x16x32_bf16 v[16:19], v[156:159], v[76:79], v[16:19]
    v_mfma_f32_16x16x32_bf16 v[20:23], v[160:163], v[76:79], v[20:23]
    v_mfma_f32_16x16x32_bf16 v[24:27], v[156:159], v[80:83], v[24:27]
    buffer_load_dwordx4 v101, s[84:87], s44 offen offset:1024 sc1 lds
    v_mfma_f32_16x16x32_bf16 v[28:31], v[160:163], v[80:83], v[28:31]
    v_mfma_f32_16x16x32_bf16 v[32:35], v[156:159], v[84:87], v[32:35]
    v_mfma_f32_16x16x32_bf16 v[36:39], v[160:163], v[84:87], v[36:39]
    s_bitcmp1_b32 s28, 0
    s_cbranch_scc0 L3_a41
    s_add_u32 m0, s100, 61440
    s_sub_u32 s44, s44, s101
    buffer_load_dwordx4 v102, s[84:87], s44 offen offset:2048 sc1 lds
L3_a41:
    v_mfma_f32_16x16x32_bf16 v[40:43], v[156:159], v[88:91], v[40:43]
    v_mfma_f32_16x16x32_bf16 v[44:47], v[160:163], v[88:91], v[44:47]
    v_mfma_f32_16x16x32_bf16 v[48:51], v[156:159], v[92:95], v[48:51]
    v_mfma_f32_16x16x32_bf16 v[52:55], v[160:163], v[92:95], v[52:55]
    s_waitcnt vmcnt(10)
    s_barrier
    s_add_u32 m0, s45, 0
    s_add_u32 s44, s76, 12288
    buffer_load_dwordx4 v100, s[84:87], s44 offen offset:0 sc1 lds
    ds_read_b128 v[76:79], v109 offset:20480
    ds_read_b128 v[80:83], v109 offset:21504
    ds_read_b128 v[84:87], v109 offset:22528
    ds_read_b128 v[88:91], v109 offset:23552
    ds_read_b128 v[92:95], v109 offset:24576
    s_waitcnt lgkmcnt(5)
    v_mfma_f32_16x16x32_bf16 v[16:19], v[164:167], v[56:59], v[16:19]
    v_mfma_f32_16x16x32_bf16 v[20:23], v[168:171], v[56:59], v[20:23]
    v_mfma_f32_16x16x32_bf16 v[24:27], v[164:167], v[60:63], v[24:27]
    buffer_load_dwordx4 v101, s[84:87], s44 offen offset:1024 sc1 lds
    v_mfma_f32_16x16x32_bf16 v[28:31], v[168:171], v[60:63], v[28:31]
    v_mfma_f32_16x16x32_bf16 v[32:35], v[164:167], v[64:67], v[32:35]
    v_mfma_f32_16x16x32_bf16 v[36:39], v[168:171], v[64:67], v[36:39]
    s_bitcmp1_b32 s28, 0
    s_cbranch_scc1 L3_a42
    s_add_u32 m0, s100, 0
    s_sub_u32 s44, s44, s101
    buffer_load_dwordx4 v102, s[84:87], s44 offen offset:2048 sc1 lds
L3_a42:
    v_mfma_f32_16x16x32_bf16 v[40:43], v[164:167], v[68:71], v[40:43]
    v_mfma_f32_16x16x32_bf16 v[44:47], v[168:171], v[68:71], v[44:47]
    v_mfma_f32_16x16x32_bf16 v[48:51], v[164:167], v[72:75], v[48:51]
    v_mfma_f32_16x16x32_bf16 v[52:55], v[168:171], v[72:75], v[52:55]
    s_waitcnt vmcnt(10)
    s_barrier
    s_add_u32 m0, s45, 10240
    s_add_u32 s44, s76, 14336
    buffer_load_dwordx4 v100, s[84:87], s44 offen offset:0 sc1 lds
    ds_read_b128 v[56:59], v109 offset:30720
    ds_read_b128 v[60:63], v109 offset:31744
    ds_read_b128 v[64:67], v109 offset:32768
    ds_read_b128 v[68:71], v109 offset:33792
    ds_read_b128 v[72:75], v109 offset:34816
    s_waitcnt lgkmcnt(5)
    v_mfma_f32_16x16x32_bf16 v[16:19], v[172:175], v[76:79], v[16:19]
    v_mfma_f32_16x16x32_bf16 v[20:23], v[176:179], v[76:79], v[20:23]
    v_mfma_f32_16x16x32_bf16 v[24:27], v[172:175], v[80:83], v[24:27]
    buffer_load_dwordx4 v101, s[84:87], s44 offen offset:1024 sc1 lds
    v_mfma_f32_16x16x32_bf16 v[28:31], v[176:179], v[80:83], v[28:31]
    v_mfma_f32_16x16x32_bf16 v[32:35], v[172:175], v[84:87], v[32:35]
    v_mfma_f32_16x16x32_bf16 v[36:39], v[176:179], v[84:87], v[36:39]
    s_bitcmp1_b32 s28, 0
    s_cbranch_scc0 L3_a43
    s_add_u32 m0, s100, 10240
    s_sub_u32 s44, s44, s101
    buffer_load_dwordx4 v102, s[84:87], s44 offen offset:2048 sc1 lds
L3_a43:
    v_mfma_f32_16x16x32_bf16 v[40:43], v[172:175], v[88:91], v[40:43]
    v_mfma_f32_16x16x32_bf16 v[44:47], v[176:179], v[88:91], v[44:47]
    v_mfma_f32_16x16x32_bf16 v[48:51], v[172:175], v[92:95], v[48:51]
    v_mfma_f32_16x16x32_bf16 v[52:55], v[176:179], v[92:95], v[52:55]
    s_waitcnt vmcnt(10)
    s_barrier
    s_add_u32 m0, s45, 20480
    s_add_u32 s44, s76, 16384
    buffer_load_dwordx4 v100, s[84:87], s44 offen offset:0 sc1 lds
    ds_read_b128 v[76:79], v110 offset:0
    ds_read_b128 v[80:83], v110 offset:1024
    ds_read_b128 v[84:87], v110 offset:2048
    ds_read_b128 v[88:91], v110 offset:3072
    ds_read_b128 v[92:95], v110 offset:4096
    s_waitcnt lgkmcnt(5)
    v_mfma_f32_16x16x32_bf16 v[16:19], v[180:183], v[56:59], v[16:19]
    v_mfma_f32_16x16x32_bf16 v[20:23], v[184:187], v[56:59], v[20:23]
    v_mfma_f32_16x16x32_bf16 v[24:27], v[180:183], v[60:63], v[24:27]
    buffer_load_dwordx4 v101, s[84:87], s44 offen offset:1024 sc1 lds
    v_mfma_f32_16x16x32_bf16 v[28:31], v[184:187], v[60:63], v[28:31]
    v_mfma_f32_16x16x32_bf16 v[32:35], v[180:183], v[64:67], v[32:35]
    v_mfma_f32_16x16x32_bf16 v[36:39], v[184:187], v[64:67], v[36:39]
    s_bitcmp1_b32 s28, 0
    s_cbranch_scc1 L3_a44
    s_add_u32 m0, s100, 20480
    s_sub_u32 s44, s44, s101
    buffer_load_dwordx4 v102, s[84:87], s44 offen offset:2048 sc1 lds
L3_a44:
    v_mfma_f32_16x16x32_bf16 v[40:43], v[180:183], v[68:71], v[40:43]
    v_mfma_f32_16x16x32_bf16 v[44:47], v[184:187], v[68:71], v[44:47]
    v_mfma_f32_16x16x32_bf16 v[48:51], v[180:183], v[72:75], v[48:51]
    v_mfma_f32_16x16x32_bf16 v[52:55], v[184:187], v[72:75], v[52:55]
    s_waitcnt vmcnt(10)
    s_barrier
    ds_read_b128 v[56:59], v110 offset:10240
    ds_read_b128 v[60:63], v110 offset:11264
    ds_read_b128 v[64:67], v110 offset:12288
    ds_read_b128 v[68:71], v110 offset:13312
    ds_read_b128 v[72:75], v110 offset:14336
    s_waitcnt lgkmcnt(5)
    v_mfma_f32_16x16x32_bf16 v[16:19], v[188:191], v[76:79], v[16:19]
    v_mfma_f32_16x16x32_bf16 v[20:23], v[192:195], v[76:79], v[20:23]
    v_mfma_f32_16x16x32_bf16 v[24:27], v[188:191], v[80:83], v[24:27]
    v_mfma_f32_16x16x32_bf16 v[28:31], v[192:195], v[80:83], v[28:31]
    v_mfma_f32_16x16x32_bf16 v[32:35], v[188:191], v[84:87], v[32:35]
    v_mfma_f32_16x16x32_bf16 v[36:39], v[192:195], v[84:87], v[36:39]
    v_mfma_f32_16x16x32_bf16 v[40:43], v[188:191], v[88:91], v[40:43]
    v_mfma_f32_16x16x32_bf16 v[44:47], v[192:195], v[88:91], v[44:47]
    v_mfma_f32_16x16x32_bf16 v[48:51], v[188:191], v[92:95], v[48:51]
    v_mfma_f32_16x16x32_bf16 v[52:55], v[192:195], v[92:95], v[52:55]
    s_waitcnt vmcnt(7)
    s_barrier
    ds_read_b128 v[76:79], v110 offset:20480
    ds_read_b128 v[80:83], v110 offset:21504
    ds_read_b128 v[84:87], v110 offset:22528
    ds_read_b128 v[88:91], v110 offset:23552
    ds_read_b128 v[92:95], v110 offset:24576
    s_waitcnt lgkmcnt(5)
    v_mfma_f32_16x16x32_bf16 v[16:19], v[196:199], v[56:59], v[16:19]
    v_mfma_f32_16x16x32_bf16 v[20:23], v[200:203], v[56:59], v[20:23]
    v_mfma_f32_16x16x32_bf16 v[24:27], v[196:199], v[60:63], v[24:27]
    v_mfma_f32_16x16x32_bf16 v[28:31], v[200:203], v[60:63], v[28:31]
    v_mfma_f32_16x16x32_bf16 v[32:35], v[196:199], v[64:67], v[32:35]
    v_mfma_f32_16x16x32_bf16 v[36:39], v[200:203], v[64:67], v[36:39]
    v_mfma_f32_16x16x32_bf16 v[40:43], v[196:199], v[68:71], v[40:43]
    v_mfma_f32_16x16x32_bf16 v[44:47], v[200:203], v[68:71], v[44:47]
    v_mfma_f32_16x16x32_bf16 v[48:51], v[196:199], v[72:75], v[48:51]
    v_mfma_f32_16x16x32_bf16 v[52:55], v[200:203], v[72:75], v[52:55]
    s_waitcnt vmcnt(5)
    s_barrier
    buffer_load_dwordx4 v[116:119], v111, s[80:83], 0 offen
    buffer_load_dwordx4 v[120:123], v112, s[80:83], 0 offen
    buffer_load_dwordx4 v[124:127], v113, s[80:83], 0 offen
    ds_read_b128 v[56:59], v109 offset:0
    ds_read_b128 v[60:63], v109 offset:1024
    ds_read_b128 v[64:67], v109 offset:2048
    ds_read_b128 v[68:71], v109 offset:3072
    ds_read_b128 v[72:75], v109 offset:4096
    s_waitcnt lgkmcnt(5)
    v_mfma_f32_16x16x32_bf16 v[16:19], v[204:207], v[76:79], v[16:19]
    v_mfma_f32_16x16x32_bf16 v[20:23], v[208:211], v[76:79], v[20:23]
    v_mfma_f32_16x16x32_bf16 v[24:27], v[204:207], v[80:83], v[24:27]
    v_mfma_f32_16x16x32_bf16 v[28:31], v[208:211], v[80:83], v[28:31]
    v_mfma_f32_16x16x32_bf16 v[32:35], v[204:207], v[84:87], v[32:35]
    v_mfma_f32_16x16x32_bf16 v[36:39], v[208:211], v[84:87], v[36:39]
    v_mfma_f32_16x16x32_bf16 v[40:43], v[204:207], v[88:91], v[40:43]
    v_mfma_f32_16x16x32_bf16 v[44:47], v[208:211], v[88:91], v[44:47]
    v_mfma_f32_16x16x32_bf16 v[48:51], v[204:207], v[92:95], v[48:51]
    v_mfma_f32_16x16x32_bf16 v[52:55], v[208:211], v[92:95], v[52:55]
    s_waitcnt vmcnt(5)
    s_barrier
    v_and_b32 v4, 15, v1
    v_mul_u32_u24 v4, 272, v4
    v_lshrrev_b32 v5, 4, v1
    ds_read_b128 v[76:79], v109 offset:10240
    ds_read_b128 v[80:83], v109 offset:11264
    ds_read_b128 v[84:87], v109 offset:12288
    ds_read_b128 v[88:91], v109 offset:13312
    ds_read_b128 v[92:95], v109 offset:14336
    s_waitcnt lgkmcnt(5)
    v_mfma_f32_16x16x32_bf16 v[16:19], v[212:215], v[56:59], v[16:19]
    v_lshl_add_u32 v4, v5, 4, v4
    v_mfma_f32_16x16x32_bf16 v[20:23], v[216:219], v[56:59], v[20:23]
    s_and_b32 s35, s46, 1
    s_lshl_b32 s35, s35, 7
    v_mfma_f32_16x16x32_bf16 v[24:27], v[212:215], v[60:63], v[24:27]
    s_lshr_b32 s36, s46, 1
    s_mul_i32 s36, s36, 57344
    v_mfma_f32_16x16x32_bf16 v[28:31], v[216:219], v[60:63], v[28:31]
    s_add_u32 s35, s35, s36
    s_add_u32 s35, s35, 30720
    v_mfma_f32_16x16x32_bf16 v[32:35], v[212:215], v[64:67], v[32:35]
    v_add_u32 v4, s35, v4
    v_mfma_f32_16x16x32_bf16 v[36:39], v[216:219], v[64:67], v[36:39]
    v_lshrrev_b32 v5, 3, v1
    v_mul_u32_u24 v5, 272, v5
    v_mfma_f32_16x16x32_bf16 v[40:43], v[212:215], v[68:71], v[40:43]
    v_and_b32 v6, 7, v1
    v_lshl_add_u32 v5, v6, 5, v5
    v_mfma_f32_16x16x32_bf16 v[44:47], v[216:219], v[68:71], v[44:47]
    s_mul_i32 s35, s46, 2176
    s_add_u32 s35, s35, 30720
    v_mfma_f32_16x16x32_bf16 v[48:51], v[212:215], v[72:75], v[48:51]
    v_add_u32 v5, s35, v5
    v_add_u32 v6, 57344, v5
    v_mfma_f32_16x16x32_bf16 v[52:55], v[216:219], v[72:75], v[52:55]
    s_waitcnt vmcnt(3)
    s_barrier
    ds_read_b128 v[56:59], v109 offset:20480
    ds_read_b128 v[60:63], v109 offset:21504
    ds_read_b128 v[64:67], v109 offset:22528
    ds_read_b128 v[68:71], v109 offset:23552
    ds_read_b128 v[72:75], v109 offset:24576
    s_waitcnt lgkmcnt(5)
    v_mfma_f32_16x16x32_bf16 v[16:19], v[220:223], v[76:79], v[16:19]
    v_mfma_f32_16x16x32_bf16 v[20:23], v[224:227], v[76:79], v[20:23]
    v_mfma_f32_16x16x32_bf16 v[24:27], v[220:223], v[80:83], v[24:27]
    v_mfma_f32_16x16x32_bf16 v[28:31], v[224:227], v[80:83], v[28:31]
    v_mfma_f32_16x16x32_bf16 v[32:35], v[220:223], v[84:87], v[32:35]
    v_mfma_f32_16x16x32_bf16 v[36:39], v[224:227], v[84:87], v[36:39]
    v_mfma_f32_16x16x32_bf16 v[40:43], v[220:223], v[88:91], v[40:43]
    v_mfma_f32_16x16x32_bf16 v[44:47], v[224:227], v[88:91], v[44:47]
    v_mfma_f32_16x16x32_bf16 v[48:51], v[220:223], v[92:95], v[48:51]
    v_mfma_f32_16x16x32_bf16 v[52:55], v[224:227], v[92:95], v[52:55]
    s_waitcnt lgkmcnt(0)
    v_mfma_f32_16x16x32_bf16 v[16:19], v[228:231], v[56:59], v[16:19]
    v_mfma_f32_16x16x32_bf16 v[20:23], v[232:235], v[56:59], v[20:23]
    v_mfma_f32_16x16x32_bf16 v[24:27], v[228:231], v[60:63], v[24:27]
    v_mfma_f32_16x16x32_bf16 v[28:31], v[232:235], v[60:63], v[28:31]
    v_mfma_f32_16x16x32_bf16 v[32:35], v[228:231], v[64:67], v[32:35]
    v_mfma_f32_16x16x32_bf16 v[36:39], v[232:235], v[64:67], v[36:39]
    v_mfma_f32_16x16x32_bf16 v[40:43], v[228:231], v[68:71], v[40:43]
    v_mfma_f32_16x16x32_bf16 v[44:47], v[232:235], v[68:71], v[44:47]
    v_mfma_f32_16x16x32_bf16 v[48:51], v[228:231], v[72:75], v[48:51]
    v_mfma_f32_16x16x32_bf16 v[52:55], v[232:235], v[72:75], v[52:55]
    s_nop 0
    ds_write_b128 v4, v[16:19] offset:0
    ds_write_b128 v4, v[20:23] offset:64
    ds_write_b128 v4, v[24:27] offset:4352
    ds_write_b128 v4, v[28:31] offset:4416
    ds_write_b128 v4, v[32:35] offset:8704
    ds_write_b128 v4, v[36:39] offset:8768
    ds_write_b128 v4, v[40:43] offset:13056
    ds_write_b128 v4, v[44:47] offset:13120
    ds_write_b128 v4, v[48:51] offset:17408
    ds_write_b128 v4, v[52:55] offset:17472
    s_waitcnt lgkmcnt(0)
    s_barrier
    ds_read_b128 v[128:131], v5 offset:0
    ds_read_b128 v[132:135], v5 offset:16
    ds_read_b128 v[136:139], v6 offset:0
    ds_read_b128 v[140:143], v6 offset:16
    ds_read_b128 v[144:147], v5 offset:8704
    ds_read_b128 v[148:151], v5 offset:8720
    ds_read_b128 v[152:155], v6 offset:8704
    ds_read_b128 v[156:159], v6 offset:8720
    ds_read_b128 v[160:163], v5 offset:17408
    ds_read_b128 v[164:167], v5 offset:17424
    ds_read_b128 v[168:171], v6 offset:17408
    ds_read_b128 v[172:175], v6 offset:17424
    s_waitcnt vmcnt(0)
    v_lshlrev_b32 v16, 16, v116
    v_and_b32 v17, 0xffff0000, v116
    v_lshlrev_b32 v18, 16, v117
    v_and_b32 v19, 0xffff0000, v117
    v_lshlrev_b32 v20, 16, v118
    v_and_b32 v21, 0xffff0000, v118
    v_lshlrev_b32 v22, 16, v119
    v_and_b32 v23, 0xffff0000, v119
    s_waitcnt lgkmcnt(8)
    v_add_f32 v16, v16, v128
    v_add_f32 v17, v17, v129
    v_add_f32 v18, v18, v130
    v_add_f32 v19, v19, v131
    v_add_f32 v20, v20, v132
    v_add_f32 v21, v21, v133
    v_add_f32 v22, v22, v134
    v_add_f32 v23, v23, v135
    v_add_f32 v16, v16, v136
    v_add_f32 v17, v17, v137
    v_add_f32 v18, v18, v138
    v_add_f32 v19, v19, v139
    v_add_f32 v20, v20, v140
    v_add_f32 v21, v21, v141
    v_add_f32 v22, v22, v142
    v_add_f32 v23, v23, v143
    v_cvt_pk_bf16_f32 v116, v16, v17
    v_cvt_pk_bf16_f32 v117, v18, v19
    v_cvt_pk_bf16_f32 v118, v20, v21
    v_cvt_pk_bf16_f32 v119, v22, v23
    buffer_store_dwordx4 v[116:119], v111, s[72:75], 0 offen sc1
    v_lshlrev_b32 v24, 16, v120
    v_and_b32 v25, 0xffff0000, v120
    v_lshlrev_b32 v26, 16, v121
    v_and_b32 v27, 0xffff0000, v121
    v_lshlrev_b32 v28, 16, v122
    v_and_b32 v29, 0xffff0000, v122
    v_lshlrev_b32 v30, 16, v123
    v_and_b32 v31, 0xffff0000, v123
    s_waitcnt lgkmcnt(4)
    v_add_f32 v24, v24, v144
    v_add_f32 v25, v25, v145
    v_add_f32 v26, v26, v146
    v_add_f32 v27, v27, v147
    v_add_f32 v28, v28, v148
    v_add_f32 v29, v29, v149
    v_add_f32 v30, v30, v150
    v_add_f32 v31, v31, v151
    v_add_f32 v24, v24, v152
    v_add_f32 v25, v25, v153
    v_add_f32 v26, v26, v154
    v_add_f32 v27, v27, v155
    v_add_f32 v28, v28, v156
    v_add_f32 v29, v29, v157
    v_add_f32 v30, v30, v158
    v_add_f32 v31, v31, v159
    v_cvt_pk_bf16_f32 v120, v24, v25
    v_cvt_pk_bf16_f32 v121, v26, v27
    v_cvt_pk_bf16_f32 v122, v28, v29
    v_cvt_pk_bf16_f32 v123, v30, v31
    buffer_store_dwordx4 v[120:123], v112, s[72:75], 0 offen sc1
    v_lshlrev_b32 v32, 16, v124
    v_and_b32 v33, 0xffff0000, v124
    v_lshlrev_b32 v34, 16, v125
    v_and_b32 v35, 0xffff0000, v125
    v_lshlrev_b32 v36, 16, v126
    v_and_b32 v37, 0xffff0000, v126
    v_lshlrev_b32 v38, 16, v127
    v_and_b32 v39, 0xffff0000, v127
    s_waitcnt lgkmcnt(0)
    v_add_f32 v32, v32, v160
    v_add_f32 v33, v33, v161
    v_add_f32 v34, v34, v162
    v_add_f32 v35, v35, v163
    v_add_f32 v36, v36, v164
    v_add_f32 v37, v37, v165
    v_add_f32 v38, v38, v166
    v_add_f32 v39, v39, v167
    v_add_f32 v32, v32, v168
    v_add_f32 v33, v33, v169
    v_add_f32 v34, v34, v170
    v_add_f32 v35, v35, v171
    v_add_f32 v36, v36, v172
    v_add_f32 v37, v37, v173
    v_add_f32 v38, v38, v174
    v_add_f32 v39, v39, v175
    v_cvt_pk_bf16_f32 v124, v32, v33
    v_cvt_pk_bf16_f32 v125, v34, v35
    v_cvt_pk_bf16_f32 v126, v36, v37
    v_cvt_pk_bf16_f32 v127, v38, v39
    buffer_store_dwordx4 v[124:127], v113, s[72:75], 0 offen sc1
L2_end:
    s_endpgm
Lcode_end:
.section .rodata,"a"
.p2align 6
.amdhsa_kernel k1_kernel
  .amdhsa_next_free_vgpr 384
  .amdhsa_next_free_sgpr 102
  .amdhsa_accum_offset 256
  .amdhsa_group_segment_fixed_size 0
  .amdhsa_kernarg_size 88
  .amdhsa_user_sgpr_count 2
  .amdhsa_user_sgpr_kernarg_segment_ptr 1
  .amdhsa_system_sgpr_workgroup_id_x 1
.end_amdhsa_kernel
.p2align 6
.amdhsa_kernel k2_kernel
  .amdhsa_next_free_vgpr 256
  .amdhsa_next_free_sgpr 102
  .amdhsa_accum_offset 256
  .amdhsa_group_segment_fixed_size 0
  .amdhsa_kernarg_size 88
  .amdhsa_user_sgpr_count 2
  .amdhsa_user_sgpr_kernarg_segment_ptr 1
  .amdhsa_system_sgpr_workgroup_id_x 1
.end_amdhsa_kernel
```
